```python
import torch

def _softmax(x, axis=-1):
    return torch.softmax(x, dim=axis)
def _gelu(x):
    return torch.nn.functional.gelu(x, approximate="tanh")
def _silu(x):
    return torch.nn.functional.silu(x)
def _sigmoid(x):
    return torch.sigmoid(x)
def _layernorm(x, axis=-1, eps=1e-5):
    m = x.mean(dim=axis, keepdim=True)
    v = x.var(dim=axis, keepdim=True, unbiased=False)
    return (x - m) / torch.sqrt(v + eps)
def _scatter_add(tgt, idx, src, axis=0):
    return tgt.clone().index_add_(axis, idx, src)
def _segment_sum(src, seg, n):
    out = torch.zeros((n,) + src.shape[1:], dtype=src.dtype)
    return out.index_add_(0, seg, src)
def _pad(x, pw):
    flat = tuple(v for pair in reversed(pw) for v in pair)
    return torch.nn.functional.pad(x, flat)

kernel_name = 'concat_heads__mha_block_cached__gqa_block_cached__near_ridge'

def setup_inputs():

    _w = (lambda a: (lambda t: t.to(torch.bfloat16) if t.is_floating_point() else t)(torch.as_tensor(a)))
    def _A_setup():
        B, Sq, D = 8, 288, 576
        H, Sk, Dh = 32, 1024, 128
        return {
            "x": _w((lambda *s: torch.randn(*s, dtype=torch.bfloat16) * 0.8)(B, Sq, D)),
            "k_cache": _w((lambda *s: torch.randn(*s, dtype=torch.bfloat16) * 0.8)(B, H, Sk, Dh)),
            "v_cache": _w((lambda *s: torch.randn(*s, dtype=torch.bfloat16) * 0.05)(B, H, Sk, Dh)),
            "wq": _w((lambda *s: torch.randn(*s, dtype=torch.bfloat16) * 0.8)(D, H * Dh) * (D ** -0.5)),
            "wo": _w((lambda *s: torch.randn(*s, dtype=torch.bfloat16) * 0.05)(H * Dh, D) * ((H * Dh) ** -0.5)),
        }
    _A_in = _A_setup()

    def _B_setup():
        B, Sq, D = 8, 288, 576
        Hq, Hkv, Sk, Dh = 32, 32, 1024, 128
        assert Hq % Hkv == 0, (Hq, Hkv)
        return {
            "x": _w((lambda *s: torch.randn(*s, dtype=torch.bfloat16) * 0.8)(B, Sq, D)),
            "k_cache": _w((lambda *s: torch.randn(*s, dtype=torch.bfloat16) * 0.8)(B, Hkv, Sk, Dh)),
            "v_cache": _w((lambda *s: torch.randn(*s, dtype=torch.bfloat16) * 0.05)(B, Hkv, Sk, Dh)),
            "wq": _w((lambda *s: torch.randn(*s, dtype=torch.bfloat16) * 0.8)(D, Hq * Dh) * (D ** -0.5)),
            "wo": _w((lambda *s: torch.randn(*s, dtype=torch.bfloat16) * 0.05)(Hq * Dh, D) * ((Hq * Dh) ** -0.5)),
        }
    _B_in = _B_setup()

    return {
        "A_x": _A_in["x"],
        "A_k_cache": _A_in["k_cache"],
        "A_v_cache": _A_in["v_cache"],
        "A_wq": _A_in["wq"],
        "A_wo": _A_in["wo"],
        "B_x": _B_in["x"],
        "B_k_cache": _B_in["k_cache"],
        "B_v_cache": _B_in["v_cache"],
        "B_wq": _B_in["wq"],
        "B_wo": _B_in["wo"],
    }

def reference(A_x, A_k_cache, A_v_cache, A_wq, A_wo, B_x, B_k_cache, B_v_cache, B_wq, B_wo):
    def _A_ref(x, k_cache, v_cache, wq, wo):
        B, Sq, D = x.shape
        H, Dh = 32, 128
        q = (lambda x, *d: x.permute(*d))((x @ wq).reshape(B, Sq, H, Dh), 0, 2, 1, 3)
        scores = torch.einsum("bhqd,bhkd->bhqk", q, k_cache) * (Dh ** -0.5)
        p = _softmax(scores, axis=-1)
        o = torch.einsum("bhqk,bhkd->bhqd", p, v_cache)
        return (lambda x, *d: x.permute(*d))(o, 0, 2, 1, 3).reshape(B, Sq, H * Dh) @ wo

    def _B_ref(x, k_cache, v_cache, wq, wo):
        B, Sq, D = x.shape
        Hq, Dh = 32, 128
        Hkv = k_cache.shape[1]
        rep = Hq // Hkv
        q = (lambda x, *d: x.permute(*d))((x @ wq).reshape(B, Sq, Hq, Dh), 0, 2, 1, 3)
        k = (lambda x, n, axis: torch.repeat_interleave(x, n, dim=axis))(k_cache, rep, axis=1)
        v = (lambda x, n, axis: torch.repeat_interleave(x, n, dim=axis))(v_cache, rep, axis=1)
        scores = torch.einsum("bhqd,bhkd->bhqk", q, k) * (Dh ** -0.5)
        p = _softmax(scores, axis=-1)
        o = torch.einsum("bhqk,bhkd->bhqd", p, v)
        return (lambda x, *d: x.permute(*d))(o, 0, 2, 1, 3).reshape(B, Sq, Hq * Dh) @ wo

    a = _A_ref(A_x, A_k_cache, A_v_cache, A_wq, A_wo)
    b = _B_ref(B_x, B_k_cache, B_v_cache, B_wq, B_wo)
    return torch.concatenate([a, b], axis=-1)
```

```asm
; @launch grid=(256,1,1) block=(256,1,1) lds=155904
.amdgcn_target "amdgcn-amd-amdhsa--gfx950"
.text
.globl concat_heads__mha_block_cached__gqa_block_cached__near_ridge_kernel
.p2align 8
.type concat_heads__mha_block_cached__gqa_block_cached__near_ridge_kernel,@function
concat_heads__mha_block_cached__gqa_block_cached__near_ridge_kernel:
s_cmp_ge_u32 s2, 256
s_cbranch_scc1 L_attn_end
s_mov_b32 s76, 0
L_start:
s_load_dwordx16 s[4:19], s[0:1], 0
s_load_dwordx4 s[20:23], s[0:1], 64
s_load_dwordx2 s[24:25], s[0:1], 96
s_load_dwordx2 s[78:79], s[0:1], 80
s_load_dwordx2 s[80:81], s[0:1], 88
v_lshrrev_b32 v1, 6, v0
v_and_b32 v0, 63, v0
v_readfirstlane_b32 s48, v1
v_lshrrev_b32 v1, 4, v0
v_bfe_u32 v2, v0, 2, 2
v_and_b32 v3, 3, v0
v_lshlrev_b32 v249, 4, v0
s_and_b32 s49, s48, 1
s_and_b32 s26, s2, 7
s_lshr_b32 s3, s2, 3
s_and_b32 s27, s26, 2
s_lshl_b32 s27, s27, 1
s_lshr_b32 s50, s3, 3
s_add_u32 s27, s27, s50
s_and_b32 s3, s3, 7
s_and_b32 s50, s26, 1
s_lshl_b32 s50, s50, 3
s_add_u32 s3, s3, s50
s_lshr_b32 s26, s26, 2
s_add_u32 s50, s27, s3
s_and_b32 s50, s50, 3
s_mov_b32 s62, 0x86534210
s_mov_b32 s72, 7
s_cmp_eq_u32 s50, 1
s_cselect_b32 s62, 0x76453201, s62
s_cselect_b32 s72, 8, s72
s_cmp_eq_u32 s50, 2
s_cselect_b32 s62, 0x75643120, s62
s_cselect_b32 s72, 8, s72
s_cmp_eq_u32 s50, 3
s_cselect_b32 s62, 0x67542310, s62
s_cselect_b32 s72, 8, s72
v_lshlrev_b32 v4, 6, v1
v_lshl_add_u32 v4, v3, 4, v4
v_lshl_add_u32 v248, v2, 8, v4
v_lshl_add_u32 v253, v2, 13, v4
v_and_b32 v5, 1, v1
v_lshl_add_u32 v5, v5, 3, v2
v_mul_u32_u24 v5, 1152, v5
v_lshrrev_b32 v6, 1, v1
v_lshl_add_u32 v5, v6, 6, v5
v_lshl_add_u32 v254, v3, 4, v5
s_mul_i32 s51, s48, 73728
s_lshr_b32 s50, s48, 1
s_mul_i32 s52, s50, 18432
s_add_u32 s52, s52, 294912
s_add_u32 s66, s50, 16
s_lshl_b32 s66, s66, 11
s_lshl_b32 s53, s48, 17
s_mul_i32 s54, s48, 21120
s_add_u32 s54, s54, 67584
s_mul_i32 s55, s48, 4224
s_waitcnt lgkmcnt(0)
s_cmp_eq_u32 s26, 0
s_cselect_b64 s[4:5], s[4:5], s[14:15]
s_cselect_b64 s[6:7], s[6:7], s[16:17]
s_cselect_b64 s[8:9], s[8:9], s[18:19]
s_cselect_b64 s[10:11], s[10:11], s[20:21]
s_cselect_b64 s[12:13], s[12:13], s[22:23]
s_mul_i32 s50, s27, 331776
s_add_u32 s28, s4, s50
s_addc_u32 s29, s5, 0
s_and_b32 s29, s29, 0xffff
s_mov_b32 s30, 331776
s_mov_b32 s31, 0x20000
s_lshl_b32 s50, s3, 9
s_add_u32 s32, s10, s50
s_addc_u32 s33, s11, 0
s_and_b32 s33, s33, 0xffff
s_sub_u32 s34, 4718592, s50
s_mov_b32 s35, 0x20000
s_bfe_u32 s17, s62, 0x40000
s_lshl_b32 s17, s17, 7
s_add_u32 s73, s51, s17
s_add_u32 s14, s52, s17
s_add_u32 m0, s54, 0
s_add_u32 s50, s73, 0
s_nop 0
buffer_load_dwordx4 v254, s[28:31], s50 offen offset:0 lds
s_add_u32 s50, s73, 3552
buffer_load_dwordx4 v254, s[28:31], s50 offen offset:1056 lds
s_add_u32 s50, s73, 16320
buffer_load_dwordx4 v254, s[28:31], s50 offen offset:2112 lds
s_add_u32 s50, s73, 19872
buffer_load_dwordx4 v254, s[28:31], s50 offen offset:3168 lds
s_add_u32 m0, s54, 4224
s_add_u32 s50, s73, 36864
buffer_load_dwordx4 v254, s[28:31], s50 offen offset:0 lds
s_add_u32 s50, s73, 40416
buffer_load_dwordx4 v254, s[28:31], s50 offen offset:1056 lds
s_lshl_b32 s15, s27, 4
s_add_u32 s15, s15, s3
s_lshl_b32 s15, s15, 2
s_add_u32 s15, s15, s48
s_lshl_b32 s50, s27, 4
s_add_u32 s50, s50, s3
s_lshl_b32 s50, s50, 19
s_add_u32 s36, s6, s50
s_addc_u32 s37, s7, 0
s_and_b32 s37, s37, 0xffff
s_mov_b32 s38, 524288
s_mov_b32 s39, 0x20000
s_add_u32 s40, s8, s50
s_addc_u32 s41, s9, 0
s_and_b32 s41, s41, 0xffff
s_mov_b32 s42, 524288
s_mov_b32 s43, 0x20000
s_mul_i32 s50, s26, 18874368
s_mul_i32 s77, s27, 36864
s_add_u32 s50, s50, s77
s_mul_i32 s77, s3, 1179648
s_add_u32 s50, s50, s77
s_add_u32 s44, s24, s50
s_addc_u32 s45, s25, 0
s_and_b32 s45, s45, 0xffff
s_sub_u32 s46, 37748736, s50
s_mov_b32 s47, 0x20000
s_lshl_b32 s20, s49, 8
s_sub_u32 s21, 256, s20
s_mul_i32 s22, s49, 8448
s_sub_u32 s23, 8448, s22
v_mul_u32_u24 v4, 1056, v2
v_lshl_add_u32 v4, v3, 6, v4
v_lshl_add_u32 v4, v1, 4, v4
v_mul_u32_u24 v5, 1056, v1
v_lshl_add_u32 v5, v2, 6, v5
v_lshl_add_u32 v5, v3, 3, v5
v_add_u32 v5, 67584, v5
s_add_u32 s50, s20, s22
v_add_u32 v240, s50, v4
s_add_u32 s50, s21, s22
v_add_u32 v241, s50, v4
s_add_u32 s50, s20, s23
v_add_u32 v242, s50, v4
s_add_u32 s50, s21, s23
v_add_u32 v243, s50, v4
s_add_u32 s50, s20, s22
v_add_u32 v244, s50, v5
s_add_u32 s50, s21, s22
v_add_u32 v245, s50, v5
s_add_u32 s50, s20, s23
v_add_u32 v246, s50, v5
s_add_u32 s50, s21, s23
v_add_u32 v247, s50, v5
v_mul_u32_u24 v6, 2112, v1
v_and_b32 v7, 1, v1
v_lshl_add_u32 v6, v7, 3, v6
v_lshl_add_u32 v6, v2, 6, v6
v_lshl_add_u32 v6, v3, 4, v6
v_add_u32 v250, s20, v6
v_add_u32 v251, s21, v6
v_and_b32 v7, 1, v2
v_mul_u32_u24 v7, 1056, v7
v_lshrrev_b32 v8, 1, v2
v_lshl_add_u32 v7, v8, 8, v7
v_lshl_add_u32 v7, v3, 6, v7
v_lshl_add_u32 v7, v1, 4, v7
v_add_u32 v252, s54, v7
s_lshl_b32 s18, s48, 12
s_nop 0
s_xor_b32 s19, s18, 4096
s_add_u32 s18, s18, 135168
s_add_u32 s19, s19, 135168
s_mul_i32 s67, s48, 4224
s_add_u32 s68, s67, 67584
s_add_u32 s69, s67, 67584
s_add_u32 s70, s68, 67584
s_lshl_b32 s56, s48, 12
s_mov_b32 s57, s56
s_mov_b32 s58, s67
s_mov_b32 s59, s68
s_mov_b32 s60, 33792
s_mov_b32 s61, 33792
s_lshl_b32 s50, s48, 13
s_lshl_b32 s77, s49, 10
s_add_u32 s64, s50, s77
s_add_u32 s66, s66, s77
s_sub_u32 s77, 1024, s77
s_add_u32 s65, s50, s77
s_mov_b32 s71, 0x3e0293ee
s_mov_b32 s63, 0
s_mov_b32 s74, 0x21800000
s_mov_b32 s75, 0x5d800000
v_mov_b32 v255, s71
s_add_u32 s50, s73, 53184
buffer_load_dwordx4 v254, s[28:31], s50 offen offset:2112 lds
s_add_u32 s50, s73, 56736
buffer_load_dwordx4 v254, s[28:31], s50 offen offset:3168 lds
s_add_u32 m0, s54, 8448
s_add_u32 s50, s14, 0
buffer_load_dwordx4 v254, s[28:31], s50 offen offset:0 lds
s_add_u32 s50, s14, 3552
buffer_load_dwordx4 v254, s[28:31], s50 offen offset:1056 lds
s_bfe_u32 s17, s62, 0x40000
s_lshl_b32 s17, s17, 19
s_add_u32 s16, s53, s17
s_add_u32 m0, s55, 33792
s_add_u32 s50, s16, 0
s_nop 0
buffer_load_dwordx4 v253, s[32:35], s50 offen offset:0 lds
s_add_u32 s50, s16, 31712
buffer_load_dwordx4 v253, s[32:35], s50 offen offset:1056 lds
s_add_u32 s50, s16, 63416
buffer_load_dwordx4 v253, s[32:35], s50 offen offset:2120 lds
s_add_u32 s50, s16, 95128
buffer_load_dwordx4 v253, s[32:35], s50 offen offset:3176 lds
s_getpc_b64 s[20:21]
L_pc:
s_and_b32 s21, s21, 0xffff
s_mov_b32 s22, L_hot_end-L_pc
s_mov_b32 s23, 0x20000
s_lshr_b32 s50, s2, 3
s_lshl_b32 s50, s50, 2
s_add_u32 s50, s50, s48
s_mul_i32 s100, s50, 384
s_mul_i32 s50, s50, 640
v_lshlrev_b32 v9, 3, v249
s_add_u32 s100, s100, L_h_tail-L_pc
s_mov_b64 exec, 31
buffer_load_dword a255, v9, s[20:23], s50 offen
s_mov_b64 exec, -1
s_nop 0
s_add_u32 m0, s55, 50688
s_add_u32 s50, s16, 256
buffer_load_dwordx4 v253, s[32:35], s50 offen offset:0 lds
s_add_u32 s50, s16, 31968
buffer_load_dwordx4 v253, s[32:35], s50 offen offset:1056 lds
s_add_u32 s50, s16, 63672
buffer_load_dwordx4 v253, s[32:35], s50 offen offset:2120 lds
s_add_u32 s50, s16, 95384
buffer_load_dwordx4 v253, s[32:35], s50 offen offset:3176 lds
s_bfe_u32 s17, s62, 0x40004
s_lshl_b32 s17, s17, 7
s_add_u32 s73, s51, s17
s_add_u32 s14, s52, s17
s_add_u32 m0, s54, 10560
s_add_u32 s50, s73, 0
buffer_load_dwordx4 v254, s[28:31], s50 offen offset:0 lds
s_add_u32 s50, s73, 3552
buffer_load_dwordx4 v254, s[28:31], s50 offen offset:1056 lds
s_add_u32 s8, s24, 41943040
s_addc_u32 s9, s25, 0
s_and_b32 s9, s9, 0xffff
s_mov_b32 s10, 8554496
s_mov_b32 s11, 0x20000
s_lshl_b32 s50, s2, 9
s_add_u32 s50, s50, 8388608
v_lshl_add_u32 v10, v0, 7, s50
s_lshl_b32 s50, s26, 3
s_add_u32 s50, s50, s27
s_lshl_b32 s7, s50, 2
s_lshl_b32 s50, s50, 5
s_add_u32 s50, s50, s3
s_lshl_b32 s50, s50, 2
s_add_u32 s50, s50, 8519680
v_writelane_b32 v10, s50, 4
v_mov_b32 v11, 0
s_lshl_b32 s50, s2, 7
s_add_u32 s50, s50, 8521600
v_lshl_add_u32 v12, v0, 2, s50
v_cmp_lt_u32 vcc, 31, v0
v_lshrrev_b32 v13, 3, v0
s_nop 0
v_cndmask_b32 v10, v10, v12, vcc
v_cmp_eq_u32 vcc, 5, v13
v_mov_b32 v12, 3
s_nop 0
v_cndmask_b32 v11, v11, v12, vcc
s_or_b32 s50, s48, s76
s_cmp_eq_u32 s50, 0
s_cselect_b32 s50, 0, 1073741824
s_cselect_b32 s7, s7, 1073741824
s_mov_b32 exec_lo, 31
buffer_store_dword v11, v10, s[8:11], s50 offen sc1
s_mov_b64 exec, -1
s_waitcnt vmcnt(12)
s_nop 0
ds_read_b128 a[80:83], v252 offset:0
ds_read_b128 a[84:87], v252 offset:512
ds_read_b128 a[88:91], v252 offset:2112
ds_read_b128 a[92:95], v252 offset:2624
ds_read_b128 a[96:99], v252 offset:4224
ds_read_b128 a[100:103], v252 offset:4736
ds_read_b128 a[104:107], v252 offset:6336
ds_read_b128 a[108:111], v252 offset:6848
ds_read_b128 a[112:115], v252 offset:8448
ds_read_b128 a[116:119], v252 offset:8960
s_waitcnt vmcnt(8)
s_barrier
ds_read_b64_tr_b16 a[120:121], v250 offset:33792
ds_read_b64_tr_b16 a[122:123], v250 offset:34848
ds_read_b64_tr_b16 a[124:125], v250 offset:42240
ds_read_b64_tr_b16 a[126:127], v250 offset:43296
ds_read_b64_tr_b16 a[128:129], v250 offset:33800
ds_read_b64_tr_b16 a[130:131], v250 offset:34856
ds_read_b64_tr_b16 a[132:133], v250 offset:42248
ds_read_b64_tr_b16 a[134:135], v250 offset:43304
s_waitcnt lgkmcnt(6)
v_mfma_f32_16x16x32_bf16 v[0:3], a[120:123], a[80:83], 0
s_waitcnt lgkmcnt(4)
s_add_u32 s50, s73, 16320
ds_read_b64_tr_b16 a[136:137], v251 offset:33792
v_mfma_f32_16x16x32_bf16 v[0:3], a[124:127], a[84:87], v[0:3]
ds_read_b64_tr_b16 a[138:139], v251 offset:34848
buffer_load_dwordx4 v254, s[28:31], s50 offen offset:2112 lds
v_mfma_f32_16x16x32_bf16 v[8:11], a[120:123], a[88:91], 0
ds_read_b64_tr_b16 a[140:141], v251 offset:42240
v_mfma_f32_16x16x32_bf16 v[8:11], a[124:127], a[92:95], v[8:11]
ds_read_b64_tr_b16 a[142:143], v251 offset:43296
v_mfma_f32_16x16x32_bf16 v[16:19], a[120:123], a[96:99], 0
v_mfma_f32_16x16x32_bf16 v[16:19], a[124:127], a[100:103], v[16:19]
s_add_u32 s50, s73, 19872
v_mfma_f32_16x16x32_bf16 v[24:27], a[120:123], a[104:107], 0
buffer_load_dwordx4 v254, s[28:31], s50 offen offset:3168 lds
v_mfma_f32_16x16x32_bf16 v[24:27], a[124:127], a[108:111], v[24:27]
v_mfma_f32_16x16x32_bf16 v[208:211], a[120:123], a[112:115], 0
v_mfma_f32_16x16x32_bf16 v[208:211], a[124:127], a[116:119], v[208:211]
s_waitcnt lgkmcnt(4)
ds_read_b64_tr_b16 a[120:121], v251 offset:33800
v_mfma_f32_16x16x32_bf16 v[4:7], a[128:131], a[80:83], 0
s_add_u32 m0, s54, 14784
ds_read_b64_tr_b16 a[122:123], v251 offset:34856
v_mfma_f32_16x16x32_bf16 v[4:7], a[132:135], a[84:87], v[4:7]
s_add_u32 s50, s73, 36864
ds_read_b64_tr_b16 a[124:125], v251 offset:42248
v_mfma_f32_16x16x32_bf16 v[12:15], a[128:131], a[88:91], 0
ds_read_b64_tr_b16 a[126:127], v251 offset:43304
buffer_load_dwordx4 v254, s[28:31], s50 offen offset:0 lds
v_mfma_f32_16x16x32_bf16 v[12:15], a[132:135], a[92:95], v[12:15]
v_mfma_f32_16x16x32_bf16 v[20:23], a[128:131], a[96:99], 0
v_mfma_f32_16x16x32_bf16 v[20:23], a[132:135], a[100:103], v[20:23]
v_mfma_f32_16x16x32_bf16 v[28:31], a[128:131], a[104:107], 0
s_add_u32 s50, s73, 40416
v_mfma_f32_16x16x32_bf16 v[28:31], a[132:135], a[108:111], v[28:31]
buffer_load_dwordx4 v254, s[28:31], s50 offen offset:1056 lds
v_mfma_f32_16x16x32_bf16 v[212:215], a[128:131], a[112:115], 0
v_mfma_f32_16x16x32_bf16 v[212:215], a[132:135], a[116:119], v[212:215]
s_waitcnt lgkmcnt(4)
ds_read_b64_tr_b16 a[128:129], v250 offset:34304
v_mfma_f32_16x16x32_bf16 v[32:35], a[136:139], a[80:83], 0
ds_read_b64_tr_b16 a[130:131], v250 offset:35360
v_mfma_f32_16x16x32_bf16 v[32:35], a[140:143], a[84:87], v[32:35]
s_add_u32 s50, s73, 53184
ds_read_b64_tr_b16 a[132:133], v250 offset:42752
v_mfma_f32_16x16x32_bf16 v[40:43], a[136:139], a[88:91], 0
ds_read_b64_tr_b16 a[134:135], v250 offset:43808
buffer_load_dwordx4 v254, s[28:31], s50 offen offset:2112 lds
v_mfma_f32_16x16x32_bf16 v[40:43], a[140:143], a[92:95], v[40:43]
v_mfma_f32_16x16x32_bf16 v[48:51], a[136:139], a[96:99], 0
v_mfma_f32_16x16x32_bf16 v[48:51], a[140:143], a[100:103], v[48:51]
v_mfma_f32_16x16x32_bf16 v[56:59], a[136:139], a[104:107], 0
s_add_u32 s50, s73, 56736
v_mfma_f32_16x16x32_bf16 v[56:59], a[140:143], a[108:111], v[56:59]
s_waitcnt lgkmcnt(4)
ds_read_b64_tr_b16 a[136:137], v250 offset:34312
buffer_load_dwordx4 v254, s[28:31], s50 offen offset:3168 lds
v_mfma_f32_16x16x32_bf16 v[36:39], a[120:123], a[80:83], 0
ds_read_b64_tr_b16 a[138:139], v250 offset:35368
v_mfma_f32_16x16x32_bf16 v[36:39], a[124:127], a[84:87], v[36:39]
ds_read_b64_tr_b16 a[140:141], v250 offset:42760
v_mfma_f32_16x16x32_bf16 v[44:47], a[120:123], a[88:91], 0
s_add_u32 m0, s54, 19008
ds_read_b64_tr_b16 a[142:143], v250 offset:43816
v_mfma_f32_16x16x32_bf16 v[44:47], a[124:127], a[92:95], v[44:47]
s_add_u32 s50, s14, 0
v_mfma_f32_16x16x32_bf16 v[52:55], a[120:123], a[96:99], 0
buffer_load_dwordx4 v254, s[28:31], s50 offen offset:0 lds
v_mfma_f32_16x16x32_bf16 v[52:55], a[124:127], a[100:103], v[52:55]
v_mfma_f32_16x16x32_bf16 v[60:63], a[120:123], a[104:107], 0
v_mfma_f32_16x16x32_bf16 v[60:63], a[124:127], a[108:111], v[60:63]
s_waitcnt lgkmcnt(4)
ds_read_b64_tr_b16 a[120:121], v251 offset:34304
v_mfma_f32_16x16x32_bf16 v[64:67], a[128:131], a[80:83], 0
s_add_u32 s50, s14, 3552
ds_read_b64_tr_b16 a[122:123], v251 offset:35360
v_mfma_f32_16x16x32_bf16 v[64:67], a[132:135], a[84:87], v[64:67]
ds_read_b64_tr_b16 a[124:125], v251 offset:42752
buffer_load_dwordx4 v254, s[28:31], s50 offen offset:1056 lds
v_mfma_f32_16x16x32_bf16 v[72:75], a[128:131], a[88:91], 0
ds_read_b64_tr_b16 a[126:127], v251 offset:43808
v_mfma_f32_16x16x32_bf16 v[72:75], a[132:135], a[92:95], v[72:75]
v_mfma_f32_16x16x32_bf16 v[80:83], a[128:131], a[96:99], 0
s_bfe_u32 s17, s62, 0x40004
v_mfma_f32_16x16x32_bf16 v[80:83], a[132:135], a[100:103], v[80:83]
s_lshl_b32 s17, s17, 19
v_mfma_f32_16x16x32_bf16 v[88:91], a[128:131], a[104:107], 0
s_add_u32 s16, s53, s17
v_mfma_f32_16x16x32_bf16 v[88:91], a[132:135], a[108:111], v[88:91]
s_add_u32 m0, s55, 0
v_mfma_f32_16x16x32_bf16 v[216:219], a[128:131], a[112:115], 0
s_add_u32 s50, s16, 0
v_mfma_f32_16x16x32_bf16 v[216:219], a[132:135], a[116:119], v[216:219]
s_waitcnt lgkmcnt(4)
ds_read_b64_tr_b16 a[128:129], v251 offset:34312
buffer_load_dwordx4 v253, s[32:35], s50 offen offset:0 lds
v_mfma_f32_16x16x32_bf16 v[68:71], a[136:139], a[80:83], 0
ds_read_b64_tr_b16 a[130:131], v251 offset:35368
v_mfma_f32_16x16x32_bf16 v[68:71], a[140:143], a[84:87], v[68:71]
ds_read_b64_tr_b16 a[132:133], v251 offset:42760
v_mfma_f32_16x16x32_bf16 v[76:79], a[136:139], a[88:91], 0
ds_read_b64_tr_b16 a[134:135], v251 offset:43816
v_mfma_f32_16x16x32_bf16 v[76:79], a[140:143], a[92:95], v[76:79]
s_add_u32 s50, s16, 31712
v_mfma_f32_16x16x32_bf16 v[84:87], a[136:139], a[96:99], 0
buffer_load_dwordx4 v253, s[32:35], s50 offen offset:1056 lds
v_mfma_f32_16x16x32_bf16 v[84:87], a[140:143], a[100:103], v[84:87]
v_mfma_f32_16x16x32_bf16 v[92:95], a[136:139], a[104:107], 0
v_mfma_f32_16x16x32_bf16 v[92:95], a[140:143], a[108:111], v[92:95]
v_mfma_f32_16x16x32_bf16 v[220:223], a[136:139], a[112:115], 0
s_waitcnt vmcnt(13) lgkmcnt(0)
v_mfma_f32_16x16x32_bf16 v[220:223], a[140:143], a[116:119], v[220:223]
s_barrier
v_mfma_f32_16x16x32_bf16 v[96:99], a[120:123], a[80:83], 0
s_add_u32 s50, s16, 63416
ds_read_b64_tr_b16 a[136:137], v250 offset:50688
v_mfma_f32_16x16x32_bf16 v[96:99], a[124:127], a[84:87], v[96:99]
ds_read_b64_tr_b16 a[138:139], v250 offset:51744
buffer_load_dwordx4 v253, s[32:35], s50 offen offset:2120 lds
v_mfma_f32_16x16x32_bf16 v[104:107], a[120:123], a[88:91], 0
ds_read_b64_tr_b16 a[140:141], v250 offset:59136
v_mfma_f32_16x16x32_bf16 v[104:107], a[124:127], a[92:95], v[104:107]
ds_read_b64_tr_b16 a[142:143], v250 offset:60192
v_mfma_f32_16x16x32_bf16 v[112:115], a[120:123], a[96:99], 0
v_mfma_f32_16x16x32_bf16 v[112:115], a[124:127], a[100:103], v[112:115]
s_add_u32 s50, s16, 95128
v_mfma_f32_16x16x32_bf16 v[120:123], a[120:123], a[104:107], 0
buffer_load_dwordx4 v253, s[32:35], s50 offen offset:3176 lds
v_mfma_f32_16x16x32_bf16 v[120:123], a[124:127], a[108:111], v[120:123]
ds_read_b64_tr_b16 a[120:121], v250 offset:50696
v_mfma_f32_16x16x32_bf16 v[100:103], a[128:131], a[80:83], 0
ds_read_b64_tr_b16 a[122:123], v250 offset:51752
v_mfma_f32_16x16x32_bf16 v[100:103], a[132:135], a[84:87], v[100:103]
s_add_u32 m0, s55, 16896
ds_read_b64_tr_b16 a[124:125], v250 offset:59144
v_mfma_f32_16x16x32_bf16 v[108:111], a[128:131], a[88:91], 0
s_add_u32 s50, s16, 256
ds_read_b64_tr_b16 a[126:127], v250 offset:60200
v_mfma_f32_16x16x32_bf16 v[108:111], a[132:135], a[92:95], v[108:111]
buffer_load_dwordx4 v253, s[32:35], s50 offen offset:0 lds
v_mfma_f32_16x16x32_bf16 v[116:119], a[128:131], a[96:99], 0
v_mfma_f32_16x16x32_bf16 v[116:119], a[132:135], a[100:103], v[116:119]
v_mfma_f32_16x16x32_bf16 v[124:127], a[128:131], a[104:107], 0
v_mfma_f32_16x16x32_bf16 v[124:127], a[132:135], a[108:111], v[124:127]
s_waitcnt lgkmcnt(4)
ds_read_b64_tr_b16 a[128:129], v251 offset:50688
v_mfma_f32_16x16x32_bf16 v[128:131], a[136:139], a[80:83], 0
s_add_u32 s50, s16, 31968
ds_read_b64_tr_b16 a[130:131], v251 offset:51744
v_mfma_f32_16x16x32_bf16 v[128:131], a[140:143], a[84:87], v[128:131]
ds_read_b64_tr_b16 a[132:133], v251 offset:59136
buffer_load_dwordx4 v253, s[32:35], s50 offen offset:1056 lds
v_mfma_f32_16x16x32_bf16 v[136:139], a[136:139], a[88:91], 0
ds_read_b64_tr_b16 a[134:135], v251 offset:60192
v_mfma_f32_16x16x32_bf16 v[136:139], a[140:143], a[92:95], v[136:139]
v_mfma_f32_16x16x32_bf16 v[144:147], a[136:139], a[96:99], 0
v_mfma_f32_16x16x32_bf16 v[144:147], a[140:143], a[100:103], v[144:147]
s_add_u32 s50, s16, 63672
v_mfma_f32_16x16x32_bf16 v[152:155], a[136:139], a[104:107], 0
buffer_load_dwordx4 v253, s[32:35], s50 offen offset:2120 lds
v_mfma_f32_16x16x32_bf16 v[152:155], a[140:143], a[108:111], v[152:155]
v_mfma_f32_16x16x32_bf16 v[224:227], a[136:139], a[112:115], 0
v_mfma_f32_16x16x32_bf16 v[224:227], a[140:143], a[116:119], v[224:227]
s_waitcnt lgkmcnt(4)
ds_read_b64_tr_b16 a[136:137], v251 offset:50696
v_mfma_f32_16x16x32_bf16 v[132:135], a[120:123], a[80:83], 0
s_add_u32 s50, s16, 95384
ds_read_b64_tr_b16 a[138:139], v251 offset:51752
v_mfma_f32_16x16x32_bf16 v[132:135], a[124:127], a[84:87], v[132:135]
ds_read_b64_tr_b16 a[140:141], v251 offset:59144
buffer_load_dwordx4 v253, s[32:35], s50 offen offset:3176 lds
v_mfma_f32_16x16x32_bf16 v[140:143], a[120:123], a[88:91], 0
ds_read_b64_tr_b16 a[142:143], v251 offset:60200
v_mfma_f32_16x16x32_bf16 v[140:143], a[124:127], a[92:95], v[140:143]
v_mfma_f32_16x16x32_bf16 v[148:151], a[120:123], a[96:99], 0
s_bfe_u32 s17, s62, 0x40008
v_mfma_f32_16x16x32_bf16 v[148:151], a[124:127], a[100:103], v[148:151]
s_lshl_b32 s17, s17, 7
v_mfma_f32_16x16x32_bf16 v[156:159], a[120:123], a[104:107], 0
s_add_u32 s73, s51, s17
v_mfma_f32_16x16x32_bf16 v[156:159], a[124:127], a[108:111], v[156:159]
s_add_u32 s14, s52, s17
v_mfma_f32_16x16x32_bf16 v[228:231], a[120:123], a[112:115], 0
s_add_u32 m0, s54, 0
v_mfma_f32_16x16x32_bf16 v[228:231], a[124:127], a[116:119], v[228:231]
s_waitcnt lgkmcnt(4)
ds_read_b64_tr_b16 a[120:121], v250 offset:51200
v_mfma_f32_16x16x32_bf16 v[160:163], a[128:131], a[80:83], 0
s_add_u32 s50, s73, 0
ds_read_b64_tr_b16 a[122:123], v250 offset:52256
v_mfma_f32_16x16x32_bf16 v[160:163], a[132:135], a[84:87], v[160:163]
ds_read_b64_tr_b16 a[124:125], v250 offset:59648
buffer_load_dwordx4 v254, s[28:31], s50 offen offset:0 lds
v_mfma_f32_16x16x32_bf16 v[168:171], a[128:131], a[88:91], 0
ds_read_b64_tr_b16 a[126:127], v250 offset:60704
v_mfma_f32_16x16x32_bf16 v[168:171], a[132:135], a[92:95], v[168:171]
v_mfma_f32_16x16x32_bf16 v[176:179], a[128:131], a[96:99], 0
v_mfma_f32_16x16x32_bf16 v[176:179], a[132:135], a[100:103], v[176:179]
v_mfma_f32_16x16x32_bf16 v[184:187], a[128:131], a[104:107], 0
s_add_u32 s50, s73, 3552
v_mfma_f32_16x16x32_bf16 v[184:187], a[132:135], a[108:111], v[184:187]
s_waitcnt lgkmcnt(4)
ds_read_b64_tr_b16 a[128:129], v250 offset:51208
buffer_load_dwordx4 v254, s[28:31], s50 offen offset:1056 lds
v_mfma_f32_16x16x32_bf16 v[164:167], a[136:139], a[80:83], 0
s_waitcnt vmcnt(10)
ds_read_b64_tr_b16 a[130:131], v250 offset:52264
v_mfma_f32_16x16x32_bf16 v[164:167], a[140:143], a[84:87], v[164:167]
ds_read_b64_tr_b16 a[132:133], v250 offset:59656
v_mfma_f32_16x16x32_bf16 v[172:175], a[136:139], a[88:91], 0
ds_read_b64_tr_b16 a[134:135], v250 offset:60712
v_mfma_f32_16x16x32_bf16 v[172:175], a[140:143], a[92:95], v[172:175]
ds_read_b128 a[0:3], v252 offset:10560
v_mfma_f32_16x16x32_bf16 v[180:183], a[136:139], a[96:99], 0
s_add_u32 s50, s73, 16320
ds_read_b128 a[4:7], v252 offset:11072
v_mfma_f32_16x16x32_bf16 v[180:183], a[140:143], a[100:103], v[180:183]
ds_read_b128 a[8:11], v252 offset:12672
buffer_load_dwordx4 v254, s[28:31], s50 offen offset:2112 lds
v_mfma_f32_16x16x32_bf16 v[188:191], a[136:139], a[104:107], 0
ds_read_b128 a[12:15], v252 offset:13184
v_mfma_f32_16x16x32_bf16 v[188:191], a[140:143], a[108:111], v[188:191]
s_waitcnt lgkmcnt(8)
ds_read_b64_tr_b16 a[136:137], v251 offset:51200
v_mfma_f32_16x16x32_bf16 v[192:195], a[120:123], a[80:83], 0
ds_read_b64_tr_b16 a[138:139], v251 offset:52256
v_mfma_f32_16x16x32_bf16 v[192:195], a[124:127], a[84:87], v[192:195]
ds_read_b64_tr_b16 a[140:141], v251 offset:59648
v_mfma_f32_16x16x32_bf16 v[200:203], a[120:123], a[88:91], 0
s_add_u32 s50, s73, 19872
ds_read_b64_tr_b16 a[142:143], v251 offset:60704
v_mfma_f32_16x16x32_bf16 v[200:203], a[124:127], a[92:95], v[200:203]
ds_read_b128 a[16:19], v252 offset:14784
buffer_load_dwordx4 v254, s[28:31], s50 offen offset:3168 lds
v_mfma_f32_16x16x32_bf16 a[160:163], a[120:123], a[96:99], 0
ds_read_b128 a[20:23], v252 offset:15296
v_mfma_f32_16x16x32_bf16 a[160:163], a[124:127], a[100:103], a[160:163]
ds_read_b128 a[24:27], v252 offset:16896
v_mfma_f32_16x16x32_bf16 a[168:171], a[120:123], a[104:107], 0
ds_read_b128 a[28:31], v252 offset:17408
v_mfma_f32_16x16x32_bf16 a[168:171], a[124:127], a[108:111], a[168:171]
s_add_u32 m0, s54, 4224
ds_read_b128 a[32:35], v252 offset:19008
v_mfma_f32_16x16x32_bf16 v[232:235], a[120:123], a[112:115], 0
s_add_u32 s50, s73, 36864
ds_read_b128 a[36:39], v252 offset:19520
v_mfma_f32_16x16x32_bf16 v[232:235], a[124:127], a[116:119], v[232:235]
s_waitcnt lgkmcnt(14)
ds_read_b64_tr_b16 a[120:121], v251 offset:51208
buffer_load_dwordx4 v254, s[28:31], s50 offen offset:0 lds
v_mfma_f32_16x16x32_bf16 v[196:199], a[128:131], a[80:83], 0
ds_read_b64_tr_b16 a[122:123], v251 offset:52264
v_mfma_f32_16x16x32_bf16 v[196:199], a[132:135], a[84:87], v[196:199]
ds_read_b64_tr_b16 a[124:125], v251 offset:59656
v_mfma_f32_16x16x32_bf16 v[204:207], a[128:131], a[88:91], 0
ds_read_b64_tr_b16 a[126:127], v251 offset:60712
v_mfma_f32_16x16x32_bf16 v[204:207], a[132:135], a[92:95], v[204:207]
v_mfma_f32_16x16x32_bf16 a[164:167], a[128:131], a[96:99], 0
s_add_u32 s50, s73, 40416
v_mfma_f32_16x16x32_bf16 a[164:167], a[132:135], a[100:103], a[164:167]
buffer_load_dwordx4 v254, s[28:31], s50 offen offset:1056 lds
v_mfma_f32_16x16x32_bf16 a[172:175], a[128:131], a[104:107], 0
v_mfma_f32_16x16x32_bf16 a[172:175], a[132:135], a[108:111], a[172:175]
v_mfma_f32_16x16x32_bf16 v[236:239], a[128:131], a[112:115], 0
s_waitcnt vmcnt(10) lgkmcnt(0)
v_mfma_f32_16x16x32_bf16 v[236:239], a[132:135], a[116:119], v[236:239]
s_barrier
v_mfma_f32_16x16x32_bf16 a[176:179], a[136:139], a[80:83], 0
s_add_u32 s50, s73, 53184
ds_read_b64_tr_b16 a[128:129], v250 offset:0
v_mfma_f32_16x16x32_bf16 a[176:179], a[140:143], a[84:87], a[176:179]
ds_read_b64_tr_b16 a[130:131], v250 offset:1056
buffer_load_dwordx4 v254, s[28:31], s50 offen offset:2112 lds
v_mfma_f32_16x16x32_bf16 a[184:187], a[136:139], a[88:91], 0
ds_read_b64_tr_b16 a[132:133], v250 offset:8448
v_mfma_f32_16x16x32_bf16 a[184:187], a[140:143], a[92:95], a[184:187]
ds_read_b64_tr_b16 a[134:135], v250 offset:9504
v_mfma_f32_16x16x32_bf16 a[192:195], a[136:139], a[96:99], 0
v_mfma_f32_16x16x32_bf16 a[192:195], a[140:143], a[100:103], a[192:195]
v_mfma_f32_16x16x32_bf16 a[200:203], a[136:139], a[104:107], 0
s_add_u32 s50, s73, 56736
v_mfma_f32_16x16x32_bf16 a[200:203], a[140:143], a[108:111], a[200:203]
ds_read_b64_tr_b16 a[136:137], v250 offset:8
buffer_load_dwordx4 v254, s[28:31], s50 offen offset:3168 lds
v_mfma_f32_16x16x32_bf16 a[180:183], a[120:123], a[80:83], 0
ds_read_b64_tr_b16 a[138:139], v250 offset:1064
v_mfma_f32_16x16x32_bf16 a[180:183], a[124:127], a[84:87], a[180:183]
ds_read_b64_tr_b16 a[140:141], v250 offset:8456
v_mfma_f32_16x16x32_bf16 a[188:191], a[120:123], a[88:91], 0
ds_read_b64_tr_b16 a[142:143], v250 offset:9512
v_mfma_f32_16x16x32_bf16 a[188:191], a[124:127], a[92:95], a[188:191]
s_add_u32 m0, s54, 8448
v_mfma_f32_16x16x32_bf16 a[196:199], a[120:123], a[96:99], 0
s_add_u32 s50, s14, 0
v_mfma_f32_16x16x32_bf16 a[196:199], a[124:127], a[100:103], a[196:199]
buffer_load_dwordx4 v254, s[28:31], s50 offen offset:0 lds
v_mfma_f32_16x16x32_bf16 a[204:207], a[120:123], a[104:107], 0
v_mfma_f32_16x16x32_bf16 a[204:207], a[124:127], a[108:111], a[204:207]
s_waitcnt lgkmcnt(4)
ds_read_b64_tr_b16 a[120:121], v251 offset:0
v_mfma_f32_16x16x32_bf16 v[0:3], a[128:131], a[0:3], v[0:3]
ds_read_b64_tr_b16 a[122:123], v251 offset:1056
v_mfma_f32_16x16x32_bf16 v[0:3], a[132:135], a[4:7], v[0:3]
ds_read_b64_tr_b16 a[124:125], v251 offset:8448
v_mfma_f32_16x16x32_bf16 v[8:11], a[128:131], a[8:11], v[8:11]
s_add_u32 s50, s14, 3552
ds_read_b64_tr_b16 a[126:127], v251 offset:9504
v_mfma_f32_16x16x32_bf16 v[8:11], a[132:135], a[12:15], v[8:11]
buffer_load_dwordx4 v254, s[28:31], s50 offen offset:1056 lds
v_mfma_f32_16x16x32_bf16 v[16:19], a[128:131], a[16:19], v[16:19]
v_mfma_f32_16x16x32_bf16 v[16:19], a[132:135], a[20:23], v[16:19]
v_mfma_f32_16x16x32_bf16 v[24:27], a[128:131], a[24:27], v[24:27]
v_mfma_f32_16x16x32_bf16 v[24:27], a[132:135], a[28:31], v[24:27]
s_bfe_u32 s17, s62, 0x40008
v_mfma_f32_16x16x32_bf16 v[208:211], a[128:131], a[32:35], v[208:211]
s_lshl_b32 s17, s17, 19
v_mfma_f32_16x16x32_bf16 v[208:211], a[132:135], a[36:39], v[208:211]
s_waitcnt lgkmcnt(4)
ds_read_b64_tr_b16 a[128:129], v251 offset:8
v_mfma_f32_16x16x32_bf16 v[4:7], a[136:139], a[0:3], v[4:7]
s_add_u32 s16, s53, s17
ds_read_b64_tr_b16 a[130:131], v251 offset:1064
v_mfma_f32_16x16x32_bf16 v[4:7], a[140:143], a[4:7], v[4:7]
s_add_u32 m0, s55, 33792
ds_read_b64_tr_b16 a[132:133], v251 offset:8456
v_mfma_f32_16x16x32_bf16 v[12:15], a[136:139], a[8:11], v[12:15]
s_add_u32 s50, s16, 0
ds_read_b64_tr_b16 a[134:135], v251 offset:9512
v_mfma_f32_16x16x32_bf16 v[12:15], a[140:143], a[12:15], v[12:15]
buffer_load_dwordx4 v253, s[32:35], s50 offen offset:0 lds
v_mfma_f32_16x16x32_bf16 v[20:23], a[136:139], a[16:19], v[20:23]
v_mfma_f32_16x16x32_bf16 v[20:23], a[140:143], a[20:23], v[20:23]
v_mfma_f32_16x16x32_bf16 v[28:31], a[136:139], a[24:27], v[28:31]
v_mfma_f32_16x16x32_bf16 v[28:31], a[140:143], a[28:31], v[28:31]
v_mfma_f32_16x16x32_bf16 v[212:215], a[136:139], a[32:35], v[212:215]
s_add_u32 s50, s16, 31712
v_mfma_f32_16x16x32_bf16 v[212:215], a[140:143], a[36:39], v[212:215]
s_waitcnt lgkmcnt(4)
ds_read_b64_tr_b16 a[136:137], v250 offset:512
buffer_load_dwordx4 v253, s[32:35], s50 offen offset:1056 lds
v_mfma_f32_16x16x32_bf16 v[32:35], a[120:123], a[0:3], v[32:35]
ds_read_b64_tr_b16 a[138:139], v250 offset:1568
v_mfma_f32_16x16x32_bf16 v[32:35], a[124:127], a[4:7], v[32:35]
ds_read_b64_tr_b16 a[140:141], v250 offset:8960
v_mfma_f32_16x16x32_bf16 v[40:43], a[120:123], a[8:11], v[40:43]
ds_read_b64_tr_b16 a[142:143], v250 offset:10016
v_mfma_f32_16x16x32_bf16 v[40:43], a[124:127], a[12:15], v[40:43]
v_mfma_f32_16x16x32_bf16 v[48:51], a[120:123], a[16:19], v[48:51]
s_add_u32 s50, s16, 63416
v_mfma_f32_16x16x32_bf16 v[48:51], a[124:127], a[20:23], v[48:51]
buffer_load_dwordx4 v253, s[32:35], s50 offen offset:2120 lds
v_mfma_f32_16x16x32_bf16 v[56:59], a[120:123], a[24:27], v[56:59]
v_mfma_f32_16x16x32_bf16 v[56:59], a[124:127], a[28:31], v[56:59]
s_waitcnt lgkmcnt(4)
ds_read_b64_tr_b16 a[120:121], v250 offset:520
v_mfma_f32_16x16x32_bf16 v[36:39], a[128:131], a[0:3], v[36:39]
ds_read_b64_tr_b16 a[122:123], v250 offset:1576
v_mfma_f32_16x16x32_bf16 v[36:39], a[132:135], a[4:7], v[36:39]
ds_read_b64_tr_b16 a[124:125], v250 offset:8968
v_mfma_f32_16x16x32_bf16 v[44:47], a[128:131], a[8:11], v[44:47]
s_add_u32 s50, s16, 95128
ds_read_b64_tr_b16 a[126:127], v250 offset:10024
v_mfma_f32_16x16x32_bf16 v[44:47], a[132:135], a[12:15], v[44:47]
buffer_load_dwordx4 v253, s[32:35], s50 offen offset:3176 lds
v_mfma_f32_16x16x32_bf16 v[52:55], a[128:131], a[16:19], v[52:55]
v_mfma_f32_16x16x32_bf16 v[52:55], a[132:135], a[20:23], v[52:55]
v_mfma_f32_16x16x32_bf16 v[60:63], a[128:131], a[24:27], v[60:63]
v_mfma_f32_16x16x32_bf16 v[60:63], a[132:135], a[28:31], v[60:63]
s_waitcnt lgkmcnt(4)
ds_read_b64_tr_b16 a[128:129], v251 offset:512
v_mfma_f32_16x16x32_bf16 v[64:67], a[136:139], a[0:3], v[64:67]
s_add_u32 m0, s55, 50688
ds_read_b64_tr_b16 a[130:131], v251 offset:1568
v_mfma_f32_16x16x32_bf16 v[64:67], a[140:143], a[4:7], v[64:67]
s_add_u32 s50, s16, 256
ds_read_b64_tr_b16 a[132:133], v251 offset:8960
v_mfma_f32_16x16x32_bf16 v[72:75], a[136:139], a[8:11], v[72:75]
ds_read_b64_tr_b16 a[134:135], v251 offset:10016
buffer_load_dwordx4 v253, s[32:35], s50 offen offset:0 lds
v_mfma_f32_16x16x32_bf16 v[72:75], a[140:143], a[12:15], v[72:75]
v_mfma_f32_16x16x32_bf16 v[80:83], a[136:139], a[16:19], v[80:83]
v_mfma_f32_16x16x32_bf16 v[80:83], a[140:143], a[20:23], v[80:83]
v_mfma_f32_16x16x32_bf16 v[88:91], a[136:139], a[24:27], v[88:91]
v_mfma_f32_16x16x32_bf16 v[88:91], a[140:143], a[28:31], v[88:91]
s_add_u32 s50, s16, 31968
v_mfma_f32_16x16x32_bf16 v[216:219], a[136:139], a[32:35], v[216:219]
buffer_load_dwordx4 v253, s[32:35], s50 offen offset:1056 lds
v_mfma_f32_16x16x32_bf16 v[216:219], a[140:143], a[36:39], v[216:219]
s_waitcnt lgkmcnt(4)
ds_read_b64_tr_b16 a[136:137], v251 offset:520
v_mfma_f32_16x16x32_bf16 v[68:71], a[120:123], a[0:3], v[68:71]
ds_read_b64_tr_b16 a[138:139], v251 offset:1576
v_mfma_f32_16x16x32_bf16 v[68:71], a[124:127], a[4:7], v[68:71]
ds_read_b64_tr_b16 a[140:141], v251 offset:8968
v_mfma_f32_16x16x32_bf16 v[76:79], a[120:123], a[8:11], v[76:79]
ds_read_b64_tr_b16 a[142:143], v251 offset:10024
v_mfma_f32_16x16x32_bf16 v[76:79], a[124:127], a[12:15], v[76:79]
s_add_u32 s50, s16, 63672
v_mfma_f32_16x16x32_bf16 v[84:87], a[120:123], a[16:19], v[84:87]
buffer_load_dwordx4 v253, s[32:35], s50 offen offset:2120 lds
v_mfma_f32_16x16x32_bf16 v[84:87], a[124:127], a[20:23], v[84:87]
v_mfma_f32_16x16x32_bf16 v[92:95], a[120:123], a[24:27], v[92:95]
v_mfma_f32_16x16x32_bf16 v[92:95], a[124:127], a[28:31], v[92:95]
v_mfma_f32_16x16x32_bf16 v[220:223], a[120:123], a[32:35], v[220:223]
s_waitcnt vmcnt(17) lgkmcnt(0)
v_mfma_f32_16x16x32_bf16 v[220:223], a[124:127], a[36:39], v[220:223]
s_barrier
v_mfma_f32_16x16x32_bf16 v[96:99], a[128:131], a[0:3], v[96:99]
s_add_u32 s50, s16, 95384
ds_read_b64_tr_b16 a[120:121], v250 offset:16896
v_mfma_f32_16x16x32_bf16 v[96:99], a[132:135], a[4:7], v[96:99]
ds_read_b64_tr_b16 a[122:123], v250 offset:17952
buffer_load_dwordx4 v253, s[32:35], s50 offen offset:3176 lds
v_mfma_f32_16x16x32_bf16 v[104:107], a[128:131], a[8:11], v[104:107]
ds_read_b64_tr_b16 a[124:125], v250 offset:25344
v_mfma_f32_16x16x32_bf16 v[104:107], a[132:135], a[12:15], v[104:107]
ds_read_b64_tr_b16 a[126:127], v250 offset:26400
v_mfma_f32_16x16x32_bf16 v[112:115], a[128:131], a[16:19], v[112:115]
v_mfma_f32_16x16x32_bf16 v[112:115], a[132:135], a[20:23], v[112:115]
s_bfe_u32 s17, s62, 0x4000c
v_mfma_f32_16x16x32_bf16 v[120:123], a[128:131], a[24:27], v[120:123]
s_lshl_b32 s17, s17, 7
v_mfma_f32_16x16x32_bf16 v[120:123], a[132:135], a[28:31], v[120:123]
s_add_u32 s73, s51, s17
ds_read_b64_tr_b16 a[128:129], v250 offset:16904
v_mfma_f32_16x16x32_bf16 v[100:103], a[136:139], a[0:3], v[100:103]
s_add_u32 s14, s52, s17
ds_read_b64_tr_b16 a[130:131], v250 offset:17960
v_mfma_f32_16x16x32_bf16 v[100:103], a[140:143], a[4:7], v[100:103]
s_add_u32 m0, s54, 10560
ds_read_b64_tr_b16 a[132:133], v250 offset:25352
v_mfma_f32_16x16x32_bf16 v[108:111], a[136:139], a[8:11], v[108:111]
s_add_u32 s50, s73, 0
ds_read_b64_tr_b16 a[134:135], v250 offset:26408
v_mfma_f32_16x16x32_bf16 v[108:111], a[140:143], a[12:15], v[108:111]
buffer_load_dwordx4 v254, s[28:31], s50 offen offset:0 lds
v_mfma_f32_16x16x32_bf16 v[116:119], a[136:139], a[16:19], v[116:119]
v_mfma_f32_16x16x32_bf16 v[116:119], a[140:143], a[20:23], v[116:119]
v_mfma_f32_16x16x32_bf16 v[124:127], a[136:139], a[24:27], v[124:127]
v_mfma_f32_16x16x32_bf16 v[124:127], a[140:143], a[28:31], v[124:127]
s_waitcnt lgkmcnt(4)
ds_read_b64_tr_b16 a[136:137], v251 offset:16896
v_mfma_f32_16x16x32_bf16 v[128:131], a[120:123], a[0:3], v[128:131]
s_add_u32 s50, s73, 3552
ds_read_b64_tr_b16 a[138:139], v251 offset:17952
v_mfma_f32_16x16x32_bf16 v[128:131], a[124:127], a[4:7], v[128:131]
ds_read_b64_tr_b16 a[140:141], v251 offset:25344
buffer_load_dwordx4 v254, s[28:31], s50 offen offset:1056 lds
v_mfma_f32_16x16x32_bf16 v[136:139], a[120:123], a[8:11], v[136:139]
ds_read_b64_tr_b16 a[142:143], v251 offset:26400
v_mfma_f32_16x16x32_bf16 v[136:139], a[124:127], a[12:15], v[136:139]
v_mfma_f32_16x16x32_bf16 v[144:147], a[120:123], a[16:19], v[144:147]
v_mfma_f32_16x16x32_bf16 v[144:147], a[124:127], a[20:23], v[144:147]
v_mfma_f32_16x16x32_bf16 v[152:155], a[120:123], a[24:27], v[152:155]
s_add_u32 s50, s73, 16320
v_mfma_f32_16x16x32_bf16 v[152:155], a[124:127], a[28:31], v[152:155]
buffer_load_dwordx4 v254, s[28:31], s50 offen offset:2112 lds
v_mfma_f32_16x16x32_bf16 v[224:227], a[120:123], a[32:35], v[224:227]
v_mfma_f32_16x16x32_bf16 v[224:227], a[124:127], a[36:39], v[224:227]
s_waitcnt lgkmcnt(4)
ds_read_b64_tr_b16 a[120:121], v251 offset:16904
v_mfma_f32_16x16x32_bf16 v[132:135], a[128:131], a[0:3], v[132:135]
ds_read_b64_tr_b16 a[122:123], v251 offset:17960
v_mfma_f32_16x16x32_bf16 v[132:135], a[132:135], a[4:7], v[132:135]
ds_read_b64_tr_b16 a[124:125], v251 offset:25352
v_mfma_f32_16x16x32_bf16 v[140:143], a[128:131], a[8:11], v[140:143]
s_add_u32 s50, s73, 19872
ds_read_b64_tr_b16 a[126:127], v251 offset:26408
v_mfma_f32_16x16x32_bf16 v[140:143], a[132:135], a[12:15], v[140:143]
buffer_load_dwordx4 v254, s[28:31], s50 offen offset:3168 lds
v_mfma_f32_16x16x32_bf16 v[148:151], a[128:131], a[16:19], v[148:151]
v_mfma_f32_16x16x32_bf16 v[148:151], a[132:135], a[20:23], v[148:151]
v_mfma_f32_16x16x32_bf16 v[156:159], a[128:131], a[24:27], v[156:159]
v_mfma_f32_16x16x32_bf16 v[156:159], a[132:135], a[28:31], v[156:159]
s_add_u32 m0, s54, 14784
v_mfma_f32_16x16x32_bf16 v[228:231], a[128:131], a[32:35], v[228:231]
s_add_u32 s50, s73, 36864
v_mfma_f32_16x16x32_bf16 v[228:231], a[132:135], a[36:39], v[228:231]
s_waitcnt lgkmcnt(4)
ds_read_b64_tr_b16 a[128:129], v250 offset:17408
buffer_load_dwordx4 v254, s[28:31], s50 offen offset:0 lds
v_mfma_f32_16x16x32_bf16 v[160:163], a[136:139], a[0:3], v[160:163]
ds_read_b64_tr_b16 a[130:131], v250 offset:18464
v_mfma_f32_16x16x32_bf16 v[160:163], a[140:143], a[4:7], v[160:163]
ds_read_b64_tr_b16 a[132:133], v250 offset:25856
v_mfma_f32_16x16x32_bf16 v[168:171], a[136:139], a[8:11], v[168:171]
ds_read_b64_tr_b16 a[134:135], v250 offset:26912
v_mfma_f32_16x16x32_bf16 v[168:171], a[140:143], a[12:15], v[168:171]
v_mfma_f32_16x16x32_bf16 v[176:179], a[136:139], a[16:19], v[176:179]
s_add_u32 s50, s73, 40416
v_mfma_f32_16x16x32_bf16 v[176:179], a[140:143], a[20:23], v[176:179]
buffer_load_dwordx4 v254, s[28:31], s50 offen offset:1056 lds
v_mfma_f32_16x16x32_bf16 v[184:187], a[136:139], a[24:27], v[184:187]
v_mfma_f32_16x16x32_bf16 v[184:187], a[140:143], a[28:31], v[184:187]
s_waitcnt lgkmcnt(4)
ds_read_b64_tr_b16 a[136:137], v250 offset:17416
v_mfma_f32_16x16x32_bf16 v[164:167], a[120:123], a[0:3], v[164:167]
s_waitcnt vmcnt(14)
ds_read_b64_tr_b16 a[138:139], v250 offset:18472
v_mfma_f32_16x16x32_bf16 v[164:167], a[124:127], a[4:7], v[164:167]
ds_read_b64_tr_b16 a[140:141], v250 offset:25864
v_mfma_f32_16x16x32_bf16 v[172:175], a[120:123], a[8:11], v[172:175]
s_add_u32 s50, s73, 53184
ds_read_b64_tr_b16 a[142:143], v250 offset:26920
v_mfma_f32_16x16x32_bf16 v[172:175], a[124:127], a[12:15], v[172:175]
ds_read_b128 a[80:83], v252 offset:0
buffer_load_dwordx4 v254, s[28:31], s50 offen offset:2112 lds
v_mfma_f32_16x16x32_bf16 v[180:183], a[120:123], a[16:19], v[180:183]
ds_read_b128 a[84:87], v252 offset:512
v_mfma_f32_16x16x32_bf16 v[180:183], a[124:127], a[20:23], v[180:183]
ds_read_b128 a[88:91], v252 offset:2112
v_mfma_f32_16x16x32_bf16 v[188:191], a[120:123], a[24:27], v[188:191]
ds_read_b128 a[92:95], v252 offset:2624
v_mfma_f32_16x16x32_bf16 v[188:191], a[124:127], a[28:31], v[188:191]
s_waitcnt lgkmcnt(8)
ds_read_b64_tr_b16 a[120:121], v251 offset:17408
v_mfma_f32_16x16x32_bf16 v[192:195], a[128:131], a[0:3], v[192:195]
s_add_u32 s50, s73, 56736
ds_read_b64_tr_b16 a[122:123], v251 offset:18464
v_mfma_f32_16x16x32_bf16 v[192:195], a[132:135], a[4:7], v[192:195]
ds_read_b64_tr_b16 a[124:125], v251 offset:25856
buffer_load_dwordx4 v254, s[28:31], s50 offen offset:3168 lds
v_mfma_f32_16x16x32_bf16 v[200:203], a[128:131], a[8:11], v[200:203]
ds_read_b64_tr_b16 a[126:127], v251 offset:26912
v_mfma_f32_16x16x32_bf16 v[200:203], a[132:135], a[12:15], v[200:203]
ds_read_b128 a[96:99], v252 offset:4224
v_mfma_f32_16x16x32_bf16 a[160:163], a[128:131], a[16:19], a[160:163]
ds_read_b128 a[100:103], v252 offset:4736
v_mfma_f32_16x16x32_bf16 a[160:163], a[132:135], a[20:23], a[160:163]
s_add_u32 m0, s54, 19008
ds_read_b128 a[104:107], v252 offset:6336
v_mfma_f32_16x16x32_bf16 a[168:171], a[128:131], a[24:27], a[168:171]
s_add_u32 s50, s14, 0
ds_read_b128 a[108:111], v252 offset:6848
v_mfma_f32_16x16x32_bf16 a[168:171], a[132:135], a[28:31], a[168:171]
ds_read_b128 a[112:115], v252 offset:8448
buffer_load_dwordx4 v254, s[28:31], s50 offen offset:0 lds
v_mfma_f32_16x16x32_bf16 v[232:235], a[128:131], a[32:35], v[232:235]
ds_read_b128 a[116:119], v252 offset:8960
v_mfma_f32_16x16x32_bf16 v[232:235], a[132:135], a[36:39], v[232:235]
s_waitcnt lgkmcnt(14)
ds_read_b64_tr_b16 a[128:129], v251 offset:17416
v_mfma_f32_16x16x32_bf16 v[196:199], a[136:139], a[0:3], v[196:199]
ds_read_b64_tr_b16 a[130:131], v251 offset:18472
v_mfma_f32_16x16x32_bf16 v[196:199], a[140:143], a[4:7], v[196:199]
ds_read_b64_tr_b16 a[132:133], v251 offset:25864
v_mfma_f32_16x16x32_bf16 v[204:207], a[136:139], a[8:11], v[204:207]
s_add_u32 s50, s14, 3552
ds_read_b64_tr_b16 a[134:135], v251 offset:26920
v_mfma_f32_16x16x32_bf16 v[204:207], a[140:143], a[12:15], v[204:207]
buffer_load_dwordx4 v254, s[28:31], s50 offen offset:1056 lds
v_mfma_f32_16x16x32_bf16 a[164:167], a[136:139], a[16:19], a[164:167]
v_mfma_f32_16x16x32_bf16 a[164:167], a[140:143], a[20:23], a[164:167]
v_mfma_f32_16x16x32_bf16 a[172:175], a[136:139], a[24:27], a[172:175]
v_mfma_f32_16x16x32_bf16 a[172:175], a[140:143], a[28:31], a[172:175]
s_bfe_u32 s17, s62, 0x4000c
v_mfma_f32_16x16x32_bf16 v[236:239], a[136:139], a[32:35], v[236:239]
s_waitcnt vmcnt(14) lgkmcnt(0)
v_mfma_f32_16x16x32_bf16 v[236:239], a[140:143], a[36:39], v[236:239]
s_barrier
v_mfma_f32_16x16x32_bf16 a[176:179], a[120:123], a[0:3], a[176:179]
s_lshl_b32 s17, s17, 19
ds_read_b64_tr_b16 a[136:137], v250 offset:33792
v_mfma_f32_16x16x32_bf16 a[176:179], a[124:127], a[4:7], a[176:179]
s_add_u32 s16, s53, s17
ds_read_b64_tr_b16 a[138:139], v250 offset:34848
v_mfma_f32_16x16x32_bf16 a[184:187], a[120:123], a[8:11], a[184:187]
s_add_u32 m0, s55, 0
ds_read_b64_tr_b16 a[140:141], v250 offset:42240
v_mfma_f32_16x16x32_bf16 a[184:187], a[124:127], a[12:15], a[184:187]
s_add_u32 s50, s16, 0
ds_read_b64_tr_b16 a[142:143], v250 offset:43296
v_mfma_f32_16x16x32_bf16 a[192:195], a[120:123], a[16:19], a[192:195]
buffer_load_dwordx4 v253, s[32:35], s50 offen offset:0 lds
v_mfma_f32_16x16x32_bf16 a[192:195], a[124:127], a[20:23], a[192:195]
v_mfma_f32_16x16x32_bf16 a[200:203], a[120:123], a[24:27], a[200:203]
v_mfma_f32_16x16x32_bf16 a[200:203], a[124:127], a[28:31], a[200:203]
ds_read_b64_tr_b16 a[120:121], v250 offset:33800
v_mfma_f32_16x16x32_bf16 a[180:183], a[128:131], a[0:3], a[180:183]
ds_read_b64_tr_b16 a[122:123], v250 offset:34856
v_mfma_f32_16x16x32_bf16 a[180:183], a[132:135], a[4:7], a[180:183]
s_add_u32 s50, s16, 31712
ds_read_b64_tr_b16 a[124:125], v250 offset:42248
v_mfma_f32_16x16x32_bf16 a[188:191], a[128:131], a[8:11], a[188:191]
ds_read_b64_tr_b16 a[126:127], v250 offset:43304
buffer_load_dwordx4 v253, s[32:35], s50 offen offset:1056 lds
v_mfma_f32_16x16x32_bf16 a[188:191], a[132:135], a[12:15], a[188:191]
v_mfma_f32_16x16x32_bf16 a[196:199], a[128:131], a[16:19], a[196:199]
v_mfma_f32_16x16x32_bf16 a[196:199], a[132:135], a[20:23], a[196:199]
v_mfma_f32_16x16x32_bf16 a[204:207], a[128:131], a[24:27], a[204:207]
v_mfma_f32_16x16x32_bf16 a[204:207], a[132:135], a[28:31], a[204:207]
s_waitcnt lgkmcnt(4)
ds_read_b64_tr_b16 a[128:129], v251 offset:33792
v_mfma_f32_16x16x32_bf16 v[0:3], a[136:139], a[80:83], v[0:3]
s_add_u32 s50, s16, 63416
ds_read_b64_tr_b16 a[130:131], v251 offset:34848
v_mfma_f32_16x16x32_bf16 v[0:3], a[140:143], a[84:87], v[0:3]
ds_read_b64_tr_b16 a[132:133], v251 offset:42240
buffer_load_dwordx4 v253, s[32:35], s50 offen offset:2120 lds
v_mfma_f32_16x16x32_bf16 v[8:11], a[136:139], a[88:91], v[8:11]
ds_read_b64_tr_b16 a[134:135], v251 offset:43296
v_mfma_f32_16x16x32_bf16 v[8:11], a[140:143], a[92:95], v[8:11]
v_mfma_f32_16x16x32_bf16 v[16:19], a[136:139], a[96:99], v[16:19]
v_mfma_f32_16x16x32_bf16 v[16:19], a[140:143], a[100:103], v[16:19]
v_mfma_f32_16x16x32_bf16 v[24:27], a[136:139], a[104:107], v[24:27]
s_add_u32 s50, s16, 95128
v_mfma_f32_16x16x32_bf16 v[24:27], a[140:143], a[108:111], v[24:27]
buffer_load_dwordx4 v253, s[32:35], s50 offen offset:3176 lds
v_mfma_f32_16x16x32_bf16 v[208:211], a[136:139], a[112:115], v[208:211]
v_mfma_f32_16x16x32_bf16 v[208:211], a[140:143], a[116:119], v[208:211]
s_waitcnt lgkmcnt(4)
ds_read_b64_tr_b16 a[136:137], v251 offset:33800
v_mfma_f32_16x16x32_bf16 v[4:7], a[120:123], a[80:83], v[4:7]
ds_read_b64_tr_b16 a[138:139], v251 offset:34856
v_mfma_f32_16x16x32_bf16 v[4:7], a[124:127], a[84:87], v[4:7]
s_add_u32 m0, s55, 16896
ds_read_b64_tr_b16 a[140:141], v251 offset:42248
v_mfma_f32_16x16x32_bf16 v[12:15], a[120:123], a[88:91], v[12:15]
s_add_u32 s50, s16, 256
ds_read_b64_tr_b16 a[142:143], v251 offset:43304
v_mfma_f32_16x16x32_bf16 v[12:15], a[124:127], a[92:95], v[12:15]
buffer_load_dwordx4 v253, s[32:35], s50 offen offset:0 lds
v_mfma_f32_16x16x32_bf16 v[20:23], a[120:123], a[96:99], v[20:23]
v_mfma_f32_16x16x32_bf16 v[20:23], a[124:127], a[100:103], v[20:23]
v_mfma_f32_16x16x32_bf16 v[28:31], a[120:123], a[104:107], v[28:31]
v_mfma_f32_16x16x32_bf16 v[28:31], a[124:127], a[108:111], v[28:31]
v_mfma_f32_16x16x32_bf16 v[212:215], a[120:123], a[112:115], v[212:215]
s_add_u32 s50, s16, 31968
v_mfma_f32_16x16x32_bf16 v[212:215], a[124:127], a[116:119], v[212:215]
s_waitcnt lgkmcnt(4)
ds_read_b64_tr_b16 a[120:121], v250 offset:34304
buffer_load_dwordx4 v253, s[32:35], s50 offen offset:1056 lds
v_mfma_f32_16x16x32_bf16 v[32:35], a[128:131], a[80:83], v[32:35]
ds_read_b64_tr_b16 a[122:123], v250 offset:35360
v_mfma_f32_16x16x32_bf16 v[32:35], a[132:135], a[84:87], v[32:35]
ds_read_b64_tr_b16 a[124:125], v250 offset:42752
v_mfma_f32_16x16x32_bf16 v[40:43], a[128:131], a[88:91], v[40:43]
ds_read_b64_tr_b16 a[126:127], v250 offset:43808
v_mfma_f32_16x16x32_bf16 v[40:43], a[132:135], a[92:95], v[40:43]
v_mfma_f32_16x16x32_bf16 v[48:51], a[128:131], a[96:99], v[48:51]
s_add_u32 s50, s16, 63672
v_mfma_f32_16x16x32_bf16 v[48:51], a[132:135], a[100:103], v[48:51]
buffer_load_dwordx4 v253, s[32:35], s50 offen offset:2120 lds
v_mfma_f32_16x16x32_bf16 v[56:59], a[128:131], a[104:107], v[56:59]
v_mfma_f32_16x16x32_bf16 v[56:59], a[132:135], a[108:111], v[56:59]
s_waitcnt lgkmcnt(4)
ds_read_b64_tr_b16 a[128:129], v250 offset:34312
v_mfma_f32_16x16x32_bf16 v[36:39], a[136:139], a[80:83], v[36:39]
ds_read_b64_tr_b16 a[130:131], v250 offset:35368
v_mfma_f32_16x16x32_bf16 v[36:39], a[140:143], a[84:87], v[36:39]
ds_read_b64_tr_b16 a[132:133], v250 offset:42760
v_mfma_f32_16x16x32_bf16 v[44:47], a[136:139], a[88:91], v[44:47]
s_add_u32 s50, s16, 95384
ds_read_b64_tr_b16 a[134:135], v250 offset:43816
v_mfma_f32_16x16x32_bf16 v[44:47], a[140:143], a[92:95], v[44:47]
buffer_load_dwordx4 v253, s[32:35], s50 offen offset:3176 lds
v_mfma_f32_16x16x32_bf16 v[52:55], a[136:139], a[96:99], v[52:55]
v_mfma_f32_16x16x32_bf16 v[52:55], a[140:143], a[100:103], v[52:55]
v_mfma_f32_16x16x32_bf16 v[60:63], a[136:139], a[104:107], v[60:63]
v_mfma_f32_16x16x32_bf16 v[60:63], a[140:143], a[108:111], v[60:63]
s_waitcnt lgkmcnt(4)
ds_read_b64_tr_b16 a[136:137], v251 offset:34304
v_mfma_f32_16x16x32_bf16 v[64:67], a[120:123], a[80:83], v[64:67]
s_bfe_u32 s17, s62, 0x40010
ds_read_b64_tr_b16 a[138:139], v251 offset:35360
v_mfma_f32_16x16x32_bf16 v[64:67], a[124:127], a[84:87], v[64:67]
s_lshl_b32 s17, s17, 7
ds_read_b64_tr_b16 a[140:141], v251 offset:42752
v_mfma_f32_16x16x32_bf16 v[72:75], a[120:123], a[88:91], v[72:75]
s_add_u32 s73, s51, s17
ds_read_b64_tr_b16 a[142:143], v251 offset:43808
v_mfma_f32_16x16x32_bf16 v[72:75], a[124:127], a[92:95], v[72:75]
s_add_u32 s14, s52, s17
v_mfma_f32_16x16x32_bf16 v[80:83], a[120:123], a[96:99], v[80:83]
s_add_u32 m0, s54, 0
v_mfma_f32_16x16x32_bf16 v[80:83], a[124:127], a[100:103], v[80:83]
s_add_u32 s50, s73, 0
v_mfma_f32_16x16x32_bf16 v[88:91], a[120:123], a[104:107], v[88:91]
buffer_load_dwordx4 v254, s[28:31], s50 offen offset:0 lds
v_mfma_f32_16x16x32_bf16 v[88:91], a[124:127], a[108:111], v[88:91]
v_mfma_f32_16x16x32_bf16 v[216:219], a[120:123], a[112:115], v[216:219]
v_mfma_f32_16x16x32_bf16 v[216:219], a[124:127], a[116:119], v[216:219]
s_waitcnt lgkmcnt(4)
ds_read_b64_tr_b16 a[120:121], v251 offset:34312
v_mfma_f32_16x16x32_bf16 v[68:71], a[128:131], a[80:83], v[68:71]
ds_read_b64_tr_b16 a[122:123], v251 offset:35368
v_mfma_f32_16x16x32_bf16 v[68:71], a[132:135], a[84:87], v[68:71]
s_add_u32 s50, s73, 3552
ds_read_b64_tr_b16 a[124:125], v251 offset:42760
v_mfma_f32_16x16x32_bf16 v[76:79], a[128:131], a[88:91], v[76:79]
ds_read_b64_tr_b16 a[126:127], v251 offset:43816
buffer_load_dwordx4 v254, s[28:31], s50 offen offset:1056 lds
v_mfma_f32_16x16x32_bf16 v[76:79], a[132:135], a[92:95], v[76:79]
v_mfma_f32_16x16x32_bf16 v[84:87], a[128:131], a[96:99], v[84:87]
v_mfma_f32_16x16x32_bf16 v[84:87], a[132:135], a[100:103], v[84:87]
v_mfma_f32_16x16x32_bf16 v[92:95], a[128:131], a[104:107], v[92:95]
v_mfma_f32_16x16x32_bf16 v[92:95], a[132:135], a[108:111], v[92:95]
s_add_u32 s50, s73, 16320
v_mfma_f32_16x16x32_bf16 v[220:223], a[128:131], a[112:115], v[220:223]
s_waitcnt vmcnt(20) lgkmcnt(0)
buffer_load_dwordx4 v254, s[28:31], s50 offen offset:2112 lds
v_mfma_f32_16x16x32_bf16 v[220:223], a[132:135], a[116:119], v[220:223]
s_barrier
v_mfma_f32_16x16x32_bf16 v[96:99], a[136:139], a[80:83], v[96:99]
ds_read_b64_tr_b16 a[128:129], v250 offset:50688
v_mfma_f32_16x16x32_bf16 v[96:99], a[140:143], a[84:87], v[96:99]
ds_read_b64_tr_b16 a[130:131], v250 offset:51744
v_mfma_f32_16x16x32_bf16 v[104:107], a[136:139], a[88:91], v[104:107]
ds_read_b64_tr_b16 a[132:133], v250 offset:59136
v_mfma_f32_16x16x32_bf16 v[104:107], a[140:143], a[92:95], v[104:107]
s_add_u32 s50, s73, 19872
ds_read_b64_tr_b16 a[134:135], v250 offset:60192
v_mfma_f32_16x16x32_bf16 v[112:115], a[136:139], a[96:99], v[112:115]
buffer_load_dwordx4 v254, s[28:31], s50 offen offset:3168 lds
v_mfma_f32_16x16x32_bf16 v[112:115], a[140:143], a[100:103], v[112:115]
v_mfma_f32_16x16x32_bf16 v[120:123], a[136:139], a[104:107], v[120:123]
v_mfma_f32_16x16x32_bf16 v[120:123], a[140:143], a[108:111], v[120:123]
ds_read_b64_tr_b16 a[136:137], v250 offset:50696
v_mfma_f32_16x16x32_bf16 v[100:103], a[120:123], a[80:83], v[100:103]
s_add_u32 m0, s54, 4224
ds_read_b64_tr_b16 a[138:139], v250 offset:51752
v_mfma_f32_16x16x32_bf16 v[100:103], a[124:127], a[84:87], v[100:103]
s_add_u32 s50, s73, 36864
ds_read_b64_tr_b16 a[140:141], v250 offset:59144
v_mfma_f32_16x16x32_bf16 v[108:111], a[120:123], a[88:91], v[108:111]
ds_read_b64_tr_b16 a[142:143], v250 offset:60200
buffer_load_dwordx4 v254, s[28:31], s50 offen offset:0 lds
v_mfma_f32_16x16x32_bf16 v[108:111], a[124:127], a[92:95], v[108:111]
v_mfma_f32_16x16x32_bf16 v[116:119], a[120:123], a[96:99], v[116:119]
v_mfma_f32_16x16x32_bf16 v[116:119], a[124:127], a[100:103], v[116:119]
v_mfma_f32_16x16x32_bf16 v[124:127], a[120:123], a[104:107], v[124:127]
v_mfma_f32_16x16x32_bf16 v[124:127], a[124:127], a[108:111], v[124:127]
s_waitcnt lgkmcnt(4)
ds_read_b64_tr_b16 a[120:121], v251 offset:50688
v_mfma_f32_16x16x32_bf16 v[128:131], a[128:131], a[80:83], v[128:131]
s_add_u32 s50, s73, 40416
ds_read_b64_tr_b16 a[122:123], v251 offset:51744
v_mfma_f32_16x16x32_bf16 v[128:131], a[132:135], a[84:87], v[128:131]
ds_read_b64_tr_b16 a[124:125], v251 offset:59136
buffer_load_dwordx4 v254, s[28:31], s50 offen offset:1056 lds
v_mfma_f32_16x16x32_bf16 v[136:139], a[128:131], a[88:91], v[136:139]
ds_read_b64_tr_b16 a[126:127], v251 offset:60192
v_mfma_f32_16x16x32_bf16 v[136:139], a[132:135], a[92:95], v[136:139]
v_mfma_f32_16x16x32_bf16 v[144:147], a[128:131], a[96:99], v[144:147]
v_mfma_f32_16x16x32_bf16 v[144:147], a[132:135], a[100:103], v[144:147]
v_mfma_f32_16x16x32_bf16 v[152:155], a[128:131], a[104:107], v[152:155]
s_add_u32 s50, s73, 53184
v_mfma_f32_16x16x32_bf16 v[152:155], a[132:135], a[108:111], v[152:155]
buffer_load_dwordx4 v254, s[28:31], s50 offen offset:2112 lds
v_mfma_f32_16x16x32_bf16 v[224:227], a[128:131], a[112:115], v[224:227]
v_mfma_f32_16x16x32_bf16 v[224:227], a[132:135], a[116:119], v[224:227]
s_waitcnt lgkmcnt(4)
ds_read_b64_tr_b16 a[128:129], v251 offset:50696
v_mfma_f32_16x16x32_bf16 v[132:135], a[136:139], a[80:83], v[132:135]
ds_read_b64_tr_b16 a[130:131], v251 offset:51752
v_mfma_f32_16x16x32_bf16 v[132:135], a[140:143], a[84:87], v[132:135]
ds_read_b64_tr_b16 a[132:133], v251 offset:59144
v_mfma_f32_16x16x32_bf16 v[140:143], a[136:139], a[88:91], v[140:143]
s_add_u32 s50, s73, 56736
ds_read_b64_tr_b16 a[134:135], v251 offset:60200
v_mfma_f32_16x16x32_bf16 v[140:143], a[140:143], a[92:95], v[140:143]
buffer_load_dwordx4 v254, s[28:31], s50 offen offset:3168 lds
v_mfma_f32_16x16x32_bf16 v[148:151], a[136:139], a[96:99], v[148:151]
v_mfma_f32_16x16x32_bf16 v[148:151], a[140:143], a[100:103], v[148:151]
v_mfma_f32_16x16x32_bf16 v[156:159], a[136:139], a[104:107], v[156:159]
v_mfma_f32_16x16x32_bf16 v[156:159], a[140:143], a[108:111], v[156:159]
s_add_u32 m0, s54, 8448
v_mfma_f32_16x16x32_bf16 v[228:231], a[136:139], a[112:115], v[228:231]
s_add_u32 s50, s14, 0
v_mfma_f32_16x16x32_bf16 v[228:231], a[140:143], a[116:119], v[228:231]
s_waitcnt lgkmcnt(4)
ds_read_b64_tr_b16 a[136:137], v250 offset:51200
buffer_load_dwordx4 v254, s[28:31], s50 offen offset:0 lds
v_mfma_f32_16x16x32_bf16 v[160:163], a[120:123], a[80:83], v[160:163]
ds_read_b64_tr_b16 a[138:139], v250 offset:52256
v_mfma_f32_16x16x32_bf16 v[160:163], a[124:127], a[84:87], v[160:163]
ds_read_b64_tr_b16 a[140:141], v250 offset:59648
v_mfma_f32_16x16x32_bf16 v[168:171], a[120:123], a[88:91], v[168:171]
ds_read_b64_tr_b16 a[142:143], v250 offset:60704
v_mfma_f32_16x16x32_bf16 v[168:171], a[124:127], a[92:95], v[168:171]
v_mfma_f32_16x16x32_bf16 v[176:179], a[120:123], a[96:99], v[176:179]
s_add_u32 s50, s14, 3552
v_mfma_f32_16x16x32_bf16 v[176:179], a[124:127], a[100:103], v[176:179]
buffer_load_dwordx4 v254, s[28:31], s50 offen offset:1056 lds
v_mfma_f32_16x16x32_bf16 v[184:187], a[120:123], a[104:107], v[184:187]
s_mov_b32 s8, s12
v_mfma_f32_16x16x32_bf16 v[184:187], a[124:127], a[108:111], v[184:187]
s_waitcnt lgkmcnt(4)
ds_read_b64_tr_b16 a[120:121], v250 offset:51208
v_mfma_f32_16x16x32_bf16 v[164:167], a[128:131], a[80:83], v[164:167]
s_waitcnt vmcnt(18)
ds_read_b64_tr_b16 a[122:123], v250 offset:52264
v_mfma_f32_16x16x32_bf16 v[164:167], a[132:135], a[84:87], v[164:167]
s_and_b32 s9, s13, 0xffff
ds_read_b64_tr_b16 a[124:125], v250 offset:59656
v_mfma_f32_16x16x32_bf16 v[172:175], a[128:131], a[88:91], v[172:175]
s_mov_b32 s10, 4718592
ds_read_b64_tr_b16 a[126:127], v250 offset:60712
v_mfma_f32_16x16x32_bf16 v[172:175], a[132:135], a[92:95], v[172:175]
s_mov_b32 s11, 0x20000
ds_read_b128 a[0:3], v252 offset:10560
v_mfma_f32_16x16x32_bf16 v[180:183], a[128:131], a[96:99], v[180:183]
s_mul_i32 s15, s15, 9216
ds_read_b128 a[4:7], v252 offset:11072
v_mfma_f32_16x16x32_bf16 v[180:183], a[132:135], a[100:103], v[180:183]
ds_read_b128 a[8:11], v252 offset:12672
buffer_load_dword a254, v249, s[8:11], s15 offen
v_mfma_f32_16x16x32_bf16 v[188:191], a[128:131], a[104:107], v[188:191]
s_add_u32 s15, s15, 1024
ds_read_b128 a[12:15], v252 offset:13184
v_mfma_f32_16x16x32_bf16 v[188:191], a[132:135], a[108:111], v[188:191]
s_waitcnt lgkmcnt(8)
ds_read_b64_tr_b16 a[128:129], v251 offset:51200
buffer_load_dword a254, v249, s[8:11], s15 offen
v_mfma_f32_16x16x32_bf16 v[192:195], a[136:139], a[80:83], v[192:195]
s_add_u32 s15, s15, 1024
ds_read_b64_tr_b16 a[130:131], v251 offset:52256
v_mfma_f32_16x16x32_bf16 v[192:195], a[140:143], a[84:87], v[192:195]
ds_read_b64_tr_b16 a[132:133], v251 offset:59648
buffer_load_dword a254, v249, s[8:11], s15 offen
v_mfma_f32_16x16x32_bf16 v[200:203], a[136:139], a[88:91], v[200:203]
ds_read_b64_tr_b16 a[134:135], v251 offset:60704
v_mfma_f32_16x16x32_bf16 v[200:203], a[140:143], a[92:95], v[200:203]
ds_read_b128 a[16:19], v252 offset:14784
v_mfma_f32_16x16x32_bf16 a[160:163], a[136:139], a[96:99], a[160:163]
ds_read_b128 a[20:23], v252 offset:15296
v_mfma_f32_16x16x32_bf16 a[160:163], a[140:143], a[100:103], a[160:163]
ds_read_b128 a[24:27], v252 offset:16896
v_mfma_f32_16x16x32_bf16 a[168:171], a[136:139], a[104:107], a[168:171]
ds_read_b128 a[28:31], v252 offset:17408
v_mfma_f32_16x16x32_bf16 a[168:171], a[140:143], a[108:111], a[168:171]
ds_read_b128 a[32:35], v252 offset:19008
v_mfma_f32_16x16x32_bf16 v[232:235], a[136:139], a[112:115], v[232:235]
ds_read_b128 a[36:39], v252 offset:19520
v_mfma_f32_16x16x32_bf16 v[232:235], a[140:143], a[116:119], v[232:235]
s_waitcnt lgkmcnt(14)
ds_read_b64_tr_b16 a[136:137], v251 offset:51208
v_mfma_f32_16x16x32_bf16 v[196:199], a[120:123], a[80:83], v[196:199]
ds_read_b64_tr_b16 a[138:139], v251 offset:52264
v_mfma_f32_16x16x32_bf16 v[196:199], a[124:127], a[84:87], v[196:199]
ds_read_b64_tr_b16 a[140:141], v251 offset:59656
v_mfma_f32_16x16x32_bf16 v[204:207], a[120:123], a[88:91], v[204:207]
ds_read_b64_tr_b16 a[142:143], v251 offset:60712
v_mfma_f32_16x16x32_bf16 v[204:207], a[124:127], a[92:95], v[204:207]
v_mfma_f32_16x16x32_bf16 a[164:167], a[120:123], a[96:99], a[164:167]
v_mfma_f32_16x16x32_bf16 a[164:167], a[124:127], a[100:103], a[164:167]
v_mfma_f32_16x16x32_bf16 a[172:175], a[120:123], a[104:107], a[172:175]
v_mfma_f32_16x16x32_bf16 a[172:175], a[124:127], a[108:111], a[172:175]
v_mfma_f32_16x16x32_bf16 v[236:239], a[120:123], a[112:115], v[236:239]
s_waitcnt vmcnt(17) lgkmcnt(0)
v_mfma_f32_16x16x32_bf16 v[236:239], a[124:127], a[116:119], v[236:239]
s_barrier
v_mfma_f32_16x16x32_bf16 a[176:179], a[128:131], a[80:83], a[176:179]
ds_read_b64_tr_b16 a[120:121], v250 offset:0
v_mfma_f32_16x16x32_bf16 a[176:179], a[132:135], a[84:87], a[176:179]
ds_read_b64_tr_b16 a[122:123], v250 offset:1056
v_mfma_f32_16x16x32_bf16 a[184:187], a[128:131], a[88:91], a[184:187]
ds_read_b64_tr_b16 a[124:125], v250 offset:8448
v_mfma_f32_16x16x32_bf16 a[184:187], a[132:135], a[92:95], a[184:187]
ds_read_b64_tr_b16 a[126:127], v250 offset:9504
v_mfma_f32_16x16x32_bf16 a[192:195], a[128:131], a[96:99], a[192:195]
v_mfma_f32_16x16x32_bf16 a[192:195], a[132:135], a[100:103], a[192:195]
v_mfma_f32_16x16x32_bf16 a[200:203], a[128:131], a[104:107], a[200:203]
v_mfma_f32_16x16x32_bf16 a[200:203], a[132:135], a[108:111], a[200:203]
ds_read_b64_tr_b16 a[128:129], v250 offset:8
v_mfma_f32_16x16x32_bf16 a[180:183], a[136:139], a[80:83], a[180:183]
ds_read_b64_tr_b16 a[130:131], v250 offset:1064
v_mfma_f32_16x16x32_bf16 a[180:183], a[140:143], a[84:87], a[180:183]
ds_read_b64_tr_b16 a[132:133], v250 offset:8456
v_mfma_f32_16x16x32_bf16 a[188:191], a[136:139], a[88:91], a[188:191]
ds_read_b64_tr_b16 a[134:135], v250 offset:9512
v_mfma_f32_16x16x32_bf16 a[188:191], a[140:143], a[92:95], a[188:191]
v_mfma_f32_16x16x32_bf16 a[196:199], a[136:139], a[96:99], a[196:199]
v_mfma_f32_16x16x32_bf16 a[196:199], a[140:143], a[100:103], a[196:199]
v_mfma_f32_16x16x32_bf16 a[204:207], a[136:139], a[104:107], a[204:207]
v_mfma_f32_16x16x32_bf16 a[204:207], a[140:143], a[108:111], a[204:207]
s_waitcnt lgkmcnt(4)
ds_read_b64_tr_b16 a[136:137], v251 offset:0
v_mfma_f32_16x16x32_bf16 v[0:3], a[120:123], a[0:3], v[0:3]
ds_read_b64_tr_b16 a[138:139], v251 offset:1056
v_mfma_f32_16x16x32_bf16 v[0:3], a[124:127], a[4:7], v[0:3]
ds_read_b64_tr_b16 a[140:141], v251 offset:8448
v_mfma_f32_16x16x32_bf16 v[8:11], a[120:123], a[8:11], v[8:11]
ds_read_b64_tr_b16 a[142:143], v251 offset:9504
v_mfma_f32_16x16x32_bf16 v[8:11], a[124:127], a[12:15], v[8:11]
v_mfma_f32_16x16x32_bf16 v[16:19], a[120:123], a[16:19], v[16:19]
v_mfma_f32_16x16x32_bf16 v[16:19], a[124:127], a[20:23], v[16:19]
v_mfma_f32_16x16x32_bf16 v[24:27], a[120:123], a[24:27], v[24:27]
v_mfma_f32_16x16x32_bf16 v[24:27], a[124:127], a[28:31], v[24:27]
v_mfma_f32_16x16x32_bf16 v[208:211], a[120:123], a[32:35], v[208:211]
v_mfma_f32_16x16x32_bf16 v[208:211], a[124:127], a[36:39], v[208:211]
s_waitcnt lgkmcnt(4)
ds_read_b64_tr_b16 a[120:121], v251 offset:8
v_mfma_f32_16x16x32_bf16 v[4:7], a[128:131], a[0:3], v[4:7]
ds_read_b64_tr_b16 a[122:123], v251 offset:1064
v_mfma_f32_16x16x32_bf16 v[4:7], a[132:135], a[4:7], v[4:7]
ds_read_b64_tr_b16 a[124:125], v251 offset:8456
v_mfma_f32_16x16x32_bf16 v[12:15], a[128:131], a[8:11], v[12:15]
ds_read_b64_tr_b16 a[126:127], v251 offset:9512
v_mfma_f32_16x16x32_bf16 v[12:15], a[132:135], a[12:15], v[12:15]
v_mfma_f32_16x16x32_bf16 v[20:23], a[128:131], a[16:19], v[20:23]
v_mfma_f32_16x16x32_bf16 v[20:23], a[132:135], a[20:23], v[20:23]
s_bfe_u32 s17, s62, 0x40010
v_mfma_f32_16x16x32_bf16 v[28:31], a[128:131], a[24:27], v[28:31]
s_lshl_b32 s17, s17, 19
v_mfma_f32_16x16x32_bf16 v[28:31], a[132:135], a[28:31], v[28:31]
s_add_u32 s16, s53, s17
v_mfma_f32_16x16x32_bf16 v[212:215], a[128:131], a[32:35], v[212:215]
s_add_u32 m0, s55, 33792
v_mfma_f32_16x16x32_bf16 v[212:215], a[132:135], a[36:39], v[212:215]
s_waitcnt lgkmcnt(4)
ds_read_b64_tr_b16 a[128:129], v250 offset:512
v_mfma_f32_16x16x32_bf16 v[32:35], a[136:139], a[0:3], v[32:35]
s_add_u32 s50, s16, 0
ds_read_b64_tr_b16 a[130:131], v250 offset:1568
v_mfma_f32_16x16x32_bf16 v[32:35], a[140:143], a[4:7], v[32:35]
ds_read_b64_tr_b16 a[132:133], v250 offset:8960
buffer_load_dwordx4 v253, s[32:35], s50 offen offset:0 lds
v_mfma_f32_16x16x32_bf16 v[40:43], a[136:139], a[8:11], v[40:43]
ds_read_b64_tr_b16 a[134:135], v250 offset:10016
v_mfma_f32_16x16x32_bf16 v[40:43], a[140:143], a[12:15], v[40:43]
v_mfma_f32_16x16x32_bf16 v[48:51], a[136:139], a[16:19], v[48:51]
v_mfma_f32_16x16x32_bf16 v[48:51], a[140:143], a[20:23], v[48:51]
v_mfma_f32_16x16x32_bf16 v[56:59], a[136:139], a[24:27], v[56:59]
s_add_u32 s50, s16, 31712
v_mfma_f32_16x16x32_bf16 v[56:59], a[140:143], a[28:31], v[56:59]
s_waitcnt lgkmcnt(4)
ds_read_b64_tr_b16 a[136:137], v250 offset:520
buffer_load_dwordx4 v253, s[32:35], s50 offen offset:1056 lds
v_mfma_f32_16x16x32_bf16 v[36:39], a[120:123], a[0:3], v[36:39]
ds_read_b64_tr_b16 a[138:139], v250 offset:1576
v_mfma_f32_16x16x32_bf16 v[36:39], a[124:127], a[4:7], v[36:39]
ds_read_b64_tr_b16 a[140:141], v250 offset:8968
v_mfma_f32_16x16x32_bf16 v[44:47], a[120:123], a[8:11], v[44:47]
ds_read_b64_tr_b16 a[142:143], v250 offset:10024
v_mfma_f32_16x16x32_bf16 v[44:47], a[124:127], a[12:15], v[44:47]
v_mfma_f32_16x16x32_bf16 v[52:55], a[120:123], a[16:19], v[52:55]
s_add_u32 s50, s16, 63416
v_mfma_f32_16x16x32_bf16 v[52:55], a[124:127], a[20:23], v[52:55]
buffer_load_dwordx4 v253, s[32:35], s50 offen offset:2120 lds
v_mfma_f32_16x16x32_bf16 v[60:63], a[120:123], a[24:27], v[60:63]
v_mfma_f32_16x16x32_bf16 v[60:63], a[124:127], a[28:31], v[60:63]
s_waitcnt lgkmcnt(4)
ds_read_b64_tr_b16 a[120:121], v251 offset:512
v_mfma_f32_16x16x32_bf16 v[64:67], a[128:131], a[0:3], v[64:67]
ds_read_b64_tr_b16 a[122:123], v251 offset:1568
v_mfma_f32_16x16x32_bf16 v[64:67], a[132:135], a[4:7], v[64:67]
ds_read_b64_tr_b16 a[124:125], v251 offset:8960
v_mfma_f32_16x16x32_bf16 v[72:75], a[128:131], a[8:11], v[72:75]
s_add_u32 s50, s16, 95128
ds_read_b64_tr_b16 a[126:127], v251 offset:10016
v_mfma_f32_16x16x32_bf16 v[72:75], a[132:135], a[12:15], v[72:75]
buffer_load_dwordx4 v253, s[32:35], s50 offen offset:3176 lds
v_mfma_f32_16x16x32_bf16 v[80:83], a[128:131], a[16:19], v[80:83]
v_mfma_f32_16x16x32_bf16 v[80:83], a[132:135], a[20:23], v[80:83]
v_mfma_f32_16x16x32_bf16 v[88:91], a[128:131], a[24:27], v[88:91]
v_mfma_f32_16x16x32_bf16 v[88:91], a[132:135], a[28:31], v[88:91]
s_add_u32 m0, s55, 50688
v_mfma_f32_16x16x32_bf16 v[216:219], a[128:131], a[32:35], v[216:219]
s_add_u32 s50, s16, 256
v_mfma_f32_16x16x32_bf16 v[216:219], a[132:135], a[36:39], v[216:219]
s_waitcnt lgkmcnt(4)
ds_read_b64_tr_b16 a[128:129], v251 offset:520
buffer_load_dwordx4 v253, s[32:35], s50 offen offset:0 lds
v_mfma_f32_16x16x32_bf16 v[68:71], a[136:139], a[0:3], v[68:71]
ds_read_b64_tr_b16 a[130:131], v251 offset:1576
v_mfma_f32_16x16x32_bf16 v[68:71], a[140:143], a[4:7], v[68:71]
ds_read_b64_tr_b16 a[132:133], v251 offset:8968
v_mfma_f32_16x16x32_bf16 v[76:79], a[136:139], a[8:11], v[76:79]
ds_read_b64_tr_b16 a[134:135], v251 offset:10024
v_mfma_f32_16x16x32_bf16 v[76:79], a[140:143], a[12:15], v[76:79]
v_mfma_f32_16x16x32_bf16 v[84:87], a[136:139], a[16:19], v[84:87]
s_add_u32 s50, s16, 31968
v_mfma_f32_16x16x32_bf16 v[84:87], a[140:143], a[20:23], v[84:87]
buffer_load_dwordx4 v253, s[32:35], s50 offen offset:1056 lds
v_mfma_f32_16x16x32_bf16 v[92:95], a[136:139], a[24:27], v[92:95]
v_mfma_f32_16x16x32_bf16 v[92:95], a[140:143], a[28:31], v[92:95]
v_mfma_f32_16x16x32_bf16 v[220:223], a[136:139], a[32:35], v[220:223]
s_waitcnt vmcnt(19) lgkmcnt(0)
v_mfma_f32_16x16x32_bf16 v[220:223], a[140:143], a[36:39], v[220:223]
s_barrier
v_mfma_f32_16x16x32_bf16 v[96:99], a[120:123], a[0:3], v[96:99]
s_add_u32 s50, s16, 63672
ds_read_b64_tr_b16 a[136:137], v250 offset:16896
v_mfma_f32_16x16x32_bf16 v[96:99], a[124:127], a[4:7], v[96:99]
ds_read_b64_tr_b16 a[138:139], v250 offset:17952
buffer_load_dwordx4 v253, s[32:35], s50 offen offset:2120 lds
v_mfma_f32_16x16x32_bf16 v[104:107], a[120:123], a[8:11], v[104:107]
ds_read_b64_tr_b16 a[140:141], v250 offset:25344
v_mfma_f32_16x16x32_bf16 v[104:107], a[124:127], a[12:15], v[104:107]
ds_read_b64_tr_b16 a[142:143], v250 offset:26400
v_mfma_f32_16x16x32_bf16 v[112:115], a[120:123], a[16:19], v[112:115]
v_mfma_f32_16x16x32_bf16 v[112:115], a[124:127], a[20:23], v[112:115]
v_mfma_f32_16x16x32_bf16 v[120:123], a[120:123], a[24:27], v[120:123]
s_add_u32 s50, s16, 95384
v_mfma_f32_16x16x32_bf16 v[120:123], a[124:127], a[28:31], v[120:123]
ds_read_b64_tr_b16 a[120:121], v250 offset:16904
buffer_load_dwordx4 v253, s[32:35], s50 offen offset:3176 lds
v_mfma_f32_16x16x32_bf16 v[100:103], a[128:131], a[0:3], v[100:103]
ds_read_b64_tr_b16 a[122:123], v250 offset:17960
v_mfma_f32_16x16x32_bf16 v[100:103], a[132:135], a[4:7], v[100:103]
ds_read_b64_tr_b16 a[124:125], v250 offset:25352
v_mfma_f32_16x16x32_bf16 v[108:111], a[128:131], a[8:11], v[108:111]
ds_read_b64_tr_b16 a[126:127], v250 offset:26408
v_mfma_f32_16x16x32_bf16 v[108:111], a[132:135], a[12:15], v[108:111]
s_bfe_u32 s17, s62, 0x40014
v_mfma_f32_16x16x32_bf16 v[116:119], a[128:131], a[16:19], v[116:119]
s_lshl_b32 s17, s17, 7
v_mfma_f32_16x16x32_bf16 v[116:119], a[132:135], a[20:23], v[116:119]
s_add_u32 s73, s51, s17
v_mfma_f32_16x16x32_bf16 v[124:127], a[128:131], a[24:27], v[124:127]
s_add_u32 s14, s52, s17
v_mfma_f32_16x16x32_bf16 v[124:127], a[132:135], a[28:31], v[124:127]
s_waitcnt lgkmcnt(4)
ds_read_b64_tr_b16 a[128:129], v251 offset:16896
v_mfma_f32_16x16x32_bf16 v[128:131], a[136:139], a[0:3], v[128:131]
s_add_u32 m0, s54, 10560
ds_read_b64_tr_b16 a[130:131], v251 offset:17952
v_mfma_f32_16x16x32_bf16 v[128:131], a[140:143], a[4:7], v[128:131]
s_add_u32 s50, s73, 0
ds_read_b64_tr_b16 a[132:133], v251 offset:25344
v_mfma_f32_16x16x32_bf16 v[136:139], a[136:139], a[8:11], v[136:139]
ds_read_b64_tr_b16 a[134:135], v251 offset:26400
buffer_load_dwordx4 v254, s[28:31], s50 offen offset:0 lds
v_mfma_f32_16x16x32_bf16 v[136:139], a[140:143], a[12:15], v[136:139]
v_mfma_f32_16x16x32_bf16 v[144:147], a[136:139], a[16:19], v[144:147]
v_mfma_f32_16x16x32_bf16 v[144:147], a[140:143], a[20:23], v[144:147]
v_mfma_f32_16x16x32_bf16 v[152:155], a[136:139], a[24:27], v[152:155]
v_mfma_f32_16x16x32_bf16 v[152:155], a[140:143], a[28:31], v[152:155]
s_add_u32 s50, s73, 3552
v_mfma_f32_16x16x32_bf16 v[224:227], a[136:139], a[32:35], v[224:227]
buffer_load_dwordx4 v254, s[28:31], s50 offen offset:1056 lds
v_mfma_f32_16x16x32_bf16 v[224:227], a[140:143], a[36:39], v[224:227]
s_waitcnt lgkmcnt(4)
ds_read_b64_tr_b16 a[136:137], v251 offset:16904
v_mfma_f32_16x16x32_bf16 v[132:135], a[120:123], a[0:3], v[132:135]
ds_read_b64_tr_b16 a[138:139], v251 offset:17960
v_mfma_f32_16x16x32_bf16 v[132:135], a[124:127], a[4:7], v[132:135]
ds_read_b64_tr_b16 a[140:141], v251 offset:25352
v_mfma_f32_16x16x32_bf16 v[140:143], a[120:123], a[8:11], v[140:143]
ds_read_b64_tr_b16 a[142:143], v251 offset:26408
v_mfma_f32_16x16x32_bf16 v[140:143], a[124:127], a[12:15], v[140:143]
s_add_u32 s50, s73, 16320
v_mfma_f32_16x16x32_bf16 v[148:151], a[120:123], a[16:19], v[148:151]
buffer_load_dwordx4 v254, s[28:31], s50 offen offset:2112 lds
v_mfma_f32_16x16x32_bf16 v[148:151], a[124:127], a[20:23], v[148:151]
v_mfma_f32_16x16x32_bf16 v[156:159], a[120:123], a[24:27], v[156:159]
v_mfma_f32_16x16x32_bf16 v[156:159], a[124:127], a[28:31], v[156:159]
v_mfma_f32_16x16x32_bf16 v[228:231], a[120:123], a[32:35], v[228:231]
v_mfma_f32_16x16x32_bf16 v[228:231], a[124:127], a[36:39], v[228:231]
s_waitcnt lgkmcnt(4)
ds_read_b64_tr_b16 a[120:121], v250 offset:17408
v_mfma_f32_16x16x32_bf16 v[160:163], a[128:131], a[0:3], v[160:163]
s_add_u32 s50, s73, 19872
ds_read_b64_tr_b16 a[122:123], v250 offset:18464
v_mfma_f32_16x16x32_bf16 v[160:163], a[132:135], a[4:7], v[160:163]
ds_read_b64_tr_b16 a[124:125], v250 offset:25856
buffer_load_dwordx4 v254, s[28:31], s50 offen offset:3168 lds
v_mfma_f32_16x16x32_bf16 v[168:171], a[128:131], a[8:11], v[168:171]
ds_read_b64_tr_b16 a[126:127], v250 offset:26912
v_mfma_f32_16x16x32_bf16 v[168:171], a[132:135], a[12:15], v[168:171]
v_mfma_f32_16x16x32_bf16 v[176:179], a[128:131], a[16:19], v[176:179]
v_mfma_f32_16x16x32_bf16 v[176:179], a[132:135], a[20:23], v[176:179]
s_add_u32 m0, s54, 14784
v_mfma_f32_16x16x32_bf16 v[184:187], a[128:131], a[24:27], v[184:187]
s_add_u32 s50, s73, 36864
v_mfma_f32_16x16x32_bf16 v[184:187], a[132:135], a[28:31], v[184:187]
s_waitcnt lgkmcnt(4)
ds_read_b64_tr_b16 a[128:129], v250 offset:17416
buffer_load_dwordx4 v254, s[28:31], s50 offen offset:0 lds
v_mfma_f32_16x16x32_bf16 v[164:167], a[136:139], a[0:3], v[164:167]
s_waitcnt vmcnt(16)
ds_read_b64_tr_b16 a[130:131], v250 offset:18472
v_mfma_f32_16x16x32_bf16 v[164:167], a[140:143], a[4:7], v[164:167]
ds_read_b64_tr_b16 a[132:133], v250 offset:25864
v_mfma_f32_16x16x32_bf16 v[172:175], a[136:139], a[8:11], v[172:175]
ds_read_b64_tr_b16 a[134:135], v250 offset:26920
v_mfma_f32_16x16x32_bf16 v[172:175], a[140:143], a[12:15], v[172:175]
ds_read_b128 a[80:83], v252 offset:0
v_mfma_f32_16x16x32_bf16 v[180:183], a[136:139], a[16:19], v[180:183]
s_add_u32 s50, s73, 40416
ds_read_b128 a[84:87], v252 offset:512
v_mfma_f32_16x16x32_bf16 v[180:183], a[140:143], a[20:23], v[180:183]
ds_read_b128 a[88:91], v252 offset:2112
buffer_load_dwordx4 v254, s[28:31], s50 offen offset:1056 lds
v_mfma_f32_16x16x32_bf16 v[188:191], a[136:139], a[24:27], v[188:191]
ds_read_b128 a[92:95], v252 offset:2624
v_mfma_f32_16x16x32_bf16 v[188:191], a[140:143], a[28:31], v[188:191]
s_waitcnt lgkmcnt(8)
ds_read_b64_tr_b16 a[136:137], v251 offset:17408
v_mfma_f32_16x16x32_bf16 v[192:195], a[120:123], a[0:3], v[192:195]
ds_read_b64_tr_b16 a[138:139], v251 offset:18464
v_mfma_f32_16x16x32_bf16 v[192:195], a[124:127], a[4:7], v[192:195]
ds_read_b64_tr_b16 a[140:141], v251 offset:25856
v_mfma_f32_16x16x32_bf16 v[200:203], a[120:123], a[8:11], v[200:203]
s_add_u32 s50, s73, 53184
ds_read_b64_tr_b16 a[142:143], v251 offset:26912
v_mfma_f32_16x16x32_bf16 v[200:203], a[124:127], a[12:15], v[200:203]
ds_read_b128 a[96:99], v252 offset:4224
buffer_load_dwordx4 v254, s[28:31], s50 offen offset:2112 lds
v_mfma_f32_16x16x32_bf16 a[160:163], a[120:123], a[16:19], a[160:163]
ds_read_b128 a[100:103], v252 offset:4736
v_mfma_f32_16x16x32_bf16 a[160:163], a[124:127], a[20:23], a[160:163]
ds_read_b128 a[104:107], v252 offset:6336
v_mfma_f32_16x16x32_bf16 a[168:171], a[120:123], a[24:27], a[168:171]
ds_read_b128 a[108:111], v252 offset:6848
v_mfma_f32_16x16x32_bf16 a[168:171], a[124:127], a[28:31], a[168:171]
ds_read_b128 a[112:115], v252 offset:8448
v_mfma_f32_16x16x32_bf16 v[232:235], a[120:123], a[32:35], v[232:235]
s_add_u32 s50, s73, 56736
ds_read_b128 a[116:119], v252 offset:8960
v_mfma_f32_16x16x32_bf16 v[232:235], a[124:127], a[36:39], v[232:235]
s_waitcnt lgkmcnt(14)
ds_read_b64_tr_b16 a[120:121], v251 offset:17416
buffer_load_dwordx4 v254, s[28:31], s50 offen offset:3168 lds
v_mfma_f32_16x16x32_bf16 v[196:199], a[128:131], a[0:3], v[196:199]
ds_read_b64_tr_b16 a[122:123], v251 offset:18472
v_mfma_f32_16x16x32_bf16 v[196:199], a[132:135], a[4:7], v[196:199]
ds_read_b64_tr_b16 a[124:125], v251 offset:25864
v_mfma_f32_16x16x32_bf16 v[204:207], a[128:131], a[8:11], v[204:207]
ds_read_b64_tr_b16 a[126:127], v251 offset:26920
v_mfma_f32_16x16x32_bf16 v[204:207], a[132:135], a[12:15], v[204:207]
s_add_u32 m0, s54, 19008
v_mfma_f32_16x16x32_bf16 a[164:167], a[128:131], a[16:19], a[164:167]
s_add_u32 s50, s14, 0
v_mfma_f32_16x16x32_bf16 a[164:167], a[132:135], a[20:23], a[164:167]
buffer_load_dwordx4 v254, s[28:31], s50 offen offset:0 lds
v_mfma_f32_16x16x32_bf16 a[172:175], a[128:131], a[24:27], a[172:175]
v_mfma_f32_16x16x32_bf16 a[172:175], a[132:135], a[28:31], a[172:175]
v_mfma_f32_16x16x32_bf16 v[236:239], a[128:131], a[32:35], v[236:239]
s_waitcnt vmcnt(13) lgkmcnt(0)
v_mfma_f32_16x16x32_bf16 v[236:239], a[132:135], a[36:39], v[236:239]
s_barrier
v_mfma_f32_16x16x32_bf16 a[176:179], a[136:139], a[0:3], a[176:179]
s_add_u32 s50, s14, 3552
ds_read_b64_tr_b16 a[128:129], v250 offset:33792
v_mfma_f32_16x16x32_bf16 a[176:179], a[140:143], a[4:7], a[176:179]
ds_read_b64_tr_b16 a[130:131], v250 offset:34848
buffer_load_dwordx4 v254, s[28:31], s50 offen offset:1056 lds
v_mfma_f32_16x16x32_bf16 a[184:187], a[136:139], a[8:11], a[184:187]
ds_read_b64_tr_b16 a[132:133], v250 offset:42240
v_mfma_f32_16x16x32_bf16 a[184:187], a[140:143], a[12:15], a[184:187]
ds_read_b64_tr_b16 a[134:135], v250 offset:43296
v_mfma_f32_16x16x32_bf16 a[192:195], a[136:139], a[16:19], a[192:195]
v_mfma_f32_16x16x32_bf16 a[192:195], a[140:143], a[20:23], a[192:195]
s_bfe_u32 s17, s62, 0x40014
v_mfma_f32_16x16x32_bf16 a[200:203], a[136:139], a[24:27], a[200:203]
s_lshl_b32 s17, s17, 19
v_mfma_f32_16x16x32_bf16 a[200:203], a[140:143], a[28:31], a[200:203]
s_add_u32 s16, s53, s17
ds_read_b64_tr_b16 a[136:137], v250 offset:33800
v_mfma_f32_16x16x32_bf16 a[180:183], a[120:123], a[0:3], a[180:183]
s_add_u32 m0, s55, 0
ds_read_b64_tr_b16 a[138:139], v250 offset:34856
v_mfma_f32_16x16x32_bf16 a[180:183], a[124:127], a[4:7], a[180:183]
s_add_u32 s50, s16, 0
ds_read_b64_tr_b16 a[140:141], v250 offset:42248
v_mfma_f32_16x16x32_bf16 a[188:191], a[120:123], a[8:11], a[188:191]
ds_read_b64_tr_b16 a[142:143], v250 offset:43304
buffer_load_dwordx4 v253, s[32:35], s50 offen offset:0 lds
v_mfma_f32_16x16x32_bf16 a[188:191], a[124:127], a[12:15], a[188:191]
v_mfma_f32_16x16x32_bf16 a[196:199], a[120:123], a[16:19], a[196:199]
v_mfma_f32_16x16x32_bf16 a[196:199], a[124:127], a[20:23], a[196:199]
v_mfma_f32_16x16x32_bf16 a[204:207], a[120:123], a[24:27], a[204:207]
v_mfma_f32_16x16x32_bf16 a[204:207], a[124:127], a[28:31], a[204:207]
s_waitcnt lgkmcnt(4)
ds_read_b64_tr_b16 a[120:121], v251 offset:33792
v_mfma_f32_16x16x32_bf16 v[0:3], a[128:131], a[80:83], v[0:3]
s_add_u32 s50, s16, 31712
ds_read_b64_tr_b16 a[122:123], v251 offset:34848
v_mfma_f32_16x16x32_bf16 v[0:3], a[132:135], a[84:87], v[0:3]
ds_read_b64_tr_b16 a[124:125], v251 offset:42240
buffer_load_dwordx4 v253, s[32:35], s50 offen offset:1056 lds
v_mfma_f32_16x16x32_bf16 v[8:11], a[128:131], a[88:91], v[8:11]
ds_read_b64_tr_b16 a[126:127], v251 offset:43296
v_mfma_f32_16x16x32_bf16 v[8:11], a[132:135], a[92:95], v[8:11]
v_mfma_f32_16x16x32_bf16 v[16:19], a[128:131], a[96:99], v[16:19]
v_mfma_f32_16x16x32_bf16 v[16:19], a[132:135], a[100:103], v[16:19]
v_mfma_f32_16x16x32_bf16 v[24:27], a[128:131], a[104:107], v[24:27]
s_add_u32 s50, s16, 63416
v_mfma_f32_16x16x32_bf16 v[24:27], a[132:135], a[108:111], v[24:27]
buffer_load_dwordx4 v253, s[32:35], s50 offen offset:2120 lds
v_mfma_f32_16x16x32_bf16 v[208:211], a[128:131], a[112:115], v[208:211]
v_mfma_f32_16x16x32_bf16 v[208:211], a[132:135], a[116:119], v[208:211]
s_waitcnt lgkmcnt(4)
ds_read_b64_tr_b16 a[128:129], v251 offset:33800
v_mfma_f32_16x16x32_bf16 v[4:7], a[136:139], a[80:83], v[4:7]
ds_read_b64_tr_b16 a[130:131], v251 offset:34856
v_mfma_f32_16x16x32_bf16 v[4:7], a[140:143], a[84:87], v[4:7]
ds_read_b64_tr_b16 a[132:133], v251 offset:42248
v_mfma_f32_16x16x32_bf16 v[12:15], a[136:139], a[88:91], v[12:15]
s_add_u32 s50, s16, 95128
ds_read_b64_tr_b16 a[134:135], v251 offset:43304
v_mfma_f32_16x16x32_bf16 v[12:15], a[140:143], a[92:95], v[12:15]
buffer_load_dwordx4 v253, s[32:35], s50 offen offset:3176 lds
v_mfma_f32_16x16x32_bf16 v[20:23], a[136:139], a[96:99], v[20:23]
v_mfma_f32_16x16x32_bf16 v[20:23], a[140:143], a[100:103], v[20:23]
v_mfma_f32_16x16x32_bf16 v[28:31], a[136:139], a[104:107], v[28:31]
v_mfma_f32_16x16x32_bf16 v[28:31], a[140:143], a[108:111], v[28:31]
s_add_u32 m0, s55, 16896
v_mfma_f32_16x16x32_bf16 v[212:215], a[136:139], a[112:115], v[212:215]
s_add_u32 s50, s16, 256
v_mfma_f32_16x16x32_bf16 v[212:215], a[140:143], a[116:119], v[212:215]
s_waitcnt lgkmcnt(4)
ds_read_b64_tr_b16 a[136:137], v250 offset:34304
buffer_load_dwordx4 v253, s[32:35], s50 offen offset:0 lds
v_mfma_f32_16x16x32_bf16 v[32:35], a[120:123], a[80:83], v[32:35]
ds_read_b64_tr_b16 a[138:139], v250 offset:35360
v_mfma_f32_16x16x32_bf16 v[32:35], a[124:127], a[84:87], v[32:35]
ds_read_b64_tr_b16 a[140:141], v250 offset:42752
v_mfma_f32_16x16x32_bf16 v[40:43], a[120:123], a[88:91], v[40:43]
ds_read_b64_tr_b16 a[142:143], v250 offset:43808
v_mfma_f32_16x16x32_bf16 v[40:43], a[124:127], a[92:95], v[40:43]
v_mfma_f32_16x16x32_bf16 v[48:51], a[120:123], a[96:99], v[48:51]
s_add_u32 s50, s16, 31968
v_mfma_f32_16x16x32_bf16 v[48:51], a[124:127], a[100:103], v[48:51]
buffer_load_dwordx4 v253, s[32:35], s50 offen offset:1056 lds
v_mfma_f32_16x16x32_bf16 v[56:59], a[120:123], a[104:107], v[56:59]
v_mfma_f32_16x16x32_bf16 v[56:59], a[124:127], a[108:111], v[56:59]
s_waitcnt lgkmcnt(4)
ds_read_b64_tr_b16 a[120:121], v250 offset:34312
v_mfma_f32_16x16x32_bf16 v[36:39], a[128:131], a[80:83], v[36:39]
ds_read_b64_tr_b16 a[122:123], v250 offset:35368
v_mfma_f32_16x16x32_bf16 v[36:39], a[132:135], a[84:87], v[36:39]
ds_read_b64_tr_b16 a[124:125], v250 offset:42760
v_mfma_f32_16x16x32_bf16 v[44:47], a[128:131], a[88:91], v[44:47]
s_add_u32 s50, s16, 63672
ds_read_b64_tr_b16 a[126:127], v250 offset:43816
v_mfma_f32_16x16x32_bf16 v[44:47], a[132:135], a[92:95], v[44:47]
buffer_load_dwordx4 v253, s[32:35], s50 offen offset:2120 lds
v_mfma_f32_16x16x32_bf16 v[52:55], a[128:131], a[96:99], v[52:55]
v_mfma_f32_16x16x32_bf16 v[52:55], a[132:135], a[100:103], v[52:55]
v_mfma_f32_16x16x32_bf16 v[60:63], a[128:131], a[104:107], v[60:63]
v_mfma_f32_16x16x32_bf16 v[60:63], a[132:135], a[108:111], v[60:63]
s_waitcnt lgkmcnt(4)
ds_read_b64_tr_b16 a[128:129], v251 offset:34304
v_mfma_f32_16x16x32_bf16 v[64:67], a[136:139], a[80:83], v[64:67]
s_add_u32 s50, s16, 95384
ds_read_b64_tr_b16 a[130:131], v251 offset:35360
v_mfma_f32_16x16x32_bf16 v[64:67], a[140:143], a[84:87], v[64:67]
ds_read_b64_tr_b16 a[132:133], v251 offset:42752
buffer_load_dwordx4 v253, s[32:35], s50 offen offset:3176 lds
v_mfma_f32_16x16x32_bf16 v[72:75], a[136:139], a[88:91], v[72:75]
ds_read_b64_tr_b16 a[134:135], v251 offset:43808
v_mfma_f32_16x16x32_bf16 v[72:75], a[140:143], a[92:95], v[72:75]
v_mfma_f32_16x16x32_bf16 v[80:83], a[136:139], a[96:99], v[80:83]
v_mfma_f32_16x16x32_bf16 v[80:83], a[140:143], a[100:103], v[80:83]
s_bfe_u32 s17, s62, 0x40018
v_mfma_f32_16x16x32_bf16 v[88:91], a[136:139], a[104:107], v[88:91]
s_lshl_b32 s17, s17, 7
v_mfma_f32_16x16x32_bf16 v[88:91], a[140:143], a[108:111], v[88:91]
s_add_u32 s73, s51, s17
v_mfma_f32_16x16x32_bf16 v[216:219], a[136:139], a[112:115], v[216:219]
s_add_u32 s14, s52, s17
v_mfma_f32_16x16x32_bf16 v[216:219], a[140:143], a[116:119], v[216:219]
s_waitcnt lgkmcnt(4)
ds_read_b64_tr_b16 a[136:137], v251 offset:34312
v_mfma_f32_16x16x32_bf16 v[68:71], a[120:123], a[80:83], v[68:71]
s_add_u32 m0, s54, 0
ds_read_b64_tr_b16 a[138:139], v251 offset:35368
v_mfma_f32_16x16x32_bf16 v[68:71], a[124:127], a[84:87], v[68:71]
s_add_u32 s50, s73, 0
ds_read_b64_tr_b16 a[140:141], v251 offset:42760
v_mfma_f32_16x16x32_bf16 v[76:79], a[120:123], a[88:91], v[76:79]
ds_read_b64_tr_b16 a[142:143], v251 offset:43816
buffer_load_dwordx4 v254, s[28:31], s50 offen offset:0 lds
v_mfma_f32_16x16x32_bf16 v[76:79], a[124:127], a[92:95], v[76:79]
v_mfma_f32_16x16x32_bf16 v[84:87], a[120:123], a[96:99], v[84:87]
v_mfma_f32_16x16x32_bf16 v[84:87], a[124:127], a[100:103], v[84:87]
v_mfma_f32_16x16x32_bf16 v[92:95], a[120:123], a[104:107], v[92:95]
v_mfma_f32_16x16x32_bf16 v[92:95], a[124:127], a[108:111], v[92:95]
s_add_u32 s50, s73, 3552
v_mfma_f32_16x16x32_bf16 v[220:223], a[120:123], a[112:115], v[220:223]
s_waitcnt vmcnt(19) lgkmcnt(0)
buffer_load_dwordx4 v254, s[28:31], s50 offen offset:1056 lds
v_mfma_f32_16x16x32_bf16 v[220:223], a[124:127], a[116:119], v[220:223]
s_barrier
v_mfma_f32_16x16x32_bf16 v[96:99], a[128:131], a[80:83], v[96:99]
ds_read_b64_tr_b16 a[120:121], v250 offset:50688
v_mfma_f32_16x16x32_bf16 v[96:99], a[132:135], a[84:87], v[96:99]
ds_read_b64_tr_b16 a[122:123], v250 offset:51744
v_mfma_f32_16x16x32_bf16 v[104:107], a[128:131], a[88:91], v[104:107]
ds_read_b64_tr_b16 a[124:125], v250 offset:59136
v_mfma_f32_16x16x32_bf16 v[104:107], a[132:135], a[92:95], v[104:107]
s_add_u32 s50, s73, 16320
ds_read_b64_tr_b16 a[126:127], v250 offset:60192
v_mfma_f32_16x16x32_bf16 v[112:115], a[128:131], a[96:99], v[112:115]
buffer_load_dwordx4 v254, s[28:31], s50 offen offset:2112 lds
v_mfma_f32_16x16x32_bf16 v[112:115], a[132:135], a[100:103], v[112:115]
v_mfma_f32_16x16x32_bf16 v[120:123], a[128:131], a[104:107], v[120:123]
v_mfma_f32_16x16x32_bf16 v[120:123], a[132:135], a[108:111], v[120:123]
ds_read_b64_tr_b16 a[128:129], v250 offset:50696
v_mfma_f32_16x16x32_bf16 v[100:103], a[136:139], a[80:83], v[100:103]
ds_read_b64_tr_b16 a[130:131], v250 offset:51752
v_mfma_f32_16x16x32_bf16 v[100:103], a[140:143], a[84:87], v[100:103]
s_add_u32 s50, s73, 19872
ds_read_b64_tr_b16 a[132:133], v250 offset:59144
v_mfma_f32_16x16x32_bf16 v[108:111], a[136:139], a[88:91], v[108:111]
ds_read_b64_tr_b16 a[134:135], v250 offset:60200
buffer_load_dwordx4 v254, s[28:31], s50 offen offset:3168 lds
v_mfma_f32_16x16x32_bf16 v[108:111], a[140:143], a[92:95], v[108:111]
v_mfma_f32_16x16x32_bf16 v[116:119], a[136:139], a[96:99], v[116:119]
v_mfma_f32_16x16x32_bf16 v[116:119], a[140:143], a[100:103], v[116:119]
v_mfma_f32_16x16x32_bf16 v[124:127], a[136:139], a[104:107], v[124:127]
s_add_u32 m0, s54, 4224
v_mfma_f32_16x16x32_bf16 v[124:127], a[140:143], a[108:111], v[124:127]
s_waitcnt lgkmcnt(4)
ds_read_b64_tr_b16 a[136:137], v251 offset:50688
v_mfma_f32_16x16x32_bf16 v[128:131], a[120:123], a[80:83], v[128:131]
s_add_u32 s50, s73, 36864
ds_read_b64_tr_b16 a[138:139], v251 offset:51744
v_mfma_f32_16x16x32_bf16 v[128:131], a[124:127], a[84:87], v[128:131]
ds_read_b64_tr_b16 a[140:141], v251 offset:59136
buffer_load_dwordx4 v254, s[28:31], s50 offen offset:0 lds
v_mfma_f32_16x16x32_bf16 v[136:139], a[120:123], a[88:91], v[136:139]
ds_read_b64_tr_b16 a[142:143], v251 offset:60192
v_mfma_f32_16x16x32_bf16 v[136:139], a[124:127], a[92:95], v[136:139]
v_mfma_f32_16x16x32_bf16 v[144:147], a[120:123], a[96:99], v[144:147]
v_mfma_f32_16x16x32_bf16 v[144:147], a[124:127], a[100:103], v[144:147]
v_mfma_f32_16x16x32_bf16 v[152:155], a[120:123], a[104:107], v[152:155]
s_add_u32 s50, s73, 40416
v_mfma_f32_16x16x32_bf16 v[152:155], a[124:127], a[108:111], v[152:155]
buffer_load_dwordx4 v254, s[28:31], s50 offen offset:1056 lds
v_mfma_f32_16x16x32_bf16 v[224:227], a[120:123], a[112:115], v[224:227]
v_mfma_f32_16x16x32_bf16 v[224:227], a[124:127], a[116:119], v[224:227]
s_waitcnt lgkmcnt(4)
ds_read_b64_tr_b16 a[120:121], v251 offset:50696
v_mfma_f32_16x16x32_bf16 v[132:135], a[128:131], a[80:83], v[132:135]
ds_read_b64_tr_b16 a[122:123], v251 offset:51752
v_mfma_f32_16x16x32_bf16 v[132:135], a[132:135], a[84:87], v[132:135]
ds_read_b64_tr_b16 a[124:125], v251 offset:59144
v_mfma_f32_16x16x32_bf16 v[140:143], a[128:131], a[88:91], v[140:143]
s_add_u32 s50, s73, 53184
ds_read_b64_tr_b16 a[126:127], v251 offset:60200
v_mfma_f32_16x16x32_bf16 v[140:143], a[132:135], a[92:95], v[140:143]
buffer_load_dwordx4 v254, s[28:31], s50 offen offset:2112 lds
v_mfma_f32_16x16x32_bf16 v[148:151], a[128:131], a[96:99], v[148:151]
v_mfma_f32_16x16x32_bf16 v[148:151], a[132:135], a[100:103], v[148:151]
v_mfma_f32_16x16x32_bf16 v[156:159], a[128:131], a[104:107], v[156:159]
v_mfma_f32_16x16x32_bf16 v[156:159], a[132:135], a[108:111], v[156:159]
v_mfma_f32_16x16x32_bf16 v[228:231], a[128:131], a[112:115], v[228:231]
s_add_u32 s50, s73, 56736
v_mfma_f32_16x16x32_bf16 v[228:231], a[132:135], a[116:119], v[228:231]
s_waitcnt lgkmcnt(4)
ds_read_b64_tr_b16 a[128:129], v250 offset:51200
buffer_load_dwordx4 v254, s[28:31], s50 offen offset:3168 lds
v_mfma_f32_16x16x32_bf16 v[160:163], a[136:139], a[80:83], v[160:163]
ds_read_b64_tr_b16 a[130:131], v250 offset:52256
v_mfma_f32_16x16x32_bf16 v[160:163], a[140:143], a[84:87], v[160:163]
ds_read_b64_tr_b16 a[132:133], v250 offset:59648
v_mfma_f32_16x16x32_bf16 v[168:171], a[136:139], a[88:91], v[168:171]
ds_read_b64_tr_b16 a[134:135], v250 offset:60704
v_mfma_f32_16x16x32_bf16 v[168:171], a[140:143], a[92:95], v[168:171]
s_add_u32 m0, s54, 8448
v_mfma_f32_16x16x32_bf16 v[176:179], a[136:139], a[96:99], v[176:179]
s_add_u32 s50, s14, 0
v_mfma_f32_16x16x32_bf16 v[176:179], a[140:143], a[100:103], v[176:179]
buffer_load_dwordx4 v254, s[28:31], s50 offen offset:0 lds
v_mfma_f32_16x16x32_bf16 v[184:187], a[136:139], a[104:107], v[184:187]
v_mfma_f32_16x16x32_bf16 v[184:187], a[140:143], a[108:111], v[184:187]
s_waitcnt lgkmcnt(4)
ds_read_b64_tr_b16 a[136:137], v250 offset:51208
v_mfma_f32_16x16x32_bf16 v[164:167], a[120:123], a[80:83], v[164:167]
s_waitcnt vmcnt(17)
ds_read_b64_tr_b16 a[138:139], v250 offset:52264
v_mfma_f32_16x16x32_bf16 v[164:167], a[124:127], a[84:87], v[164:167]
ds_read_b64_tr_b16 a[140:141], v250 offset:59656
v_mfma_f32_16x16x32_bf16 v[172:175], a[120:123], a[88:91], v[172:175]
s_add_u32 s50, s14, 3552
ds_read_b64_tr_b16 a[142:143], v250 offset:60712
v_mfma_f32_16x16x32_bf16 v[172:175], a[124:127], a[92:95], v[172:175]
ds_read_b128 a[0:3], v252 offset:10560
buffer_load_dwordx4 v254, s[28:31], s50 offen offset:1056 lds
v_mfma_f32_16x16x32_bf16 v[180:183], a[120:123], a[96:99], v[180:183]
s_add_u32 s15, s15, 1024
ds_read_b128 a[4:7], v252 offset:11072
v_mfma_f32_16x16x32_bf16 v[180:183], a[124:127], a[100:103], v[180:183]
ds_read_b128 a[8:11], v252 offset:12672
buffer_load_dword a254, v249, s[8:11], s15 offen
v_mfma_f32_16x16x32_bf16 v[188:191], a[120:123], a[104:107], v[188:191]
s_add_u32 s15, s15, 1024
ds_read_b128 a[12:15], v252 offset:13184
v_mfma_f32_16x16x32_bf16 v[188:191], a[124:127], a[108:111], v[188:191]
s_waitcnt lgkmcnt(8)
ds_read_b64_tr_b16 a[120:121], v251 offset:51200
buffer_load_dword a254, v249, s[8:11], s15 offen
v_mfma_f32_16x16x32_bf16 v[192:195], a[128:131], a[80:83], v[192:195]
s_add_u32 s15, s15, 1024
ds_read_b64_tr_b16 a[122:123], v251 offset:52256
v_mfma_f32_16x16x32_bf16 v[192:195], a[132:135], a[84:87], v[192:195]
ds_read_b64_tr_b16 a[124:125], v251 offset:59648
buffer_load_dword a254, v249, s[8:11], s15 offen
v_mfma_f32_16x16x32_bf16 v[200:203], a[128:131], a[88:91], v[200:203]
ds_read_b64_tr_b16 a[126:127], v251 offset:60704
v_mfma_f32_16x16x32_bf16 v[200:203], a[132:135], a[92:95], v[200:203]
ds_read_b128 a[16:19], v252 offset:14784
v_mfma_f32_16x16x32_bf16 a[160:163], a[128:131], a[96:99], a[160:163]
ds_read_b128 a[20:23], v252 offset:15296
v_mfma_f32_16x16x32_bf16 a[160:163], a[132:135], a[100:103], a[160:163]
ds_read_b128 a[24:27], v252 offset:16896
v_mfma_f32_16x16x32_bf16 a[168:171], a[128:131], a[104:107], a[168:171]
ds_read_b128 a[28:31], v252 offset:17408
v_mfma_f32_16x16x32_bf16 a[168:171], a[132:135], a[108:111], a[168:171]
ds_read_b128 a[32:35], v252 offset:19008
v_mfma_f32_16x16x32_bf16 v[232:235], a[128:131], a[112:115], v[232:235]
ds_read_b128 a[36:39], v252 offset:19520
v_mfma_f32_16x16x32_bf16 v[232:235], a[132:135], a[116:119], v[232:235]
s_waitcnt lgkmcnt(14)
ds_read_b64_tr_b16 a[128:129], v251 offset:51208
v_mfma_f32_16x16x32_bf16 v[196:199], a[136:139], a[80:83], v[196:199]
ds_read_b64_tr_b16 a[130:131], v251 offset:52264
v_mfma_f32_16x16x32_bf16 v[196:199], a[140:143], a[84:87], v[196:199]
ds_read_b64_tr_b16 a[132:133], v251 offset:59656
v_mfma_f32_16x16x32_bf16 v[204:207], a[136:139], a[88:91], v[204:207]
ds_read_b64_tr_b16 a[134:135], v251 offset:60712
v_mfma_f32_16x16x32_bf16 v[204:207], a[140:143], a[92:95], v[204:207]
v_mfma_f32_16x16x32_bf16 a[164:167], a[136:139], a[96:99], a[164:167]
v_mfma_f32_16x16x32_bf16 a[164:167], a[140:143], a[100:103], a[164:167]
v_mfma_f32_16x16x32_bf16 a[172:175], a[136:139], a[104:107], a[172:175]
v_mfma_f32_16x16x32_bf16 a[172:175], a[140:143], a[108:111], a[172:175]
v_mfma_f32_16x16x32_bf16 v[236:239], a[136:139], a[112:115], v[236:239]
s_waitcnt vmcnt(17) lgkmcnt(0)
v_mfma_f32_16x16x32_bf16 v[236:239], a[140:143], a[116:119], v[236:239]
s_barrier
v_mfma_f32_16x16x32_bf16 a[176:179], a[120:123], a[80:83], a[176:179]
ds_read_b64_tr_b16 a[136:137], v250 offset:0
v_mfma_f32_16x16x32_bf16 a[176:179], a[124:127], a[84:87], a[176:179]
ds_read_b64_tr_b16 a[138:139], v250 offset:1056
v_mfma_f32_16x16x32_bf16 a[184:187], a[120:123], a[88:91], a[184:187]
ds_read_b64_tr_b16 a[140:141], v250 offset:8448
v_mfma_f32_16x16x32_bf16 a[184:187], a[124:127], a[92:95], a[184:187]
ds_read_b64_tr_b16 a[142:143], v250 offset:9504
v_mfma_f32_16x16x32_bf16 a[192:195], a[120:123], a[96:99], a[192:195]
v_mfma_f32_16x16x32_bf16 a[192:195], a[124:127], a[100:103], a[192:195]
v_mfma_f32_16x16x32_bf16 a[200:203], a[120:123], a[104:107], a[200:203]
v_mfma_f32_16x16x32_bf16 a[200:203], a[124:127], a[108:111], a[200:203]
ds_read_b64_tr_b16 a[120:121], v250 offset:8
v_mfma_f32_16x16x32_bf16 a[180:183], a[128:131], a[80:83], a[180:183]
ds_read_b64_tr_b16 a[122:123], v250 offset:1064
v_mfma_f32_16x16x32_bf16 a[180:183], a[132:135], a[84:87], a[180:183]
ds_read_b64_tr_b16 a[124:125], v250 offset:8456
v_mfma_f32_16x16x32_bf16 a[188:191], a[128:131], a[88:91], a[188:191]
ds_read_b64_tr_b16 a[126:127], v250 offset:9512
v_mfma_f32_16x16x32_bf16 a[188:191], a[132:135], a[92:95], a[188:191]
v_mfma_f32_16x16x32_bf16 a[196:199], a[128:131], a[96:99], a[196:199]
v_mfma_f32_16x16x32_bf16 a[196:199], a[132:135], a[100:103], a[196:199]
v_mfma_f32_16x16x32_bf16 a[204:207], a[128:131], a[104:107], a[204:207]
v_mfma_f32_16x16x32_bf16 a[204:207], a[132:135], a[108:111], a[204:207]
s_waitcnt lgkmcnt(4)
ds_read_b64_tr_b16 a[128:129], v251 offset:0
v_mfma_f32_16x16x32_bf16 v[0:3], a[136:139], a[0:3], v[0:3]
ds_read_b64_tr_b16 a[130:131], v251 offset:1056
v_mfma_f32_16x16x32_bf16 v[0:3], a[140:143], a[4:7], v[0:3]
ds_read_b64_tr_b16 a[132:133], v251 offset:8448
v_mfma_f32_16x16x32_bf16 v[8:11], a[136:139], a[8:11], v[8:11]
ds_read_b64_tr_b16 a[134:135], v251 offset:9504
v_mfma_f32_16x16x32_bf16 v[8:11], a[140:143], a[12:15], v[8:11]
v_mfma_f32_16x16x32_bf16 v[16:19], a[136:139], a[16:19], v[16:19]
v_mfma_f32_16x16x32_bf16 v[16:19], a[140:143], a[20:23], v[16:19]
v_mfma_f32_16x16x32_bf16 v[24:27], a[136:139], a[24:27], v[24:27]
v_mfma_f32_16x16x32_bf16 v[24:27], a[140:143], a[28:31], v[24:27]
v_mfma_f32_16x16x32_bf16 v[208:211], a[136:139], a[32:35], v[208:211]
v_mfma_f32_16x16x32_bf16 v[208:211], a[140:143], a[36:39], v[208:211]
s_waitcnt lgkmcnt(4)
ds_read_b64_tr_b16 a[136:137], v251 offset:8
v_mfma_f32_16x16x32_bf16 v[4:7], a[120:123], a[0:3], v[4:7]
ds_read_b64_tr_b16 a[138:139], v251 offset:1064
v_mfma_f32_16x16x32_bf16 v[4:7], a[124:127], a[4:7], v[4:7]
ds_read_b64_tr_b16 a[140:141], v251 offset:8456
v_mfma_f32_16x16x32_bf16 v[12:15], a[120:123], a[8:11], v[12:15]
ds_read_b64_tr_b16 a[142:143], v251 offset:9512
v_mfma_f32_16x16x32_bf16 v[12:15], a[124:127], a[12:15], v[12:15]
v_mfma_f32_16x16x32_bf16 v[20:23], a[120:123], a[16:19], v[20:23]
v_mfma_f32_16x16x32_bf16 v[20:23], a[124:127], a[20:23], v[20:23]
s_bfe_u32 s17, s62, 0x40018
v_mfma_f32_16x16x32_bf16 v[28:31], a[120:123], a[24:27], v[28:31]
s_lshl_b32 s17, s17, 19
v_mfma_f32_16x16x32_bf16 v[28:31], a[124:127], a[28:31], v[28:31]
s_add_u32 s16, s53, s17
v_mfma_f32_16x16x32_bf16 v[212:215], a[120:123], a[32:35], v[212:215]
s_add_u32 m0, s55, 33792
v_mfma_f32_16x16x32_bf16 v[212:215], a[124:127], a[36:39], v[212:215]
s_waitcnt lgkmcnt(4)
ds_read_b64_tr_b16 a[120:121], v250 offset:512
v_mfma_f32_16x16x32_bf16 v[32:35], a[128:131], a[0:3], v[32:35]
s_add_u32 s50, s16, 0
ds_read_b64_tr_b16 a[122:123], v250 offset:1568
v_mfma_f32_16x16x32_bf16 v[32:35], a[132:135], a[4:7], v[32:35]
ds_read_b64_tr_b16 a[124:125], v250 offset:8960
buffer_load_dwordx4 v253, s[32:35], s50 offen offset:0 lds
v_mfma_f32_16x16x32_bf16 v[40:43], a[128:131], a[8:11], v[40:43]
ds_read_b64_tr_b16 a[126:127], v250 offset:10016
v_mfma_f32_16x16x32_bf16 v[40:43], a[132:135], a[12:15], v[40:43]
v_mfma_f32_16x16x32_bf16 v[48:51], a[128:131], a[16:19], v[48:51]
v_mfma_f32_16x16x32_bf16 v[48:51], a[132:135], a[20:23], v[48:51]
v_mfma_f32_16x16x32_bf16 v[56:59], a[128:131], a[24:27], v[56:59]
s_add_u32 s50, s16, 31712
v_mfma_f32_16x16x32_bf16 v[56:59], a[132:135], a[28:31], v[56:59]
s_waitcnt lgkmcnt(4)
ds_read_b64_tr_b16 a[128:129], v250 offset:520
buffer_load_dwordx4 v253, s[32:35], s50 offen offset:1056 lds
v_mfma_f32_16x16x32_bf16 v[36:39], a[136:139], a[0:3], v[36:39]
ds_read_b64_tr_b16 a[130:131], v250 offset:1576
v_mfma_f32_16x16x32_bf16 v[36:39], a[140:143], a[4:7], v[36:39]
ds_read_b64_tr_b16 a[132:133], v250 offset:8968
v_mfma_f32_16x16x32_bf16 v[44:47], a[136:139], a[8:11], v[44:47]
ds_read_b64_tr_b16 a[134:135], v250 offset:10024
v_mfma_f32_16x16x32_bf16 v[44:47], a[140:143], a[12:15], v[44:47]
v_mfma_f32_16x16x32_bf16 v[52:55], a[136:139], a[16:19], v[52:55]
s_add_u32 s50, s16, 63416
v_mfma_f32_16x16x32_bf16 v[52:55], a[140:143], a[20:23], v[52:55]
buffer_load_dwordx4 v253, s[32:35], s50 offen offset:2120 lds
v_mfma_f32_16x16x32_bf16 v[60:63], a[136:139], a[24:27], v[60:63]
v_mfma_f32_16x16x32_bf16 v[60:63], a[140:143], a[28:31], v[60:63]
s_waitcnt lgkmcnt(4)
ds_read_b64_tr_b16 a[136:137], v251 offset:512
v_mfma_f32_16x16x32_bf16 v[64:67], a[120:123], a[0:3], v[64:67]
ds_read_b64_tr_b16 a[138:139], v251 offset:1568
v_mfma_f32_16x16x32_bf16 v[64:67], a[124:127], a[4:7], v[64:67]
ds_read_b64_tr_b16 a[140:141], v251 offset:8960
v_mfma_f32_16x16x32_bf16 v[72:75], a[120:123], a[8:11], v[72:75]
s_add_u32 s50, s16, 95128
ds_read_b64_tr_b16 a[142:143], v251 offset:10016
v_mfma_f32_16x16x32_bf16 v[72:75], a[124:127], a[12:15], v[72:75]
buffer_load_dwordx4 v253, s[32:35], s50 offen offset:3176 lds
v_mfma_f32_16x16x32_bf16 v[80:83], a[120:123], a[16:19], v[80:83]
v_mfma_f32_16x16x32_bf16 v[80:83], a[124:127], a[20:23], v[80:83]
v_mfma_f32_16x16x32_bf16 v[88:91], a[120:123], a[24:27], v[88:91]
v_mfma_f32_16x16x32_bf16 v[88:91], a[124:127], a[28:31], v[88:91]
s_add_u32 m0, s55, 50688
v_mfma_f32_16x16x32_bf16 v[216:219], a[120:123], a[32:35], v[216:219]
s_add_u32 s50, s16, 256
v_mfma_f32_16x16x32_bf16 v[216:219], a[124:127], a[36:39], v[216:219]
s_waitcnt lgkmcnt(4)
ds_read_b64_tr_b16 a[120:121], v251 offset:520
buffer_load_dwordx4 v253, s[32:35], s50 offen offset:0 lds
v_mfma_f32_16x16x32_bf16 v[68:71], a[128:131], a[0:3], v[68:71]
ds_read_b64_tr_b16 a[122:123], v251 offset:1576
v_mfma_f32_16x16x32_bf16 v[68:71], a[132:135], a[4:7], v[68:71]
ds_read_b64_tr_b16 a[124:125], v251 offset:8968
v_mfma_f32_16x16x32_bf16 v[76:79], a[128:131], a[8:11], v[76:79]
ds_read_b64_tr_b16 a[126:127], v251 offset:10024
v_mfma_f32_16x16x32_bf16 v[76:79], a[132:135], a[12:15], v[76:79]
v_mfma_f32_16x16x32_bf16 v[84:87], a[128:131], a[16:19], v[84:87]
s_add_u32 s50, s16, 31968
v_mfma_f32_16x16x32_bf16 v[84:87], a[132:135], a[20:23], v[84:87]
buffer_load_dwordx4 v253, s[32:35], s50 offen offset:1056 lds
v_mfma_f32_16x16x32_bf16 v[92:95], a[128:131], a[24:27], v[92:95]
v_mfma_f32_16x16x32_bf16 v[92:95], a[132:135], a[28:31], v[92:95]
v_mfma_f32_16x16x32_bf16 v[220:223], a[128:131], a[32:35], v[220:223]
s_waitcnt vmcnt(19) lgkmcnt(0)
v_mfma_f32_16x16x32_bf16 v[220:223], a[132:135], a[36:39], v[220:223]
s_barrier
v_mfma_f32_16x16x32_bf16 v[96:99], a[136:139], a[0:3], v[96:99]
s_add_u32 s50, s16, 63672
ds_read_b64_tr_b16 a[128:129], v250 offset:16896
v_mfma_f32_16x16x32_bf16 v[96:99], a[140:143], a[4:7], v[96:99]
ds_read_b64_tr_b16 a[130:131], v250 offset:17952
buffer_load_dwordx4 v253, s[32:35], s50 offen offset:2120 lds
v_mfma_f32_16x16x32_bf16 v[104:107], a[136:139], a[8:11], v[104:107]
ds_read_b64_tr_b16 a[132:133], v250 offset:25344
v_mfma_f32_16x16x32_bf16 v[104:107], a[140:143], a[12:15], v[104:107]
ds_read_b64_tr_b16 a[134:135], v250 offset:26400
v_mfma_f32_16x16x32_bf16 v[112:115], a[136:139], a[16:19], v[112:115]
v_mfma_f32_16x16x32_bf16 v[112:115], a[140:143], a[20:23], v[112:115]
v_mfma_f32_16x16x32_bf16 v[120:123], a[136:139], a[24:27], v[120:123]
s_add_u32 s50, s16, 95384
v_mfma_f32_16x16x32_bf16 v[120:123], a[140:143], a[28:31], v[120:123]
ds_read_b64_tr_b16 a[136:137], v250 offset:16904
buffer_load_dwordx4 v253, s[32:35], s50 offen offset:3176 lds
v_mfma_f32_16x16x32_bf16 v[100:103], a[120:123], a[0:3], v[100:103]
ds_read_b64_tr_b16 a[138:139], v250 offset:17960
v_mfma_f32_16x16x32_bf16 v[100:103], a[124:127], a[4:7], v[100:103]
ds_read_b64_tr_b16 a[140:141], v250 offset:25352
v_mfma_f32_16x16x32_bf16 v[108:111], a[120:123], a[8:11], v[108:111]
ds_read_b64_tr_b16 a[142:143], v250 offset:26408
v_mfma_f32_16x16x32_bf16 v[108:111], a[124:127], a[12:15], v[108:111]
s_bfe_u32 s17, s62, 0x4001c
v_mfma_f32_16x16x32_bf16 v[116:119], a[120:123], a[16:19], v[116:119]
s_lshl_b32 s17, s17, 7
v_mfma_f32_16x16x32_bf16 v[116:119], a[124:127], a[20:23], v[116:119]
s_add_u32 s73, s51, s17
v_mfma_f32_16x16x32_bf16 v[124:127], a[120:123], a[24:27], v[124:127]
s_add_u32 s14, s52, s17
v_mfma_f32_16x16x32_bf16 v[124:127], a[124:127], a[28:31], v[124:127]
s_waitcnt lgkmcnt(4)
ds_read_b64_tr_b16 a[120:121], v251 offset:16896
v_mfma_f32_16x16x32_bf16 v[128:131], a[128:131], a[0:3], v[128:131]
s_add_u32 m0, s54, 10560
ds_read_b64_tr_b16 a[122:123], v251 offset:17952
v_mfma_f32_16x16x32_bf16 v[128:131], a[132:135], a[4:7], v[128:131]
s_add_u32 s50, s73, 0
ds_read_b64_tr_b16 a[124:125], v251 offset:25344
v_mfma_f32_16x16x32_bf16 v[136:139], a[128:131], a[8:11], v[136:139]
ds_read_b64_tr_b16 a[126:127], v251 offset:26400
buffer_load_dwordx4 v254, s[28:31], s50 offen offset:0 lds
v_mfma_f32_16x16x32_bf16 v[136:139], a[132:135], a[12:15], v[136:139]
v_mfma_f32_16x16x32_bf16 v[144:147], a[128:131], a[16:19], v[144:147]
v_mfma_f32_16x16x32_bf16 v[144:147], a[132:135], a[20:23], v[144:147]
v_mfma_f32_16x16x32_bf16 v[152:155], a[128:131], a[24:27], v[152:155]
v_mfma_f32_16x16x32_bf16 v[152:155], a[132:135], a[28:31], v[152:155]
s_add_u32 s50, s73, 3552
v_mfma_f32_16x16x32_bf16 v[224:227], a[128:131], a[32:35], v[224:227]
buffer_load_dwordx4 v254, s[28:31], s50 offen offset:1056 lds
v_mfma_f32_16x16x32_bf16 v[224:227], a[132:135], a[36:39], v[224:227]
s_waitcnt lgkmcnt(4)
ds_read_b64_tr_b16 a[128:129], v251 offset:16904
v_mfma_f32_16x16x32_bf16 v[132:135], a[136:139], a[0:3], v[132:135]
ds_read_b64_tr_b16 a[130:131], v251 offset:17960
v_mfma_f32_16x16x32_bf16 v[132:135], a[140:143], a[4:7], v[132:135]
ds_read_b64_tr_b16 a[132:133], v251 offset:25352
v_mfma_f32_16x16x32_bf16 v[140:143], a[136:139], a[8:11], v[140:143]
ds_read_b64_tr_b16 a[134:135], v251 offset:26408
v_mfma_f32_16x16x32_bf16 v[140:143], a[140:143], a[12:15], v[140:143]
s_add_u32 s50, s73, 16320
v_mfma_f32_16x16x32_bf16 v[148:151], a[136:139], a[16:19], v[148:151]
buffer_load_dwordx4 v254, s[28:31], s50 offen offset:2112 lds
v_mfma_f32_16x16x32_bf16 v[148:151], a[140:143], a[20:23], v[148:151]
v_mfma_f32_16x16x32_bf16 v[156:159], a[136:139], a[24:27], v[156:159]
v_mfma_f32_16x16x32_bf16 v[156:159], a[140:143], a[28:31], v[156:159]
v_mfma_f32_16x16x32_bf16 v[228:231], a[136:139], a[32:35], v[228:231]
v_mfma_f32_16x16x32_bf16 v[228:231], a[140:143], a[36:39], v[228:231]
s_waitcnt lgkmcnt(4)
ds_read_b64_tr_b16 a[136:137], v250 offset:17408
v_mfma_f32_16x16x32_bf16 v[160:163], a[120:123], a[0:3], v[160:163]
s_add_u32 s50, s73, 19872
ds_read_b64_tr_b16 a[138:139], v250 offset:18464
v_mfma_f32_16x16x32_bf16 v[160:163], a[124:127], a[4:7], v[160:163]
ds_read_b64_tr_b16 a[140:141], v250 offset:25856
buffer_load_dwordx4 v254, s[28:31], s50 offen offset:3168 lds
v_mfma_f32_16x16x32_bf16 v[168:171], a[120:123], a[8:11], v[168:171]
ds_read_b64_tr_b16 a[142:143], v250 offset:26912
v_mfma_f32_16x16x32_bf16 v[168:171], a[124:127], a[12:15], v[168:171]
v_mfma_f32_16x16x32_bf16 v[176:179], a[120:123], a[16:19], v[176:179]
v_mfma_f32_16x16x32_bf16 v[176:179], a[124:127], a[20:23], v[176:179]
s_add_u32 m0, s54, 14784
v_mfma_f32_16x16x32_bf16 v[184:187], a[120:123], a[24:27], v[184:187]
s_add_u32 s50, s73, 36864
v_mfma_f32_16x16x32_bf16 v[184:187], a[124:127], a[28:31], v[184:187]
s_waitcnt lgkmcnt(4)
ds_read_b64_tr_b16 a[120:121], v250 offset:17416
buffer_load_dwordx4 v254, s[28:31], s50 offen offset:0 lds
v_mfma_f32_16x16x32_bf16 v[164:167], a[128:131], a[0:3], v[164:167]
s_waitcnt vmcnt(16)
ds_read_b64_tr_b16 a[122:123], v250 offset:18472
v_mfma_f32_16x16x32_bf16 v[164:167], a[132:135], a[4:7], v[164:167]
ds_read_b64_tr_b16 a[124:125], v250 offset:25864
v_mfma_f32_16x16x32_bf16 v[172:175], a[128:131], a[8:11], v[172:175]
ds_read_b64_tr_b16 a[126:127], v250 offset:26920
v_mfma_f32_16x16x32_bf16 v[172:175], a[132:135], a[12:15], v[172:175]
ds_read_b128 a[80:83], v252 offset:0
v_mfma_f32_16x16x32_bf16 v[180:183], a[128:131], a[16:19], v[180:183]
s_add_u32 s50, s73, 40416
ds_read_b128 a[84:87], v252 offset:512
v_mfma_f32_16x16x32_bf16 v[180:183], a[132:135], a[20:23], v[180:183]
ds_read_b128 a[88:91], v252 offset:2112
buffer_load_dwordx4 v254, s[28:31], s50 offen offset:1056 lds
v_mfma_f32_16x16x32_bf16 v[188:191], a[128:131], a[24:27], v[188:191]
ds_read_b128 a[92:95], v252 offset:2624
v_mfma_f32_16x16x32_bf16 v[188:191], a[132:135], a[28:31], v[188:191]
s_waitcnt lgkmcnt(8)
ds_read_b64_tr_b16 a[128:129], v251 offset:17408
v_mfma_f32_16x16x32_bf16 v[192:195], a[136:139], a[0:3], v[192:195]
ds_read_b64_tr_b16 a[130:131], v251 offset:18464
v_mfma_f32_16x16x32_bf16 v[192:195], a[140:143], a[4:7], v[192:195]
ds_read_b64_tr_b16 a[132:133], v251 offset:25856
v_mfma_f32_16x16x32_bf16 v[200:203], a[136:139], a[8:11], v[200:203]
s_add_u32 s50, s73, 53184
ds_read_b64_tr_b16 a[134:135], v251 offset:26912
v_mfma_f32_16x16x32_bf16 v[200:203], a[140:143], a[12:15], v[200:203]
ds_read_b128 a[96:99], v252 offset:4224
buffer_load_dwordx4 v254, s[28:31], s50 offen offset:2112 lds
v_mfma_f32_16x16x32_bf16 a[160:163], a[136:139], a[16:19], a[160:163]
ds_read_b128 a[100:103], v252 offset:4736
v_mfma_f32_16x16x32_bf16 a[160:163], a[140:143], a[20:23], a[160:163]
ds_read_b128 a[104:107], v252 offset:6336
v_mfma_f32_16x16x32_bf16 a[168:171], a[136:139], a[24:27], a[168:171]
ds_read_b128 a[108:111], v252 offset:6848
v_mfma_f32_16x16x32_bf16 a[168:171], a[140:143], a[28:31], a[168:171]
ds_read_b128 a[112:115], v252 offset:8448
v_mfma_f32_16x16x32_bf16 v[232:235], a[136:139], a[32:35], v[232:235]
s_add_u32 s50, s73, 56736
ds_read_b128 a[116:119], v252 offset:8960
v_mfma_f32_16x16x32_bf16 v[232:235], a[140:143], a[36:39], v[232:235]
s_waitcnt lgkmcnt(14)
ds_read_b64_tr_b16 a[136:137], v251 offset:17416
buffer_load_dwordx4 v254, s[28:31], s50 offen offset:3168 lds
v_mfma_f32_16x16x32_bf16 v[196:199], a[120:123], a[0:3], v[196:199]
ds_read_b64_tr_b16 a[138:139], v251 offset:18472
v_mfma_f32_16x16x32_bf16 v[196:199], a[124:127], a[4:7], v[196:199]
ds_read_b64_tr_b16 a[140:141], v251 offset:25864
v_mfma_f32_16x16x32_bf16 v[204:207], a[120:123], a[8:11], v[204:207]
ds_read_b64_tr_b16 a[142:143], v251 offset:26920
v_mfma_f32_16x16x32_bf16 v[204:207], a[124:127], a[12:15], v[204:207]
s_add_u32 m0, s54, 19008
v_mfma_f32_16x16x32_bf16 a[164:167], a[120:123], a[16:19], a[164:167]
s_add_u32 s50, s14, 0
v_mfma_f32_16x16x32_bf16 a[164:167], a[124:127], a[20:23], a[164:167]
buffer_load_dwordx4 v254, s[28:31], s50 offen offset:0 lds
v_mfma_f32_16x16x32_bf16 a[172:175], a[120:123], a[24:27], a[172:175]
v_mfma_f32_16x16x32_bf16 a[172:175], a[124:127], a[28:31], a[172:175]
v_mfma_f32_16x16x32_bf16 v[236:239], a[120:123], a[32:35], v[236:239]
s_waitcnt vmcnt(13) lgkmcnt(0)
v_mfma_f32_16x16x32_bf16 v[236:239], a[124:127], a[36:39], v[236:239]
s_barrier
v_mfma_f32_16x16x32_bf16 a[176:179], a[128:131], a[0:3], a[176:179]
s_add_u32 s50, s14, 3552
ds_read_b64_tr_b16 a[120:121], v250 offset:33792
v_mfma_f32_16x16x32_bf16 a[176:179], a[132:135], a[4:7], a[176:179]
ds_read_b64_tr_b16 a[122:123], v250 offset:34848
buffer_load_dwordx4 v254, s[28:31], s50 offen offset:1056 lds
v_mfma_f32_16x16x32_bf16 a[184:187], a[128:131], a[8:11], a[184:187]
ds_read_b64_tr_b16 a[124:125], v250 offset:42240
v_mfma_f32_16x16x32_bf16 a[184:187], a[132:135], a[12:15], a[184:187]
ds_read_b64_tr_b16 a[126:127], v250 offset:43296
v_mfma_f32_16x16x32_bf16 a[192:195], a[128:131], a[16:19], a[192:195]
v_mfma_f32_16x16x32_bf16 a[192:195], a[132:135], a[20:23], a[192:195]
s_bfe_u32 s17, s62, 0x4001c
v_mfma_f32_16x16x32_bf16 a[200:203], a[128:131], a[24:27], a[200:203]
s_lshl_b32 s17, s17, 19
v_mfma_f32_16x16x32_bf16 a[200:203], a[132:135], a[28:31], a[200:203]
s_add_u32 s16, s53, s17
ds_read_b64_tr_b16 a[128:129], v250 offset:33800
v_mfma_f32_16x16x32_bf16 a[180:183], a[136:139], a[0:3], a[180:183]
s_add_u32 m0, s55, 0
ds_read_b64_tr_b16 a[130:131], v250 offset:34856
v_mfma_f32_16x16x32_bf16 a[180:183], a[140:143], a[4:7], a[180:183]
s_add_u32 s50, s16, 0
ds_read_b64_tr_b16 a[132:133], v250 offset:42248
v_mfma_f32_16x16x32_bf16 a[188:191], a[136:139], a[8:11], a[188:191]
ds_read_b64_tr_b16 a[134:135], v250 offset:43304
buffer_load_dwordx4 v253, s[32:35], s50 offen offset:0 lds
v_mfma_f32_16x16x32_bf16 a[188:191], a[140:143], a[12:15], a[188:191]
v_mfma_f32_16x16x32_bf16 a[196:199], a[136:139], a[16:19], a[196:199]
v_mfma_f32_16x16x32_bf16 a[196:199], a[140:143], a[20:23], a[196:199]
v_mfma_f32_16x16x32_bf16 a[204:207], a[136:139], a[24:27], a[204:207]
v_mfma_f32_16x16x32_bf16 a[204:207], a[140:143], a[28:31], a[204:207]
s_waitcnt lgkmcnt(4)
ds_read_b64_tr_b16 a[136:137], v251 offset:33792
v_mfma_f32_16x16x32_bf16 v[0:3], a[120:123], a[80:83], v[0:3]
s_add_u32 s50, s16, 31712
ds_read_b64_tr_b16 a[138:139], v251 offset:34848
v_mfma_f32_16x16x32_bf16 v[0:3], a[124:127], a[84:87], v[0:3]
ds_read_b64_tr_b16 a[140:141], v251 offset:42240
buffer_load_dwordx4 v253, s[32:35], s50 offen offset:1056 lds
v_mfma_f32_16x16x32_bf16 v[8:11], a[120:123], a[88:91], v[8:11]
ds_read_b64_tr_b16 a[142:143], v251 offset:43296
v_mfma_f32_16x16x32_bf16 v[8:11], a[124:127], a[92:95], v[8:11]
v_mfma_f32_16x16x32_bf16 v[16:19], a[120:123], a[96:99], v[16:19]
v_mfma_f32_16x16x32_bf16 v[16:19], a[124:127], a[100:103], v[16:19]
v_mfma_f32_16x16x32_bf16 v[24:27], a[120:123], a[104:107], v[24:27]
s_add_u32 s50, s16, 63416
v_mfma_f32_16x16x32_bf16 v[24:27], a[124:127], a[108:111], v[24:27]
buffer_load_dwordx4 v253, s[32:35], s50 offen offset:2120 lds
v_mfma_f32_16x16x32_bf16 v[208:211], a[120:123], a[112:115], v[208:211]
v_mfma_f32_16x16x32_bf16 v[208:211], a[124:127], a[116:119], v[208:211]
s_waitcnt lgkmcnt(4)
ds_read_b64_tr_b16 a[120:121], v251 offset:33800
v_mfma_f32_16x16x32_bf16 v[4:7], a[128:131], a[80:83], v[4:7]
ds_read_b64_tr_b16 a[122:123], v251 offset:34856
v_mfma_f32_16x16x32_bf16 v[4:7], a[132:135], a[84:87], v[4:7]
ds_read_b64_tr_b16 a[124:125], v251 offset:42248
v_mfma_f32_16x16x32_bf16 v[12:15], a[128:131], a[88:91], v[12:15]
s_add_u32 s50, s16, 95128
ds_read_b64_tr_b16 a[126:127], v251 offset:43304
v_mfma_f32_16x16x32_bf16 v[12:15], a[132:135], a[92:95], v[12:15]
buffer_load_dwordx4 v253, s[32:35], s50 offen offset:3176 lds
v_mfma_f32_16x16x32_bf16 v[20:23], a[128:131], a[96:99], v[20:23]
v_mfma_f32_16x16x32_bf16 v[20:23], a[132:135], a[100:103], v[20:23]
v_mfma_f32_16x16x32_bf16 v[28:31], a[128:131], a[104:107], v[28:31]
v_mfma_f32_16x16x32_bf16 v[28:31], a[132:135], a[108:111], v[28:31]
s_add_u32 m0, s55, 16896
v_mfma_f32_16x16x32_bf16 v[212:215], a[128:131], a[112:115], v[212:215]
s_add_u32 s50, s16, 256
v_mfma_f32_16x16x32_bf16 v[212:215], a[132:135], a[116:119], v[212:215]
s_waitcnt lgkmcnt(4)
ds_read_b64_tr_b16 a[128:129], v250 offset:34304
buffer_load_dwordx4 v253, s[32:35], s50 offen offset:0 lds
v_mfma_f32_16x16x32_bf16 v[32:35], a[136:139], a[80:83], v[32:35]
ds_read_b64_tr_b16 a[130:131], v250 offset:35360
v_mfma_f32_16x16x32_bf16 v[32:35], a[140:143], a[84:87], v[32:35]
ds_read_b64_tr_b16 a[132:133], v250 offset:42752
v_mfma_f32_16x16x32_bf16 v[40:43], a[136:139], a[88:91], v[40:43]
ds_read_b64_tr_b16 a[134:135], v250 offset:43808
v_mfma_f32_16x16x32_bf16 v[40:43], a[140:143], a[92:95], v[40:43]
v_mfma_f32_16x16x32_bf16 v[48:51], a[136:139], a[96:99], v[48:51]
s_add_u32 s50, s16, 31968
v_mfma_f32_16x16x32_bf16 v[48:51], a[140:143], a[100:103], v[48:51]
buffer_load_dwordx4 v253, s[32:35], s50 offen offset:1056 lds
v_mfma_f32_16x16x32_bf16 v[56:59], a[136:139], a[104:107], v[56:59]
v_mfma_f32_16x16x32_bf16 v[56:59], a[140:143], a[108:111], v[56:59]
s_waitcnt lgkmcnt(4)
ds_read_b64_tr_b16 a[136:137], v250 offset:34312
v_mfma_f32_16x16x32_bf16 v[36:39], a[120:123], a[80:83], v[36:39]
ds_read_b64_tr_b16 a[138:139], v250 offset:35368
v_mfma_f32_16x16x32_bf16 v[36:39], a[124:127], a[84:87], v[36:39]
ds_read_b64_tr_b16 a[140:141], v250 offset:42760
v_mfma_f32_16x16x32_bf16 v[44:47], a[120:123], a[88:91], v[44:47]
s_add_u32 s50, s16, 63672
ds_read_b64_tr_b16 a[142:143], v250 offset:43816
v_mfma_f32_16x16x32_bf16 v[44:47], a[124:127], a[92:95], v[44:47]
buffer_load_dwordx4 v253, s[32:35], s50 offen offset:2120 lds
v_mfma_f32_16x16x32_bf16 v[52:55], a[120:123], a[96:99], v[52:55]
v_mfma_f32_16x16x32_bf16 v[52:55], a[124:127], a[100:103], v[52:55]
v_mfma_f32_16x16x32_bf16 v[60:63], a[120:123], a[104:107], v[60:63]
v_mfma_f32_16x16x32_bf16 v[60:63], a[124:127], a[108:111], v[60:63]
s_waitcnt lgkmcnt(4)
ds_read_b64_tr_b16 a[120:121], v251 offset:34304
v_mfma_f32_16x16x32_bf16 v[64:67], a[128:131], a[80:83], v[64:67]
s_add_u32 s50, s16, 95384
ds_read_b64_tr_b16 a[122:123], v251 offset:35360
v_mfma_f32_16x16x32_bf16 v[64:67], a[132:135], a[84:87], v[64:67]
ds_read_b64_tr_b16 a[124:125], v251 offset:42752
buffer_load_dwordx4 v253, s[32:35], s50 offen offset:3176 lds
v_mfma_f32_16x16x32_bf16 v[72:75], a[128:131], a[88:91], v[72:75]
s_lshr_b32 s77, s2, 3
ds_read_b64_tr_b16 a[126:127], v251 offset:43808
v_mfma_f32_16x16x32_bf16 v[72:75], a[132:135], a[92:95], v[72:75]
s_lshl_b32 s77, s77, 2
v_mfma_f32_16x16x32_bf16 v[80:83], a[128:131], a[96:99], v[80:83]
s_add_u32 s77, s77, s48
v_mfma_f32_16x16x32_bf16 v[80:83], a[132:135], a[100:103], v[80:83]
s_lshl_b32 s77, s77, 7
v_mfma_f32_16x16x32_bf16 v[88:91], a[128:131], a[104:107], v[88:91]
s_add_u32 s77, s77, L_h_tail-L_pc-16384
v_mfma_f32_16x16x32_bf16 v[88:91], a[132:135], a[108:111], v[88:91]
buffer_load_dword a255, off, s[20:23], s77
v_mfma_f32_16x16x32_bf16 v[216:219], a[128:131], a[112:115], v[216:219]
v_mfma_f32_16x16x32_bf16 v[216:219], a[132:135], a[116:119], v[216:219]
s_waitcnt lgkmcnt(4)
ds_read_b64_tr_b16 a[128:129], v251 offset:34312
v_mfma_f32_16x16x32_bf16 v[68:71], a[136:139], a[80:83], v[68:71]
ds_read_b64_tr_b16 a[130:131], v251 offset:35368
v_mfma_f32_16x16x32_bf16 v[68:71], a[140:143], a[84:87], v[68:71]
s_mov_b32 s17, s72
ds_read_b64_tr_b16 a[132:133], v251 offset:42760
v_mfma_f32_16x16x32_bf16 v[76:79], a[136:139], a[88:91], v[76:79]
s_lshl_b32 s17, s17, 7
ds_read_b64_tr_b16 a[134:135], v251 offset:43816
v_mfma_f32_16x16x32_bf16 v[76:79], a[140:143], a[92:95], v[76:79]
s_add_u32 s73, s51, s17
v_mfma_f32_16x16x32_bf16 v[84:87], a[136:139], a[96:99], v[84:87]
s_add_u32 s14, s52, s17
v_mfma_f32_16x16x32_bf16 v[84:87], a[140:143], a[100:103], v[84:87]
s_add_u32 m0, s54, 0
v_mfma_f32_16x16x32_bf16 v[92:95], a[136:139], a[104:107], v[92:95]
s_add_u32 s50, s73, 0
v_mfma_f32_16x16x32_bf16 v[92:95], a[140:143], a[108:111], v[92:95]
buffer_load_dwordx4 v254, s[28:31], s50 offen offset:0 lds
v_mfma_f32_16x16x32_bf16 v[220:223], a[136:139], a[112:115], v[220:223]
s_waitcnt vmcnt(20) lgkmcnt(0)
v_mfma_f32_16x16x32_bf16 v[220:223], a[140:143], a[116:119], v[220:223]
s_barrier
v_mfma_f32_16x16x32_bf16 v[96:99], a[120:123], a[80:83], v[96:99]
ds_read_b64_tr_b16 a[136:137], v250 offset:50688
v_mfma_f32_16x16x32_bf16 v[96:99], a[124:127], a[84:87], v[96:99]
ds_read_b64_tr_b16 a[138:139], v250 offset:51744
v_mfma_f32_16x16x32_bf16 v[104:107], a[120:123], a[88:91], v[104:107]
s_add_u32 s50, s73, 3552
ds_read_b64_tr_b16 a[140:141], v250 offset:59136
v_mfma_f32_16x16x32_bf16 v[104:107], a[124:127], a[92:95], v[104:107]
ds_read_b64_tr_b16 a[142:143], v250 offset:60192
buffer_load_dwordx4 v254, s[28:31], s50 offen offset:1056 lds
v_mfma_f32_16x16x32_bf16 v[112:115], a[120:123], a[96:99], v[112:115]
v_mfma_f32_16x16x32_bf16 v[112:115], a[124:127], a[100:103], v[112:115]
v_mfma_f32_16x16x32_bf16 v[120:123], a[120:123], a[104:107], v[120:123]
v_mfma_f32_16x16x32_bf16 v[120:123], a[124:127], a[108:111], v[120:123]
ds_read_b64_tr_b16 a[120:121], v250 offset:50696
v_mfma_f32_16x16x32_bf16 v[100:103], a[128:131], a[80:83], v[100:103]
s_add_u32 s50, s73, 16320
ds_read_b64_tr_b16 a[122:123], v250 offset:51752
v_mfma_f32_16x16x32_bf16 v[100:103], a[132:135], a[84:87], v[100:103]
ds_read_b64_tr_b16 a[124:125], v250 offset:59144
buffer_load_dwordx4 v254, s[28:31], s50 offen offset:2112 lds
v_mfma_f32_16x16x32_bf16 v[108:111], a[128:131], a[88:91], v[108:111]
ds_read_b64_tr_b16 a[126:127], v250 offset:60200
v_mfma_f32_16x16x32_bf16 v[108:111], a[132:135], a[92:95], v[108:111]
v_mfma_f32_16x16x32_bf16 v[116:119], a[128:131], a[96:99], v[116:119]
v_mfma_f32_16x16x32_bf16 v[116:119], a[132:135], a[100:103], v[116:119]
v_mfma_f32_16x16x32_bf16 v[124:127], a[128:131], a[104:107], v[124:127]
s_add_u32 s50, s73, 19872
v_mfma_f32_16x16x32_bf16 v[124:127], a[132:135], a[108:111], v[124:127]
s_waitcnt lgkmcnt(4)
ds_read_b64_tr_b16 a[128:129], v251 offset:50688
buffer_load_dwordx4 v254, s[28:31], s50 offen offset:3168 lds
v_mfma_f32_16x16x32_bf16 v[128:131], a[136:139], a[80:83], v[128:131]
ds_read_b64_tr_b16 a[130:131], v251 offset:51744
v_mfma_f32_16x16x32_bf16 v[128:131], a[140:143], a[84:87], v[128:131]
ds_read_b64_tr_b16 a[132:133], v251 offset:59136
v_mfma_f32_16x16x32_bf16 v[136:139], a[136:139], a[88:91], v[136:139]
ds_read_b64_tr_b16 a[134:135], v251 offset:60192
v_mfma_f32_16x16x32_bf16 v[136:139], a[140:143], a[92:95], v[136:139]
s_add_u32 m0, s54, 4224
v_mfma_f32_16x16x32_bf16 v[144:147], a[136:139], a[96:99], v[144:147]
s_add_u32 s50, s73, 36864
v_mfma_f32_16x16x32_bf16 v[144:147], a[140:143], a[100:103], v[144:147]
buffer_load_dwordx4 v254, s[28:31], s50 offen offset:0 lds
v_mfma_f32_16x16x32_bf16 v[152:155], a[136:139], a[104:107], v[152:155]
v_mfma_f32_16x16x32_bf16 v[152:155], a[140:143], a[108:111], v[152:155]
v_mfma_f32_16x16x32_bf16 v[224:227], a[136:139], a[112:115], v[224:227]
v_mfma_f32_16x16x32_bf16 v[224:227], a[140:143], a[116:119], v[224:227]
s_waitcnt lgkmcnt(4)
ds_read_b64_tr_b16 a[136:137], v251 offset:50696
v_mfma_f32_16x16x32_bf16 v[132:135], a[120:123], a[80:83], v[132:135]
s_add_u32 s50, s73, 40416
ds_read_b64_tr_b16 a[138:139], v251 offset:51752
v_mfma_f32_16x16x32_bf16 v[132:135], a[124:127], a[84:87], v[132:135]
ds_read_b64_tr_b16 a[140:141], v251 offset:59144
buffer_load_dwordx4 v254, s[28:31], s50 offen offset:1056 lds
v_mfma_f32_16x16x32_bf16 v[140:143], a[120:123], a[88:91], v[140:143]
ds_read_b64_tr_b16 a[142:143], v251 offset:60200
v_mfma_f32_16x16x32_bf16 v[140:143], a[124:127], a[92:95], v[140:143]
v_mfma_f32_16x16x32_bf16 v[148:151], a[120:123], a[96:99], v[148:151]
v_mfma_f32_16x16x32_bf16 v[148:151], a[124:127], a[100:103], v[148:151]
v_mfma_f32_16x16x32_bf16 v[156:159], a[120:123], a[104:107], v[156:159]
s_add_u32 s50, s73, 53184
v_mfma_f32_16x16x32_bf16 v[156:159], a[124:127], a[108:111], v[156:159]
buffer_load_dwordx4 v254, s[28:31], s50 offen offset:2112 lds
v_mfma_f32_16x16x32_bf16 v[228:231], a[120:123], a[112:115], v[228:231]
v_mfma_f32_16x16x32_bf16 v[228:231], a[124:127], a[116:119], v[228:231]
s_waitcnt lgkmcnt(4)
ds_read_b64_tr_b16 a[120:121], v250 offset:51200
v_mfma_f32_16x16x32_bf16 v[160:163], a[128:131], a[80:83], v[160:163]
ds_read_b64_tr_b16 a[122:123], v250 offset:52256
v_mfma_f32_16x16x32_bf16 v[160:163], a[132:135], a[84:87], v[160:163]
ds_read_b64_tr_b16 a[124:125], v250 offset:59648
v_mfma_f32_16x16x32_bf16 v[168:171], a[128:131], a[88:91], v[168:171]
s_add_u32 s50, s73, 56736
ds_read_b64_tr_b16 a[126:127], v250 offset:60704
v_mfma_f32_16x16x32_bf16 v[168:171], a[132:135], a[92:95], v[168:171]
buffer_load_dwordx4 v254, s[28:31], s50 offen offset:3168 lds
v_mfma_f32_16x16x32_bf16 v[176:179], a[128:131], a[96:99], v[176:179]
v_mfma_f32_16x16x32_bf16 v[176:179], a[132:135], a[100:103], v[176:179]
v_mfma_f32_16x16x32_bf16 v[184:187], a[128:131], a[104:107], v[184:187]
v_mfma_f32_16x16x32_bf16 v[184:187], a[132:135], a[108:111], v[184:187]
s_waitcnt lgkmcnt(4)
ds_read_b64_tr_b16 a[128:129], v250 offset:51208
v_mfma_f32_16x16x32_bf16 v[164:167], a[136:139], a[80:83], v[164:167]
s_waitcnt vmcnt(17)
ds_read_b64_tr_b16 a[130:131], v250 offset:52264
v_mfma_f32_16x16x32_bf16 v[164:167], a[140:143], a[84:87], v[164:167]
s_add_u32 m0, s54, 8448
ds_read_b64_tr_b16 a[132:133], v250 offset:59656
v_mfma_f32_16x16x32_bf16 v[172:175], a[136:139], a[88:91], v[172:175]
s_add_u32 s50, s14, 0
ds_read_b64_tr_b16 a[134:135], v250 offset:60712
v_mfma_f32_16x16x32_bf16 v[172:175], a[140:143], a[92:95], v[172:175]
ds_read_b128 a[0:3], v252 offset:10560
buffer_load_dwordx4 v254, s[28:31], s50 offen offset:0 lds
v_mfma_f32_16x16x32_bf16 v[180:183], a[136:139], a[96:99], v[180:183]
ds_read_b128 a[4:7], v252 offset:11072
v_mfma_f32_16x16x32_bf16 v[180:183], a[140:143], a[100:103], v[180:183]
ds_read_b128 a[8:11], v252 offset:12672
v_mfma_f32_16x16x32_bf16 v[188:191], a[136:139], a[104:107], v[188:191]
ds_read_b128 a[12:15], v252 offset:13184
v_mfma_f32_16x16x32_bf16 v[188:191], a[140:143], a[108:111], v[188:191]
s_waitcnt lgkmcnt(8)
ds_read_b64_tr_b16 a[136:137], v251 offset:51200
v_mfma_f32_16x16x32_bf16 v[192:195], a[120:123], a[80:83], v[192:195]
s_add_u32 s50, s14, 3552
ds_read_b64_tr_b16 a[138:139], v251 offset:52256
v_mfma_f32_16x16x32_bf16 v[192:195], a[124:127], a[84:87], v[192:195]
ds_read_b64_tr_b16 a[140:141], v251 offset:59648
buffer_load_dwordx4 v254, s[28:31], s50 offen offset:1056 lds
v_mfma_f32_16x16x32_bf16 v[200:203], a[120:123], a[88:91], v[200:203]
s_add_u32 s15, s15, 1024
ds_read_b64_tr_b16 a[142:143], v251 offset:60704
v_mfma_f32_16x16x32_bf16 v[200:203], a[124:127], a[92:95], v[200:203]
ds_read_b128 a[16:19], v252 offset:14784
buffer_load_dword a254, v249, s[8:11], s15 offen
v_mfma_f32_16x16x32_bf16 a[160:163], a[120:123], a[96:99], a[160:163]
s_add_u32 s15, s15, 1024
ds_read_b128 a[20:23], v252 offset:15296
v_mfma_f32_16x16x32_bf16 a[160:163], a[124:127], a[100:103], a[160:163]
ds_read_b128 a[24:27], v252 offset:16896
buffer_load_dword a254, v249, s[8:11], s15 offen
v_mfma_f32_16x16x32_bf16 a[168:171], a[120:123], a[104:107], a[168:171]
s_add_u32 s15, s15, 1024
ds_read_b128 a[28:31], v252 offset:17408
v_mfma_f32_16x16x32_bf16 a[168:171], a[124:127], a[108:111], a[168:171]
ds_read_b128 a[32:35], v252 offset:19008
buffer_load_dword a254, v249, s[8:11], s15 offen
v_mfma_f32_16x16x32_bf16 v[232:235], a[120:123], a[112:115], v[232:235]
ds_read_b128 a[36:39], v252 offset:19520
v_mfma_f32_16x16x32_bf16 v[232:235], a[124:127], a[116:119], v[232:235]
s_waitcnt lgkmcnt(14)
ds_read_b64_tr_b16 a[120:121], v251 offset:51208
v_mfma_f32_16x16x32_bf16 v[196:199], a[128:131], a[80:83], v[196:199]
ds_read_b64_tr_b16 a[122:123], v251 offset:52264
v_mfma_f32_16x16x32_bf16 v[196:199], a[132:135], a[84:87], v[196:199]
ds_read_b64_tr_b16 a[124:125], v251 offset:59656
v_mfma_f32_16x16x32_bf16 v[204:207], a[128:131], a[88:91], v[204:207]
ds_read_b64_tr_b16 a[126:127], v251 offset:60712
v_mfma_f32_16x16x32_bf16 v[204:207], a[132:135], a[92:95], v[204:207]
v_mfma_f32_16x16x32_bf16 a[164:167], a[128:131], a[96:99], a[164:167]
v_mfma_f32_16x16x32_bf16 a[164:167], a[132:135], a[100:103], a[164:167]
v_mfma_f32_16x16x32_bf16 a[172:175], a[128:131], a[104:107], a[172:175]
v_mfma_f32_16x16x32_bf16 a[172:175], a[132:135], a[108:111], a[172:175]
v_mfma_f32_16x16x32_bf16 v[236:239], a[128:131], a[112:115], v[236:239]
s_waitcnt vmcnt(18) lgkmcnt(0)
v_mfma_f32_16x16x32_bf16 v[236:239], a[132:135], a[116:119], v[236:239]
s_barrier
v_mfma_f32_16x16x32_bf16 a[176:179], a[136:139], a[80:83], a[176:179]
ds_read_b64_tr_b16 a[128:129], v250 offset:0
v_mfma_f32_16x16x32_bf16 a[176:179], a[140:143], a[84:87], a[176:179]
ds_read_b64_tr_b16 a[130:131], v250 offset:1056
v_mfma_f32_16x16x32_bf16 a[184:187], a[136:139], a[88:91], a[184:187]
ds_read_b64_tr_b16 a[132:133], v250 offset:8448
v_mfma_f32_16x16x32_bf16 a[184:187], a[140:143], a[92:95], a[184:187]
ds_read_b64_tr_b16 a[134:135], v250 offset:9504
v_mfma_f32_16x16x32_bf16 a[192:195], a[136:139], a[96:99], a[192:195]
v_mfma_f32_16x16x32_bf16 a[192:195], a[140:143], a[100:103], a[192:195]
v_mfma_f32_16x16x32_bf16 a[200:203], a[136:139], a[104:107], a[200:203]
v_mfma_f32_16x16x32_bf16 a[200:203], a[140:143], a[108:111], a[200:203]
ds_read_b64_tr_b16 a[136:137], v250 offset:8
v_mfma_f32_16x16x32_bf16 a[180:183], a[120:123], a[80:83], a[180:183]
ds_read_b64_tr_b16 a[138:139], v250 offset:1064
v_mfma_f32_16x16x32_bf16 a[180:183], a[124:127], a[84:87], a[180:183]
ds_read_b64_tr_b16 a[140:141], v250 offset:8456
v_mfma_f32_16x16x32_bf16 a[188:191], a[120:123], a[88:91], a[188:191]
ds_read_b64_tr_b16 a[142:143], v250 offset:9512
v_mfma_f32_16x16x32_bf16 a[188:191], a[124:127], a[92:95], a[188:191]
v_mfma_f32_16x16x32_bf16 a[196:199], a[120:123], a[96:99], a[196:199]
v_mfma_f32_16x16x32_bf16 a[196:199], a[124:127], a[100:103], a[196:199]
v_mfma_f32_16x16x32_bf16 a[204:207], a[120:123], a[104:107], a[204:207]
v_mfma_f32_16x16x32_bf16 a[204:207], a[124:127], a[108:111], a[204:207]
s_waitcnt lgkmcnt(4)
ds_read_b64_tr_b16 a[120:121], v251 offset:0
v_mfma_f32_16x16x32_bf16 v[0:3], a[128:131], a[0:3], v[0:3]
ds_read_b64_tr_b16 a[122:123], v251 offset:1056
v_mfma_f32_16x16x32_bf16 v[0:3], a[132:135], a[4:7], v[0:3]
ds_read_b64_tr_b16 a[124:125], v251 offset:8448
v_mfma_f32_16x16x32_bf16 v[8:11], a[128:131], a[8:11], v[8:11]
ds_read_b64_tr_b16 a[126:127], v251 offset:9504
v_mfma_f32_16x16x32_bf16 v[8:11], a[132:135], a[12:15], v[8:11]
v_mfma_f32_16x16x32_bf16 v[16:19], a[128:131], a[16:19], v[16:19]
v_mfma_f32_16x16x32_bf16 v[16:19], a[132:135], a[20:23], v[16:19]
v_mfma_f32_16x16x32_bf16 v[24:27], a[128:131], a[24:27], v[24:27]
v_mfma_f32_16x16x32_bf16 v[24:27], a[132:135], a[28:31], v[24:27]
v_mfma_f32_16x16x32_bf16 v[208:211], a[128:131], a[32:35], v[208:211]
v_mfma_f32_16x16x32_bf16 v[208:211], a[132:135], a[36:39], v[208:211]
s_waitcnt lgkmcnt(4)
ds_read_b64_tr_b16 a[128:129], v251 offset:8
v_mfma_f32_16x16x32_bf16 v[4:7], a[136:139], a[0:3], v[4:7]
ds_read_b64_tr_b16 a[130:131], v251 offset:1064
v_mfma_f32_16x16x32_bf16 v[4:7], a[140:143], a[4:7], v[4:7]
ds_read_b64_tr_b16 a[132:133], v251 offset:8456
v_mfma_f32_16x16x32_bf16 v[12:15], a[136:139], a[8:11], v[12:15]
ds_read_b64_tr_b16 a[134:135], v251 offset:9512
v_mfma_f32_16x16x32_bf16 v[12:15], a[140:143], a[12:15], v[12:15]
v_mfma_f32_16x16x32_bf16 v[20:23], a[136:139], a[16:19], v[20:23]
v_mfma_f32_16x16x32_bf16 v[20:23], a[140:143], a[20:23], v[20:23]
v_mfma_f32_16x16x32_bf16 v[28:31], a[136:139], a[24:27], v[28:31]
v_mfma_f32_16x16x32_bf16 v[28:31], a[140:143], a[28:31], v[28:31]
v_mfma_f32_16x16x32_bf16 v[212:215], a[136:139], a[32:35], v[212:215]
v_mfma_f32_16x16x32_bf16 v[212:215], a[140:143], a[36:39], v[212:215]
s_waitcnt lgkmcnt(4)
ds_read_b64_tr_b16 a[136:137], v250 offset:512
v_mfma_f32_16x16x32_bf16 v[32:35], a[120:123], a[0:3], v[32:35]
ds_read_b64_tr_b16 a[138:139], v250 offset:1568
v_mfma_f32_16x16x32_bf16 v[32:35], a[124:127], a[4:7], v[32:35]
s_mov_b32 s17, s72
ds_read_b64_tr_b16 a[140:141], v250 offset:8960
v_mfma_f32_16x16x32_bf16 v[40:43], a[120:123], a[8:11], v[40:43]
s_lshl_b32 s17, s17, 19
ds_read_b64_tr_b16 a[142:143], v250 offset:10016
v_mfma_f32_16x16x32_bf16 v[40:43], a[124:127], a[12:15], v[40:43]
s_add_u32 s16, s53, s17
v_mfma_f32_16x16x32_bf16 v[48:51], a[120:123], a[16:19], v[48:51]
s_add_u32 m0, s55, 33792
v_mfma_f32_16x16x32_bf16 v[48:51], a[124:127], a[20:23], v[48:51]
s_add_u32 s50, s16, 0
v_mfma_f32_16x16x32_bf16 v[56:59], a[120:123], a[24:27], v[56:59]
buffer_load_dwordx4 v253, s[32:35], s50 offen offset:0 lds
v_mfma_f32_16x16x32_bf16 v[56:59], a[124:127], a[28:31], v[56:59]
s_waitcnt lgkmcnt(4)
ds_read_b64_tr_b16 a[120:121], v250 offset:520
v_mfma_f32_16x16x32_bf16 v[36:39], a[128:131], a[0:3], v[36:39]
ds_read_b64_tr_b16 a[122:123], v250 offset:1576
v_mfma_f32_16x16x32_bf16 v[36:39], a[132:135], a[4:7], v[36:39]
ds_read_b64_tr_b16 a[124:125], v250 offset:8968
v_mfma_f32_16x16x32_bf16 v[44:47], a[128:131], a[8:11], v[44:47]
ds_read_b64_tr_b16 a[126:127], v250 offset:10024
v_mfma_f32_16x16x32_bf16 v[44:47], a[132:135], a[12:15], v[44:47]
s_add_u32 s50, s16, 31712
v_mfma_f32_16x16x32_bf16 v[52:55], a[128:131], a[16:19], v[52:55]
buffer_load_dwordx4 v253, s[32:35], s50 offen offset:1056 lds
v_mfma_f32_16x16x32_bf16 v[52:55], a[132:135], a[20:23], v[52:55]
v_mfma_f32_16x16x32_bf16 v[60:63], a[128:131], a[24:27], v[60:63]
v_mfma_f32_16x16x32_bf16 v[60:63], a[132:135], a[28:31], v[60:63]
s_waitcnt lgkmcnt(4)
ds_read_b64_tr_b16 a[128:129], v251 offset:512
v_mfma_f32_16x16x32_bf16 v[64:67], a[136:139], a[0:3], v[64:67]
ds_read_b64_tr_b16 a[130:131], v251 offset:1568
v_mfma_f32_16x16x32_bf16 v[64:67], a[140:143], a[4:7], v[64:67]
s_add_u32 s50, s16, 63416
ds_read_b64_tr_b16 a[132:133], v251 offset:8960
v_mfma_f32_16x16x32_bf16 v[72:75], a[136:139], a[8:11], v[72:75]
ds_read_b64_tr_b16 a[134:135], v251 offset:10016
buffer_load_dwordx4 v253, s[32:35], s50 offen offset:2120 lds
v_mfma_f32_16x16x32_bf16 v[72:75], a[140:143], a[12:15], v[72:75]
v_mfma_f32_16x16x32_bf16 v[80:83], a[136:139], a[16:19], v[80:83]
v_mfma_f32_16x16x32_bf16 v[80:83], a[140:143], a[20:23], v[80:83]
v_mfma_f32_16x16x32_bf16 v[88:91], a[136:139], a[24:27], v[88:91]
v_mfma_f32_16x16x32_bf16 v[88:91], a[140:143], a[28:31], v[88:91]
s_add_u32 s50, s16, 95128
v_mfma_f32_16x16x32_bf16 v[216:219], a[136:139], a[32:35], v[216:219]
buffer_load_dwordx4 v253, s[32:35], s50 offen offset:3176 lds
v_mfma_f32_16x16x32_bf16 v[216:219], a[140:143], a[36:39], v[216:219]
s_waitcnt lgkmcnt(4)
ds_read_b64_tr_b16 a[136:137], v251 offset:520
v_mfma_f32_16x16x32_bf16 v[68:71], a[120:123], a[0:3], v[68:71]
ds_read_b64_tr_b16 a[138:139], v251 offset:1576
v_mfma_f32_16x16x32_bf16 v[68:71], a[124:127], a[4:7], v[68:71]
ds_read_b64_tr_b16 a[140:141], v251 offset:8968
v_mfma_f32_16x16x32_bf16 v[76:79], a[120:123], a[8:11], v[76:79]
s_add_u32 m0, s55, 50688
ds_read_b64_tr_b16 a[142:143], v251 offset:10024
v_mfma_f32_16x16x32_bf16 v[76:79], a[124:127], a[12:15], v[76:79]
s_add_u32 s50, s16, 256
v_mfma_f32_16x16x32_bf16 v[84:87], a[120:123], a[16:19], v[84:87]
buffer_load_dwordx4 v253, s[32:35], s50 offen offset:0 lds
v_mfma_f32_16x16x32_bf16 v[84:87], a[124:127], a[20:23], v[84:87]
v_mfma_f32_16x16x32_bf16 v[92:95], a[120:123], a[24:27], v[92:95]
v_mfma_f32_16x16x32_bf16 v[92:95], a[124:127], a[28:31], v[92:95]
v_mfma_f32_16x16x32_bf16 v[220:223], a[120:123], a[32:35], v[220:223]
s_waitcnt vmcnt(19) lgkmcnt(0)
v_mfma_f32_16x16x32_bf16 v[220:223], a[124:127], a[36:39], v[220:223]
s_barrier
v_mfma_f32_16x16x32_bf16 v[96:99], a[128:131], a[0:3], v[96:99]
s_add_u32 s50, s16, 31968
ds_read_b64_tr_b16 a[120:121], v250 offset:16896
v_mfma_f32_16x16x32_bf16 v[96:99], a[132:135], a[4:7], v[96:99]
ds_read_b64_tr_b16 a[122:123], v250 offset:17952
buffer_load_dwordx4 v253, s[32:35], s50 offen offset:1056 lds
v_mfma_f32_16x16x32_bf16 v[104:107], a[128:131], a[8:11], v[104:107]
ds_read_b64_tr_b16 a[124:125], v250 offset:25344
v_mfma_f32_16x16x32_bf16 v[104:107], a[132:135], a[12:15], v[104:107]
ds_read_b64_tr_b16 a[126:127], v250 offset:26400
v_mfma_f32_16x16x32_bf16 v[112:115], a[128:131], a[16:19], v[112:115]
v_mfma_f32_16x16x32_bf16 v[112:115], a[132:135], a[20:23], v[112:115]
v_mfma_f32_16x16x32_bf16 v[120:123], a[128:131], a[24:27], v[120:123]
s_add_u32 s50, s16, 63672
v_mfma_f32_16x16x32_bf16 v[120:123], a[132:135], a[28:31], v[120:123]
ds_read_b64_tr_b16 a[128:129], v250 offset:16904
buffer_load_dwordx4 v253, s[32:35], s50 offen offset:2120 lds
v_mfma_f32_16x16x32_bf16 v[100:103], a[136:139], a[0:3], v[100:103]
ds_read_b64_tr_b16 a[130:131], v250 offset:17960
v_mfma_f32_16x16x32_bf16 v[100:103], a[140:143], a[4:7], v[100:103]
ds_read_b64_tr_b16 a[132:133], v250 offset:25352
v_mfma_f32_16x16x32_bf16 v[108:111], a[136:139], a[8:11], v[108:111]
ds_read_b64_tr_b16 a[134:135], v250 offset:26408
v_mfma_f32_16x16x32_bf16 v[108:111], a[140:143], a[12:15], v[108:111]
v_mfma_f32_16x16x32_bf16 v[116:119], a[136:139], a[16:19], v[116:119]
s_add_u32 s50, s16, 95384
v_mfma_f32_16x16x32_bf16 v[116:119], a[140:143], a[20:23], v[116:119]
buffer_load_dwordx4 v253, s[32:35], s50 offen offset:3176 lds
v_mfma_f32_16x16x32_bf16 v[124:127], a[136:139], a[24:27], v[124:127]
v_mfma_f32_16x16x32_bf16 v[124:127], a[140:143], a[28:31], v[124:127]
s_waitcnt lgkmcnt(4)
ds_read_b64_tr_b16 a[136:137], v251 offset:16896
v_mfma_f32_16x16x32_bf16 v[128:131], a[120:123], a[0:3], v[128:131]
ds_read_b64_tr_b16 a[138:139], v251 offset:17952
v_mfma_f32_16x16x32_bf16 v[128:131], a[124:127], a[4:7], v[128:131]
s_mov_b32 m0, s58
ds_read_b64_tr_b16 a[140:141], v251 offset:25344
v_mfma_f32_16x16x32_bf16 v[136:139], a[120:123], a[8:11], v[136:139]
ds_read_b64_tr_b16 a[142:143], v251 offset:26400
buffer_load_dwordx4 v248, s[36:39], s56 offen offset:0 nt lds
v_mfma_f32_16x16x32_bf16 v[136:139], a[124:127], a[12:15], v[136:139]
v_mfma_f32_16x16x32_bf16 v[144:147], a[120:123], a[16:19], v[144:147]
v_mfma_f32_16x16x32_bf16 v[144:147], a[124:127], a[20:23], v[144:147]
v_mfma_f32_16x16x32_bf16 v[152:155], a[120:123], a[24:27], v[152:155]
v_mfma_f32_16x16x32_bf16 v[152:155], a[124:127], a[28:31], v[152:155]
s_add_u32 m0, s58, 32
v_mfma_f32_16x16x32_bf16 v[224:227], a[120:123], a[32:35], v[224:227]
buffer_load_dwordx4 v248, s[36:39], s56 offen offset:1024 nt lds
v_mfma_f32_16x16x32_bf16 v[224:227], a[124:127], a[36:39], v[224:227]
s_waitcnt lgkmcnt(4)
ds_read_b64_tr_b16 a[120:121], v251 offset:16904
v_mfma_f32_16x16x32_bf16 v[132:135], a[128:131], a[0:3], v[132:135]
ds_read_b64_tr_b16 a[122:123], v251 offset:17960
v_mfma_f32_16x16x32_bf16 v[132:135], a[132:135], a[4:7], v[132:135]
ds_read_b64_tr_b16 a[124:125], v251 offset:25352
v_mfma_f32_16x16x32_bf16 v[140:143], a[128:131], a[8:11], v[140:143]
ds_read_b64_tr_b16 a[126:127], v251 offset:26408
v_mfma_f32_16x16x32_bf16 v[140:143], a[132:135], a[12:15], v[140:143]
s_add_u32 m0, s58, 64
v_mfma_f32_16x16x32_bf16 v[148:151], a[128:131], a[16:19], v[148:151]
buffer_load_dwordx4 v248, s[36:39], s56 offen offset:2048 nt lds
v_mfma_f32_16x16x32_bf16 v[148:151], a[132:135], a[20:23], v[148:151]
v_mfma_f32_16x16x32_bf16 v[156:159], a[128:131], a[24:27], v[156:159]
v_mfma_f32_16x16x32_bf16 v[156:159], a[132:135], a[28:31], v[156:159]
v_mfma_f32_16x16x32_bf16 v[228:231], a[128:131], a[32:35], v[228:231]
v_mfma_f32_16x16x32_bf16 v[228:231], a[132:135], a[36:39], v[228:231]
s_waitcnt lgkmcnt(4)
ds_read_b64_tr_b16 a[128:129], v250 offset:17408
v_mfma_f32_16x16x32_bf16 v[160:163], a[136:139], a[0:3], v[160:163]
s_add_u32 m0, s58, 96
ds_read_b64_tr_b16 a[130:131], v250 offset:18464
v_mfma_f32_16x16x32_bf16 v[160:163], a[140:143], a[4:7], v[160:163]
ds_read_b64_tr_b16 a[132:133], v250 offset:25856
buffer_load_dwordx4 v248, s[36:39], s56 offen offset:3072 nt lds
v_mfma_f32_16x16x32_bf16 v[168:171], a[136:139], a[8:11], v[168:171]
s_add_u32 s56, s56, 16384
ds_read_b64_tr_b16 a[134:135], v250 offset:26912
v_mfma_f32_16x16x32_bf16 v[168:171], a[140:143], a[12:15], v[168:171]
s_add_u32 s58, s58, 16896
v_mfma_f32_16x16x32_bf16 v[176:179], a[136:139], a[16:19], v[176:179]
s_cmp_eq_u32 s58, s69
v_mfma_f32_16x16x32_bf16 v[176:179], a[140:143], a[20:23], v[176:179]
s_cselect_b32 s58, s67, s58
v_mfma_f32_16x16x32_bf16 v[184:187], a[136:139], a[24:27], v[184:187]
v_mfma_f32_16x16x32_bf16 v[184:187], a[140:143], a[28:31], v[184:187]
s_waitcnt lgkmcnt(4)
ds_read_b64_tr_b16 a[136:137], v250 offset:17416
v_mfma_f32_16x16x32_bf16 v[164:167], a[120:123], a[0:3], v[164:167]
s_waitcnt vmcnt(15)
ds_read_b64_tr_b16 a[138:139], v250 offset:18472
v_mfma_f32_16x16x32_bf16 v[164:167], a[124:127], a[4:7], v[164:167]
ds_read_b64_tr_b16 a[140:141], v250 offset:25864
v_mfma_f32_16x16x32_bf16 v[172:175], a[120:123], a[8:11], v[172:175]
ds_read_b64_tr_b16 a[142:143], v250 offset:26920
v_mfma_f32_16x16x32_bf16 v[172:175], a[124:127], a[12:15], v[172:175]
ds_read_b128 a[80:83], v252 offset:0
v_mfma_f32_16x16x32_bf16 v[180:183], a[120:123], a[16:19], v[180:183]
ds_read_b128 a[84:87], v252 offset:512
v_mfma_f32_16x16x32_bf16 v[180:183], a[124:127], a[20:23], v[180:183]
ds_read_b128 a[88:91], v252 offset:2112
v_mfma_f32_16x16x32_bf16 v[188:191], a[120:123], a[24:27], v[188:191]
ds_read_b128 a[92:95], v252 offset:2624
v_mfma_f32_16x16x32_bf16 v[188:191], a[124:127], a[28:31], v[188:191]
s_waitcnt lgkmcnt(8)
ds_read_b64_tr_b16 a[120:121], v251 offset:17408
v_mfma_f32_16x16x32_bf16 v[192:195], a[128:131], a[0:3], v[192:195]
ds_read_b64_tr_b16 a[122:123], v251 offset:18464
v_mfma_f32_16x16x32_bf16 v[192:195], a[132:135], a[4:7], v[192:195]
ds_read_b64_tr_b16 a[124:125], v251 offset:25856
v_mfma_f32_16x16x32_bf16 v[200:203], a[128:131], a[8:11], v[200:203]
ds_read_b64_tr_b16 a[126:127], v251 offset:26912
v_mfma_f32_16x16x32_bf16 v[200:203], a[132:135], a[12:15], v[200:203]
ds_read_b128 a[96:99], v252 offset:4224
v_mfma_f32_16x16x32_bf16 a[160:163], a[128:131], a[16:19], a[160:163]
ds_read_b128 a[100:103], v252 offset:4736
v_mfma_f32_16x16x32_bf16 a[160:163], a[132:135], a[20:23], a[160:163]
ds_read_b128 a[104:107], v252 offset:6336
v_mfma_f32_16x16x32_bf16 a[168:171], a[128:131], a[24:27], a[168:171]
ds_read_b128 a[108:111], v252 offset:6848
v_mfma_f32_16x16x32_bf16 a[168:171], a[132:135], a[28:31], a[168:171]
ds_read_b128 a[112:115], v252 offset:8448
v_mfma_f32_16x16x32_bf16 v[232:235], a[128:131], a[32:35], v[232:235]
ds_read_b128 a[116:119], v252 offset:8960
v_mfma_f32_16x16x32_bf16 v[232:235], a[132:135], a[36:39], v[232:235]
s_waitcnt lgkmcnt(14)
ds_read_b64_tr_b16 a[128:129], v251 offset:17416
v_mfma_f32_16x16x32_bf16 v[196:199], a[136:139], a[0:3], v[196:199]
ds_read_b64_tr_b16 a[130:131], v251 offset:18472
v_mfma_f32_16x16x32_bf16 v[196:199], a[140:143], a[4:7], v[196:199]
ds_read_b64_tr_b16 a[132:133], v251 offset:25864
v_mfma_f32_16x16x32_bf16 v[204:207], a[136:139], a[8:11], v[204:207]
ds_read_b64_tr_b16 a[134:135], v251 offset:26920
v_mfma_f32_16x16x32_bf16 v[204:207], a[140:143], a[12:15], v[204:207]
v_mfma_f32_16x16x32_bf16 a[164:167], a[136:139], a[16:19], a[164:167]
v_mfma_f32_16x16x32_bf16 a[164:167], a[140:143], a[20:23], a[164:167]
v_mfma_f32_16x16x32_bf16 a[172:175], a[136:139], a[24:27], a[172:175]
v_mfma_f32_16x16x32_bf16 a[172:175], a[140:143], a[28:31], a[172:175]
v_mfma_f32_16x16x32_bf16 v[236:239], a[136:139], a[32:35], v[236:239]
s_waitcnt vmcnt(8) lgkmcnt(0)
v_mfma_f32_16x16x32_bf16 v[236:239], a[140:143], a[36:39], v[236:239]
s_barrier
v_mfma_f32_16x16x32_bf16 a[176:179], a[120:123], a[0:3], a[176:179]
s_mov_b32 m0, s58
ds_read_b64_tr_b16 a[136:137], v250 offset:33792
v_mfma_f32_16x16x32_bf16 a[176:179], a[124:127], a[4:7], a[176:179]
ds_read_b64_tr_b16 a[138:139], v250 offset:34848
buffer_load_dwordx4 v248, s[36:39], s56 offen offset:0 nt lds
v_mfma_f32_16x16x32_bf16 a[184:187], a[120:123], a[8:11], a[184:187]
ds_read_b64_tr_b16 a[140:141], v250 offset:42240
v_mfma_f32_16x16x32_bf16 a[184:187], a[124:127], a[12:15], a[184:187]
ds_read_b64_tr_b16 a[142:143], v250 offset:43296
v_mfma_f32_16x16x32_bf16 a[192:195], a[120:123], a[16:19], a[192:195]
v_mfma_f32_16x16x32_bf16 a[192:195], a[124:127], a[20:23], a[192:195]
v_mfma_f32_16x16x32_bf16 a[200:203], a[120:123], a[24:27], a[200:203]
s_add_u32 m0, s58, 32
v_mfma_f32_16x16x32_bf16 a[200:203], a[124:127], a[28:31], a[200:203]
ds_read_b64_tr_b16 a[120:121], v250 offset:33800
buffer_load_dwordx4 v248, s[36:39], s56 offen offset:1024 nt lds
v_mfma_f32_16x16x32_bf16 a[180:183], a[128:131], a[0:3], a[180:183]
ds_read_b64_tr_b16 a[122:123], v250 offset:34856
v_mfma_f32_16x16x32_bf16 a[180:183], a[132:135], a[4:7], a[180:183]
ds_read_b64_tr_b16 a[124:125], v250 offset:42248
v_mfma_f32_16x16x32_bf16 a[188:191], a[128:131], a[8:11], a[188:191]
ds_read_b64_tr_b16 a[126:127], v250 offset:43304
v_mfma_f32_16x16x32_bf16 a[188:191], a[132:135], a[12:15], a[188:191]
v_mfma_f32_16x16x32_bf16 a[196:199], a[128:131], a[16:19], a[196:199]
s_add_u32 m0, s58, 64
v_mfma_f32_16x16x32_bf16 a[196:199], a[132:135], a[20:23], a[196:199]
buffer_load_dwordx4 v248, s[36:39], s56 offen offset:2048 nt lds
v_mfma_f32_16x16x32_bf16 a[204:207], a[128:131], a[24:27], a[204:207]
v_mfma_f32_16x16x32_bf16 a[204:207], a[132:135], a[28:31], a[204:207]
s_waitcnt lgkmcnt(4)
ds_read_b64_tr_b16 a[128:129], v251 offset:33792
v_mfma_f32_16x16x32_bf16 v[0:3], a[136:139], a[80:83], v[0:3]
ds_read_b64_tr_b16 a[130:131], v251 offset:34848
v_add_u32 v254, s18, v249
v_mfma_f32_16x16x32_bf16 v[0:3], a[140:143], a[84:87], v[0:3]
ds_read_b64_tr_b16 a[132:133], v251 offset:42240
v_mfma_f32_16x16x32_bf16 v[8:11], a[136:139], a[88:91], v[8:11]
s_add_u32 m0, s58, 96
ds_read_b64_tr_b16 a[134:135], v251 offset:43296
v_mfma_f32_16x16x32_bf16 v[8:11], a[140:143], a[92:95], v[8:11]
buffer_load_dwordx4 v248, s[36:39], s56 offen offset:3072 nt lds
v_mfma_f32_16x16x32_bf16 v[16:19], a[136:139], a[96:99], v[16:19]
s_add_u32 s56, s56, 16384
v_mfma_f32_16x16x32_bf16 v[16:19], a[140:143], a[100:103], v[16:19]
s_add_u32 s58, s58, 16896
v_mfma_f32_16x16x32_bf16 v[24:27], a[136:139], a[104:107], v[24:27]
s_cmp_eq_u32 s58, s69
v_mfma_f32_16x16x32_bf16 v[24:27], a[140:143], a[108:111], v[24:27]
s_cselect_b32 s58, s67, s58
v_mfma_f32_16x16x32_bf16 v[208:211], a[136:139], a[112:115], v[208:211]
v_mfma_f32_16x16x32_bf16 v[208:211], a[140:143], a[116:119], v[208:211]
s_waitcnt lgkmcnt(4)
ds_read_b64_tr_b16 a[136:137], v251 offset:33800
v_mfma_f32_16x16x32_bf16 v[4:7], a[120:123], a[80:83], v[4:7]
ds_read_b64_tr_b16 a[138:139], v251 offset:34856
v_mfma_f32_16x16x32_bf16 v[4:7], a[124:127], a[84:87], v[4:7]
ds_read_b64_tr_b16 a[140:141], v251 offset:42248
v_mfma_f32_16x16x32_bf16 v[12:15], a[120:123], a[88:91], v[12:15]
ds_read_b64_tr_b16 a[142:143], v251 offset:43304
v_mfma_f32_16x16x32_bf16 v[12:15], a[124:127], a[92:95], v[12:15]
v_mfma_f32_16x16x32_bf16 v[20:23], a[120:123], a[96:99], v[20:23]
v_mfma_f32_16x16x32_bf16 v[20:23], a[124:127], a[100:103], v[20:23]
v_mfma_f32_16x16x32_bf16 v[28:31], a[120:123], a[104:107], v[28:31]
v_mfma_f32_16x16x32_bf16 v[28:31], a[124:127], a[108:111], v[28:31]
v_mfma_f32_16x16x32_bf16 v[212:215], a[120:123], a[112:115], v[212:215]
v_mfma_f32_16x16x32_bf16 v[212:215], a[124:127], a[116:119], v[212:215]
s_waitcnt lgkmcnt(4)
ds_read_b64_tr_b16 a[120:121], v250 offset:34304
v_mfma_f32_16x16x32_bf16 v[32:35], a[128:131], a[80:83], v[32:35]
ds_read_b64_tr_b16 a[122:123], v250 offset:35360
v_mfma_f32_16x16x32_bf16 v[32:35], a[132:135], a[84:87], v[32:35]
ds_read_b64_tr_b16 a[124:125], v250 offset:42752
v_mfma_f32_16x16x32_bf16 v[40:43], a[128:131], a[88:91], v[40:43]
ds_read_b64_tr_b16 a[126:127], v250 offset:43808
v_mfma_f32_16x16x32_bf16 v[40:43], a[132:135], a[92:95], v[40:43]
v_mfma_f32_16x16x32_bf16 v[48:51], a[128:131], a[96:99], v[48:51]
v_mul_f32 v208, v255, v208
v_mul_f32 v209, v255, v209
v_mfma_f32_16x16x32_bf16 v[48:51], a[132:135], a[100:103], v[48:51]
v_mul_f32 v210, v255, v210
v_mul_f32 v211, v255, v211
v_mfma_f32_16x16x32_bf16 v[56:59], a[128:131], a[104:107], v[56:59]
v_mul_f32 v212, v255, v212
v_mul_f32 v213, v255, v213
v_mfma_f32_16x16x32_bf16 v[56:59], a[132:135], a[108:111], v[56:59]
s_waitcnt lgkmcnt(4)
ds_read_b64_tr_b16 a[128:129], v250 offset:34312
v_mul_f32 v214, v255, v214
v_mfma_f32_16x16x32_bf16 v[36:39], a[136:139], a[80:83], v[36:39]
ds_read_b64_tr_b16 a[130:131], v250 offset:35368
v_mul_f32_e64 v215, v255, v215
v_mfma_f32_16x16x32_bf16 v[36:39], a[140:143], a[84:87], v[36:39]
ds_read_b64_tr_b16 a[132:133], v250 offset:42760
v_cvt_pk_bf16_f32 v208, v208, v209
v_mfma_f32_16x16x32_bf16 v[44:47], a[136:139], a[88:91], v[44:47]
ds_read_b64_tr_b16 a[134:135], v250 offset:43816
v_cvt_pk_bf16_f32 v209, v210, v211
v_mfma_f32_16x16x32_bf16 v[44:47], a[140:143], a[92:95], v[44:47]
v_cvt_pk_bf16_f32 v210, v212, v213
v_cvt_pk_bf16_f32 v211, v214, v215
v_mfma_f32_16x16x32_bf16 v[52:55], a[136:139], a[96:99], v[52:55]
v_accvgpr_write_b32 a64, v208
v_accvgpr_write_b32 a65, v209
v_mfma_f32_16x16x32_bf16 v[52:55], a[140:143], a[100:103], v[52:55]
v_accvgpr_write_b32 a66, v210
v_accvgpr_write_b32 a67, v211
v_mfma_f32_16x16x32_bf16 v[60:63], a[136:139], a[104:107], v[60:63]
v_mul_f32 v0, v255, v0
v_mul_f32 v1, v255, v1
v_mfma_f32_16x16x32_bf16 v[60:63], a[140:143], a[108:111], v[60:63]
s_waitcnt lgkmcnt(4)
ds_read_b64_tr_b16 a[136:137], v251 offset:34304
v_mul_f32 v2, v255, v2
v_mfma_f32_16x16x32_bf16 v[64:67], a[120:123], a[80:83], v[64:67]
ds_read_b64_tr_b16 a[138:139], v251 offset:35360
v_mul_f32 v3, v255, v3
v_mfma_f32_16x16x32_bf16 v[64:67], a[124:127], a[84:87], v[64:67]
ds_read_b64_tr_b16 a[140:141], v251 offset:42752
v_mul_f32 v4, v255, v4
v_mfma_f32_16x16x32_bf16 v[72:75], a[120:123], a[88:91], v[72:75]
ds_read_b64_tr_b16 a[142:143], v251 offset:43808
v_mul_f32 v5, v255, v5
v_mfma_f32_16x16x32_bf16 v[72:75], a[124:127], a[92:95], v[72:75]
v_mul_f32 v6, v255, v6
v_mul_f32_e64 v7, v255, v7
v_mfma_f32_16x16x32_bf16 v[80:83], a[120:123], a[96:99], v[80:83]
v_cvt_pk_bf16_f32 v0, v0, v1
v_cvt_pk_bf16_f32 v1, v2, v3
v_mfma_f32_16x16x32_bf16 v[80:83], a[124:127], a[100:103], v[80:83]
v_cvt_pk_bf16_f32 v2, v4, v5
v_cvt_pk_bf16_f32 v3, v6, v7
v_mfma_f32_16x16x32_bf16 v[88:91], a[120:123], a[104:107], v[88:91]
v_accvgpr_write_b32 a0, v0
v_accvgpr_write_b32 a1, v1
v_mfma_f32_16x16x32_bf16 v[88:91], a[124:127], a[108:111], v[88:91]
v_accvgpr_write_b32 a2, v2
v_accvgpr_write_b32 a3, v3
v_mfma_f32_16x16x32_bf16 v[216:219], a[120:123], a[112:115], v[216:219]
v_mul_f32 v8, v255, v8
v_mul_f32 v9, v255, v9
v_mfma_f32_16x16x32_bf16 v[216:219], a[124:127], a[116:119], v[216:219]
s_waitcnt lgkmcnt(4)
ds_read_b64_tr_b16 a[120:121], v251 offset:34312
v_mul_f32 v10, v255, v10
v_mfma_f32_16x16x32_bf16 v[68:71], a[128:131], a[80:83], v[68:71]
ds_read_b64_tr_b16 a[122:123], v251 offset:35368
v_mul_f32 v11, v255, v11
v_mfma_f32_16x16x32_bf16 v[68:71], a[132:135], a[84:87], v[68:71]
ds_read_b64_tr_b16 a[124:125], v251 offset:42760
v_mul_f32 v12, v255, v12
v_mfma_f32_16x16x32_bf16 v[76:79], a[128:131], a[88:91], v[76:79]
ds_read_b64_tr_b16 a[126:127], v251 offset:43816
v_mul_f32 v13, v255, v13
v_mfma_f32_16x16x32_bf16 v[76:79], a[132:135], a[92:95], v[76:79]
v_mul_f32 v14, v255, v14
v_mul_f32_e64 v15, v255, v15
v_mfma_f32_16x16x32_bf16 v[84:87], a[128:131], a[96:99], v[84:87]
v_cvt_pk_bf16_f32 v8, v8, v9
v_cvt_pk_bf16_f32 v9, v10, v11
v_mfma_f32_16x16x32_bf16 v[84:87], a[132:135], a[100:103], v[84:87]
v_cvt_pk_bf16_f32 v10, v12, v13
v_cvt_pk_bf16_f32 v11, v14, v15
v_mfma_f32_16x16x32_bf16 v[92:95], a[128:131], a[104:107], v[92:95]
v_accvgpr_write_b32 a16, v8
v_accvgpr_write_b32 a17, v9
v_mfma_f32_16x16x32_bf16 v[92:95], a[132:135], a[108:111], v[92:95]
v_accvgpr_write_b32 a18, v10
v_accvgpr_write_b32 a19, v11
v_mfma_f32_16x16x32_bf16 v[220:223], a[128:131], a[112:115], v[220:223]
s_waitcnt vmcnt(8) lgkmcnt(0)
v_mul_f32 v16, v255, v16
v_mfma_f32_16x16x32_bf16 v[220:223], a[132:135], a[116:119], v[220:223]
s_barrier
v_mfma_f32_16x16x32_bf16 v[96:99], a[136:139], a[80:83], v[96:99]
s_mov_b32 m0, s59
ds_read_b64_tr_b16 a[128:129], v250 offset:50688
v_mul_f32 v17, v255, v17
v_mfma_f32_16x16x32_bf16 v[96:99], a[140:143], a[84:87], v[96:99]
ds_read_b64_tr_b16 a[130:131], v250 offset:51744
buffer_load_dwordx4 v248, s[40:43], s57 offen offset:0 nt lds
v_mfma_f32_16x16x32_bf16 v[104:107], a[136:139], a[88:91], v[104:107]
ds_read_b64_tr_b16 a[132:133], v250 offset:59136
v_mul_f32 v18, v255, v18
v_mfma_f32_16x16x32_bf16 v[104:107], a[140:143], a[92:95], v[104:107]
ds_read_b64_tr_b16 a[134:135], v250 offset:60192
v_mul_f32 v19, v255, v19
v_mfma_f32_16x16x32_bf16 v[112:115], a[136:139], a[96:99], v[112:115]
v_mul_f32 v20, v255, v20
v_mul_f32 v21, v255, v21
v_mfma_f32_16x16x32_bf16 v[112:115], a[140:143], a[100:103], v[112:115]
v_mul_f32 v22, v255, v22
v_mul_f32 v23, v255, v23
v_mfma_f32_16x16x32_bf16 v[120:123], a[136:139], a[104:107], v[120:123]
s_add_u32 m0, s59, 32
v_cvt_pk_bf16_f32 v16, v16, v17
v_cvt_pk_bf16_f32 v17, v18, v19
v_mfma_f32_16x16x32_bf16 v[120:123], a[140:143], a[108:111], v[120:123]
ds_read_b64_tr_b16 a[136:137], v250 offset:50696
buffer_load_dwordx4 v248, s[40:43], s57 offen offset:1024 nt lds
v_mfma_f32_16x16x32_bf16 v[100:103], a[120:123], a[80:83], v[100:103]
ds_read_b64_tr_b16 a[138:139], v250 offset:51752
v_cvt_pk_bf16_f32 v18, v20, v21
v_mfma_f32_16x16x32_bf16 v[100:103], a[124:127], a[84:87], v[100:103]
ds_read_b64_tr_b16 a[140:141], v250 offset:59144
v_cvt_pk_bf16_f32 v19, v22, v23
v_mfma_f32_16x16x32_bf16 v[108:111], a[120:123], a[88:91], v[108:111]
ds_read_b64_tr_b16 a[142:143], v250 offset:60200
v_accvgpr_write_b32 a32, v16
v_mfma_f32_16x16x32_bf16 v[108:111], a[124:127], a[92:95], v[108:111]
v_accvgpr_write_b32 a33, v17
v_accvgpr_write_b32 a34, v18
v_mfma_f32_16x16x32_bf16 v[116:119], a[120:123], a[96:99], v[116:119]
s_add_u32 m0, s59, 64
v_accvgpr_write_b32 a35, v19
v_mul_f32 v24, v255, v24
v_mfma_f32_16x16x32_bf16 v[116:119], a[124:127], a[100:103], v[116:119]
buffer_load_dwordx4 v248, s[40:43], s57 offen offset:2048 nt lds
v_mul_f32 v25, v255, v25
v_mfma_f32_16x16x32_bf16 v[124:127], a[120:123], a[104:107], v[124:127]
v_mul_f32 v26, v255, v26
v_mul_f32 v27, v255, v27
v_mfma_f32_16x16x32_bf16 v[124:127], a[124:127], a[108:111], v[124:127]
s_waitcnt lgkmcnt(4)
ds_read_b64_tr_b16 a[120:121], v251 offset:50688
v_mul_f32 v28, v255, v28
v_mfma_f32_16x16x32_bf16 v[128:131], a[128:131], a[80:83], v[128:131]
ds_read_b64_tr_b16 a[122:123], v251 offset:51744
v_mul_f32 v29, v255, v29
v_mfma_f32_16x16x32_bf16 v[128:131], a[132:135], a[84:87], v[128:131]
ds_read_b64_tr_b16 a[124:125], v251 offset:59136
v_mul_f32 v30, v255, v30
v_mfma_f32_16x16x32_bf16 v[136:139], a[128:131], a[88:91], v[136:139]
s_add_u32 m0, s59, 96
ds_read_b64_tr_b16 a[126:127], v251 offset:60192
v_mul_f32 v31, v255, v31
v_mfma_f32_16x16x32_bf16 v[136:139], a[132:135], a[92:95], v[136:139]
buffer_load_dwordx4 v248, s[40:43], s57 offen offset:3072 nt lds
v_cvt_pk_bf16_f32 v24, v24, v25
v_mfma_f32_16x16x32_bf16 v[144:147], a[128:131], a[96:99], v[144:147]
s_add_u32 s57, s57, 16384
v_cvt_pk_bf16_f32 v25, v26, v27
v_cvt_pk_bf16_f32 v26, v28, v29
v_mfma_f32_16x16x32_bf16 v[144:147], a[132:135], a[100:103], v[144:147]
s_add_u32 s59, s59, 16896
v_cvt_pk_bf16_f32 v27, v30, v31
v_accvgpr_write_b32 a48, v24
v_mfma_f32_16x16x32_bf16 v[152:155], a[128:131], a[104:107], v[152:155]
s_cmp_eq_u32 s59, s70
v_accvgpr_write_b32 a49, v25
v_accvgpr_write_b32 a50, v26
v_mfma_f32_16x16x32_bf16 v[152:155], a[132:135], a[108:111], v[152:155]
s_cselect_b32 s59, s68, s59
v_accvgpr_write_b32 a51, v27
v_mul_f32 v32, v255, v32
v_mfma_f32_16x16x32_bf16 v[224:227], a[128:131], a[112:115], v[224:227]
s_mov_b32 m0, s58
v_mul_f32 v33, v255, v33
v_mul_f32 v34, v255, v34
v_mfma_f32_16x16x32_bf16 v[224:227], a[132:135], a[116:119], v[224:227]
s_waitcnt lgkmcnt(4)
ds_read_b64_tr_b16 a[128:129], v251 offset:50696
buffer_load_dwordx4 v248, s[36:39], s56 offen offset:0 nt lds
v_mfma_f32_16x16x32_bf16 v[132:135], a[136:139], a[80:83], v[132:135]
ds_read_b64_tr_b16 a[130:131], v251 offset:51752
v_mul_f32 v35, v255, v35
v_mfma_f32_16x16x32_bf16 v[132:135], a[140:143], a[84:87], v[132:135]
ds_read_b64_tr_b16 a[132:133], v251 offset:59144
v_mul_f32 v36, v255, v36
v_mfma_f32_16x16x32_bf16 v[140:143], a[136:139], a[88:91], v[140:143]
ds_read_b64_tr_b16 a[134:135], v251 offset:60200
v_mul_f32 v37, v255, v37
v_mfma_f32_16x16x32_bf16 v[140:143], a[140:143], a[92:95], v[140:143]
v_mul_f32 v38, v255, v38
v_mul_f32 v39, v255, v39
v_mfma_f32_16x16x32_bf16 v[148:151], a[136:139], a[96:99], v[148:151]
s_add_u32 m0, s58, 32
v_cvt_pk_bf16_f32 v32, v32, v33
v_cvt_pk_bf16_f32 v33, v34, v35
v_mfma_f32_16x16x32_bf16 v[148:151], a[140:143], a[100:103], v[148:151]
buffer_load_dwordx4 v248, s[36:39], s56 offen offset:1024 nt lds
v_cvt_pk_bf16_f32 v34, v36, v37
v_mfma_f32_16x16x32_bf16 v[156:159], a[136:139], a[104:107], v[156:159]
v_cvt_pk_bf16_f32 v35, v38, v39
v_accvgpr_write_b32 a4, v32
v_mfma_f32_16x16x32_bf16 v[156:159], a[140:143], a[108:111], v[156:159]
v_accvgpr_write_b32 a5, v33
v_accvgpr_write_b32 a6, v34
v_mfma_f32_16x16x32_bf16 v[228:231], a[136:139], a[112:115], v[228:231]
v_accvgpr_write_b32 a7, v35
v_mul_f32 v40, v255, v40
v_mfma_f32_16x16x32_bf16 v[228:231], a[140:143], a[116:119], v[228:231]
s_waitcnt lgkmcnt(4)
ds_read_b64_tr_b16 a[136:137], v250 offset:51200
v_mul_f32 v41, v255, v41
v_mfma_f32_16x16x32_bf16 v[160:163], a[120:123], a[80:83], v[160:163]
s_add_u32 m0, s58, 64
ds_read_b64_tr_b16 a[138:139], v250 offset:52256
v_mul_f32 v42, v255, v42
v_mfma_f32_16x16x32_bf16 v[160:163], a[124:127], a[84:87], v[160:163]
ds_read_b64_tr_b16 a[140:141], v250 offset:59648
buffer_load_dwordx4 v248, s[36:39], s56 offen offset:2048 nt lds
v_mfma_f32_16x16x32_bf16 v[168:171], a[120:123], a[88:91], v[168:171]
ds_read_b64_tr_b16 a[142:143], v250 offset:60704
v_mul_f32 v43, v255, v43
v_mfma_f32_16x16x32_bf16 v[168:171], a[124:127], a[92:95], v[168:171]
v_mul_f32 v44, v255, v44
v_mul_f32 v45, v255, v45
v_mfma_f32_16x16x32_bf16 v[176:179], a[120:123], a[96:99], v[176:179]
v_mul_f32 v46, v255, v46
v_mul_f32_e64 v47, v255, v47
v_mfma_f32_16x16x32_bf16 v[176:179], a[124:127], a[100:103], v[176:179]
v_cvt_pk_bf16_f32 v40, v40, v41
v_cvt_pk_bf16_f32 v41, v42, v43
v_mfma_f32_16x16x32_bf16 v[184:187], a[120:123], a[104:107], v[184:187]
s_add_u32 m0, s58, 96
v_cvt_pk_bf16_f32 v42, v44, v45
v_cvt_pk_bf16_f32 v43, v46, v47
v_mfma_f32_16x16x32_bf16 v[184:187], a[124:127], a[108:111], v[184:187]
s_waitcnt lgkmcnt(4)
ds_read_b64_tr_b16 a[120:121], v250 offset:51208
buffer_load_dwordx4 v248, s[36:39], s56 offen offset:3072 nt lds
v_mfma_f32_16x16x32_bf16 v[164:167], a[128:131], a[80:83], v[164:167]
s_add_u32 s56, s56, 16384
ds_read_b64_tr_b16 a[122:123], v250 offset:52264
v_accvgpr_write_b32 a20, v40
v_mfma_f32_16x16x32_bf16 v[164:167], a[132:135], a[84:87], v[164:167]
s_add_u32 s58, s58, 16896
ds_read_b64_tr_b16 a[124:125], v250 offset:59656
v_accvgpr_write_b32 a21, v41
v_mfma_f32_16x16x32_bf16 v[172:175], a[128:131], a[88:91], v[172:175]
s_cmp_eq_u32 s58, s69
ds_read_b64_tr_b16 a[126:127], v250 offset:60712
v_accvgpr_write_b32 a22, v42
v_mfma_f32_16x16x32_bf16 v[172:175], a[132:135], a[92:95], v[172:175]
s_cselect_b32 s58, s67, s58
v_accvgpr_write_b32 a23, v43
v_mul_f32 v48, v255, v48
v_mfma_f32_16x16x32_bf16 v[180:183], a[128:131], a[96:99], v[180:183]
s_mov_b32 m0, s59
v_mul_f32 v49, v255, v49
v_mul_f32 v50, v255, v50
v_mfma_f32_16x16x32_bf16 v[180:183], a[132:135], a[100:103], v[180:183]
buffer_load_dwordx4 v248, s[40:43], s57 offen offset:0 nt lds
v_mul_f32 v51, v255, v51
v_mfma_f32_16x16x32_bf16 v[188:191], a[128:131], a[104:107], v[188:191]
v_mul_f32 v52, v255, v52
v_mul_f32 v53, v255, v53
v_mfma_f32_16x16x32_bf16 v[188:191], a[132:135], a[108:111], v[188:191]
s_waitcnt lgkmcnt(4)
ds_read_b64_tr_b16 a[128:129], v251 offset:51200
v_mul_f32 v54, v255, v54
v_mfma_f32_16x16x32_bf16 v[192:195], a[136:139], a[80:83], v[192:195]
ds_read_b64_tr_b16 a[130:131], v251 offset:52256
v_mul_f32 v55, v255, v55
v_mfma_f32_16x16x32_bf16 v[192:195], a[140:143], a[84:87], v[192:195]
ds_read_b64_tr_b16 a[132:133], v251 offset:59648
v_cvt_pk_bf16_f32 v48, v48, v49
v_mfma_f32_16x16x32_bf16 v[200:203], a[136:139], a[88:91], v[200:203]
s_add_u32 m0, s59, 32
ds_read_b64_tr_b16 a[134:135], v251 offset:60704
v_cvt_pk_bf16_f32 v49, v50, v51
v_mfma_f32_16x16x32_bf16 v[200:203], a[140:143], a[92:95], v[200:203]
buffer_load_dwordx4 v248, s[40:43], s57 offen offset:1024 nt lds
v_cvt_pk_bf16_f32 v50, v52, v53
v_mfma_f32_16x16x32_bf16 a[160:163], a[136:139], a[96:99], a[160:163]
v_cvt_pk_bf16_f32 v51, v54, v55
v_accvgpr_write_b32 a36, v48
v_mfma_f32_16x16x32_bf16 a[160:163], a[140:143], a[100:103], a[160:163]
v_accvgpr_write_b32 a37, v49
v_accvgpr_write_b32 a38, v50
v_mfma_f32_16x16x32_bf16 a[168:171], a[136:139], a[104:107], a[168:171]
v_accvgpr_write_b32 a39, v51
v_mul_f32 v56, v255, v56
v_mfma_f32_16x16x32_bf16 a[168:171], a[140:143], a[108:111], a[168:171]
v_mul_f32 v57, v255, v57
v_mul_f32 v58, v255, v58
v_mfma_f32_16x16x32_bf16 v[232:235], a[136:139], a[112:115], v[232:235]
v_mul_f32 v59, v255, v59
v_mul_f32 v60, v255, v60
v_mfma_f32_16x16x32_bf16 v[232:235], a[140:143], a[116:119], v[232:235]
s_waitcnt lgkmcnt(4)
ds_read_b64_tr_b16 a[136:137], v251 offset:51208
v_mul_f32 v61, v255, v61
v_mfma_f32_16x16x32_bf16 v[196:199], a[120:123], a[80:83], v[196:199]
ds_read_b64_tr_b16 a[138:139], v251 offset:52264
v_mul_f32 v62, v255, v62
v_mfma_f32_16x16x32_bf16 v[196:199], a[124:127], a[84:87], v[196:199]
ds_read_b64_tr_b16 a[140:141], v251 offset:59656
v_mul_f32_e64 v63, v255, v63
v_mfma_f32_16x16x32_bf16 v[204:207], a[120:123], a[88:91], v[204:207]
ds_read_b64_tr_b16 a[142:143], v251 offset:60712
v_cvt_pk_bf16_f32 v56, v56, v57
v_mfma_f32_16x16x32_bf16 v[204:207], a[124:127], a[92:95], v[204:207]
v_cvt_pk_bf16_f32 v57, v58, v59
v_cvt_pk_bf16_f32 v58, v60, v61
v_mfma_f32_16x16x32_bf16 a[164:167], a[120:123], a[96:99], a[164:167]
v_cvt_pk_bf16_f32 v59, v62, v63
v_accvgpr_write_b32 a52, v56
v_mfma_f32_16x16x32_bf16 a[164:167], a[124:127], a[100:103], a[164:167]
v_accvgpr_write_b32 a53, v57
v_accvgpr_write_b32 a54, v58
v_mfma_f32_16x16x32_bf16 a[172:175], a[120:123], a[104:107], a[172:175]
v_accvgpr_write_b32 a55, v59
v_mul_f32 v216, v255, v216
v_mfma_f32_16x16x32_bf16 a[172:175], a[124:127], a[108:111], a[172:175]
v_mul_f32 v217, v255, v217
v_mul_f32 v218, v255, v218
v_mfma_f32_16x16x32_bf16 v[236:239], a[120:123], a[112:115], v[236:239]
s_waitcnt vmcnt(14) lgkmcnt(0)
v_mul_f32 v219, v255, v219
v_mfma_f32_16x16x32_bf16 v[236:239], a[124:127], a[116:119], v[236:239]
s_barrier
v_mfma_f32_16x16x32_bf16 a[176:179], a[128:131], a[80:83], a[176:179]
ds_read_b128 a[208:211], v240 offset:0
v_mul_f32 v220, v255, v220
v_mfma_f32_16x16x32_bf16 a[176:179], a[132:135], a[84:87], a[176:179]
ds_read_b128 a[212:215], v241 offset:0
v_mul_f32 v221, v255, v221
v_mfma_f32_16x16x32_bf16 a[184:187], a[128:131], a[88:91], a[184:187]
ds_read_b128 a[216:219], v240 offset:512
v_mul_f32 v222, v255, v222
v_mfma_f32_16x16x32_bf16 a[184:187], a[132:135], a[92:95], a[184:187]
ds_read_b128 a[220:223], v241 offset:512
v_mul_f32 v223, v255, v223
v_mfma_f32_16x16x32_bf16 a[192:195], a[128:131], a[96:99], a[192:195]
v_cvt_pk_bf16_f32 v216, v216, v217
v_cvt_pk_bf16_f32 v217, v218, v219
v_mfma_f32_16x16x32_bf16 a[192:195], a[132:135], a[100:103], a[192:195]
v_cvt_pk_bf16_f32 v218, v220, v221
v_cvt_pk_bf16_f32 v219, v222, v223
v_mfma_f32_16x16x32_bf16 a[200:203], a[128:131], a[104:107], a[200:203]
v_accvgpr_write_b32 a72, v216
v_accvgpr_write_b32 a73, v217
v_mfma_f32_16x16x32_bf16 a[200:203], a[132:135], a[108:111], a[200:203]
v_accvgpr_write_b32 a74, v218
v_accvgpr_write_b32 a75, v219
v_mfma_f32_16x16x32_bf16 a[180:183], a[136:139], a[80:83], a[180:183]
v_mul_f32 v64, v255, v64
v_mul_f32 v65, v255, v65
v_mfma_f32_16x16x32_bf16 a[180:183], a[140:143], a[84:87], a[180:183]
v_mul_f32 v66, v255, v66
v_mul_f32 v67, v255, v67
v_mfma_f32_16x16x32_bf16 a[188:191], a[136:139], a[88:91], a[188:191]
v_mul_f32 v68, v255, v68
v_mul_f32 v69, v255, v69
v_mfma_f32_16x16x32_bf16 a[188:191], a[140:143], a[92:95], a[188:191]
v_mul_f32 v70, v255, v70
v_mul_f32 v71, v255, v71
v_mfma_f32_16x16x32_bf16 a[196:199], a[136:139], a[96:99], a[196:199]
v_cvt_pk_bf16_f32 v64, v64, v65
v_cvt_pk_bf16_f32 v65, v66, v67
v_mfma_f32_16x16x32_bf16 a[196:199], a[140:143], a[100:103], a[196:199]
v_cvt_pk_bf16_f32 v66, v68, v69
v_cvt_pk_bf16_f32 v67, v70, v71
v_mfma_f32_16x16x32_bf16 a[204:207], a[136:139], a[104:107], a[204:207]
v_accvgpr_write_b32 a8, v64
v_accvgpr_write_b32 a9, v65
v_mfma_f32_16x16x32_bf16 a[204:207], a[140:143], a[108:111], a[204:207]
v_accvgpr_write_b32 a10, v66
v_accvgpr_write_b32 a11, v67
ds_write_b128 v254, v[208:211] offset:0
ds_write_b128 v254, v[216:219] offset:1024
v_pk_mul_f32 v[72:73], v[72:73], v[254:255] op_sel:[0,1] op_sel_hi:[1,1]
v_pk_mul_f32 v[74:75], v[74:75], v[254:255] op_sel:[0,1] op_sel_hi:[1,1]
v_pk_mul_f32 v[76:77], v[76:77], v[254:255] op_sel:[0,1] op_sel_hi:[1,1]
v_pk_mul_f32 v[78:79], v[78:79], v[254:255] op_sel:[0,1] op_sel_hi:[1,1]
v_cvt_pk_bf16_f32 v72, v72, v73
v_cvt_pk_bf16_f32 v73, v74, v75
v_cvt_pk_bf16_f32 v74, v76, v77
v_cvt_pk_bf16_f32 v75, v78, v79
v_accvgpr_write_b32 a24, v72
v_accvgpr_write_b32 a25, v73
v_accvgpr_write_b32 a26, v74
v_accvgpr_write_b32 a27, v75
v_pk_mul_f32 v[80:81], v[80:81], v[254:255] op_sel:[0,1] op_sel_hi:[1,1]
v_pk_mul_f32 v[82:83], v[82:83], v[254:255] op_sel:[0,1] op_sel_hi:[1,1]
v_pk_mul_f32 v[84:85], v[84:85], v[254:255] op_sel:[0,1] op_sel_hi:[1,1]
v_pk_mul_f32 v[86:87], v[86:87], v[254:255] op_sel:[0,1] op_sel_hi:[1,1]
v_cvt_pk_bf16_f32 v80, v80, v81
v_cvt_pk_bf16_f32 v81, v82, v83
v_cvt_pk_bf16_f32 v82, v84, v85
v_cvt_pk_bf16_f32 v83, v86, v87
v_accvgpr_write_b32 a40, v80
v_accvgpr_write_b32 a41, v81
v_accvgpr_write_b32 a42, v82
v_accvgpr_write_b32 a43, v83
v_pk_mul_f32 v[88:89], v[88:89], v[254:255] op_sel:[0,1] op_sel_hi:[1,1]
v_pk_mul_f32 v[90:91], v[90:91], v[254:255] op_sel:[0,1] op_sel_hi:[1,1]
v_pk_mul_f32 v[92:93], v[92:93], v[254:255] op_sel:[0,1] op_sel_hi:[1,1]
v_pk_mul_f32 v[94:95], v[94:95], v[254:255] op_sel:[0,1] op_sel_hi:[1,1]
v_cvt_pk_bf16_f32 v88, v88, v89
v_cvt_pk_bf16_f32 v89, v90, v91
v_cvt_pk_bf16_f32 v90, v92, v93
v_cvt_pk_bf16_f32 v91, v94, v95
v_accvgpr_write_b32 a56, v88
v_accvgpr_write_b32 a57, v89
v_accvgpr_write_b32 a58, v90
v_accvgpr_write_b32 a59, v91
v_pk_mul_f32 v[96:97], v[96:97], v[254:255] op_sel:[0,1] op_sel_hi:[1,1]
v_pk_mul_f32 v[98:99], v[98:99], v[254:255] op_sel:[0,1] op_sel_hi:[1,1]
v_pk_mul_f32 v[100:101], v[100:101], v[254:255] op_sel:[0,1] op_sel_hi:[1,1]
v_pk_mul_f32 v[102:103], v[102:103], v[254:255] op_sel:[0,1] op_sel_hi:[1,1]
v_cvt_pk_bf16_f32 v96, v96, v97
v_cvt_pk_bf16_f32 v97, v98, v99
v_cvt_pk_bf16_f32 v98, v100, v101
v_cvt_pk_bf16_f32 v99, v102, v103
v_accvgpr_write_b32 a12, v96
v_accvgpr_write_b32 a13, v97
v_accvgpr_write_b32 a14, v98
v_accvgpr_write_b32 a15, v99
v_pk_mul_f32 v[104:105], v[104:105], v[254:255] op_sel:[0,1] op_sel_hi:[1,1]
v_pk_mul_f32 v[106:107], v[106:107], v[254:255] op_sel:[0,1] op_sel_hi:[1,1]
v_pk_mul_f32 v[108:109], v[108:109], v[254:255] op_sel:[0,1] op_sel_hi:[1,1]
v_pk_mul_f32 v[110:111], v[110:111], v[254:255] op_sel:[0,1] op_sel_hi:[1,1]
v_cvt_pk_bf16_f32 v104, v104, v105
v_cvt_pk_bf16_f32 v105, v106, v107
v_cvt_pk_bf16_f32 v106, v108, v109
v_cvt_pk_bf16_f32 v107, v110, v111
v_accvgpr_write_b32 a28, v104
v_accvgpr_write_b32 a29, v105
v_accvgpr_write_b32 a30, v106
v_accvgpr_write_b32 a31, v107
v_pk_mul_f32 v[112:113], v[112:113], v[254:255] op_sel:[0,1] op_sel_hi:[1,1]
v_pk_mul_f32 v[114:115], v[114:115], v[254:255] op_sel:[0,1] op_sel_hi:[1,1]
v_pk_mul_f32 v[116:117], v[116:117], v[254:255] op_sel:[0,1] op_sel_hi:[1,1]
v_pk_mul_f32 v[118:119], v[118:119], v[254:255] op_sel:[0,1] op_sel_hi:[1,1]
v_cvt_pk_bf16_f32 v112, v112, v113
v_cvt_pk_bf16_f32 v113, v114, v115
v_cvt_pk_bf16_f32 v114, v116, v117
v_cvt_pk_bf16_f32 v115, v118, v119
v_accvgpr_write_b32 a44, v112
v_accvgpr_write_b32 a45, v113
v_accvgpr_write_b32 a46, v114
v_accvgpr_write_b32 a47, v115
v_pk_mul_f32 v[120:121], v[120:121], v[254:255] op_sel:[0,1] op_sel_hi:[1,1]
v_pk_mul_f32 v[122:123], v[122:123], v[254:255] op_sel:[0,1] op_sel_hi:[1,1]
v_pk_mul_f32 v[124:125], v[124:125], v[254:255] op_sel:[0,1] op_sel_hi:[1,1]
v_pk_mul_f32 v[126:127], v[126:127], v[254:255] op_sel:[0,1] op_sel_hi:[1,1]
v_cvt_pk_bf16_f32 v120, v120, v121
v_cvt_pk_bf16_f32 v121, v122, v123
v_cvt_pk_bf16_f32 v122, v124, v125
v_cvt_pk_bf16_f32 v123, v126, v127
v_accvgpr_write_b32 a60, v120
v_accvgpr_write_b32 a61, v121
v_accvgpr_write_b32 a62, v122
v_accvgpr_write_b32 a63, v123
v_pk_mul_f32 v[224:225], v[224:225], v[254:255] op_sel:[0,1] op_sel_hi:[1,1]
v_pk_mul_f32 v[226:227], v[226:227], v[254:255] op_sel:[0,1] op_sel_hi:[1,1]
v_pk_mul_f32 v[228:229], v[228:229], v[254:255] op_sel:[0,1] op_sel_hi:[1,1]
v_pk_mul_f32 v[230:231], v[230:231], v[254:255] op_sel:[0,1] op_sel_hi:[1,1]
v_cvt_pk_bf16_f32 v224, v224, v225
v_cvt_pk_bf16_f32 v225, v226, v227
v_cvt_pk_bf16_f32 v226, v228, v229
v_cvt_pk_bf16_f32 v227, v230, v231
ds_write_b128 v254, v[224:227] offset:2048
v_pk_mul_f32 v[128:129], v[128:129], v[254:255] op_sel:[0,1] op_sel_hi:[1,1]
v_pk_mul_f32 v[130:131], v[130:131], v[254:255] op_sel:[0,1] op_sel_hi:[1,1]
v_pk_mul_f32 v[132:133], v[132:133], v[254:255] op_sel:[0,1] op_sel_hi:[1,1]
v_pk_mul_f32 v[134:135], v[134:135], v[254:255] op_sel:[0,1] op_sel_hi:[1,1]
v_cvt_pk_bf16_f32 v128, v128, v129
v_cvt_pk_bf16_f32 v129, v130, v131
v_cvt_pk_bf16_f32 v130, v132, v133
v_cvt_pk_bf16_f32 v131, v134, v135
v_pk_mul_f32 v[136:137], v[136:137], v[254:255] op_sel:[0,1] op_sel_hi:[1,1]
v_pk_mul_f32 v[138:139], v[138:139], v[254:255] op_sel:[0,1] op_sel_hi:[1,1]
v_pk_mul_f32 v[140:141], v[140:141], v[254:255] op_sel:[0,1] op_sel_hi:[1,1]
v_pk_mul_f32 v[142:143], v[142:143], v[254:255] op_sel:[0,1] op_sel_hi:[1,1]
v_cvt_pk_bf16_f32 v136, v136, v137
v_cvt_pk_bf16_f32 v137, v138, v139
v_cvt_pk_bf16_f32 v138, v140, v141
v_cvt_pk_bf16_f32 v139, v142, v143
v_pk_mul_f32 v[144:145], v[144:145], v[254:255] op_sel:[0,1] op_sel_hi:[1,1]
v_pk_mul_f32 v[146:147], v[146:147], v[254:255] op_sel:[0,1] op_sel_hi:[1,1]
v_pk_mul_f32 v[148:149], v[148:149], v[254:255] op_sel:[0,1] op_sel_hi:[1,1]
v_pk_mul_f32 v[150:151], v[150:151], v[254:255] op_sel:[0,1] op_sel_hi:[1,1]
v_cvt_pk_bf16_f32 v144, v144, v145
v_cvt_pk_bf16_f32 v145, v146, v147
v_cvt_pk_bf16_f32 v146, v148, v149
v_cvt_pk_bf16_f32 v147, v150, v151
v_pk_mul_f32 v[152:153], v[152:153], v[254:255] op_sel:[0,1] op_sel_hi:[1,1]
v_pk_mul_f32 v[154:155], v[154:155], v[254:255] op_sel:[0,1] op_sel_hi:[1,1]
v_pk_mul_f32 v[156:157], v[156:157], v[254:255] op_sel:[0,1] op_sel_hi:[1,1]
v_pk_mul_f32 v[158:159], v[158:159], v[254:255] op_sel:[0,1] op_sel_hi:[1,1]
v_cvt_pk_bf16_f32 v152, v152, v153
v_cvt_pk_bf16_f32 v153, v154, v155
v_cvt_pk_bf16_f32 v154, v156, v157
v_cvt_pk_bf16_f32 v155, v158, v159
v_pk_mul_f32 v[160:161], v[160:161], v[254:255] op_sel:[0,1] op_sel_hi:[1,1]
v_pk_mul_f32 v[162:163], v[162:163], v[254:255] op_sel:[0,1] op_sel_hi:[1,1]
v_pk_mul_f32 v[164:165], v[164:165], v[254:255] op_sel:[0,1] op_sel_hi:[1,1]
v_pk_mul_f32 v[166:167], v[166:167], v[254:255] op_sel:[0,1] op_sel_hi:[1,1]
v_cvt_pk_bf16_f32 v160, v160, v161
v_cvt_pk_bf16_f32 v161, v162, v163
v_cvt_pk_bf16_f32 v162, v164, v165
v_cvt_pk_bf16_f32 v163, v166, v167
v_pk_mul_f32 v[168:169], v[168:169], v[254:255] op_sel:[0,1] op_sel_hi:[1,1]
v_pk_mul_f32 v[170:171], v[170:171], v[254:255] op_sel:[0,1] op_sel_hi:[1,1]
v_pk_mul_f32 v[172:173], v[172:173], v[254:255] op_sel:[0,1] op_sel_hi:[1,1]
v_pk_mul_f32 v[174:175], v[174:175], v[254:255] op_sel:[0,1] op_sel_hi:[1,1]
v_cvt_pk_bf16_f32 v168, v168, v169
v_cvt_pk_bf16_f32 v169, v170, v171
v_cvt_pk_bf16_f32 v170, v172, v173
v_cvt_pk_bf16_f32 v171, v174, v175
v_pk_mul_f32 v[176:177], v[176:177], v[254:255] op_sel:[0,1] op_sel_hi:[1,1]
v_pk_mul_f32 v[178:179], v[178:179], v[254:255] op_sel:[0,1] op_sel_hi:[1,1]
v_pk_mul_f32 v[180:181], v[180:181], v[254:255] op_sel:[0,1] op_sel_hi:[1,1]
v_pk_mul_f32 v[182:183], v[182:183], v[254:255] op_sel:[0,1] op_sel_hi:[1,1]
v_cvt_pk_bf16_f32 v176, v176, v177
v_cvt_pk_bf16_f32 v177, v178, v179
v_cvt_pk_bf16_f32 v178, v180, v181
v_cvt_pk_bf16_f32 v179, v182, v183
v_pk_mul_f32 v[184:185], v[184:185], v[254:255] op_sel:[0,1] op_sel_hi:[1,1]
v_pk_mul_f32 v[186:187], v[186:187], v[254:255] op_sel:[0,1] op_sel_hi:[1,1]
v_pk_mul_f32 v[188:189], v[188:189], v[254:255] op_sel:[0,1] op_sel_hi:[1,1]
v_pk_mul_f32 v[190:191], v[190:191], v[254:255] op_sel:[0,1] op_sel_hi:[1,1]
v_cvt_pk_bf16_f32 v184, v184, v185
v_cvt_pk_bf16_f32 v185, v186, v187
v_cvt_pk_bf16_f32 v186, v188, v189
v_cvt_pk_bf16_f32 v187, v190, v191
v_pk_mul_f32 v[232:233], v[232:233], v[254:255] op_sel:[0,1] op_sel_hi:[1,1]
v_pk_mul_f32 v[234:235], v[234:235], v[254:255] op_sel:[0,1] op_sel_hi:[1,1]
v_pk_mul_f32 v[236:237], v[236:237], v[254:255] op_sel:[0,1] op_sel_hi:[1,1]
v_pk_mul_f32 v[238:239], v[238:239], v[254:255] op_sel:[0,1] op_sel_hi:[1,1]
v_cvt_pk_bf16_f32 v232, v232, v233
v_cvt_pk_bf16_f32 v233, v234, v235
v_cvt_pk_bf16_f32 v234, v236, v237
v_cvt_pk_bf16_f32 v235, v238, v239
ds_write_b128 v254, v[232:235] offset:3072
v_pk_mul_f32 v[192:193], v[192:193], v[254:255] op_sel:[0,1] op_sel_hi:[1,1]
v_pk_mul_f32 v[194:195], v[194:195], v[254:255] op_sel:[0,1] op_sel_hi:[1,1]
v_pk_mul_f32 v[196:197], v[196:197], v[254:255] op_sel:[0,1] op_sel_hi:[1,1]
v_pk_mul_f32 v[198:199], v[198:199], v[254:255] op_sel:[0,1] op_sel_hi:[1,1]
v_cvt_pk_bf16_f32 v192, v192, v193
v_cvt_pk_bf16_f32 v193, v194, v195
v_cvt_pk_bf16_f32 v194, v196, v197
v_cvt_pk_bf16_f32 v195, v198, v199
v_pk_mul_f32 v[200:201], v[200:201], v[254:255] op_sel:[0,1] op_sel_hi:[1,1]
v_pk_mul_f32 v[202:203], v[202:203], v[254:255] op_sel:[0,1] op_sel_hi:[1,1]
v_pk_mul_f32 v[204:205], v[204:205], v[254:255] op_sel:[0,1] op_sel_hi:[1,1]
v_pk_mul_f32 v[206:207], v[206:207], v[254:255] op_sel:[0,1] op_sel_hi:[1,1]
v_cvt_pk_bf16_f32 v200, v200, v201
v_cvt_pk_bf16_f32 v201, v202, v203
v_cvt_pk_bf16_f32 v202, v204, v205
v_cvt_pk_bf16_f32 v203, v206, v207
v_accvgpr_read_b32 v0, a160
v_accvgpr_read_b32 v1, a161
v_accvgpr_read_b32 v2, a162
v_accvgpr_read_b32 v3, a163
v_accvgpr_read_b32 v4, a164
v_accvgpr_read_b32 v5, a165
v_accvgpr_read_b32 v6, a166
v_accvgpr_read_b32 v7, a167
v_pk_mul_f32 v[0:1], v[0:1], v[254:255] op_sel:[0,1] op_sel_hi:[1,1]
v_pk_mul_f32 v[2:3], v[2:3], v[254:255] op_sel:[0,1] op_sel_hi:[1,1]
v_pk_mul_f32 v[4:5], v[4:5], v[254:255] op_sel:[0,1] op_sel_hi:[1,1]
v_pk_mul_f32 v[6:7], v[6:7], v[254:255] op_sel:[0,1] op_sel_hi:[1,1]
v_cvt_pk_bf16_f32 v0, v0, v1
v_cvt_pk_bf16_f32 v1, v2, v3
v_cvt_pk_bf16_f32 v2, v4, v5
v_cvt_pk_bf16_f32 v3, v6, v7
v_accvgpr_write_b32 a120, v0
v_accvgpr_write_b32 a121, v1
v_accvgpr_write_b32 a122, v2
v_accvgpr_write_b32 a123, v3
v_accvgpr_read_b32 v8, a168
v_accvgpr_read_b32 v9, a169
v_accvgpr_read_b32 v10, a170
v_accvgpr_read_b32 v11, a171
v_accvgpr_read_b32 v12, a172
v_accvgpr_read_b32 v13, a173
v_accvgpr_read_b32 v14, a174
v_accvgpr_read_b32 v15, a175
v_pk_mul_f32 v[8:9], v[8:9], v[254:255] op_sel:[0,1] op_sel_hi:[1,1]
v_pk_mul_f32 v[10:11], v[10:11], v[254:255] op_sel:[0,1] op_sel_hi:[1,1]
v_pk_mul_f32 v[12:13], v[12:13], v[254:255] op_sel:[0,1] op_sel_hi:[1,1]
v_pk_mul_f32 v[14:15], v[14:15], v[254:255] op_sel:[0,1] op_sel_hi:[1,1]
v_cvt_pk_bf16_f32 v8, v8, v9
v_cvt_pk_bf16_f32 v9, v10, v11
v_cvt_pk_bf16_f32 v10, v12, v13
v_cvt_pk_bf16_f32 v11, v14, v15
v_accvgpr_write_b32 a136, v8
v_accvgpr_write_b32 a137, v9
v_accvgpr_write_b32 a138, v10
v_accvgpr_write_b32 a139, v11
v_accvgpr_read_b32 v0, a176
v_accvgpr_read_b32 v1, a177
v_accvgpr_read_b32 v2, a178
v_accvgpr_read_b32 v3, a179
v_accvgpr_read_b32 v4, a180
v_accvgpr_read_b32 v5, a181
v_accvgpr_read_b32 v6, a182
v_accvgpr_read_b32 v7, a183
v_pk_mul_f32 v[0:1], v[0:1], v[254:255] op_sel:[0,1] op_sel_hi:[1,1]
v_pk_mul_f32 v[2:3], v[2:3], v[254:255] op_sel:[0,1] op_sel_hi:[1,1]
v_pk_mul_f32 v[4:5], v[4:5], v[254:255] op_sel:[0,1] op_sel_hi:[1,1]
v_pk_mul_f32 v[6:7], v[6:7], v[254:255] op_sel:[0,1] op_sel_hi:[1,1]
v_cvt_pk_bf16_f32 v0, v0, v1
v_cvt_pk_bf16_f32 v1, v2, v3
v_cvt_pk_bf16_f32 v2, v4, v5
v_cvt_pk_bf16_f32 v3, v6, v7
v_accvgpr_write_b32 a92, v0
v_accvgpr_write_b32 a93, v1
v_accvgpr_write_b32 a94, v2
v_accvgpr_write_b32 a95, v3
v_accvgpr_read_b32 v8, a184
v_accvgpr_read_b32 v9, a185
v_accvgpr_read_b32 v10, a186
v_accvgpr_read_b32 v11, a187
v_accvgpr_read_b32 v12, a188
v_accvgpr_read_b32 v13, a189
v_accvgpr_read_b32 v14, a190
v_accvgpr_read_b32 v15, a191
v_pk_mul_f32 v[8:9], v[8:9], v[254:255] op_sel:[0,1] op_sel_hi:[1,1]
v_pk_mul_f32 v[10:11], v[10:11], v[254:255] op_sel:[0,1] op_sel_hi:[1,1]
v_pk_mul_f32 v[12:13], v[12:13], v[254:255] op_sel:[0,1] op_sel_hi:[1,1]
v_pk_mul_f32 v[14:15], v[14:15], v[254:255] op_sel:[0,1] op_sel_hi:[1,1]
v_cvt_pk_bf16_f32 v8, v8, v9
v_cvt_pk_bf16_f32 v9, v10, v11
v_cvt_pk_bf16_f32 v10, v12, v13
v_cvt_pk_bf16_f32 v11, v14, v15
v_accvgpr_write_b32 a108, v8
v_accvgpr_write_b32 a109, v9
v_accvgpr_write_b32 a110, v10
v_accvgpr_write_b32 a111, v11
v_accvgpr_read_b32 v0, a192
v_accvgpr_read_b32 v1, a193
v_accvgpr_read_b32 v2, a194
v_accvgpr_read_b32 v3, a195
v_accvgpr_read_b32 v4, a196
v_accvgpr_read_b32 v5, a197
v_accvgpr_read_b32 v6, a198
v_accvgpr_read_b32 v7, a199
v_pk_mul_f32 v[0:1], v[0:1], v[254:255] op_sel:[0,1] op_sel_hi:[1,1]
v_pk_mul_f32 v[2:3], v[2:3], v[254:255] op_sel:[0,1] op_sel_hi:[1,1]
v_pk_mul_f32 v[4:5], v[4:5], v[254:255] op_sel:[0,1] op_sel_hi:[1,1]
v_pk_mul_f32 v[6:7], v[6:7], v[254:255] op_sel:[0,1] op_sel_hi:[1,1]
v_cvt_pk_bf16_f32 v0, v0, v1
v_cvt_pk_bf16_f32 v1, v2, v3
v_cvt_pk_bf16_f32 v2, v4, v5
v_cvt_pk_bf16_f32 v3, v6, v7
v_accvgpr_write_b32 a124, v0
v_accvgpr_write_b32 a125, v1
v_accvgpr_write_b32 a126, v2
v_accvgpr_write_b32 a127, v3
v_accvgpr_read_b32 v8, a200
v_accvgpr_read_b32 v9, a201
v_accvgpr_read_b32 v10, a202
v_accvgpr_read_b32 v11, a203
v_accvgpr_read_b32 v12, a204
v_accvgpr_read_b32 v13, a205
v_accvgpr_read_b32 v14, a206
v_accvgpr_read_b32 v15, a207
v_pk_mul_f32 v[8:9], v[8:9], v[254:255] op_sel:[0,1] op_sel_hi:[1,1]
v_pk_mul_f32 v[10:11], v[10:11], v[254:255] op_sel:[0,1] op_sel_hi:[1,1]
v_pk_mul_f32 v[12:13], v[12:13], v[254:255] op_sel:[0,1] op_sel_hi:[1,1]
v_pk_mul_f32 v[14:15], v[14:15], v[254:255] op_sel:[0,1] op_sel_hi:[1,1]
v_cvt_pk_bf16_f32 v8, v8, v9
v_cvt_pk_bf16_f32 v9, v10, v11
v_cvt_pk_bf16_f32 v10, v12, v13
v_cvt_pk_bf16_f32 v11, v14, v15
v_accvgpr_write_b32 a140, v8
v_accvgpr_write_b32 a141, v9
v_accvgpr_write_b32 a142, v10
v_accvgpr_write_b32 a143, v11
v_accvgpr_write_b32 a144, v224
v_accvgpr_write_b32 a145, v225
v_accvgpr_write_b32 a146, v226
v_accvgpr_write_b32 a147, v227
v_accvgpr_write_b32 a80, v128
v_accvgpr_write_b32 a81, v129
v_accvgpr_write_b32 a82, v130
v_accvgpr_write_b32 a83, v131
v_accvgpr_write_b32 a96, v136
v_accvgpr_write_b32 a97, v137
v_accvgpr_write_b32 a98, v138
v_accvgpr_write_b32 a99, v139
v_accvgpr_write_b32 a112, v144
v_accvgpr_write_b32 a113, v145
v_accvgpr_write_b32 a114, v146
v_accvgpr_write_b32 a115, v147
v_accvgpr_write_b32 a128, v152
v_accvgpr_write_b32 a129, v153
v_accvgpr_write_b32 a130, v154
v_accvgpr_write_b32 a131, v155
v_accvgpr_write_b32 a84, v160
v_accvgpr_write_b32 a85, v161
v_accvgpr_write_b32 a86, v162
v_accvgpr_write_b32 a87, v163
v_accvgpr_write_b32 a100, v168
v_accvgpr_write_b32 a101, v169
v_accvgpr_write_b32 a102, v170
v_accvgpr_write_b32 a103, v171
v_accvgpr_write_b32 a116, v176
v_accvgpr_write_b32 a117, v177
v_accvgpr_write_b32 a118, v178
v_accvgpr_write_b32 a119, v179
v_accvgpr_write_b32 a132, v184
v_accvgpr_write_b32 a133, v185
v_accvgpr_write_b32 a134, v186
v_accvgpr_write_b32 a135, v187
v_accvgpr_write_b32 a152, v232
v_accvgpr_write_b32 a153, v233
v_accvgpr_write_b32 a154, v234
v_accvgpr_write_b32 a155, v235
v_accvgpr_write_b32 a88, v192
v_accvgpr_write_b32 a89, v193
v_accvgpr_write_b32 a90, v194
v_accvgpr_write_b32 a91, v195
v_accvgpr_write_b32 a104, v200
v_accvgpr_write_b32 a105, v201
v_accvgpr_write_b32 a106, v202
v_accvgpr_write_b32 a107, v203
v_add_u32 v251, s19, v249
v_mov_b32 v250, v254
s_waitcnt lgkmcnt(0)
s_barrier
ds_read_b128 a[68:71], v251 offset:0
ds_read_b128 a[76:79], v251 offset:1024
ds_read_b128 a[148:151], v251 offset:2048
ds_read_b128 a[156:159], v251 offset:3072
v_lshrrev_b32 v0, 4, v249
v_and_b32 v1, 1, v0
v_cmp_eq_u32 vcc, 1, v1
v_mov_b32 v2, 0x44444444
v_mov_b32 v3, 0xeeeeeeee
v_cndmask_b32 v228, v2, v3, vcc
v_and_b32 v1, 2, v0
v_cmp_eq_u32 vcc, 0, v1
v_mov_b32 v2, 0x3f803f80
v_and_b32 v4, 15, v0
v_cndmask_b32 v224, 0, v2, vcc
v_mov_b32 v225, v224
v_mov_b32 v226, v224
v_mov_b32 v227, v224
v_lshlrev_b32 v4, 5, v4
v_add_u32 v253, 151552, v4
s_lshr_b32 s50, s48, 1
s_lshl_b32 s50, s50, 9
s_lshl_b32 s77, s49, 4
s_add_u32 s50, s50, s77
v_lshrrev_b32 v5, 4, v0
v_lshl_add_u32 v5, v5, 2, v253
v_add_u32 v252, s50, v5
v_accvgpr_write_b32 a192, 0
v_accvgpr_write_b32 a193, 0
v_accvgpr_write_b32 a194, 0
v_accvgpr_write_b32 a195, 0
v_accvgpr_write_b32 a196, 0
v_accvgpr_write_b32 a197, 0
v_accvgpr_write_b32 a198, 0
v_accvgpr_write_b32 a199, 0
v_accvgpr_write_b32 a200, 0
v_accvgpr_write_b32 a201, 0
v_accvgpr_write_b32 a202, 0
v_accvgpr_write_b32 a203, 0
v_accvgpr_write_b32 a204, 0
v_accvgpr_write_b32 a205, 0
v_accvgpr_write_b32 a206, 0
v_accvgpr_write_b32 a207, 0
v_mov_b32 v229, 0
v_cmp_gt_u32 vcc, 3, v0
v_lshlrev_b32 v1, 7, v0
v_mov_b32 v2, 1073741824
v_cndmask_b32 v254, v2, v1, vcc
s_waitcnt lgkmcnt(0)
s_cmp_eq_u32 s76, 1
s_cbranch_scc1 L_s_head
L_h_head:
s_nop 1
v_mfma_f32_16x16x32_bf16 v[200:203], a[208:211], a[0:3], 0
ds_read_b128 a[224:227], v240 offset:4224
v_mfma_f32_16x16x32_bf16 v[200:203], a[212:215], a[4:7], v[200:203]
ds_read_b128 a[228:231], v241 offset:4224
v_mfma_f32_16x16x32_bf16 v[200:203], a[216:219], a[8:11], v[200:203]
s_add_u32 m0, s59, 64
ds_read_b128 a[232:235], v240 offset:4736
v_mfma_f32_16x16x32_bf16 v[200:203], a[220:223], a[12:15], v[200:203]
ds_read_b128 a[236:239], v241 offset:4736
buffer_load_dwordx4 v248, s[40:43], s57 offen offset:2048 nt lds
v_mfma_f32_16x16x32_bf16 v[204:207], a[208:211], a[16:19], 0
v_mfma_f32_16x16x32_bf16 v[204:207], a[212:215], a[20:23], v[204:207]
v_mfma_f32_16x16x32_bf16 v[204:207], a[216:219], a[24:27], v[204:207]
v_mfma_f32_16x16x32_bf16 v[204:207], a[220:223], a[28:31], v[204:207]
v_mfma_f32_16x16x32_bf16 v[208:211], a[208:211], a[32:35], 0
s_add_u32 m0, s59, 96
v_exp_f32 v200, v200
v_mfma_f32_16x16x32_bf16 v[208:211], a[212:215], a[36:39], v[208:211]
buffer_load_dwordx4 v248, s[40:43], s57 offen offset:3072 nt lds
v_exp_f32 v201, v201
v_mfma_f32_16x16x32_bf16 v[208:211], a[216:219], a[40:43], v[208:211]
s_add_u32 s57, s57, 16384
v_exp_f32 v202, v202
v_cvt_pk_bf16_f32 v128, v200, v201
v_mfma_f32_16x16x32_bf16 v[208:211], a[220:223], a[44:47], v[208:211]
s_add_u32 s59, s59, 16896
v_exp_f32 v203, v203
v_mfma_f32_16x16x32_bf16 v[212:215], a[208:211], a[48:51], 0
s_cmp_eq_u32 s59, s70
v_exp_f32 v204, v204
v_cvt_pk_bf16_f32 v129, v202, v203
v_mfma_f32_16x16x32_bf16 v[212:215], a[212:215], a[52:55], v[212:215]
s_cselect_b32 s59, s68, s59
v_exp_f32 v205, v205
v_mfma_f32_16x16x32_bf16 v[212:215], a[216:219], a[56:59], v[212:215]
s_mov_b32 m0, s58
v_exp_f32 v206, v206
v_cvt_pk_bf16_f32 v136, v204, v205
v_mfma_f32_16x16x32_bf16 v[212:215], a[220:223], a[60:63], v[212:215]
buffer_load_dwordx4 v248, s[36:39], s56 offen offset:0 nt lds
v_exp_f32 v207, v207
v_mfma_f32_16x16x32_bf16 v[216:219], a[208:211], a[64:67], 0
v_exp_f32 v208, v208
v_cvt_pk_bf16_f32 v137, v206, v207
v_mfma_f32_16x16x32_bf16 v[216:219], a[212:215], a[68:71], v[216:219]
v_exp_f32 v209, v209
v_mfma_f32_16x16x32_bf16 v[216:219], a[216:219], a[72:75], v[216:219]
v_exp_f32 v210, v210
v_cvt_pk_bf16_f32 v144, v208, v209
v_mfma_f32_16x16x32_bf16 v[216:219], a[220:223], a[76:79], v[216:219]
s_waitcnt lgkmcnt(0)
ds_read_b128 a[208:211], v242 offset:0
v_exp_f32 v211, v211
v_mfma_f32_16x16x32_bf16 v[220:223], a[224:227], a[0:3], 0
s_add_u32 m0, s58, 32
ds_read_b128 a[212:215], v243 offset:0
v_exp_f32 v212, v212
v_cvt_pk_bf16_f32 v145, v210, v211
v_mfma_f32_16x16x32_bf16 v[220:223], a[228:231], a[4:7], v[220:223]
ds_read_b128 a[216:219], v242 offset:512
buffer_load_dwordx4 v248, s[36:39], s56 offen offset:1024 nt lds
v_exp_f32 v213, v213
v_mfma_f32_16x16x32_bf16 v[220:223], a[232:235], a[8:11], v[220:223]
ds_read_b128 a[220:223], v243 offset:512
v_exp_f32 v214, v214
v_cvt_pk_bf16_f32 v152, v212, v213
v_mfma_f32_16x16x32_bf16 v[220:223], a[236:239], a[12:15], v[220:223]
v_exp_f32 v215, v215
v_mfma_f32_16x16x32_bf16 v[200:203], a[224:227], a[16:19], 0
v_exp_f32 v216, v216
v_cvt_pk_bf16_f32 v153, v214, v215
v_mfma_f32_16x16x32_bf16 v[200:203], a[228:231], a[20:23], v[200:203]
v_exp_f32 v217, v217
v_add_f32 v229, v229, v216
v_mfma_f32_16x16x32_bf16 v[200:203], a[232:235], a[24:27], v[200:203]
s_add_u32 m0, s58, 64
v_exp_f32 v218, v218
v_cvt_pk_bf16_f32 v160, v216, v217
v_add_f32 v229, v229, v217
v_mfma_f32_16x16x32_bf16 v[200:203], a[236:239], a[28:31], v[200:203]
buffer_load_dwordx4 v248, s[36:39], s56 offen offset:2048 nt lds
v_exp_f32 v219, v219
v_add_f32 v229, v229, v218
v_mfma_f32_16x16x32_bf16 v[204:207], a[224:227], a[32:35], 0
v_exp_f32 v220, v220
v_cvt_pk_bf16_f32 v161, v218, v219
v_add_f32 v229, v229, v219
v_mfma_f32_16x16x32_bf16 v[204:207], a[228:231], a[36:39], v[204:207]
v_exp_f32 v221, v221
v_mfma_f32_16x16x32_bf16 v[204:207], a[232:235], a[40:43], v[204:207]
v_exp_f32 v222, v222
v_cvt_pk_bf16_f32 v130, v220, v221
v_mfma_f32_16x16x32_bf16 v[204:207], a[236:239], a[44:47], v[204:207]
v_exp_f32 v223, v223
v_mfma_f32_16x16x32_bf16 v[208:211], a[224:227], a[48:51], 0
s_add_u32 m0, s58, 96
v_exp_f32 v200, v200
v_cvt_pk_bf16_f32 v131, v222, v223
v_mfma_f32_16x16x32_bf16 v[208:211], a[228:231], a[52:55], v[208:211]
buffer_load_dwordx4 v248, s[36:39], s56 offen offset:3072 nt lds
v_exp_f32 v201, v201
v_mfma_f32_16x16x32_bf16 v[208:211], a[232:235], a[56:59], v[208:211]
s_add_u32 s56, s56, 16384
v_exp_f32 v202, v202
v_cvt_pk_bf16_f32 v138, v200, v201
v_mfma_f32_16x16x32_bf16 v[208:211], a[236:239], a[60:63], v[208:211]
s_add_u32 s58, s58, 16896
v_exp_f32 v203, v203
v_mfma_f32_16x16x32_bf16 v[212:215], a[224:227], a[64:67], 0
s_cmp_eq_u32 s58, s69
v_exp_f32 v204, v204
v_cvt_pk_bf16_f32 v139, v202, v203
v_mfma_f32_16x16x32_bf16 v[212:215], a[228:231], a[68:71], v[212:215]
s_cselect_b32 s58, s67, s58
v_exp_f32 v205, v205
v_mfma_f32_16x16x32_bf16 v[212:215], a[232:235], a[72:75], v[212:215]
v_exp_f32 v206, v206
v_cvt_pk_bf16_f32 v146, v204, v205
v_mfma_f32_16x16x32_bf16 v[212:215], a[236:239], a[76:79], v[212:215]
s_waitcnt lgkmcnt(0)
ds_read_b128 a[224:227], v242 offset:4224
v_exp_f32 v207, v207
v_mfma_f32_16x16x32_bf16 v[216:219], a[208:211], a[0:3], 0
ds_read_b128 a[228:231], v243 offset:4224
v_exp_f32 v208, v208
v_cvt_pk_bf16_f32 v147, v206, v207
v_mfma_f32_16x16x32_bf16 v[216:219], a[212:215], a[4:7], v[216:219]
ds_read_b128 a[232:235], v242 offset:4736
v_exp_f32 v209, v209
v_mfma_f32_16x16x32_bf16 v[216:219], a[216:219], a[8:11], v[216:219]
ds_read_b128 a[236:239], v243 offset:4736
v_exp_f32 v210, v210
v_cvt_pk_bf16_f32 v154, v208, v209
v_mfma_f32_16x16x32_bf16 v[216:219], a[220:223], a[12:15], v[216:219]
v_exp_f32 v211, v211
v_mfma_f32_16x16x32_bf16 v[220:223], a[208:211], a[16:19], 0
v_exp_f32 v212, v212
v_cvt_pk_bf16_f32 v155, v210, v211
v_mfma_f32_16x16x32_bf16 v[220:223], a[212:215], a[20:23], v[220:223]
v_exp_f32 v213, v213
v_add_f32 v229, v229, v212
v_mfma_f32_16x16x32_bf16 v[220:223], a[216:219], a[24:27], v[220:223]
v_exp_f32 v214, v214
v_cvt_pk_bf16_f32 v162, v212, v213
v_add_f32 v229, v229, v213
v_mfma_f32_16x16x32_bf16 v[220:223], a[220:223], a[28:31], v[220:223]
v_exp_f32 v215, v215
v_add_f32 v229, v229, v214
v_mfma_f32_16x16x32_bf16 v[200:203], a[208:211], a[32:35], 0
v_exp_f32 v216, v216
v_cvt_pk_bf16_f32 v163, v214, v215
v_add_f32 v229, v229, v215
v_mfma_f32_16x16x32_bf16 v[200:203], a[212:215], a[36:39], v[200:203]
v_exp_f32 v217, v217
v_mfma_f32_16x16x32_bf16 v[200:203], a[216:219], a[40:43], v[200:203]
v_exp_f32 v218, v218
v_cvt_pk_bf16_f32 v132, v216, v217
v_mfma_f32_16x16x32_bf16 v[200:203], a[220:223], a[44:47], v[200:203]
v_exp_f32 v219, v219
v_mfma_f32_16x16x32_bf16 v[204:207], a[208:211], a[48:51], 0
v_exp_f32 v220, v220
v_cvt_pk_bf16_f32 v133, v218, v219
v_mfma_f32_16x16x32_bf16 v[204:207], a[212:215], a[52:55], v[204:207]
v_exp_f32 v221, v221
v_mfma_f32_16x16x32_bf16 v[204:207], a[216:219], a[56:59], v[204:207]
v_exp_f32 v222, v222
v_cvt_pk_bf16_f32 v140, v220, v221
v_mfma_f32_16x16x32_bf16 v[204:207], a[220:223], a[60:63], v[204:207]
s_waitcnt lgkmcnt(0)
v_exp_f32 v223, v223
v_mfma_f32_16x16x32_bf16 v[208:211], a[224:227], a[0:3], 0
v_exp_f32 v200, v200
v_cvt_pk_bf16_f32 v141, v222, v223
v_mfma_f32_16x16x32_bf16 v[208:211], a[228:231], a[4:7], v[208:211]
v_exp_f32 v201, v201
v_mfma_f32_16x16x32_bf16 v[208:211], a[232:235], a[8:11], v[208:211]
v_exp_f32 v202, v202
v_cvt_pk_bf16_f32 v148, v200, v201
v_mfma_f32_16x16x32_bf16 v[208:211], a[236:239], a[12:15], v[208:211]
s_waitcnt vmcnt(12)
s_barrier
v_exp_f32 v203, v203
v_mfma_f32_16x16x32_bf16 v[212:215], a[224:227], a[16:19], 0
s_mov_b32 m0, s59
ds_read_b128 a[208:211], v240 offset:16896
v_exp_f32 v204, v204
v_cvt_pk_bf16_f32 v149, v202, v203
v_mfma_f32_16x16x32_bf16 v[212:215], a[228:231], a[20:23], v[212:215]
ds_read_b128 a[212:215], v241 offset:16896
buffer_load_dwordx4 v248, s[40:43], s57 offen offset:0 nt lds
v_exp_f32 v205, v205
v_mfma_f32_16x16x32_bf16 v[212:215], a[232:235], a[24:27], v[212:215]
ds_read_b128 a[216:219], v240 offset:17408
v_exp_f32 v206, v206
v_cvt_pk_bf16_f32 v156, v204, v205
v_mfma_f32_16x16x32_bf16 v[212:215], a[236:239], a[28:31], v[212:215]
ds_read_b128 a[220:223], v241 offset:17408
v_exp_f32 v207, v207
v_mfma_f32_16x16x32_bf16 v[216:219], a[224:227], a[32:35], 0
s_add_u32 m0, s59, 32
ds_read_b64_tr_b16 a[240:241], v244 offset:0
v_exp_f32 v208, v208
v_cvt_pk_bf16_f32 v157, v206, v207
v_mfma_f32_16x16x32_bf16 v[216:219], a[228:231], a[36:39], v[216:219]
ds_read_b64_tr_b16 a[242:243], v244 offset:4224
buffer_load_dwordx4 v248, s[40:43], s57 offen offset:1024 nt lds
v_exp_f32 v209, v209
v_mfma_f32_16x16x32_bf16 v[216:219], a[232:235], a[40:43], v[216:219]
ds_read_b64_tr_b16 a[244:245], v246 offset:0
v_exp_f32 v210, v210
v_cvt_pk_bf16_f32 v134, v208, v209
v_mfma_f32_16x16x32_bf16 v[216:219], a[236:239], a[44:47], v[216:219]
ds_read_b64_tr_b16 a[246:247], v246 offset:4224
v_exp_f32 v211, v211
v_mfma_f32_16x16x32_bf16 v[220:223], a[224:227], a[48:51], 0
v_exp_f32 v212, v212
v_cvt_pk_bf16_f32 v135, v210, v211
v_mfma_f32_16x16x32_bf16 v[220:223], a[228:231], a[52:55], v[220:223]
v_exp_f32 v213, v213
v_mfma_f32_16x16x32_bf16 v[220:223], a[232:235], a[56:59], v[220:223]
s_waitcnt lgkmcnt(4)
v_exp_f32 v214, v214
v_cvt_pk_bf16_f32 v142, v212, v213
v_mfma_f32_16x16x32_bf16 v[220:223], a[236:239], a[60:63], v[220:223]
v_exp_f32 v215, v215
v_exp_f32 v216, v216
v_cvt_pk_bf16_f32 v143, v214, v215
v_exp_f32 v217, v217
v_exp_f32 v218, v218
v_exp_f32 v219, v219
v_cvt_pk_bf16_f32 v150, v216, v217
v_cvt_pk_bf16_f32 v151, v218, v219
v_mfma_f32_16x16x32_bf16 v[200:203], a[208:211], a[0:3], 0
v_exp_f32 v220, v220
v_mfma_f32_16x16x32_bf16 v[200:203], a[212:215], a[4:7], v[200:203]
ds_read_b64_tr_b16 a[248:249], v244 offset:32
ds_read_b64_tr_b16 a[250:251], v244 offset:4256
v_mfma_f32_16x16x32_bf16 v[200:203], a[216:219], a[8:11], v[200:203]
v_exp_f32 v221, v221
v_mfma_f32_16x16x32_bf16 v[200:203], a[220:223], a[12:15], v[200:203]
s_waitcnt lgkmcnt(2)
ds_read_b64_tr_b16 a[252:253], v246 offset:32
ds_read_b64_tr_b16 a[254:255], v246 offset:4256
v_mfma_f32_16x16x32_bf16 v[0:3], a[240:243], v[128:131], 0
v_exp_f32 v222, v222
v_mfma_f32_16x16x32_bf16 v[0:3], a[244:247], v[132:135], v[0:3]
ds_read_b128 a[224:227], v240 offset:21120
v_cvt_pk_bf16_f32 v158, v220, v221
v_mfma_f32_16x16x32_bf16 v[32:35], a[240:243], v[136:139], 0
v_exp_f32 v223, v223
v_mfma_f32_16x16x32_bf16 v[32:35], a[244:247], v[140:143], v[32:35]
ds_read_b128 a[228:231], v241 offset:21120
v_cvt_pk_bf16_f32 v159, v222, v223
v_mfma_f32_16x16x32_bf16 v[204:207], a[208:211], a[16:19], 0
s_add_u32 m0, s59, 64
v_exp_f32 v200, v200
v_mfma_f32_16x16x32_bf16 v[204:207], a[212:215], a[20:23], v[204:207]
ds_read_b128 a[232:235], v240 offset:21632
buffer_load_dwordx4 v248, s[40:43], s57 offen offset:2048 nt lds
v_mfma_f32_16x16x32_bf16 v[204:207], a[216:219], a[24:27], v[204:207]
v_exp_f32 v201, v201
v_mfma_f32_16x16x32_bf16 v[204:207], a[220:223], a[28:31], v[204:207]
ds_read_b128 a[236:239], v241 offset:21632
v_cvt_pk_bf16_f32 v164, v200, v201
v_mfma_f32_16x16x32_bf16 v[64:67], a[240:243], v[144:147], 0
v_exp_f32 v202, v202
v_mfma_f32_16x16x32_bf16 v[64:67], a[244:247], v[148:151], v[64:67]
v_add_u32 v240, s60, v240
v_add_u32 v241, s60, v241
v_mfma_f32_16x16x32_bf16 a[160:163], a[240:243], v[160:163], 0
v_exp_f32 v203, v203
v_mfma_f32_16x16x32_bf16 v[96:99], a[240:243], v[152:155], 0
v_cvt_pk_bf16_f32 v165, v202, v203
v_mfma_f32_16x16x32_bf16 v[96:99], a[244:247], v[156:159], v[96:99]
ds_read_b64_tr_b16 a[240:241], v245 offset:0
v_mfma_f32_16x16x32_bf16 v[208:211], a[208:211], a[32:35], 0
v_exp_f32 v204, v204
v_mfma_f32_16x16x32_bf16 v[208:211], a[212:215], a[36:39], v[208:211]
ds_read_b64_tr_b16 a[242:243], v245 offset:4224
ds_read_b64_tr_b16 a[244:245], v247 offset:0
v_mfma_f32_16x16x32_bf16 v[208:211], a[216:219], a[40:43], v[208:211]
v_exp_f32 v205, v205
v_mfma_f32_16x16x32_bf16 v[208:211], a[220:223], a[44:47], v[208:211]
s_waitcnt lgkmcnt(7)
ds_read_b64_tr_b16 a[246:247], v247 offset:4224
v_cvt_pk_bf16_f32 v172, v204, v205
v_mfma_f32_16x16x32_bf16 v[4:7], a[248:251], v[128:131], 0
v_exp_f32 v206, v206
v_mfma_f32_16x16x32_bf16 v[4:7], a[252:255], v[132:135], v[4:7]
v_mfma_f32_16x16x32_bf16 v[36:39], a[248:251], v[136:139], 0
v_exp_f32 v207, v207
v_mfma_f32_16x16x32_bf16 v[36:39], a[252:255], v[140:143], v[36:39]
v_cvt_pk_bf16_f32 v173, v206, v207
v_mfma_f32_16x16x32_bf16 v[212:215], a[208:211], a[48:51], 0
v_exp_f32 v208, v208
v_mfma_f32_16x16x32_bf16 v[212:215], a[212:215], a[52:55], v[212:215]
s_add_u32 m0, s59, 96
v_mfma_f32_16x16x32_bf16 v[212:215], a[216:219], a[56:59], v[212:215]
v_exp_f32 v209, v209
v_mfma_f32_16x16x32_bf16 v[212:215], a[220:223], a[60:63], v[212:215]
buffer_load_dwordx4 v248, s[40:43], s57 offen offset:3072 nt lds
v_cvt_pk_bf16_f32 v180, v208, v209
v_mfma_f32_16x16x32_bf16 v[68:71], a[248:251], v[144:147], 0
s_add_u32 s57, s57, 16384
v_exp_f32 v210, v210
v_mfma_f32_16x16x32_bf16 v[68:71], a[252:255], v[148:151], v[68:71]
s_add_u32 s59, s59, 16896
v_mfma_f32_16x16x32_bf16 v[100:103], a[248:251], v[152:155], 0
s_cmp_eq_u32 s59, s70
v_exp_f32 v211, v211
v_mfma_f32_16x16x32_bf16 v[100:103], a[252:255], v[156:159], v[100:103]
s_cselect_b32 s59, s68, s59
v_cvt_pk_bf16_f32 v181, v210, v211
v_mfma_f32_16x16x32_bf16 v[216:219], a[208:211], a[64:67], 0
v_exp_f32 v212, v212
v_mfma_f32_16x16x32_bf16 v[216:219], a[212:215], a[68:71], v[216:219]
v_mfma_f32_16x16x32_bf16 v[216:219], a[216:219], a[72:75], v[216:219]
v_exp_f32 v213, v213
v_mfma_f32_16x16x32_bf16 v[216:219], a[220:223], a[76:79], v[216:219]
ds_read_b128 a[208:211], v242 offset:16896
v_cvt_pk_bf16_f32 v188, v212, v213
v_mfma_f32_16x16x32_bf16 a[164:167], a[248:251], v[160:163], 0
v_exp_f32 v214, v214
v_smfmac_f32_16x16x64_bf16 a[192:195], v[224:227], v[128:135], v228
s_waitcnt lgkmcnt(1)
ds_read_b64_tr_b16 a[248:249], v245 offset:32
ds_read_b64_tr_b16 a[250:251], v245 offset:4256
v_mfma_f32_16x16x32_bf16 v[8:11], a[240:243], v[128:131], 0
v_exp_f32 v215, v215
v_mfma_f32_16x16x32_bf16 v[8:11], a[244:247], v[132:135], v[8:11]
ds_read_b64_tr_b16 a[252:253], v247 offset:32
ds_read_b64_tr_b16 a[254:255], v247 offset:4256
v_mfma_f32_16x16x32_bf16 v[220:223], a[224:227], a[0:3], 0
v_exp_f32 v216, v216
v_mfma_f32_16x16x32_bf16 v[220:223], a[228:231], a[4:7], v[220:223]
ds_read_b128 a[212:215], v243 offset:16896
v_cvt_pk_bf16_f32 v189, v214, v215
v_mfma_f32_16x16x32_bf16 v[220:223], a[232:235], a[8:11], v[220:223]
v_exp_f32 v217, v217
v_mfma_f32_16x16x32_bf16 v[220:223], a[236:239], a[12:15], v[220:223]
ds_read_b128 a[216:219], v242 offset:17408
v_cvt_pk_bf16_f32 v196, v216, v217
v_mfma_f32_16x16x32_bf16 v[40:43], a[240:243], v[136:139], 0
s_mov_b32 m0, s58
v_exp_f32 v218, v218
v_mfma_f32_16x16x32_bf16 v[40:43], a[244:247], v[140:143], v[40:43]
ds_read_b128 a[220:223], v243 offset:17408
buffer_load_dwordx4 v248, s[36:39], s56 offen offset:0 nt lds
v_mfma_f32_16x16x32_bf16 v[72:75], a[240:243], v[144:147], 0
v_exp_f32 v219, v219
v_mfma_f32_16x16x32_bf16 v[72:75], a[244:247], v[148:151], v[72:75]
v_cvt_pk_bf16_f32 v197, v218, v219
v_add_f32 v229, v229, v216
v_mfma_f32_16x16x32_bf16 v[200:203], a[224:227], a[16:19], 0
v_exp_f32 v220, v220
v_mfma_f32_16x16x32_bf16 v[200:203], a[228:231], a[20:23], v[200:203]
v_add_f32 v229, v229, v217
v_add_f32 v229, v229, v218
v_mfma_f32_16x16x32_bf16 v[200:203], a[232:235], a[24:27], v[200:203]
v_exp_f32 v221, v221
v_mfma_f32_16x16x32_bf16 v[200:203], a[236:239], a[28:31], v[200:203]
v_cvt_pk_bf16_f32 v166, v220, v221
v_add_f32 v229, v229, v219
v_mfma_f32_16x16x32_bf16 v[104:107], a[240:243], v[152:155], 0
v_exp_f32 v222, v222
v_mfma_f32_16x16x32_bf16 v[104:107], a[244:247], v[156:159], v[104:107]
v_mfma_f32_16x16x32_bf16 a[168:171], a[240:243], v[160:163], 0
s_waitcnt lgkmcnt(3)
v_exp_f32_e64 v223, v223
v_mfma_f32_16x16x32_bf16 v[12:15], a[248:251], v[128:131], 0
ds_read_b64_tr_b16 a[240:241], v244 offset:512
ds_read_b64_tr_b16 a[242:243], v244 offset:4736
v_mfma_f32_16x16x32_bf16 v[12:15], a[252:255], v[132:135], v[12:15]
ds_read_b64_tr_b16 a[244:245], v246 offset:512
v_cvt_pk_bf16_f32 v167, v222, v223
v_mfma_f32_16x16x32_bf16 v[204:207], a[224:227], a[32:35], 0
v_exp_f32 v200, v200
v_mfma_f32_16x16x32_bf16 v[204:207], a[228:231], a[36:39], v[204:207]
ds_read_b64_tr_b16 a[246:247], v246 offset:4736
v_mfma_f32_16x16x32_bf16 v[204:207], a[232:235], a[40:43], v[204:207]
v_exp_f32 v201, v201
v_mfma_f32_16x16x32_bf16 v[204:207], a[236:239], a[44:47], v[204:207]
v_cvt_pk_bf16_f32 v174, v200, v201
v_mfma_f32_16x16x32_bf16 v[44:47], a[248:251], v[136:139], 0
v_exp_f32 v202, v202
v_mfma_f32_16x16x32_bf16 v[44:47], a[252:255], v[140:143], v[44:47]
s_add_u32 m0, s58, 32
v_mfma_f32_16x16x32_bf16 v[76:79], a[248:251], v[144:147], 0
v_exp_f32 v203, v203
v_mfma_f32_16x16x32_bf16 v[76:79], a[252:255], v[148:151], v[76:79]
buffer_load_dwordx4 v248, s[36:39], s56 offen offset:1024 nt lds
v_cvt_pk_bf16_f32 v175, v202, v203
v_mfma_f32_16x16x32_bf16 v[208:211], a[224:227], a[48:51], 0
v_exp_f32 v204, v204
v_mfma_f32_16x16x32_bf16 v[208:211], a[228:231], a[52:55], v[208:211]
v_mfma_f32_16x16x32_bf16 v[208:211], a[232:235], a[56:59], v[208:211]
v_exp_f32 v205, v205
v_mfma_f32_16x16x32_bf16 v[208:211], a[236:239], a[60:63], v[208:211]
v_cvt_pk_bf16_f32 v182, v204, v205
v_mfma_f32_16x16x32_bf16 v[108:111], a[248:251], v[152:155], 0
v_exp_f32 v206, v206
v_mfma_f32_16x16x32_bf16 v[108:111], a[252:255], v[156:159], v[108:111]
v_mfma_f32_16x16x32_bf16 a[172:175], a[248:251], v[160:163], 0
v_exp_f32 v207, v207
v_smfmac_f32_16x16x64_bf16 a[196:199], v[224:227], v[136:143], v228
ds_read_b64_tr_b16 a[248:249], v244 offset:544
ds_read_b64_tr_b16 a[250:251], v244 offset:4768
v_mfma_f32_16x16x32_bf16 v[212:215], a[224:227], a[64:67], 0
v_exp_f32 v208, v208
v_mfma_f32_16x16x32_bf16 v[212:215], a[228:231], a[68:71], v[212:215]
ds_read_b64_tr_b16 a[252:253], v246 offset:544
ds_read_b64_tr_b16 a[254:255], v246 offset:4768
v_mfma_f32_16x16x32_bf16 v[212:215], a[232:235], a[72:75], v[212:215]
v_exp_f32 v209, v209
v_mfma_f32_16x16x32_bf16 v[212:215], a[236:239], a[76:79], v[212:215]
s_waitcnt lgkmcnt(4)
ds_read_b128 a[224:227], v242 offset:21120
v_cvt_pk_bf16_f32 v183, v206, v207
v_mfma_f32_16x16x32_bf16 v[16:19], a[240:243], v[128:131], 0
v_exp_f32 v210, v210
v_mfma_f32_16x16x32_bf16 v[16:19], a[244:247], v[132:135], v[16:19]
ds_read_b128 a[228:231], v243 offset:21120
v_cvt_pk_bf16_f32 v190, v208, v209
v_mfma_f32_16x16x32_bf16 v[48:51], a[240:243], v[136:139], 0
v_exp_f32 v211, v211
v_mfma_f32_16x16x32_bf16 v[48:51], a[244:247], v[140:143], v[48:51]
ds_read_b128 a[232:235], v242 offset:21632
v_cvt_pk_bf16_f32 v191, v210, v211
v_mfma_f32_16x16x32_bf16 v[216:219], a[208:211], a[0:3], 0
s_add_u32 m0, s58, 64
v_exp_f32 v212, v212
v_mfma_f32_16x16x32_bf16 v[216:219], a[212:215], a[4:7], v[216:219]
ds_read_b128 a[236:239], v243 offset:21632
buffer_load_dwordx4 v248, s[36:39], s56 offen offset:2048 nt lds
v_mfma_f32_16x16x32_bf16 v[216:219], a[216:219], a[8:11], v[216:219]
v_exp_f32 v213, v213
v_mfma_f32_16x16x32_bf16 v[216:219], a[220:223], a[12:15], v[216:219]
v_cvt_pk_bf16_f32 v198, v212, v213
v_add_f32 v229, v229, v212
v_mfma_f32_16x16x32_bf16 v[80:83], a[240:243], v[144:147], 0
v_exp_f32 v214, v214
v_mfma_f32_16x16x32_bf16 v[80:83], a[244:247], v[148:151], v[80:83]
v_add_f32 v229, v229, v213
v_add_f32 v229, v229, v214
v_mfma_f32_16x16x32_bf16 v[112:115], a[240:243], v[152:155], 0
v_exp_f32 v215, v215
v_mfma_f32_16x16x32_bf16 v[112:115], a[244:247], v[156:159], v[112:115]
v_cvt_pk_bf16_f32 v199, v214, v215
v_add_f32 v229, v229, v215
v_mfma_f32_16x16x32_bf16 v[220:223], a[208:211], a[16:19], 0
v_exp_f32 v216, v216
v_mfma_f32_16x16x32_bf16 v[220:223], a[212:215], a[20:23], v[220:223]
v_add_u32 v242, s60, v242
v_add_u32 v243, s60, v243
v_mfma_f32_16x16x32_bf16 v[220:223], a[216:219], a[24:27], v[220:223]
s_mul_i32 s60, s60, -1
v_exp_f32 v217, v217
v_mfma_f32_16x16x32_bf16 v[220:223], a[220:223], a[28:31], v[220:223]
v_cvt_pk_bf16_f32 v168, v216, v217
v_mfma_f32_16x16x32_bf16 a[176:179], a[240:243], v[160:163], 0
s_waitcnt lgkmcnt(4)
v_exp_f32 v218, v218
v_mfma_f32_16x16x32_bf16 v[20:23], a[248:251], v[128:131], 0
ds_read_b64_tr_b16 a[240:241], v245 offset:512
ds_read_b64_tr_b16 a[242:243], v245 offset:4736
v_mfma_f32_16x16x32_bf16 v[20:23], a[252:255], v[132:135], v[20:23]
v_exp_f32_e64 v219, v219
v_mfma_f32_16x16x32_bf16 v[52:55], a[248:251], v[136:139], 0
ds_read_b64_tr_b16 a[244:245], v247 offset:512
ds_read_b64_tr_b16 a[246:247], v247 offset:4736
v_mfma_f32_16x16x32_bf16 v[52:55], a[252:255], v[140:143], v[52:55]
v_cvt_pk_bf16_f32 v169, v218, v219
v_mfma_f32_16x16x32_bf16 v[200:203], a[208:211], a[32:35], 0
v_exp_f32 v220, v220
v_mfma_f32_16x16x32_bf16 v[200:203], a[212:215], a[36:39], v[200:203]
s_add_u32 m0, s58, 96
v_mfma_f32_16x16x32_bf16 v[200:203], a[216:219], a[40:43], v[200:203]
v_exp_f32 v221, v221
v_mfma_f32_16x16x32_bf16 v[200:203], a[220:223], a[44:47], v[200:203]
buffer_load_dwordx4 v248, s[36:39], s56 offen offset:3072 nt lds
v_cvt_pk_bf16_f32 v176, v220, v221
v_mfma_f32_16x16x32_bf16 v[84:87], a[248:251], v[144:147], 0
s_add_u32 s56, s56, 16384
v_exp_f32 v222, v222
v_mfma_f32_16x16x32_bf16 v[84:87], a[252:255], v[148:151], v[84:87]
s_add_u32 s58, s58, 16896
v_mfma_f32_16x16x32_bf16 v[116:119], a[248:251], v[152:155], 0
s_cmp_eq_u32 s58, s69
v_exp_f32 v223, v223
v_mfma_f32_16x16x32_bf16 v[116:119], a[252:255], v[156:159], v[116:119]
s_cselect_b32 s58, s67, s58
v_cvt_pk_bf16_f32 v177, v222, v223
v_mfma_f32_16x16x32_bf16 v[204:207], a[208:211], a[48:51], 0
v_exp_f32 v200, v200
v_mfma_f32_16x16x32_bf16 v[204:207], a[212:215], a[52:55], v[204:207]
v_mfma_f32_16x16x32_bf16 v[204:207], a[216:219], a[56:59], v[204:207]
v_exp_f32 v201, v201
v_mfma_f32_16x16x32_bf16 v[204:207], a[220:223], a[60:63], v[204:207]
v_cvt_pk_bf16_f32 v184, v200, v201
v_mfma_f32_16x16x32_bf16 a[180:183], a[248:251], v[160:163], 0
v_exp_f32 v202, v202
v_smfmac_f32_16x16x64_bf16 a[200:203], v[224:227], v[144:151], v228
s_waitcnt lgkmcnt(0)
ds_read_b64_tr_b16 a[248:249], v245 offset:544
ds_read_b64_tr_b16 a[250:251], v245 offset:4768
v_mfma_f32_16x16x32_bf16 v[24:27], a[240:243], v[128:131], 0
v_exp_f32 v203, v203
v_mfma_f32_16x16x32_bf16 v[24:27], a[244:247], v[132:135], v[24:27]
ds_read_b64_tr_b16 a[252:253], v247 offset:544
ds_read_b64_tr_b16 a[254:255], v247 offset:4768
v_mfma_f32_16x16x32_bf16 v[208:211], a[224:227], a[0:3], 0
v_exp_f32 v204, v204
v_mfma_f32_16x16x32_bf16 v[208:211], a[228:231], a[4:7], v[208:211]
v_cvt_pk_bf16_f32 v185, v202, v203
v_mfma_f32_16x16x32_bf16 v[208:211], a[232:235], a[8:11], v[208:211]
s_waitcnt vmcnt(12)
v_exp_f32 v205, v205
v_mfma_f32_16x16x32_bf16 v[208:211], a[236:239], a[12:15], v[208:211]
s_barrier
v_mfma_f32_16x16x32_bf16 v[56:59], a[240:243], v[136:139], 0
s_mov_b32 m0, s59
v_exp_f32 v206, v206
v_mfma_f32_16x16x32_bf16 v[56:59], a[244:247], v[140:143], v[56:59]
ds_read_b128 a[208:211], v240 offset:0
buffer_load_dwordx4 v248, s[40:43], s57 offen offset:0 nt lds
v_cvt_pk_bf16_f32 v192, v204, v205
v_mfma_f32_16x16x32_bf16 v[88:91], a[240:243], v[144:147], 0
v_exp_f32 v207, v207
v_mfma_f32_16x16x32_bf16 v[88:91], a[244:247], v[148:151], v[88:91]
ds_read_b128 a[212:215], v241 offset:0
v_cvt_pk_bf16_f32 v193, v206, v207
v_mfma_f32_16x16x32_bf16 v[212:215], a[224:227], a[16:19], 0
v_exp_f32 v208, v208
v_mfma_f32_16x16x32_bf16 v[212:215], a[228:231], a[20:23], v[212:215]
ds_read_b128 a[216:219], v240 offset:512
v_mfma_f32_16x16x32_bf16 v[212:215], a[232:235], a[24:27], v[212:215]
v_exp_f32 v209, v209
v_mfma_f32_16x16x32_bf16 v[212:215], a[236:239], a[28:31], v[212:215]
ds_read_b128 a[220:223], v241 offset:512
v_cvt_pk_bf16_f32 v170, v208, v209
v_mfma_f32_16x16x32_bf16 v[120:123], a[240:243], v[152:155], 0
v_exp_f32 v210, v210
v_mfma_f32_16x16x32_bf16 v[120:123], a[244:247], v[156:159], v[120:123]
v_mfma_f32_16x16x32_bf16 a[184:187], a[240:243], v[160:163], 0
v_exp_f32 v211, v211
v_smfmac_f32_16x16x64_bf16 a[204:207], v[224:227], v[152:159], v228
ds_read_b64_tr_b16 a[240:241], v244 offset:16896
ds_read_b64_tr_b16 a[242:243], v244 offset:21120
v_mfma_f32_16x16x32_bf16 v[216:219], a[224:227], a[32:35], 0
v_exp_f32 v212, v212
v_mfma_f32_16x16x32_bf16 v[216:219], a[228:231], a[36:39], v[216:219]
ds_read_b64_tr_b16 a[244:245], v246 offset:16896
ds_read_b64_tr_b16 a[246:247], v246 offset:21120
v_mfma_f32_16x16x32_bf16 v[216:219], a[232:235], a[40:43], v[216:219]
v_exp_f32 v213, v213
v_mfma_f32_16x16x32_bf16 v[216:219], a[236:239], a[44:47], v[216:219]
s_waitcnt lgkmcnt(8)
v_cvt_pk_bf16_f32 v171, v210, v211
v_cvt_pk_bf16_f32 v178, v212, v213
v_mfma_f32_16x16x32_bf16 v[28:31], a[248:251], v[128:131], 0
v_exp_f32 v214, v214
v_mfma_f32_16x16x32_bf16 v[28:31], a[252:255], v[132:135], v[28:31]
v_mfma_f32_16x16x32_bf16 v[60:63], a[248:251], v[136:139], 0
s_add_u32 m0, s59, 32
v_exp_f32 v215, v215
v_mfma_f32_16x16x32_bf16 v[60:63], a[252:255], v[140:143], v[60:63]
buffer_load_dwordx4 v248, s[40:43], s57 offen offset:1024 nt lds
v_cvt_pk_bf16_f32 v179, v214, v215
v_mfma_f32_16x16x32_bf16 v[220:223], a[224:227], a[48:51], 0
v_exp_f32 v216, v216
v_mfma_f32_16x16x32_bf16 v[220:223], a[228:231], a[52:55], v[220:223]
v_mfma_f32_16x16x32_bf16 v[220:223], a[232:235], a[56:59], v[220:223]
v_exp_f32 v217, v217
v_mfma_f32_16x16x32_bf16 v[220:223], a[236:239], a[60:63], v[220:223]
v_cvt_pk_bf16_f32 v186, v216, v217
v_mfma_f32_16x16x32_bf16 v[92:95], a[248:251], v[144:147], 0
s_mul_i32 s62, s63, -2
v_exp_f32 v218, v218
v_mfma_f32_16x16x32_bf16 v[92:95], a[252:255], v[148:151], v[92:95]
s_add_u32 s62, s62, 7
v_mfma_f32_16x16x32_bf16 v[124:127], a[248:251], v[152:155], 0
v_exp_f32 v219, v219
v_mfma_f32_16x16x32_bf16 v[124:127], a[252:255], v[156:159], v[124:127]
s_waitcnt lgkmcnt(4)
v_cvt_pk_bf16_f32 v187, v218, v219
v_mfma_f32_16x16x32_bf16 a[188:191], a[248:251], v[160:163], 0
L_h_loop:
v_mfma_f32_16x16x32_bf16 v[200:203], a[208:211], a[0:3], 0
v_exp_f32 v220, v220
v_mfma_f32_16x16x32_bf16 v[200:203], a[212:215], a[4:7], v[200:203]
ds_read_b64_tr_b16 a[248:249], v244 offset:16928
ds_read_b64_tr_b16 a[250:251], v244 offset:21152
v_mfma_f32_16x16x32_bf16 v[200:203], a[216:219], a[8:11], v[200:203]
v_exp_f32 v221, v221
v_mfma_f32_16x16x32_bf16 v[200:203], a[220:223], a[12:15], v[200:203]
s_waitcnt lgkmcnt(2)
ds_read_b64_tr_b16 a[252:253], v246 offset:16928
ds_read_b64_tr_b16 a[254:255], v246 offset:21152
v_mfma_f32_16x16x32_bf16 v[0:3], a[240:243], v[164:167], v[0:3]
v_exp_f32 v222, v222
v_mfma_f32_16x16x32_bf16 v[0:3], a[244:247], v[168:171], v[0:3]
ds_read_b128 a[224:227], v240 offset:4224
v_cvt_pk_bf16_f32 v194, v220, v221
v_mfma_f32_16x16x32_bf16 v[32:35], a[240:243], v[172:175], v[32:35]
v_exp_f32 v223, v223
v_mfma_f32_16x16x32_bf16 v[32:35], a[244:247], v[176:179], v[32:35]
ds_read_b128 a[228:231], v241 offset:4224
v_cvt_pk_bf16_f32 v195, v222, v223
v_mfma_f32_16x16x32_bf16 v[204:207], a[208:211], a[16:19], 0
v_exp_f32 v200, v200
v_mfma_f32_16x16x32_bf16 v[204:207], a[212:215], a[20:23], v[204:207]
ds_read_b128 a[232:235], v240 offset:4736
buffer_load_dword v255, v254, s[20:23], s100 offen
v_mfma_f32_16x16x32_bf16 v[204:207], a[216:219], a[24:27], v[204:207]
s_add_u32 m0, s59, 64
v_exp_f32 v201, v201
v_mfma_f32_16x16x32_bf16 v[204:207], a[220:223], a[28:31], v[204:207]
ds_read_b128 a[236:239], v241 offset:4736
v_cvt_pk_bf16_f32 v128, v200, v201
v_mfma_f32_16x16x32_bf16 v[64:67], a[240:243], v[180:183], v[64:67]
v_exp_f32 v202, v202
v_mfma_f32_16x16x32_bf16 v[64:67], a[244:247], v[184:187], v[64:67]
buffer_load_dwordx4 v248, s[40:43], s57 offen offset:2048 nt lds
v_mfma_f32_16x16x32_bf16 a[160:163], a[240:243], v[196:199], a[160:163]
v_exp_f32 v203, v203
v_mfma_f32_16x16x32_bf16 v[96:99], a[240:243], v[188:191], v[96:99]
v_cvt_pk_bf16_f32 v129, v202, v203
v_mfma_f32_16x16x32_bf16 v[96:99], a[244:247], v[192:195], v[96:99]
ds_read_b64_tr_b16 a[240:241], v245 offset:16896
v_mfma_f32_16x16x32_bf16 v[208:211], a[208:211], a[32:35], 0
v_exp_f32 v204, v204
v_mfma_f32_16x16x32_bf16 v[208:211], a[212:215], a[36:39], v[208:211]
ds_read_b64_tr_b16 a[242:243], v245 offset:21120
ds_read_b64_tr_b16 a[244:245], v247 offset:16896
v_mfma_f32_16x16x32_bf16 v[208:211], a[216:219], a[40:43], v[208:211]
v_exp_f32 v205, v205
v_mfma_f32_16x16x32_bf16 v[208:211], a[220:223], a[44:47], v[208:211]
s_waitcnt lgkmcnt(7)
ds_read_b64_tr_b16 a[246:247], v247 offset:21120
v_cvt_pk_bf16_f32 v136, v204, v205
v_mfma_f32_16x16x32_bf16 v[4:7], a[248:251], v[164:167], v[4:7]
v_exp_f32 v206, v206
v_mfma_f32_16x16x32_bf16 v[4:7], a[252:255], v[168:171], v[4:7]
v_mfma_f32_16x16x32_bf16 v[36:39], a[248:251], v[172:175], v[36:39]
v_exp_f32 v207, v207
v_mfma_f32_16x16x32_bf16 v[36:39], a[252:255], v[176:179], v[36:39]
v_cvt_pk_bf16_f32 v137, v206, v207
v_mfma_f32_16x16x32_bf16 v[212:215], a[208:211], a[48:51], 0
v_exp_f32 v208, v208
v_mfma_f32_16x16x32_bf16 v[212:215], a[212:215], a[52:55], v[212:215]
v_mfma_f32_16x16x32_bf16 v[212:215], a[216:219], a[56:59], v[212:215]
v_exp_f32 v209, v209
v_mfma_f32_16x16x32_bf16 v[212:215], a[220:223], a[60:63], v[212:215]
v_cvt_pk_bf16_f32 v144, v208, v209
v_mfma_f32_16x16x32_bf16 v[68:71], a[248:251], v[180:183], v[68:71]
v_exp_f32 v210, v210
v_mfma_f32_16x16x32_bf16 v[68:71], a[252:255], v[184:187], v[68:71]
s_add_u32 m0, s59, 96
v_mfma_f32_16x16x32_bf16 v[100:103], a[248:251], v[188:191], v[100:103]
v_exp_f32 v211, v211
v_mfma_f32_16x16x32_bf16 v[100:103], a[252:255], v[192:195], v[100:103]
buffer_load_dwordx4 v248, s[40:43], s57 offen offset:3072 nt lds
v_cvt_pk_bf16_f32 v145, v210, v211
v_mfma_f32_16x16x32_bf16 v[216:219], a[208:211], a[64:67], 0
s_add_u32 s57, s57, 16384
v_exp_f32 v212, v212
v_mfma_f32_16x16x32_bf16 v[216:219], a[212:215], a[68:71], v[216:219]
s_add_u32 s59, s59, 16896
v_mfma_f32_16x16x32_bf16 v[216:219], a[216:219], a[72:75], v[216:219]
s_cmp_eq_u32 s59, s70
v_exp_f32 v213, v213
v_mfma_f32_16x16x32_bf16 v[216:219], a[220:223], a[76:79], v[216:219]
s_cselect_b32 s59, s68, s59
ds_read_b128 a[208:211], v242 offset:0
v_cvt_pk_bf16_f32 v152, v212, v213
v_mfma_f32_16x16x32_bf16 a[164:167], a[248:251], v[196:199], a[164:167]
v_exp_f32 v214, v214
v_smfmac_f32_16x16x64_bf16 a[192:195], v[224:227], v[164:171], v228
s_waitcnt lgkmcnt(1)
ds_read_b64_tr_b16 a[248:249], v245 offset:16928
ds_read_b64_tr_b16 a[250:251], v245 offset:21152
v_mfma_f32_16x16x32_bf16 v[8:11], a[240:243], v[164:167], v[8:11]
v_exp_f32 v215, v215
v_mfma_f32_16x16x32_bf16 v[8:11], a[244:247], v[168:171], v[8:11]
ds_read_b64_tr_b16 a[252:253], v247 offset:16928
ds_read_b64_tr_b16 a[254:255], v247 offset:21152
v_mfma_f32_16x16x32_bf16 v[220:223], a[224:227], a[0:3], 0
v_exp_f32 v216, v216
v_mfma_f32_16x16x32_bf16 v[220:223], a[228:231], a[4:7], v[220:223]
ds_read_b128 a[212:215], v243 offset:0
v_cvt_pk_bf16_f32 v153, v214, v215
v_mfma_f32_16x16x32_bf16 v[220:223], a[232:235], a[8:11], v[220:223]
v_exp_f32 v217, v217
v_mfma_f32_16x16x32_bf16 v[220:223], a[236:239], a[12:15], v[220:223]
ds_read_b128 a[216:219], v242 offset:512
v_cvt_pk_bf16_f32 v160, v216, v217
v_mfma_f32_16x16x32_bf16 v[40:43], a[240:243], v[172:175], v[40:43]
v_exp_f32 v218, v218
v_mfma_f32_16x16x32_bf16 v[40:43], a[244:247], v[176:179], v[40:43]
ds_read_b128 a[220:223], v243 offset:512
v_add_f32 v229, v229, v216
v_mfma_f32_16x16x32_bf16 v[72:75], a[240:243], v[180:183], v[72:75]
v_exp_f32 v219, v219
v_mfma_f32_16x16x32_bf16 v[72:75], a[244:247], v[184:187], v[72:75]
v_cvt_pk_bf16_f32 v161, v218, v219
v_add_f32 v229, v229, v217
v_mfma_f32_16x16x32_bf16 v[200:203], a[224:227], a[16:19], 0
s_mov_b32 m0, s58
v_exp_f32 v220, v220
v_mfma_f32_16x16x32_bf16 v[200:203], a[228:231], a[20:23], v[200:203]
buffer_load_dwordx4 v248, s[36:39], s56 offen offset:0 nt lds
v_add_f32 v229, v229, v218
v_mfma_f32_16x16x32_bf16 v[200:203], a[232:235], a[24:27], v[200:203]
v_exp_f32 v221, v221
v_mfma_f32_16x16x32_bf16 v[200:203], a[236:239], a[28:31], v[200:203]
v_cvt_pk_bf16_f32 v130, v220, v221
v_add_f32 v229, v229, v219
v_mfma_f32_16x16x32_bf16 v[104:107], a[240:243], v[188:191], v[104:107]
v_exp_f32 v222, v222
v_mfma_f32_16x16x32_bf16 v[104:107], a[244:247], v[192:195], v[104:107]
v_mfma_f32_16x16x32_bf16 a[168:171], a[240:243], v[196:199], a[168:171]
s_waitcnt lgkmcnt(3)
v_exp_f32_e64 v223, v223
v_mfma_f32_16x16x32_bf16 v[12:15], a[248:251], v[164:167], v[12:15]
ds_read_b64_tr_b16 a[240:241], v244 offset:17408
ds_read_b64_tr_b16 a[242:243], v244 offset:21632
v_mfma_f32_16x16x32_bf16 v[12:15], a[252:255], v[168:171], v[12:15]
ds_read_b64_tr_b16 a[244:245], v246 offset:17408
v_cvt_pk_bf16_f32 v131, v222, v223
v_mfma_f32_16x16x32_bf16 v[204:207], a[224:227], a[32:35], 0
v_exp_f32 v200, v200
v_mfma_f32_16x16x32_bf16 v[204:207], a[228:231], a[36:39], v[204:207]
ds_read_b64_tr_b16 a[246:247], v246 offset:21632
v_mfma_f32_16x16x32_bf16 v[204:207], a[232:235], a[40:43], v[204:207]
v_exp_f32 v201, v201
v_mfma_f32_16x16x32_bf16 v[204:207], a[236:239], a[44:47], v[204:207]
v_cvt_pk_bf16_f32 v138, v200, v201
v_mfma_f32_16x16x32_bf16 v[44:47], a[248:251], v[172:175], v[44:47]
v_exp_f32 v202, v202
v_mfma_f32_16x16x32_bf16 v[44:47], a[252:255], v[176:179], v[44:47]
v_mfma_f32_16x16x32_bf16 v[76:79], a[248:251], v[180:183], v[76:79]
v_exp_f32 v203, v203
v_mfma_f32_16x16x32_bf16 v[76:79], a[252:255], v[184:187], v[76:79]
v_cvt_pk_bf16_f32 v139, v202, v203
v_mfma_f32_16x16x32_bf16 v[208:211], a[224:227], a[48:51], 0
v_exp_f32 v204, v204
v_mfma_f32_16x16x32_bf16 v[208:211], a[228:231], a[52:55], v[208:211]
s_add_u32 m0, s58, 32
v_mfma_f32_16x16x32_bf16 v[208:211], a[232:235], a[56:59], v[208:211]
v_exp_f32 v205, v205
v_mfma_f32_16x16x32_bf16 v[208:211], a[236:239], a[60:63], v[208:211]
buffer_load_dwordx4 v248, s[36:39], s56 offen offset:1024 nt lds
v_cvt_pk_bf16_f32 v146, v204, v205
v_mfma_f32_16x16x32_bf16 v[108:111], a[248:251], v[188:191], v[108:111]
v_exp_f32 v206, v206
v_mfma_f32_16x16x32_bf16 v[108:111], a[252:255], v[192:195], v[108:111]
v_mfma_f32_16x16x32_bf16 a[172:175], a[248:251], v[196:199], a[172:175]
v_exp_f32 v207, v207
v_smfmac_f32_16x16x64_bf16 a[196:199], v[224:227], v[172:179], v228
ds_read_b64_tr_b16 a[248:249], v244 offset:17440
ds_read_b64_tr_b16 a[250:251], v244 offset:21664
v_mfma_f32_16x16x32_bf16 v[212:215], a[224:227], a[64:67], 0
v_exp_f32 v208, v208
v_mfma_f32_16x16x32_bf16 v[212:215], a[228:231], a[68:71], v[212:215]
ds_read_b64_tr_b16 a[252:253], v246 offset:17440
ds_read_b64_tr_b16 a[254:255], v246 offset:21664
v_mfma_f32_16x16x32_bf16 v[212:215], a[232:235], a[72:75], v[212:215]
v_exp_f32 v209, v209
v_mfma_f32_16x16x32_bf16 v[212:215], a[236:239], a[76:79], v[212:215]
s_waitcnt lgkmcnt(4)
ds_read_b128 a[224:227], v242 offset:4224
v_cvt_pk_bf16_f32 v147, v206, v207
v_mfma_f32_16x16x32_bf16 v[16:19], a[240:243], v[164:167], v[16:19]
v_exp_f32 v210, v210
v_mfma_f32_16x16x32_bf16 v[16:19], a[244:247], v[168:171], v[16:19]
ds_read_b128 a[228:231], v243 offset:4224
v_cvt_pk_bf16_f32 v154, v208, v209
v_mfma_f32_16x16x32_bf16 v[48:51], a[240:243], v[172:175], v[48:51]
v_exp_f32 v211, v211
v_mfma_f32_16x16x32_bf16 v[48:51], a[244:247], v[176:179], v[48:51]
ds_read_b128 a[232:235], v242 offset:4736
v_cvt_pk_bf16_f32 v155, v210, v211
v_mfma_f32_16x16x32_bf16 v[216:219], a[208:211], a[0:3], 0
v_exp_f32 v212, v212
v_mfma_f32_16x16x32_bf16 v[216:219], a[212:215], a[4:7], v[216:219]
ds_read_b128 a[236:239], v243 offset:4736
v_add_f32 v229, v229, v212
v_mfma_f32_16x16x32_bf16 v[216:219], a[216:219], a[8:11], v[216:219]
v_exp_f32 v213, v213
v_mfma_f32_16x16x32_bf16 v[216:219], a[220:223], a[12:15], v[216:219]
v_cvt_pk_bf16_f32 v162, v212, v213
v_add_f32 v229, v229, v213
v_mfma_f32_16x16x32_bf16 v[80:83], a[240:243], v[180:183], v[80:83]
s_add_u32 m0, s58, 64
v_exp_f32 v214, v214
v_mfma_f32_16x16x32_bf16 v[80:83], a[244:247], v[184:187], v[80:83]
buffer_load_dwordx4 v248, s[36:39], s56 offen offset:2048 nt lds
v_add_f32 v229, v229, v214
v_mfma_f32_16x16x32_bf16 v[112:115], a[240:243], v[188:191], v[112:115]
v_exp_f32 v215, v215
v_mfma_f32_16x16x32_bf16 v[112:115], a[244:247], v[192:195], v[112:115]
v_cvt_pk_bf16_f32 v163, v214, v215
v_add_f32 v229, v229, v215
v_mfma_f32_16x16x32_bf16 v[220:223], a[208:211], a[16:19], 0
v_exp_f32 v216, v216
v_mfma_f32_16x16x32_bf16 v[220:223], a[212:215], a[20:23], v[220:223]
v_add_u32 v244, s61, v244
v_add_u32 v246, s61, v246
v_mfma_f32_16x16x32_bf16 v[220:223], a[216:219], a[24:27], v[220:223]
v_exp_f32 v217, v217
v_mfma_f32_16x16x32_bf16 v[220:223], a[220:223], a[28:31], v[220:223]
v_cvt_pk_bf16_f32 v132, v216, v217
v_mfma_f32_16x16x32_bf16 a[176:179], a[240:243], v[196:199], a[176:179]
s_waitcnt lgkmcnt(4)
v_exp_f32 v218, v218
v_mfma_f32_16x16x32_bf16 v[20:23], a[248:251], v[164:167], v[20:23]
ds_read_b64_tr_b16 a[240:241], v245 offset:17408
ds_read_b64_tr_b16 a[242:243], v245 offset:21632
v_mfma_f32_16x16x32_bf16 v[20:23], a[252:255], v[168:171], v[20:23]
v_exp_f32 v219, v219
v_mfma_f32_16x16x32_bf16 v[52:55], a[248:251], v[172:175], v[52:55]
ds_read_b64_tr_b16 a[244:245], v247 offset:17408
ds_read_b64_tr_b16 a[246:247], v247 offset:21632
v_mfma_f32_16x16x32_bf16 v[52:55], a[252:255], v[176:179], v[52:55]
v_cvt_pk_bf16_f32 v133, v218, v219
v_mfma_f32_16x16x32_bf16 v[200:203], a[208:211], a[32:35], 0
v_exp_f32 v220, v220
v_mfma_f32_16x16x32_bf16 v[200:203], a[212:215], a[36:39], v[200:203]
v_mfma_f32_16x16x32_bf16 v[200:203], a[216:219], a[40:43], v[200:203]
v_exp_f32 v221, v221
v_mfma_f32_16x16x32_bf16 v[200:203], a[220:223], a[44:47], v[200:203]
v_cvt_pk_bf16_f32 v140, v220, v221
v_mfma_f32_16x16x32_bf16 v[84:87], a[248:251], v[180:183], v[84:87]
v_exp_f32 v222, v222
v_mfma_f32_16x16x32_bf16 v[84:87], a[252:255], v[184:187], v[84:87]
s_add_u32 m0, s58, 96
v_mfma_f32_16x16x32_bf16 v[116:119], a[248:251], v[188:191], v[116:119]
v_exp_f32 v223, v223
v_mfma_f32_16x16x32_bf16 v[116:119], a[252:255], v[192:195], v[116:119]
buffer_load_dwordx4 v248, s[36:39], s56 offen offset:3072 nt lds
v_cvt_pk_bf16_f32 v141, v222, v223
v_mfma_f32_16x16x32_bf16 v[204:207], a[208:211], a[48:51], 0
s_add_u32 s56, s56, 16384
v_exp_f32 v200, v200
v_mfma_f32_16x16x32_bf16 v[204:207], a[212:215], a[52:55], v[204:207]
s_add_u32 s58, s58, 16896
v_mfma_f32_16x16x32_bf16 v[204:207], a[216:219], a[56:59], v[204:207]
s_cmp_eq_u32 s58, s69
v_exp_f32 v201, v201
v_mfma_f32_16x16x32_bf16 v[204:207], a[220:223], a[60:63], v[204:207]
s_cselect_b32 s58, s67, s58
v_cvt_pk_bf16_f32 v148, v200, v201
v_mfma_f32_16x16x32_bf16 a[180:183], a[248:251], v[196:199], a[180:183]
v_exp_f32 v202, v202
v_smfmac_f32_16x16x64_bf16 a[200:203], v[224:227], v[180:187], v228
s_waitcnt lgkmcnt(0)
ds_read_b64_tr_b16 a[248:249], v245 offset:17440
ds_read_b64_tr_b16 a[250:251], v245 offset:21664
v_mfma_f32_16x16x32_bf16 v[24:27], a[240:243], v[164:167], v[24:27]
v_exp_f32 v203, v203
v_mfma_f32_16x16x32_bf16 v[24:27], a[244:247], v[168:171], v[24:27]
ds_read_b64_tr_b16 a[252:253], v247 offset:17440
ds_read_b64_tr_b16 a[254:255], v247 offset:21664
v_mfma_f32_16x16x32_bf16 v[208:211], a[224:227], a[0:3], 0
v_exp_f32 v204, v204
v_mfma_f32_16x16x32_bf16 v[208:211], a[228:231], a[4:7], v[208:211]
v_cvt_pk_bf16_f32 v149, v202, v203
v_add_u32 v245, s61, v245
v_mfma_f32_16x16x32_bf16 v[208:211], a[232:235], a[8:11], v[208:211]
s_waitcnt vmcnt(12)
v_exp_f32 v205, v205
v_mfma_f32_16x16x32_bf16 v[208:211], a[236:239], a[12:15], v[208:211]
s_barrier
v_mfma_f32_16x16x32_bf16 v[56:59], a[240:243], v[172:175], v[56:59]
s_mov_b32 m0, s59
v_exp_f32 v206, v206
v_mfma_f32_16x16x32_bf16 v[56:59], a[244:247], v[176:179], v[56:59]
ds_read_b128 a[208:211], v240 offset:16896
buffer_load_dwordx4 v248, s[40:43], s57 offen offset:0 nt lds
v_cvt_pk_bf16_f32 v156, v204, v205
v_mfma_f32_16x16x32_bf16 v[88:91], a[240:243], v[180:183], v[88:91]
v_exp_f32 v207, v207
v_mfma_f32_16x16x32_bf16 v[88:91], a[244:247], v[184:187], v[88:91]
ds_read_b128 a[212:215], v241 offset:16896
v_cvt_pk_bf16_f32 v157, v206, v207
v_mfma_f32_16x16x32_bf16 v[212:215], a[224:227], a[16:19], 0
v_exp_f32 v208, v208
v_mfma_f32_16x16x32_bf16 v[212:215], a[228:231], a[20:23], v[212:215]
ds_read_b128 a[216:219], v240 offset:17408
v_add_u32 v247, s61, v247
v_mfma_f32_16x16x32_bf16 v[212:215], a[232:235], a[24:27], v[212:215]
s_mul_i32 s61, s61, -1
v_exp_f32 v209, v209
v_mfma_f32_16x16x32_bf16 v[212:215], a[236:239], a[28:31], v[212:215]
ds_read_b128 a[220:223], v241 offset:17408
v_cvt_pk_bf16_f32 v134, v208, v209
v_mfma_f32_16x16x32_bf16 v[120:123], a[240:243], v[188:191], v[120:123]
v_exp_f32 v210, v210
v_mfma_f32_16x16x32_bf16 v[120:123], a[244:247], v[192:195], v[120:123]
v_mfma_f32_16x16x32_bf16 a[184:187], a[240:243], v[196:199], a[184:187]
v_exp_f32 v211, v211
v_smfmac_f32_16x16x64_bf16 a[204:207], v[224:227], v[188:195], v228
ds_read_b64_tr_b16 a[240:241], v244 offset:0
ds_read_b64_tr_b16 a[242:243], v244 offset:4224
v_mfma_f32_16x16x32_bf16 v[216:219], a[224:227], a[32:35], 0
v_exp_f32 v212, v212
v_mfma_f32_16x16x32_bf16 v[216:219], a[228:231], a[36:39], v[216:219]
ds_read_b64_tr_b16 a[244:245], v246 offset:0
ds_read_b64_tr_b16 a[246:247], v246 offset:4224
v_mfma_f32_16x16x32_bf16 v[216:219], a[232:235], a[40:43], v[216:219]
v_exp_f32 v213, v213
v_mfma_f32_16x16x32_bf16 v[216:219], a[236:239], a[44:47], v[216:219]
s_waitcnt lgkmcnt(8)
v_cvt_pk_bf16_f32 v135, v210, v211
v_cvt_pk_bf16_f32 v142, v212, v213
v_mfma_f32_16x16x32_bf16 v[28:31], a[248:251], v[164:167], v[28:31]
v_exp_f32 v214, v214
v_mfma_f32_16x16x32_bf16 v[28:31], a[252:255], v[168:171], v[28:31]
v_mfma_f32_16x16x32_bf16 v[60:63], a[248:251], v[172:175], v[60:63]
s_add_u32 m0, s59, 32
v_exp_f32 v215, v215
v_mfma_f32_16x16x32_bf16 v[60:63], a[252:255], v[176:179], v[60:63]
buffer_load_dwordx4 v248, s[40:43], s57 offen offset:1024 nt lds
v_cvt_pk_bf16_f32 v143, v214, v215
v_mfma_f32_16x16x32_bf16 v[220:223], a[224:227], a[48:51], 0
v_exp_f32 v216, v216
v_mfma_f32_16x16x32_bf16 v[220:223], a[228:231], a[52:55], v[220:223]
v_mfma_f32_16x16x32_bf16 v[220:223], a[232:235], a[56:59], v[220:223]
v_exp_f32 v217, v217
v_mfma_f32_16x16x32_bf16 v[220:223], a[236:239], a[60:63], v[220:223]
v_cvt_pk_bf16_f32 v150, v216, v217
v_mfma_f32_16x16x32_bf16 v[92:95], a[248:251], v[180:183], v[92:95]
v_exp_f32 v218, v218
v_mfma_f32_16x16x32_bf16 v[92:95], a[252:255], v[184:187], v[92:95]
v_mfma_f32_16x16x32_bf16 v[124:127], a[248:251], v[188:191], v[124:127]
v_exp_f32 v219, v219
v_mfma_f32_16x16x32_bf16 v[124:127], a[252:255], v[192:195], v[124:127]
s_waitcnt lgkmcnt(4)
v_cvt_pk_bf16_f32 v151, v218, v219
v_mfma_f32_16x16x32_bf16 a[188:191], a[248:251], v[196:199], a[188:191]
v_mfma_f32_16x16x32_bf16 v[200:203], a[208:211], a[0:3], 0
v_exp_f32 v220, v220
v_mfma_f32_16x16x32_bf16 v[200:203], a[212:215], a[4:7], v[200:203]
ds_read_b64_tr_b16 a[248:249], v244 offset:32
ds_read_b64_tr_b16 a[250:251], v244 offset:4256
v_mfma_f32_16x16x32_bf16 v[200:203], a[216:219], a[8:11], v[200:203]
v_exp_f32 v221, v221
v_mfma_f32_16x16x32_bf16 v[200:203], a[220:223], a[12:15], v[200:203]
s_waitcnt lgkmcnt(2)
ds_read_b64_tr_b16 a[252:253], v246 offset:32
ds_read_b64_tr_b16 a[254:255], v246 offset:4256
v_mfma_f32_16x16x32_bf16 v[0:3], a[240:243], v[128:131], v[0:3]
v_exp_f32 v222, v222
v_mfma_f32_16x16x32_bf16 v[0:3], a[244:247], v[132:135], v[0:3]
ds_read_b128 a[224:227], v240 offset:21120
v_cvt_pk_bf16_f32 v158, v220, v221
v_mfma_f32_16x16x32_bf16 v[32:35], a[240:243], v[136:139], v[32:35]
v_exp_f32 v223, v223
v_mfma_f32_16x16x32_bf16 v[32:35], a[244:247], v[140:143], v[32:35]
ds_read_b128 a[228:231], v241 offset:21120
v_cvt_pk_bf16_f32 v159, v222, v223
v_mfma_f32_16x16x32_bf16 v[204:207], a[208:211], a[16:19], 0
s_add_u32 m0, s59, 64
v_exp_f32 v200, v200
v_mfma_f32_16x16x32_bf16 v[204:207], a[212:215], a[20:23], v[204:207]
ds_read_b128 a[232:235], v240 offset:21632
buffer_load_dwordx4 v248, s[40:43], s57 offen offset:2048 nt lds
v_mfma_f32_16x16x32_bf16 v[204:207], a[216:219], a[24:27], v[204:207]
v_exp_f32 v201, v201
v_mfma_f32_16x16x32_bf16 v[204:207], a[220:223], a[28:31], v[204:207]
ds_read_b128 a[236:239], v241 offset:21632
v_cvt_pk_bf16_f32 v164, v200, v201
v_mfma_f32_16x16x32_bf16 v[64:67], a[240:243], v[144:147], v[64:67]
v_exp_f32 v202, v202
v_mfma_f32_16x16x32_bf16 v[64:67], a[244:247], v[148:151], v[64:67]
v_add_u32 v240, s60, v240
v_add_u32 v241, s60, v241
v_mfma_f32_16x16x32_bf16 a[160:163], a[240:243], v[160:163], a[160:163]
v_exp_f32 v203, v203
v_mfma_f32_16x16x32_bf16 v[96:99], a[240:243], v[152:155], v[96:99]
v_cvt_pk_bf16_f32 v165, v202, v203
v_mfma_f32_16x16x32_bf16 v[96:99], a[244:247], v[156:159], v[96:99]
ds_read_b64_tr_b16 a[240:241], v245 offset:0
v_mfma_f32_16x16x32_bf16 v[208:211], a[208:211], a[32:35], 0
v_exp_f32 v204, v204
v_mfma_f32_16x16x32_bf16 v[208:211], a[212:215], a[36:39], v[208:211]
ds_read_b64_tr_b16 a[242:243], v245 offset:4224
ds_read_b64_tr_b16 a[244:245], v247 offset:0
v_mfma_f32_16x16x32_bf16 v[208:211], a[216:219], a[40:43], v[208:211]
v_exp_f32 v205, v205
v_mfma_f32_16x16x32_bf16 v[208:211], a[220:223], a[44:47], v[208:211]
s_waitcnt lgkmcnt(7)
ds_read_b64_tr_b16 a[246:247], v247 offset:4224
v_cvt_pk_bf16_f32 v172, v204, v205
v_mfma_f32_16x16x32_bf16 v[4:7], a[248:251], v[128:131], v[4:7]
v_exp_f32 v206, v206
v_mfma_f32_16x16x32_bf16 v[4:7], a[252:255], v[132:135], v[4:7]
v_mfma_f32_16x16x32_bf16 v[36:39], a[248:251], v[136:139], v[36:39]
v_exp_f32 v207, v207
v_mfma_f32_16x16x32_bf16 v[36:39], a[252:255], v[140:143], v[36:39]
v_cvt_pk_bf16_f32 v173, v206, v207
v_mfma_f32_16x16x32_bf16 v[212:215], a[208:211], a[48:51], 0
v_exp_f32 v208, v208
v_mfma_f32_16x16x32_bf16 v[212:215], a[212:215], a[52:55], v[212:215]
s_add_u32 m0, s59, 96
v_mfma_f32_16x16x32_bf16 v[212:215], a[216:219], a[56:59], v[212:215]
v_exp_f32 v209, v209
v_mfma_f32_16x16x32_bf16 v[212:215], a[220:223], a[60:63], v[212:215]
buffer_load_dwordx4 v248, s[40:43], s57 offen offset:3072 nt lds
v_cvt_pk_bf16_f32 v180, v208, v209
v_mfma_f32_16x16x32_bf16 v[68:71], a[248:251], v[144:147], v[68:71]
s_add_u32 s57, s57, 16384
v_exp_f32 v210, v210
v_mfma_f32_16x16x32_bf16 v[68:71], a[252:255], v[148:151], v[68:71]
s_add_u32 s59, s59, 16896
v_mfma_f32_16x16x32_bf16 v[100:103], a[248:251], v[152:155], v[100:103]
s_cmp_eq_u32 s59, s70
v_exp_f32 v211, v211
v_mfma_f32_16x16x32_bf16 v[100:103], a[252:255], v[156:159], v[100:103]
s_cselect_b32 s59, s68, s59
v_cvt_pk_bf16_f32 v181, v210, v211
v_mfma_f32_16x16x32_bf16 v[216:219], a[208:211], a[64:67], 0
v_exp_f32 v212, v212
v_mfma_f32_16x16x32_bf16 v[216:219], a[212:215], a[68:71], v[216:219]
v_mfma_f32_16x16x32_bf16 v[216:219], a[216:219], a[72:75], v[216:219]
v_exp_f32 v213, v213
v_mfma_f32_16x16x32_bf16 v[216:219], a[220:223], a[76:79], v[216:219]
ds_read_b128 a[208:211], v242 offset:16896
v_cvt_pk_bf16_f32 v188, v212, v213
v_mfma_f32_16x16x32_bf16 a[164:167], a[248:251], v[160:163], a[164:167]
v_exp_f32 v214, v214
v_smfmac_f32_16x16x64_bf16 a[192:195], v[224:227], v[128:135], v228
s_waitcnt lgkmcnt(1)
ds_read_b64_tr_b16 a[248:249], v245 offset:32
ds_read_b64_tr_b16 a[250:251], v245 offset:4256
v_mfma_f32_16x16x32_bf16 v[8:11], a[240:243], v[128:131], v[8:11]
v_exp_f32 v215, v215
v_mfma_f32_16x16x32_bf16 v[8:11], a[244:247], v[132:135], v[8:11]
ds_read_b64_tr_b16 a[252:253], v247 offset:32
ds_read_b64_tr_b16 a[254:255], v247 offset:4256
v_mfma_f32_16x16x32_bf16 v[220:223], a[224:227], a[0:3], 0
v_exp_f32 v216, v216
v_mfma_f32_16x16x32_bf16 v[220:223], a[228:231], a[4:7], v[220:223]
ds_read_b128 a[212:215], v243 offset:16896
v_cvt_pk_bf16_f32 v189, v214, v215
v_mfma_f32_16x16x32_bf16 v[220:223], a[232:235], a[8:11], v[220:223]
v_exp_f32 v217, v217
v_mfma_f32_16x16x32_bf16 v[220:223], a[236:239], a[12:15], v[220:223]
ds_read_b128 a[216:219], v242 offset:17408
v_cvt_pk_bf16_f32 v196, v216, v217
v_mfma_f32_16x16x32_bf16 v[40:43], a[240:243], v[136:139], v[40:43]
s_mov_b32 m0, s58
v_exp_f32 v218, v218
v_mfma_f32_16x16x32_bf16 v[40:43], a[244:247], v[140:143], v[40:43]
ds_read_b128 a[220:223], v243 offset:17408
buffer_load_dwordx4 v248, s[36:39], s56 offen offset:0 nt lds
v_mfma_f32_16x16x32_bf16 v[72:75], a[240:243], v[144:147], v[72:75]
v_exp_f32 v219, v219
v_mfma_f32_16x16x32_bf16 v[72:75], a[244:247], v[148:151], v[72:75]
v_cvt_pk_bf16_f32 v197, v218, v219
v_add_f32 v229, v229, v216
v_mfma_f32_16x16x32_bf16 v[200:203], a[224:227], a[16:19], 0
v_exp_f32 v220, v220
v_mfma_f32_16x16x32_bf16 v[200:203], a[228:231], a[20:23], v[200:203]
v_add_f32 v229, v229, v217
v_add_f32 v229, v229, v218
v_mfma_f32_16x16x32_bf16 v[200:203], a[232:235], a[24:27], v[200:203]
v_exp_f32 v221, v221
v_mfma_f32_16x16x32_bf16 v[200:203], a[236:239], a[28:31], v[200:203]
v_cvt_pk_bf16_f32 v166, v220, v221
v_add_f32 v229, v229, v219
v_mfma_f32_16x16x32_bf16 v[104:107], a[240:243], v[152:155], v[104:107]
v_exp_f32 v222, v222
v_mfma_f32_16x16x32_bf16 v[104:107], a[244:247], v[156:159], v[104:107]
v_mfma_f32_16x16x32_bf16 a[168:171], a[240:243], v[160:163], a[168:171]
s_waitcnt lgkmcnt(3)
v_exp_f32 v223, v223
v_mfma_f32_16x16x32_bf16 v[12:15], a[248:251], v[128:131], v[12:15]
ds_read_b64_tr_b16 a[240:241], v244 offset:512
ds_read_b64_tr_b16 a[242:243], v244 offset:4736
v_mfma_f32_16x16x32_bf16 v[12:15], a[252:255], v[132:135], v[12:15]
ds_read_b64_tr_b16 a[244:245], v246 offset:512
v_cvt_pk_bf16_f32 v167, v222, v223
v_mfma_f32_16x16x32_bf16 v[204:207], a[224:227], a[32:35], 0
v_exp_f32 v200, v200
v_mfma_f32_16x16x32_bf16 v[204:207], a[228:231], a[36:39], v[204:207]
ds_read_b64_tr_b16 a[246:247], v246 offset:4736
v_mfma_f32_16x16x32_bf16 v[204:207], a[232:235], a[40:43], v[204:207]
v_exp_f32 v201, v201
v_mfma_f32_16x16x32_bf16 v[204:207], a[236:239], a[44:47], v[204:207]
v_cvt_pk_bf16_f32 v174, v200, v201
v_mfma_f32_16x16x32_bf16 v[44:47], a[248:251], v[136:139], v[44:47]
v_exp_f32 v202, v202
v_mfma_f32_16x16x32_bf16 v[44:47], a[252:255], v[140:143], v[44:47]
s_add_u32 m0, s58, 32
v_mfma_f32_16x16x32_bf16 v[76:79], a[248:251], v[144:147], v[76:79]
v_exp_f32 v203, v203
v_mfma_f32_16x16x32_bf16 v[76:79], a[252:255], v[148:151], v[76:79]
buffer_load_dwordx4 v248, s[36:39], s56 offen offset:1024 nt lds
v_cvt_pk_bf16_f32 v175, v202, v203
v_mfma_f32_16x16x32_bf16 v[208:211], a[224:227], a[48:51], 0
v_exp_f32 v204, v204
v_mfma_f32_16x16x32_bf16 v[208:211], a[228:231], a[52:55], v[208:211]
v_mfma_f32_16x16x32_bf16 v[208:211], a[232:235], a[56:59], v[208:211]
v_exp_f32 v205, v205
v_mfma_f32_16x16x32_bf16 v[208:211], a[236:239], a[60:63], v[208:211]
v_cvt_pk_bf16_f32 v182, v204, v205
v_mfma_f32_16x16x32_bf16 v[108:111], a[248:251], v[152:155], v[108:111]
v_exp_f32 v206, v206
v_mfma_f32_16x16x32_bf16 v[108:111], a[252:255], v[156:159], v[108:111]
v_mfma_f32_16x16x32_bf16 a[172:175], a[248:251], v[160:163], a[172:175]
v_exp_f32 v207, v207
v_smfmac_f32_16x16x64_bf16 a[196:199], v[224:227], v[136:143], v228
ds_read_b64_tr_b16 a[248:249], v244 offset:544
ds_read_b64_tr_b16 a[250:251], v244 offset:4768
v_mfma_f32_16x16x32_bf16 v[212:215], a[224:227], a[64:67], 0
v_exp_f32 v208, v208
v_mfma_f32_16x16x32_bf16 v[212:215], a[228:231], a[68:71], v[212:215]
ds_read_b64_tr_b16 a[252:253], v246 offset:544
ds_read_b64_tr_b16 a[254:255], v246 offset:4768
v_mfma_f32_16x16x32_bf16 v[212:215], a[232:235], a[72:75], v[212:215]
v_exp_f32 v209, v209
v_mfma_f32_16x16x32_bf16 v[212:215], a[236:239], a[76:79], v[212:215]
s_waitcnt lgkmcnt(4)
ds_read_b128 a[224:227], v242 offset:21120
v_cvt_pk_bf16_f32 v183, v206, v207
v_mfma_f32_16x16x32_bf16 v[16:19], a[240:243], v[128:131], v[16:19]
v_exp_f32 v210, v210
v_mfma_f32_16x16x32_bf16 v[16:19], a[244:247], v[132:135], v[16:19]
ds_read_b128 a[228:231], v243 offset:21120
v_cvt_pk_bf16_f32 v190, v208, v209
v_mfma_f32_16x16x32_bf16 v[48:51], a[240:243], v[136:139], v[48:51]
v_exp_f32 v211, v211
v_mfma_f32_16x16x32_bf16 v[48:51], a[244:247], v[140:143], v[48:51]
ds_read_b128 a[232:235], v242 offset:21632
v_cvt_pk_bf16_f32 v191, v210, v211
v_mfma_f32_16x16x32_bf16 v[216:219], a[208:211], a[0:3], 0
s_add_u32 m0, s58, 64
v_exp_f32 v212, v212
v_mfma_f32_16x16x32_bf16 v[216:219], a[212:215], a[4:7], v[216:219]
ds_read_b128 a[236:239], v243 offset:21632
buffer_load_dwordx4 v248, s[36:39], s56 offen offset:2048 nt lds
v_mfma_f32_16x16x32_bf16 v[216:219], a[216:219], a[8:11], v[216:219]
v_exp_f32 v213, v213
v_mfma_f32_16x16x32_bf16 v[216:219], a[220:223], a[12:15], v[216:219]
v_cvt_pk_bf16_f32 v198, v212, v213
v_add_f32 v229, v229, v212
v_mfma_f32_16x16x32_bf16 v[80:83], a[240:243], v[144:147], v[80:83]
v_exp_f32 v214, v214
v_mfma_f32_16x16x32_bf16 v[80:83], a[244:247], v[148:151], v[80:83]
v_add_f32 v229, v229, v213
v_add_f32 v229, v229, v214
v_mfma_f32_16x16x32_bf16 v[112:115], a[240:243], v[152:155], v[112:115]
v_exp_f32 v215, v215
v_mfma_f32_16x16x32_bf16 v[112:115], a[244:247], v[156:159], v[112:115]
v_cvt_pk_bf16_f32 v199, v214, v215
v_add_f32 v229, v229, v215
v_mfma_f32_16x16x32_bf16 v[220:223], a[208:211], a[16:19], 0
v_exp_f32 v216, v216
v_mfma_f32_16x16x32_bf16 v[220:223], a[212:215], a[20:23], v[220:223]
v_add_u32 v242, s60, v242
v_add_u32 v243, s60, v243
v_mfma_f32_16x16x32_bf16 v[220:223], a[216:219], a[24:27], v[220:223]
s_mul_i32 s60, s60, -1
v_exp_f32 v217, v217
v_mfma_f32_16x16x32_bf16 v[220:223], a[220:223], a[28:31], v[220:223]
v_cvt_pk_bf16_f32 v168, v216, v217
v_mfma_f32_16x16x32_bf16 a[176:179], a[240:243], v[160:163], a[176:179]
s_waitcnt lgkmcnt(4)
v_exp_f32 v218, v218
v_mfma_f32_16x16x32_bf16 v[20:23], a[248:251], v[128:131], v[20:23]
ds_read_b64_tr_b16 a[240:241], v245 offset:512
ds_read_b64_tr_b16 a[242:243], v245 offset:4736
v_mfma_f32_16x16x32_bf16 v[20:23], a[252:255], v[132:135], v[20:23]
v_exp_f32_e64 v219, v219
v_mfma_f32_16x16x32_bf16 v[52:55], a[248:251], v[136:139], v[52:55]
ds_read_b64_tr_b16 a[244:245], v247 offset:512
ds_read_b64_tr_b16 a[246:247], v247 offset:4736
v_mfma_f32_16x16x32_bf16 v[52:55], a[252:255], v[140:143], v[52:55]
v_cvt_pk_bf16_f32 v169, v218, v219
v_mfma_f32_16x16x32_bf16 v[200:203], a[208:211], a[32:35], 0
v_exp_f32 v220, v220
v_mfma_f32_16x16x32_bf16 v[200:203], a[212:215], a[36:39], v[200:203]
s_add_u32 m0, s58, 96
v_mfma_f32_16x16x32_bf16 v[200:203], a[216:219], a[40:43], v[200:203]
v_exp_f32 v221, v221
v_mfma_f32_16x16x32_bf16 v[200:203], a[220:223], a[44:47], v[200:203]
buffer_load_dwordx4 v248, s[36:39], s56 offen offset:3072 nt lds
v_cvt_pk_bf16_f32 v176, v220, v221
v_mfma_f32_16x16x32_bf16 v[84:87], a[248:251], v[144:147], v[84:87]
s_add_u32 s56, s56, 16384
v_exp_f32 v222, v222
v_mfma_f32_16x16x32_bf16 v[84:87], a[252:255], v[148:151], v[84:87]
s_add_u32 s58, s58, 16896
v_mfma_f32_16x16x32_bf16 v[116:119], a[248:251], v[152:155], v[116:119]
s_cmp_eq_u32 s58, s69
v_exp_f32 v223, v223
v_mfma_f32_16x16x32_bf16 v[116:119], a[252:255], v[156:159], v[116:119]
s_cselect_b32 s58, s67, s58
v_cvt_pk_bf16_f32 v177, v222, v223
v_mfma_f32_16x16x32_bf16 v[204:207], a[208:211], a[48:51], 0
v_exp_f32 v200, v200
v_mfma_f32_16x16x32_bf16 v[204:207], a[212:215], a[52:55], v[204:207]
v_mfma_f32_16x16x32_bf16 v[204:207], a[216:219], a[56:59], v[204:207]
v_exp_f32 v201, v201
v_mfma_f32_16x16x32_bf16 v[204:207], a[220:223], a[60:63], v[204:207]
v_cvt_pk_bf16_f32 v184, v200, v201
v_mfma_f32_16x16x32_bf16 a[180:183], a[248:251], v[160:163], a[180:183]
v_exp_f32 v202, v202
v_smfmac_f32_16x16x64_bf16 a[200:203], v[224:227], v[144:151], v228
s_waitcnt lgkmcnt(0)
ds_read_b64_tr_b16 a[248:249], v245 offset:544
ds_read_b64_tr_b16 a[250:251], v245 offset:4768
v_mfma_f32_16x16x32_bf16 v[24:27], a[240:243], v[128:131], v[24:27]
v_exp_f32 v203, v203
v_mfma_f32_16x16x32_bf16 v[24:27], a[244:247], v[132:135], v[24:27]
ds_read_b64_tr_b16 a[252:253], v247 offset:544
ds_read_b64_tr_b16 a[254:255], v247 offset:4768
v_mfma_f32_16x16x32_bf16 v[208:211], a[224:227], a[0:3], 0
v_exp_f32 v204, v204
v_mfma_f32_16x16x32_bf16 v[208:211], a[228:231], a[4:7], v[208:211]
v_cvt_pk_bf16_f32 v185, v202, v203
v_mfma_f32_16x16x32_bf16 v[208:211], a[232:235], a[8:11], v[208:211]
s_waitcnt vmcnt(12)
v_exp_f32 v205, v205
v_mfma_f32_16x16x32_bf16 v[208:211], a[236:239], a[12:15], v[208:211]
s_barrier
v_mfma_f32_16x16x32_bf16 v[56:59], a[240:243], v[136:139], v[56:59]
s_mov_b32 m0, s59
v_exp_f32 v206, v206
v_mfma_f32_16x16x32_bf16 v[56:59], a[244:247], v[140:143], v[56:59]
ds_read_b128 a[208:211], v240 offset:0
buffer_load_dwordx4 v248, s[40:43], s57 offen offset:0 nt lds
v_cvt_pk_bf16_f32 v192, v204, v205
v_mfma_f32_16x16x32_bf16 v[88:91], a[240:243], v[144:147], v[88:91]
v_exp_f32 v207, v207
v_mfma_f32_16x16x32_bf16 v[88:91], a[244:247], v[148:151], v[88:91]
ds_read_b128 a[212:215], v241 offset:0
v_cvt_pk_bf16_f32 v193, v206, v207
v_mfma_f32_16x16x32_bf16 v[212:215], a[224:227], a[16:19], 0
v_exp_f32 v208, v208
v_mfma_f32_16x16x32_bf16 v[212:215], a[228:231], a[20:23], v[212:215]
ds_read_b128 a[216:219], v240 offset:512
v_mfma_f32_16x16x32_bf16 v[212:215], a[232:235], a[24:27], v[212:215]
v_exp_f32 v209, v209
v_mfma_f32_16x16x32_bf16 v[212:215], a[236:239], a[28:31], v[212:215]
ds_read_b128 a[220:223], v241 offset:512
v_cvt_pk_bf16_f32 v170, v208, v209
v_mfma_f32_16x16x32_bf16 v[120:123], a[240:243], v[152:155], v[120:123]
v_exp_f32 v210, v210
v_mfma_f32_16x16x32_bf16 v[120:123], a[244:247], v[156:159], v[120:123]
v_mfma_f32_16x16x32_bf16 a[184:187], a[240:243], v[160:163], a[184:187]
v_exp_f32 v211, v211
v_smfmac_f32_16x16x64_bf16 a[204:207], v[224:227], v[152:159], v228
ds_read_b64_tr_b16 a[240:241], v244 offset:16896
ds_read_b64_tr_b16 a[242:243], v244 offset:21120
v_mfma_f32_16x16x32_bf16 v[216:219], a[224:227], a[32:35], 0
v_exp_f32 v212, v212
v_mfma_f32_16x16x32_bf16 v[216:219], a[228:231], a[36:39], v[216:219]
ds_read_b64_tr_b16 a[244:245], v246 offset:16896
ds_read_b64_tr_b16 a[246:247], v246 offset:21120
v_mfma_f32_16x16x32_bf16 v[216:219], a[232:235], a[40:43], v[216:219]
v_exp_f32 v213, v213
v_mfma_f32_16x16x32_bf16 v[216:219], a[236:239], a[44:47], v[216:219]
s_waitcnt lgkmcnt(8)
v_cvt_pk_bf16_f32 v171, v210, v211
v_cvt_pk_bf16_f32 v178, v212, v213
v_mfma_f32_16x16x32_bf16 v[28:31], a[248:251], v[128:131], v[28:31]
v_exp_f32 v214, v214
v_mfma_f32_16x16x32_bf16 v[28:31], a[252:255], v[132:135], v[28:31]
v_mfma_f32_16x16x32_bf16 v[60:63], a[248:251], v[136:139], v[60:63]
s_add_u32 m0, s59, 32
v_exp_f32 v215, v215
v_mfma_f32_16x16x32_bf16 v[60:63], a[252:255], v[140:143], v[60:63]
buffer_load_dwordx4 v248, s[40:43], s57 offen offset:1024 nt lds
v_cvt_pk_bf16_f32 v179, v214, v215
v_mfma_f32_16x16x32_bf16 v[220:223], a[224:227], a[48:51], 0
v_exp_f32 v216, v216
v_mfma_f32_16x16x32_bf16 v[220:223], a[228:231], a[52:55], v[220:223]
v_mfma_f32_16x16x32_bf16 v[220:223], a[232:235], a[56:59], v[220:223]
v_exp_f32 v217, v217
v_mfma_f32_16x16x32_bf16 v[220:223], a[236:239], a[60:63], v[220:223]
v_cvt_pk_bf16_f32 v186, v216, v217
v_mfma_f32_16x16x32_bf16 v[92:95], a[248:251], v[144:147], v[92:95]
s_sub_u32 s62, s62, 1
v_exp_f32 v218, v218
v_mfma_f32_16x16x32_bf16 v[92:95], a[252:255], v[148:151], v[92:95]
s_cmp_lg_u32 s62, 0
v_mfma_f32_16x16x32_bf16 v[124:127], a[248:251], v[152:155], v[124:127]
v_exp_f32 v219, v219
v_mfma_f32_16x16x32_bf16 v[124:127], a[252:255], v[156:159], v[124:127]
s_waitcnt lgkmcnt(4)
v_cvt_pk_bf16_f32 v187, v218, v219
v_mfma_f32_16x16x32_bf16 a[188:191], a[248:251], v[160:163], a[188:191]
s_cbranch_scc1 L_h_loop
s_cmp_eq_u32 s63, 1
s_cbranch_scc1 L_h_last
L_h_tail:
s_waitcnt lgkmcnt(2)
v_mfma_f32_16x16x32_bf16 v[0:3], a[240:243], v[164:167], v[0:3]
s_waitcnt lgkmcnt(0)
v_exp_f32 v220, v220
v_mfma_f32_16x16x32_bf16 v[0:3], a[244:247], v[168:171], v[0:3]
v_exp_f32 v221, v221
v_mfma_f32_16x16x32_bf16 v[32:35], a[240:243], v[172:175], v[32:35]
v_exp_f32 v222, v222
v_mfma_f32_16x16x32_bf16 v[32:35], a[244:247], v[176:179], v[32:35]
v_exp_f32 v223, v223
v_mfma_f32_16x16x32_bf16 v[64:67], a[240:243], v[180:183], v[64:67]
ds_read_b64_tr_b16 a[248:249], v244 offset:16928
v_cvt_pk_bf16_f32 v194, v220, v221
v_mfma_f32_16x16x32_bf16 v[64:67], a[244:247], v[184:187], v[64:67]
ds_read_b64_tr_b16 a[250:251], v244 offset:21152
v_cvt_pk_bf16_f32 v195, v222, v223
v_mfma_f32_16x16x32_bf16 a[160:163], a[240:243], v[196:199], a[160:163]
ds_read_b64_tr_b16 a[252:253], v246 offset:16928
v_accvgpr_mov_b32 a0, a80
v_mfma_f32_16x16x32_bf16 v[96:99], a[240:243], v[188:191], v[96:99]
ds_read_b64_tr_b16 a[254:255], v246 offset:21152
v_accvgpr_mov_b32 a1, a81
v_mfma_f32_16x16x32_bf16 v[96:99], a[244:247], v[192:195], v[96:99]
ds_read_b64_tr_b16 a[240:241], v245 offset:16896
v_accvgpr_mov_b32 a2, a82
v_smfmac_f32_16x16x64_bf16 a[192:195], v[224:227], v[164:171], v228
ds_read_b64_tr_b16 a[242:243], v245 offset:21120
v_accvgpr_mov_b32 a3, a83
v_smfmac_f32_16x16x64_bf16 a[196:199], v[224:227], v[172:179], v228
ds_read_b64_tr_b16 a[244:245], v247 offset:16896
v_accvgpr_mov_b32 a4, a84
v_smfmac_f32_16x16x64_bf16 a[200:203], v[224:227], v[180:187], v228
ds_read_b64_tr_b16 a[246:247], v247 offset:21120
v_accvgpr_mov_b32 a5, a85
v_smfmac_f32_16x16x64_bf16 a[204:207], v[224:227], v[188:195], v228
s_waitcnt lgkmcnt(4)
v_accvgpr_mov_b32 a6, a86
v_accvgpr_mov_b32 a7, a87
v_mfma_f32_16x16x32_bf16 v[4:7], a[248:251], v[164:167], v[4:7]
v_accvgpr_mov_b32 a8, a88
v_accvgpr_mov_b32 a9, a89
v_mfma_f32_16x16x32_bf16 v[4:7], a[252:255], v[168:171], v[4:7]
v_accvgpr_mov_b32 a10, a90
v_accvgpr_mov_b32 a11, a91
v_mfma_f32_16x16x32_bf16 v[36:39], a[248:251], v[172:175], v[36:39]
v_accvgpr_mov_b32 a12, a92
v_accvgpr_mov_b32 a13, a93
v_mfma_f32_16x16x32_bf16 v[36:39], a[252:255], v[176:179], v[36:39]
v_accvgpr_mov_b32 a14, a94
v_accvgpr_mov_b32 a15, a95
v_mfma_f32_16x16x32_bf16 v[68:71], a[248:251], v[180:183], v[68:71]
v_accvgpr_mov_b32 a16, a96
v_accvgpr_mov_b32 a17, a97
v_mfma_f32_16x16x32_bf16 v[68:71], a[252:255], v[184:187], v[68:71]
v_accvgpr_mov_b32 a18, a98
v_accvgpr_mov_b32 a19, a99
v_mfma_f32_16x16x32_bf16 v[100:103], a[248:251], v[188:191], v[100:103]
v_accvgpr_mov_b32 a20, a100
v_accvgpr_mov_b32 a21, a101
v_mfma_f32_16x16x32_bf16 v[100:103], a[252:255], v[192:195], v[100:103]
v_accvgpr_mov_b32 a22, a102
v_accvgpr_mov_b32 a23, a103
v_mfma_f32_16x16x32_bf16 a[164:167], a[248:251], v[196:199], a[164:167]
s_waitcnt lgkmcnt(0)
ds_read_b64_tr_b16 a[248:249], v245 offset:16928
v_accvgpr_read_b32 v200, a192
v_mfma_f32_16x16x32_bf16 v[8:11], a[240:243], v[164:167], v[8:11]
ds_read_b64_tr_b16 a[250:251], v245 offset:21152
v_accvgpr_read_b32 v201, a193
v_mfma_f32_16x16x32_bf16 v[8:11], a[244:247], v[168:171], v[8:11]
ds_read_b64_tr_b16 a[252:253], v247 offset:16928
v_accvgpr_read_b32 v202, a196
v_mfma_f32_16x16x32_bf16 v[40:43], a[240:243], v[172:175], v[40:43]
ds_read_b64_tr_b16 a[254:255], v247 offset:21152
v_accvgpr_read_b32 v203, a197
v_mfma_f32_16x16x32_bf16 v[40:43], a[244:247], v[176:179], v[40:43]
v_accvgpr_read_b32 v204, a200
v_accvgpr_read_b32 v205, a201
v_mfma_f32_16x16x32_bf16 v[72:75], a[240:243], v[180:183], v[72:75]
v_accvgpr_read_b32 v206, a204
v_accvgpr_read_b32 v207, a205
v_mfma_f32_16x16x32_bf16 v[72:75], a[244:247], v[184:187], v[72:75]
v_add_f32 v200, v200, v201
v_add_f32 v202, v202, v203
v_mfma_f32_16x16x32_bf16 v[104:107], a[240:243], v[188:191], v[104:107]
v_add_f32 v204, v204, v205
v_add_f32 v206, v206, v207
v_mfma_f32_16x16x32_bf16 v[104:107], a[244:247], v[192:195], v[104:107]
v_rcp_f32 v230, v200
v_mfma_f32_16x16x32_bf16 a[168:171], a[240:243], v[196:199], a[168:171]
s_waitcnt lgkmcnt(0)
ds_read_b64_tr_b16 a[240:241], v244 offset:17408
v_mfma_f32_16x16x32_bf16 v[12:15], a[248:251], v[164:167], v[12:15]
ds_read_b64_tr_b16 a[242:243], v244 offset:21632
v_mfma_f32_16x16x32_bf16 v[12:15], a[252:255], v[168:171], v[12:15]
ds_read_b64_tr_b16 a[244:245], v246 offset:17408
v_mfma_f32_16x16x32_bf16 v[44:47], a[248:251], v[172:175], v[44:47]
ds_read_b64_tr_b16 a[246:247], v246 offset:21632
v_mfma_f32_16x16x32_bf16 v[44:47], a[252:255], v[176:179], v[44:47]
v_rcp_f32 v231, v202
v_mfma_f32_16x16x32_bf16 v[76:79], a[248:251], v[180:183], v[76:79]
v_rcp_f32 v232, v204
v_mfma_f32_16x16x32_bf16 v[76:79], a[252:255], v[184:187], v[76:79]
v_rcp_f32 v233, v206
v_mfma_f32_16x16x32_bf16 v[108:111], a[248:251], v[188:191], v[108:111]
v_min3_u32 v201, v200, v202, v204
v_max3_u32 v203, v200, v202, v204
v_mfma_f32_16x16x32_bf16 v[108:111], a[252:255], v[192:195], v[108:111]
v_min_u32 v201, v201, v206
v_max_u32 v203, v203, v206
v_mfma_f32_16x16x32_bf16 a[172:175], a[248:251], v[196:199], a[172:175]
s_waitcnt lgkmcnt(0)
ds_read_b64_tr_b16 a[248:249], v244 offset:17440
v_cmp_gt_u32 s[72:73], s74, v201
v_mfma_f32_16x16x32_bf16 v[16:19], a[240:243], v[164:167], v[16:19]
ds_read_b64_tr_b16 a[250:251], v244 offset:21664
v_cmp_lt_u32 vcc, s75, v203
v_mfma_f32_16x16x32_bf16 v[16:19], a[244:247], v[168:171], v[16:19]
s_lshl_b32 s50, s48, 2
s_add_u32 s50, s50, 152576
ds_read_b64_tr_b16 a[252:253], v246 offset:17440
v_mfma_f32_16x16x32_bf16 v[48:51], a[240:243], v[172:175], v[48:51]
s_or_b64 s[72:73], s[72:73], vcc
s_or_b32 s72, s72, s73
ds_read_b64_tr_b16 a[254:255], v246 offset:21664
v_mfma_f32_16x16x32_bf16 v[48:51], a[244:247], v[176:179], v[48:51]
v_mov_b32 v201, s50
v_mov_b32 v200, s72
v_mfma_f32_16x16x32_bf16 v[80:83], a[240:243], v[180:183], v[80:83]
v_add_u32 v244, s61, v244
v_add_u32 v246, s61, v246
v_mfma_f32_16x16x32_bf16 v[80:83], a[244:247], v[184:187], v[80:83]
v_accvgpr_write_b32 a192, 0
v_accvgpr_write_b32 a193, 0
v_mfma_f32_16x16x32_bf16 v[112:115], a[240:243], v[188:191], v[112:115]
v_accvgpr_write_b32 a196, 0
v_accvgpr_write_b32 a197, 0
v_mfma_f32_16x16x32_bf16 v[112:115], a[244:247], v[192:195], v[112:115]
v_accvgpr_write_b32 a200, 0
v_accvgpr_write_b32 a201, 0
v_mfma_f32_16x16x32_bf16 a[176:179], a[240:243], v[196:199], a[176:179]
s_waitcnt lgkmcnt(0)
ds_read_b64_tr_b16 a[240:241], v245 offset:17408
v_accvgpr_write_b32 a204, 0
v_mfma_f32_16x16x32_bf16 v[20:23], a[248:251], v[164:167], v[20:23]
ds_read_b64_tr_b16 a[242:243], v245 offset:21632
v_accvgpr_write_b32 a205, 0
v_mfma_f32_16x16x32_bf16 v[20:23], a[252:255], v[168:171], v[20:23]
ds_read_b64_tr_b16 a[244:245], v247 offset:17408
v_accvgpr_mov_b32 a24, a104
v_mfma_f32_16x16x32_bf16 v[52:55], a[248:251], v[172:175], v[52:55]
ds_read_b64_tr_b16 a[246:247], v247 offset:21632
v_accvgpr_mov_b32 a25, a105
v_mfma_f32_16x16x32_bf16 v[52:55], a[252:255], v[176:179], v[52:55]
v_accvgpr_mov_b32 a26, a106
v_accvgpr_mov_b32 a27, a107
v_mfma_f32_16x16x32_bf16 v[84:87], a[248:251], v[180:183], v[84:87]
v_accvgpr_mov_b32 a28, a108
v_accvgpr_mov_b32 a29, a109
v_mfma_f32_16x16x32_bf16 v[84:87], a[252:255], v[184:187], v[84:87]
v_accvgpr_mov_b32 a30, a110
v_accvgpr_mov_b32 a31, a111
v_mfma_f32_16x16x32_bf16 v[116:119], a[248:251], v[188:191], v[116:119]
v_accvgpr_mov_b32 a32, a112
v_accvgpr_mov_b32 a33, a113
v_mfma_f32_16x16x32_bf16 v[116:119], a[252:255], v[192:195], v[116:119]
v_accvgpr_mov_b32 a34, a114
v_accvgpr_mov_b32 a35, a115
v_mfma_f32_16x16x32_bf16 a[180:183], a[248:251], v[196:199], a[180:183]
s_waitcnt lgkmcnt(0)
ds_read_b64_tr_b16 a[248:249], v245 offset:17440
v_accvgpr_mov_b32 a36, a116
v_mfma_f32_16x16x32_bf16 v[24:27], a[240:243], v[164:167], v[24:27]
ds_read_b64_tr_b16 a[250:251], v245 offset:21664
v_accvgpr_mov_b32 a37, a117
v_mfma_f32_16x16x32_bf16 v[24:27], a[244:247], v[168:171], v[24:27]
ds_read_b64_tr_b16 a[252:253], v247 offset:17440
v_accvgpr_mov_b32 a38, a118
v_mfma_f32_16x16x32_bf16 v[56:59], a[240:243], v[172:175], v[56:59]
ds_read_b64_tr_b16 a[254:255], v247 offset:21664
v_accvgpr_mov_b32 a39, a119
v_mfma_f32_16x16x32_bf16 v[56:59], a[244:247], v[176:179], v[56:59]
v_accvgpr_mov_b32 a40, a120
v_accvgpr_mov_b32 a41, a121
v_mfma_f32_16x16x32_bf16 v[88:91], a[240:243], v[180:183], v[88:91]
v_add_u32 v245, s61, v245
v_add_u32 v247, s61, v247
v_mfma_f32_16x16x32_bf16 v[88:91], a[244:247], v[184:187], v[88:91]
s_mul_i32 s61, s61, -1
v_accvgpr_mov_b32 a42, a122
v_accvgpr_mov_b32 a43, a123
v_mfma_f32_16x16x32_bf16 v[120:123], a[240:243], v[188:191], v[120:123]
v_accvgpr_mov_b32 a44, a124
v_accvgpr_mov_b32 a45, a125
v_mfma_f32_16x16x32_bf16 v[120:123], a[244:247], v[192:195], v[120:123]
v_accvgpr_mov_b32 a46, a126
v_accvgpr_mov_b32 a47, a127
v_mfma_f32_16x16x32_bf16 a[184:187], a[240:243], v[196:199], a[184:187]
s_waitcnt lgkmcnt(0)
v_accvgpr_mov_b32 a48, a128
v_accvgpr_mov_b32 a49, a129
v_mfma_f32_16x16x32_bf16 v[28:31], a[248:251], v[164:167], v[28:31]
v_accvgpr_mov_b32 a50, a130
v_accvgpr_mov_b32 a51, a131
v_mfma_f32_16x16x32_bf16 v[28:31], a[252:255], v[168:171], v[28:31]
v_accvgpr_mov_b32 a52, a132
v_accvgpr_mov_b32 a53, a133
v_mfma_f32_16x16x32_bf16 v[60:63], a[248:251], v[172:175], v[60:63]
v_accvgpr_mov_b32 a54, a134
v_accvgpr_mov_b32 a55, a135
v_mfma_f32_16x16x32_bf16 v[60:63], a[252:255], v[176:179], v[60:63]
v_accvgpr_mov_b32 a56, a136
v_accvgpr_mov_b32 a57, a137
v_mfma_f32_16x16x32_bf16 v[92:95], a[248:251], v[180:183], v[92:95]
v_accvgpr_mov_b32 a58, a138
v_accvgpr_mov_b32 a59, a139
v_mfma_f32_16x16x32_bf16 v[92:95], a[252:255], v[184:187], v[92:95]
v_accvgpr_mov_b32 a60, a140
v_accvgpr_mov_b32 a61, a141
v_mfma_f32_16x16x32_bf16 v[124:127], a[248:251], v[188:191], v[124:127]
v_accvgpr_mov_b32 a62, a142
v_accvgpr_mov_b32 a63, a143
v_mfma_f32_16x16x32_bf16 v[124:127], a[252:255], v[192:195], v[124:127]
v_accvgpr_mov_b32 a64, a144
v_accvgpr_mov_b32 a65, a145
v_mfma_f32_16x16x32_bf16 a[188:191], a[248:251], v[196:199], a[188:191]
v_accvgpr_mov_b32 a66, a146
v_accvgpr_mov_b32 a67, a147
ds_write_b128 v250, a[168:171] offset:0
ds_write_b128 v250, a[172:175] offset:1024
ds_write_b32 v252, v229
ds_write_b32 v201, v200
v_mov_b32 v229, 0
v_accvgpr_mov_b32 a68, a148
v_accvgpr_mov_b32 a69, a149
v_accvgpr_mov_b32 a70, a150
v_accvgpr_mov_b32 a71, a151
v_accvgpr_mov_b32 a72, a152
v_accvgpr_mov_b32 a73, a153
ds_write_b128 v250, a[184:187] offset:2048
ds_write_b128 v250, a[188:191] offset:3072
v_accvgpr_mov_b32 a74, a154
v_accvgpr_mov_b32 a75, a155
v_accvgpr_mov_b32 a76, a156
v_accvgpr_mov_b32 a77, a157
v_accvgpr_mov_b32 a78, a158
v_accvgpr_mov_b32 a79, a159
v_pk_mul_f32 v[0:1], v[0:1], v[230:231] op_sel:[0,0] op_sel_hi:[1,0]
v_pk_mul_f32 v[2:3], v[2:3], v[230:231] op_sel:[0,0] op_sel_hi:[1,0]
v_pk_mul_f32 v[4:5], v[4:5], v[230:231] op_sel:[0,0] op_sel_hi:[1,0]
v_pk_mul_f32 v[6:7], v[6:7], v[230:231] op_sel:[0,0] op_sel_hi:[1,0]
s_add_u32 s50, s64, 0
v_cvt_pk_bf16_f32 v0, v0, v1
v_cvt_pk_bf16_f32 v1, v2, v3
v_cvt_pk_bf16_f32 v2, v4, v5
v_cvt_pk_bf16_f32 v3, v6, v7
buffer_store_dwordx4 v[0:3], v249, s[44:47], s50 offen offset:0 sc1
v_pk_mul_f32 v[32:33], v[32:33], v[230:231] op_sel:[0,1] op_sel_hi:[1,1]
v_pk_mul_f32 v[34:35], v[34:35], v[230:231] op_sel:[0,1] op_sel_hi:[1,1]
v_pk_mul_f32 v[36:37], v[36:37], v[230:231] op_sel:[0,1] op_sel_hi:[1,1]
v_pk_mul_f32 v[38:39], v[38:39], v[230:231] op_sel:[0,1] op_sel_hi:[1,1]
s_add_u32 s50, s64, 2048
v_cvt_pk_bf16_f32 v32, v32, v33
v_cvt_pk_bf16_f32 v33, v34, v35
v_cvt_pk_bf16_f32 v34, v36, v37
v_mov_b32 v208, 152576
s_waitcnt lgkmcnt(0)
s_barrier
ds_read_b128 v[180:183], v253 offset:0
ds_read_b128 v[184:187], v253 offset:16
ds_read_b128 v[188:191], v253 offset:512
ds_read_b128 v[192:195], v253 offset:528
ds_read_b128 v[196:199], v208
ds_read_b128 v[164:167], v251 offset:0
ds_read_b128 v[168:171], v251 offset:1024
ds_read_b128 v[172:175], v251 offset:2048
ds_read_b128 v[176:179], v251 offset:3072
v_cvt_pk_bf16_f32 v35, v38, v39
buffer_store_dwordx4 v[32:35], v249, s[44:47], s50 offen offset:0 sc1
v_pk_mul_f32 v[64:65], v[64:65], v[232:233] op_sel:[0,0] op_sel_hi:[1,0]
v_pk_mul_f32 v[66:67], v[66:67], v[232:233] op_sel:[0,0] op_sel_hi:[1,0]
v_pk_mul_f32 v[68:69], v[68:69], v[232:233] op_sel:[0,0] op_sel_hi:[1,0]
v_pk_mul_f32 v[70:71], v[70:71], v[232:233] op_sel:[0,0] op_sel_hi:[1,0]
s_add_u32 s50, s64, 4096
v_cvt_pk_bf16_f32 v64, v64, v65
v_cvt_pk_bf16_f32 v65, v66, v67
v_cvt_pk_bf16_f32 v66, v68, v69
v_cvt_pk_bf16_f32 v67, v70, v71
buffer_store_dwordx4 v[64:67], v249, s[44:47], s50 offen offset:0 sc1
v_pk_mul_f32 v[96:97], v[96:97], v[232:233] op_sel:[0,1] op_sel_hi:[1,1]
v_pk_mul_f32 v[98:99], v[98:99], v[232:233] op_sel:[0,1] op_sel_hi:[1,1]
v_pk_mul_f32 v[100:101], v[100:101], v[232:233] op_sel:[0,1] op_sel_hi:[1,1]
v_pk_mul_f32 v[102:103], v[102:103], v[232:233] op_sel:[0,1] op_sel_hi:[1,1]
s_add_u32 s50, s64, 6144
v_cvt_pk_bf16_f32 v96, v96, v97
v_cvt_pk_bf16_f32 v97, v98, v99
v_cvt_pk_bf16_f32 v98, v100, v101
v_cvt_pk_bf16_f32 v99, v102, v103
buffer_store_dwordx4 v[96:99], v249, s[44:47], s50 offen offset:0 sc1
v_pk_mul_f32 v[8:9], v[8:9], v[230:231] op_sel:[0,0] op_sel_hi:[1,0]
v_pk_mul_f32 v[10:11], v[10:11], v[230:231] op_sel:[0,0] op_sel_hi:[1,0]
v_pk_mul_f32 v[12:13], v[12:13], v[230:231] op_sel:[0,0] op_sel_hi:[1,0]
v_pk_mul_f32 v[14:15], v[14:15], v[230:231] op_sel:[0,0] op_sel_hi:[1,0]
s_add_u32 s50, s65, 0
s_nop 0
v_cvt_pk_bf16_f32 v8, v8, v9
v_cvt_pk_bf16_f32 v9, v10, v11
v_cvt_pk_bf16_f32 v10, v12, v13
v_cvt_pk_bf16_f32 v11, v14, v15
buffer_store_dwordx4 v[8:11], v249, s[44:47], s50 offen offset:0 sc1
v_pk_mul_f32 v[40:41], v[40:41], v[230:231] op_sel:[0,1] op_sel_hi:[1,1]
v_pk_mul_f32 v[42:43], v[42:43], v[230:231] op_sel:[0,1] op_sel_hi:[1,1]
v_pk_mul_f32 v[44:45], v[44:45], v[230:231] op_sel:[0,1] op_sel_hi:[1,1]
v_pk_mul_f32 v[46:47], v[46:47], v[230:231] op_sel:[0,1] op_sel_hi:[1,1]
s_add_u32 s50, s65, 2048
v_cvt_pk_bf16_f32 v40, v40, v41
v_cvt_pk_bf16_f32 v41, v42, v43
v_cvt_pk_bf16_f32 v42, v44, v45
v_cvt_pk_bf16_f32 v43, v46, v47
buffer_store_dwordx4 v[40:43], v249, s[44:47], s50 offen offset:0 sc1
v_pk_mul_f32 v[72:73], v[72:73], v[232:233] op_sel:[0,0] op_sel_hi:[1,0]
v_pk_mul_f32 v[74:75], v[74:75], v[232:233] op_sel:[0,0] op_sel_hi:[1,0]
v_pk_mul_f32 v[76:77], v[76:77], v[232:233] op_sel:[0,0] op_sel_hi:[1,0]
v_pk_mul_f32 v[78:79], v[78:79], v[232:233] op_sel:[0,0] op_sel_hi:[1,0]
v_cvt_pk_bf16_f32 v72, v72, v73
v_cvt_pk_bf16_f32 v73, v74, v75
v_cvt_pk_bf16_f32 v74, v76, v77
v_cvt_pk_bf16_f32 v75, v78, v79
v_accvgpr_write_b32 a104, v72
v_accvgpr_write_b32 a105, v73
v_accvgpr_write_b32 a106, v74
v_accvgpr_write_b32 a107, v75
v_pk_mul_f32 v[104:105], v[104:105], v[232:233] op_sel:[0,1] op_sel_hi:[1,1]
v_pk_mul_f32 v[106:107], v[106:107], v[232:233] op_sel:[0,1] op_sel_hi:[1,1]
v_pk_mul_f32 v[108:109], v[108:109], v[232:233] op_sel:[0,1] op_sel_hi:[1,1]
v_pk_mul_f32 v[110:111], v[110:111], v[232:233] op_sel:[0,1] op_sel_hi:[1,1]
v_cvt_pk_bf16_f32 v104, v104, v105
v_cvt_pk_bf16_f32 v105, v106, v107
v_cvt_pk_bf16_f32 v106, v108, v109
v_cvt_pk_bf16_f32 v107, v110, v111
v_accvgpr_write_b32 a108, v104
v_accvgpr_write_b32 a109, v105
v_accvgpr_write_b32 a110, v106
v_accvgpr_write_b32 a111, v107
v_pk_mul_f32 v[16:17], v[16:17], v[230:231] op_sel:[0,0] op_sel_hi:[1,0]
v_pk_mul_f32 v[18:19], v[18:19], v[230:231] op_sel:[0,0] op_sel_hi:[1,0]
v_pk_mul_f32 v[20:21], v[20:21], v[230:231] op_sel:[0,0] op_sel_hi:[1,0]
v_pk_mul_f32 v[22:23], v[22:23], v[230:231] op_sel:[0,0] op_sel_hi:[1,0]
v_cvt_pk_bf16_f32 v16, v16, v17
v_cvt_pk_bf16_f32 v17, v18, v19
v_cvt_pk_bf16_f32 v18, v20, v21
v_cvt_pk_bf16_f32 v19, v22, v23
v_accvgpr_write_b32 a112, v16
v_accvgpr_write_b32 a113, v17
v_accvgpr_write_b32 a114, v18
v_accvgpr_write_b32 a115, v19
v_pk_mul_f32 v[48:49], v[48:49], v[230:231] op_sel:[0,1] op_sel_hi:[1,1]
v_pk_mul_f32 v[50:51], v[50:51], v[230:231] op_sel:[0,1] op_sel_hi:[1,1]
v_pk_mul_f32 v[52:53], v[52:53], v[230:231] op_sel:[0,1] op_sel_hi:[1,1]
v_pk_mul_f32 v[54:55], v[54:55], v[230:231] op_sel:[0,1] op_sel_hi:[1,1]
v_cvt_pk_bf16_f32 v48, v48, v49
v_cvt_pk_bf16_f32 v49, v50, v51
v_cvt_pk_bf16_f32 v50, v52, v53
v_cvt_pk_bf16_f32 v51, v54, v55
v_accvgpr_write_b32 a116, v48
v_accvgpr_write_b32 a117, v49
v_accvgpr_write_b32 a118, v50
v_accvgpr_write_b32 a119, v51
v_pk_mul_f32 v[80:81], v[80:81], v[232:233] op_sel:[0,0] op_sel_hi:[1,0]
v_pk_mul_f32 v[82:83], v[82:83], v[232:233] op_sel:[0,0] op_sel_hi:[1,0]
v_pk_mul_f32 v[84:85], v[84:85], v[232:233] op_sel:[0,0] op_sel_hi:[1,0]
v_pk_mul_f32 v[86:87], v[86:87], v[232:233] op_sel:[0,0] op_sel_hi:[1,0]
v_cvt_pk_bf16_f32 v80, v80, v81
v_cvt_pk_bf16_f32 v81, v82, v83
v_cvt_pk_bf16_f32 v82, v84, v85
v_cvt_pk_bf16_f32 v83, v86, v87
v_accvgpr_write_b32 a120, v80
v_accvgpr_write_b32 a121, v81
v_accvgpr_write_b32 a122, v82
v_accvgpr_write_b32 a123, v83
v_pk_mul_f32 v[112:113], v[112:113], v[232:233] op_sel:[0,1] op_sel_hi:[1,1]
v_pk_mul_f32 v[114:115], v[114:115], v[232:233] op_sel:[0,1] op_sel_hi:[1,1]
v_pk_mul_f32 v[116:117], v[116:117], v[232:233] op_sel:[0,1] op_sel_hi:[1,1]
v_pk_mul_f32 v[118:119], v[118:119], v[232:233] op_sel:[0,1] op_sel_hi:[1,1]
v_cvt_pk_bf16_f32 v112, v112, v113
v_cvt_pk_bf16_f32 v113, v114, v115
v_cvt_pk_bf16_f32 v114, v116, v117
v_cvt_pk_bf16_f32 v115, v118, v119
v_accvgpr_write_b32 a124, v112
v_accvgpr_write_b32 a125, v113
v_accvgpr_write_b32 a126, v114
v_accvgpr_write_b32 a127, v115
v_pk_mul_f32 v[24:25], v[24:25], v[230:231] op_sel:[0,0] op_sel_hi:[1,0]
v_pk_mul_f32 v[26:27], v[26:27], v[230:231] op_sel:[0,0] op_sel_hi:[1,0]
v_pk_mul_f32 v[28:29], v[28:29], v[230:231] op_sel:[0,0] op_sel_hi:[1,0]
v_pk_mul_f32 v[30:31], v[30:31], v[230:231] op_sel:[0,0] op_sel_hi:[1,0]
v_cvt_pk_bf16_f32 v24, v24, v25
v_cvt_pk_bf16_f32 v25, v26, v27
v_cvt_pk_bf16_f32 v26, v28, v29
v_cvt_pk_bf16_f32 v27, v30, v31
v_accvgpr_write_b32 a128, v24
v_accvgpr_write_b32 a129, v25
v_accvgpr_write_b32 a130, v26
v_accvgpr_write_b32 a131, v27
v_pk_mul_f32 v[56:57], v[56:57], v[230:231] op_sel:[0,1] op_sel_hi:[1,1]
v_pk_mul_f32 v[58:59], v[58:59], v[230:231] op_sel:[0,1] op_sel_hi:[1,1]
v_pk_mul_f32 v[60:61], v[60:61], v[230:231] op_sel:[0,1] op_sel_hi:[1,1]
v_pk_mul_f32 v[62:63], v[62:63], v[230:231] op_sel:[0,1] op_sel_hi:[1,1]
v_cvt_pk_bf16_f32 v56, v56, v57
v_cvt_pk_bf16_f32 v57, v58, v59
v_cvt_pk_bf16_f32 v58, v60, v61
v_cvt_pk_bf16_f32 v59, v62, v63
v_accvgpr_write_b32 a132, v56
v_accvgpr_write_b32 a133, v57
v_accvgpr_write_b32 a134, v58
v_accvgpr_write_b32 a135, v59
v_pk_mul_f32 v[88:89], v[88:89], v[232:233] op_sel:[0,0] op_sel_hi:[1,0]
v_pk_mul_f32 v[90:91], v[90:91], v[232:233] op_sel:[0,0] op_sel_hi:[1,0]
v_pk_mul_f32 v[92:93], v[92:93], v[232:233] op_sel:[0,0] op_sel_hi:[1,0]
v_pk_mul_f32 v[94:95], v[94:95], v[232:233] op_sel:[0,0] op_sel_hi:[1,0]
v_cvt_pk_bf16_f32 v88, v88, v89
v_cvt_pk_bf16_f32 v89, v90, v91
v_cvt_pk_bf16_f32 v90, v92, v93
v_cvt_pk_bf16_f32 v91, v94, v95
v_accvgpr_write_b32 a136, v88
v_accvgpr_write_b32 a137, v89
v_accvgpr_write_b32 a138, v90
v_accvgpr_write_b32 a139, v91
v_pk_mul_f32 v[120:121], v[120:121], v[232:233] op_sel:[0,1] op_sel_hi:[1,1]
v_pk_mul_f32 v[122:123], v[122:123], v[232:233] op_sel:[0,1] op_sel_hi:[1,1]
v_pk_mul_f32 v[124:125], v[124:125], v[232:233] op_sel:[0,1] op_sel_hi:[1,1]
v_pk_mul_f32 v[126:127], v[126:127], v[232:233] op_sel:[0,1] op_sel_hi:[1,1]
v_cvt_pk_bf16_f32 v120, v120, v121
v_cvt_pk_bf16_f32 v121, v122, v123
v_cvt_pk_bf16_f32 v122, v124, v125
v_cvt_pk_bf16_f32 v123, v126, v127
v_accvgpr_write_b32 a140, v120
v_accvgpr_write_b32 a141, v121
v_accvgpr_write_b32 a142, v122
v_accvgpr_write_b32 a143, v123
s_waitcnt lgkmcnt(8)
v_pk_add_f32 v[180:181], v[180:181], v[182:183]
s_waitcnt lgkmcnt(7)
v_pk_add_f32 v[184:185], v[184:185], v[186:187]
v_pk_add_f32 v[180:181], v[180:181], v[184:185]
v_add_f32 v180, v180, v181
s_waitcnt lgkmcnt(6)
v_pk_add_f32 v[188:189], v[188:189], v[190:191]
s_waitcnt lgkmcnt(5)
v_pk_add_f32 v[192:193], v[192:193], v[194:195]
v_pk_add_f32 v[188:189], v[188:189], v[192:193]
v_add_f32 v188, v188, v189
s_cmp_lt_u32 s48, 2
s_cselect_b64 vcc, -1, 0
v_cndmask_b32 v200, v188, v180, vcc
v_rcp_f32 v234, v200
s_waitcnt lgkmcnt(4)
v_or3_b32 v196, v196, v197, v198
v_or_b32 v196, v196, v199
v_min_u32 v181, v180, v188
v_max_u32 v182, v180, v188
v_cmp_ne_u32 s[72:73], 0, v196
v_cmp_gt_u32 s[96:97], s74, v181
v_cmp_lt_u32 vcc, s75, v182
s_nop 0
v_accvgpr_read_b32 v200, a160
v_accvgpr_read_b32 v201, a161
v_accvgpr_read_b32 v202, a162
v_accvgpr_read_b32 v203, a163
v_accvgpr_read_b32 v204, a164
v_accvgpr_read_b32 v205, a165
v_accvgpr_read_b32 v206, a166
v_accvgpr_read_b32 v207, a167
s_or_b64 s[72:73], s[72:73], vcc
s_or_b64 s[72:73], s[72:73], s[96:97]
s_waitcnt lgkmcnt(3)
v_pk_add_f32 v[164:165], v[164:165], v[200:201]
v_pk_add_f32 v[166:167], v[166:167], v[202:203]
s_waitcnt lgkmcnt(2)
v_pk_add_f32 v[168:169], v[168:169], v[204:205]
v_pk_add_f32 v[170:171], v[170:171], v[206:207]
v_pk_mul_f32 v[164:165], v[164:165], v[234:235] op_sel:[0,0] op_sel_hi:[1,0]
v_pk_mul_f32 v[166:167], v[166:167], v[234:235] op_sel:[0,0] op_sel_hi:[1,0]
v_pk_mul_f32 v[168:169], v[168:169], v[234:235] op_sel:[0,0] op_sel_hi:[1,0]
v_pk_mul_f32 v[170:171], v[170:171], v[234:235] op_sel:[0,0] op_sel_hi:[1,0]
v_cvt_pk_bf16_f32 v164, v164, v165
v_cvt_pk_bf16_f32 v165, v166, v167
v_cvt_pk_bf16_f32 v166, v168, v169
v_cvt_pk_bf16_f32 v167, v170, v171
v_accvgpr_write_b32 a144, v164
v_accvgpr_write_b32 a145, v165
v_accvgpr_write_b32 a146, v166
v_accvgpr_write_b32 a147, v167
v_accvgpr_read_b32 v200, a176
v_accvgpr_read_b32 v201, a177
v_accvgpr_read_b32 v202, a178
v_accvgpr_read_b32 v203, a179
v_accvgpr_read_b32 v204, a180
v_accvgpr_read_b32 v205, a181
v_accvgpr_read_b32 v206, a182
v_accvgpr_read_b32 v207, a183
s_waitcnt lgkmcnt(1)
v_pk_add_f32 v[172:173], v[172:173], v[200:201]
v_pk_add_f32 v[174:175], v[174:175], v[202:203]
s_waitcnt lgkmcnt(0)
v_pk_add_f32 v[176:177], v[176:177], v[204:205]
v_pk_add_f32 v[178:179], v[178:179], v[206:207]
v_pk_mul_f32 v[172:173], v[172:173], v[234:235] op_sel:[0,0] op_sel_hi:[1,0]
v_pk_mul_f32 v[174:175], v[174:175], v[234:235] op_sel:[0,0] op_sel_hi:[1,0]
v_pk_mul_f32 v[176:177], v[176:177], v[234:235] op_sel:[0,0] op_sel_hi:[1,0]
v_pk_mul_f32 v[178:179], v[178:179], v[234:235] op_sel:[0,0] op_sel_hi:[1,0]
v_cvt_pk_bf16_f32 v172, v172, v173
v_cvt_pk_bf16_f32 v173, v174, v175
v_cvt_pk_bf16_f32 v174, v176, v177
v_cvt_pk_bf16_f32 v175, v178, v179
v_accvgpr_write_b32 a148, v172
v_accvgpr_write_b32 a149, v173
v_accvgpr_write_b32 a150, v174
v_accvgpr_write_b32 a151, v175
s_mov_b32 s8, s80
s_and_b32 s9, s81, 0xffff
s_mov_b32 s10, 64
s_mov_b32 s11, 0x20000
v_mov_b32 v200, 1
s_mov_b64 exec, 1
buffer_atomic_add v200, off, s[8:11], s7 sc1
s_mov_b64 exec, -1
s_cmp_lg_u64 s[72:73], 0
s_cbranch_scc1 L_restart
s_mov_b32 s63, 1
s_branch L_h_head
L_h_last:
v_mfma_f32_16x16x32_bf16 v[200:203], a[208:211], a[0:3], 0
v_exp_f32 v220, v220
v_mfma_f32_16x16x32_bf16 v[200:203], a[212:215], a[4:7], v[200:203]
ds_read_b64_tr_b16 a[248:249], v244 offset:16928
ds_read_b64_tr_b16 a[250:251], v244 offset:21152
v_mfma_f32_16x16x32_bf16 v[200:203], a[216:219], a[8:11], v[200:203]
s_add_u32 m0, s59, 64
v_exp_f32 v221, v221
v_mfma_f32_16x16x32_bf16 v[200:203], a[220:223], a[12:15], v[200:203]
s_waitcnt lgkmcnt(2)
ds_read_b64_tr_b16 a[252:253], v246 offset:16928
ds_read_b64_tr_b16 a[254:255], v246 offset:21152
buffer_load_dwordx4 v248, s[40:43], s57 offen offset:2048 nt lds
v_mfma_f32_16x16x32_bf16 v[0:3], a[240:243], v[164:167], v[0:3]
v_exp_f32 v222, v222
v_mfma_f32_16x16x32_bf16 v[0:3], a[244:247], v[168:171], v[0:3]
ds_read_b128 a[224:227], v240 offset:4224
v_cvt_pk_bf16_f32 v194, v220, v221
v_mfma_f32_16x16x32_bf16 v[32:35], a[240:243], v[172:175], v[32:35]
v_exp_f32 v223, v223
v_mfma_f32_16x16x32_bf16 v[32:35], a[244:247], v[176:179], v[32:35]
ds_read_b128 a[228:231], v241 offset:4224
v_cvt_pk_bf16_f32 v195, v222, v223
v_mfma_f32_16x16x32_bf16 v[204:207], a[208:211], a[16:19], 0
v_exp_f32 v200, v200
v_mfma_f32_16x16x32_bf16 v[204:207], a[212:215], a[20:23], v[204:207]
ds_read_b128 a[232:235], v240 offset:4736
v_mfma_f32_16x16x32_bf16 v[204:207], a[216:219], a[24:27], v[204:207]
v_exp_f32 v201, v201
v_mfma_f32_16x16x32_bf16 v[204:207], a[220:223], a[28:31], v[204:207]
ds_read_b128 a[236:239], v241 offset:4736
v_cvt_pk_bf16_f32 v128, v200, v201
v_mfma_f32_16x16x32_bf16 v[64:67], a[240:243], v[180:183], v[64:67]
v_exp_f32 v202, v202
v_mfma_f32_16x16x32_bf16 v[64:67], a[244:247], v[184:187], v[64:67]
v_mfma_f32_16x16x32_bf16 a[160:163], a[240:243], v[196:199], a[160:163]
v_exp_f32 v203, v203
v_mfma_f32_16x16x32_bf16 v[96:99], a[240:243], v[188:191], v[96:99]
v_cvt_pk_bf16_f32 v129, v202, v203
v_mfma_f32_16x16x32_bf16 v[96:99], a[244:247], v[192:195], v[96:99]
ds_read_b64_tr_b16 a[240:241], v245 offset:16896
v_mfma_f32_16x16x32_bf16 v[208:211], a[208:211], a[32:35], 0
v_exp_f32 v204, v204
v_mfma_f32_16x16x32_bf16 v[208:211], a[212:215], a[36:39], v[208:211]
ds_read_b64_tr_b16 a[242:243], v245 offset:21120
ds_read_b64_tr_b16 a[244:245], v247 offset:16896
v_mfma_f32_16x16x32_bf16 v[208:211], a[216:219], a[40:43], v[208:211]
v_exp_f32 v205, v205
v_mfma_f32_16x16x32_bf16 v[208:211], a[220:223], a[44:47], v[208:211]
s_waitcnt lgkmcnt(7)
ds_read_b64_tr_b16 a[246:247], v247 offset:21120
v_cvt_pk_bf16_f32 v136, v204, v205
v_mfma_f32_16x16x32_bf16 v[4:7], a[248:251], v[164:167], v[4:7]
s_add_u32 m0, s59, 96
v_exp_f32 v206, v206
v_mfma_f32_16x16x32_bf16 v[4:7], a[252:255], v[168:171], v[4:7]
buffer_load_dwordx4 v248, s[40:43], s57 offen offset:3072 nt lds
v_mfma_f32_16x16x32_bf16 v[36:39], a[248:251], v[172:175], v[36:39]
s_add_u32 s57, s57, 16384
v_exp_f32 v207, v207
v_mfma_f32_16x16x32_bf16 v[36:39], a[252:255], v[176:179], v[36:39]
s_add_u32 s59, s59, 16896
v_cvt_pk_bf16_f32 v137, v206, v207
v_mfma_f32_16x16x32_bf16 v[212:215], a[208:211], a[48:51], 0
s_cmp_eq_u32 s59, s70
v_exp_f32 v208, v208
v_mfma_f32_16x16x32_bf16 v[212:215], a[212:215], a[52:55], v[212:215]
s_cselect_b32 s59, s68, s59
v_mfma_f32_16x16x32_bf16 v[212:215], a[216:219], a[56:59], v[212:215]
v_exp_f32 v209, v209
v_mfma_f32_16x16x32_bf16 v[212:215], a[220:223], a[60:63], v[212:215]
v_cvt_pk_bf16_f32 v144, v208, v209
v_mfma_f32_16x16x32_bf16 v[68:71], a[248:251], v[180:183], v[68:71]
v_exp_f32 v210, v210
v_mfma_f32_16x16x32_bf16 v[68:71], a[252:255], v[184:187], v[68:71]
v_mfma_f32_16x16x32_bf16 v[100:103], a[248:251], v[188:191], v[100:103]
v_exp_f32 v211, v211
v_mfma_f32_16x16x32_bf16 v[100:103], a[252:255], v[192:195], v[100:103]
v_cvt_pk_bf16_f32 v145, v210, v211
v_mfma_f32_16x16x32_bf16 v[216:219], a[208:211], a[64:67], 0
v_exp_f32 v212, v212
v_mfma_f32_16x16x32_bf16 v[216:219], a[212:215], a[68:71], v[216:219]
v_mfma_f32_16x16x32_bf16 v[216:219], a[216:219], a[72:75], v[216:219]
v_exp_f32 v213, v213
v_mfma_f32_16x16x32_bf16 v[216:219], a[220:223], a[76:79], v[216:219]
ds_read_b128 a[208:211], v242 offset:0
v_cvt_pk_bf16_f32 v152, v212, v213
v_mfma_f32_16x16x32_bf16 a[164:167], a[248:251], v[196:199], a[164:167]
v_exp_f32 v214, v214
v_smfmac_f32_16x16x64_bf16 a[192:195], v[224:227], v[164:171], v228
s_waitcnt lgkmcnt(1)
ds_read_b64_tr_b16 a[248:249], v245 offset:16928
ds_read_b64_tr_b16 a[250:251], v245 offset:21152
v_mfma_f32_16x16x32_bf16 v[8:11], a[240:243], v[164:167], v[8:11]
s_mov_b32 m0, s58
v_exp_f32 v215, v215
v_mfma_f32_16x16x32_bf16 v[8:11], a[244:247], v[168:171], v[8:11]
ds_read_b64_tr_b16 a[252:253], v247 offset:16928
ds_read_b64_tr_b16 a[254:255], v247 offset:21152
buffer_load_dwordx4 v248, s[36:39], s56 offen offset:0 nt lds
v_mfma_f32_16x16x32_bf16 v[220:223], a[224:227], a[0:3], 0
v_exp_f32 v216, v216
v_mfma_f32_16x16x32_bf16 v[220:223], a[228:231], a[4:7], v[220:223]
ds_read_b128 a[212:215], v243 offset:0
v_cvt_pk_bf16_f32 v153, v214, v215
v_mfma_f32_16x16x32_bf16 v[220:223], a[232:235], a[8:11], v[220:223]
v_exp_f32 v217, v217
v_mfma_f32_16x16x32_bf16 v[220:223], a[236:239], a[12:15], v[220:223]
ds_read_b128 a[216:219], v242 offset:512
v_cvt_pk_bf16_f32 v160, v216, v217
v_mfma_f32_16x16x32_bf16 v[40:43], a[240:243], v[172:175], v[40:43]
v_exp_f32 v218, v218
v_mfma_f32_16x16x32_bf16 v[40:43], a[244:247], v[176:179], v[40:43]
ds_read_b128 a[220:223], v243 offset:512
v_add_f32 v229, v229, v216
v_mfma_f32_16x16x32_bf16 v[72:75], a[240:243], v[180:183], v[72:75]
v_exp_f32 v219, v219
v_mfma_f32_16x16x32_bf16 v[72:75], a[244:247], v[184:187], v[72:75]
v_cvt_pk_bf16_f32 v161, v218, v219
v_add_f32 v229, v229, v217
v_mfma_f32_16x16x32_bf16 v[200:203], a[224:227], a[16:19], 0
v_exp_f32 v220, v220
v_mfma_f32_16x16x32_bf16 v[200:203], a[228:231], a[20:23], v[200:203]
v_add_f32 v229, v229, v218
v_add_f32 v229, v229, v219
v_mfma_f32_16x16x32_bf16 v[200:203], a[232:235], a[24:27], v[200:203]
v_exp_f32 v221, v221
v_mfma_f32_16x16x32_bf16 v[200:203], a[236:239], a[28:31], v[200:203]
v_cvt_pk_bf16_f32 v130, v220, v221
v_mfma_f32_16x16x32_bf16 v[104:107], a[240:243], v[188:191], v[104:107]
v_exp_f32 v222, v222
v_mfma_f32_16x16x32_bf16 v[104:107], a[244:247], v[192:195], v[104:107]
v_mfma_f32_16x16x32_bf16 a[168:171], a[240:243], v[196:199], a[168:171]
s_waitcnt lgkmcnt(3)
v_exp_f32 v223, v223
v_mfma_f32_16x16x32_bf16 v[12:15], a[248:251], v[164:167], v[12:15]
ds_read_b64_tr_b16 a[240:241], v244 offset:17408
ds_read_b64_tr_b16 a[242:243], v244 offset:21632
v_mfma_f32_16x16x32_bf16 v[12:15], a[252:255], v[168:171], v[12:15]
s_add_u32 m0, s58, 32
ds_read_b64_tr_b16 a[244:245], v246 offset:17408
v_cvt_pk_bf16_f32 v131, v222, v223
v_mfma_f32_16x16x32_bf16 v[204:207], a[224:227], a[32:35], 0
v_exp_f32 v200, v200
v_mfma_f32_16x16x32_bf16 v[204:207], a[228:231], a[36:39], v[204:207]
ds_read_b64_tr_b16 a[246:247], v246 offset:21632
buffer_load_dwordx4 v248, s[36:39], s56 offen offset:1024 nt lds
v_mfma_f32_16x16x32_bf16 v[204:207], a[232:235], a[40:43], v[204:207]
v_exp_f32 v201, v201
v_mfma_f32_16x16x32_bf16 v[204:207], a[236:239], a[44:47], v[204:207]
v_cvt_pk_bf16_f32 v138, v200, v201
v_mfma_f32_16x16x32_bf16 v[44:47], a[248:251], v[172:175], v[44:47]
v_exp_f32 v202, v202
v_mfma_f32_16x16x32_bf16 v[44:47], a[252:255], v[176:179], v[44:47]
v_mfma_f32_16x16x32_bf16 v[76:79], a[248:251], v[180:183], v[76:79]
v_exp_f32 v203, v203
v_mfma_f32_16x16x32_bf16 v[76:79], a[252:255], v[184:187], v[76:79]
v_cvt_pk_bf16_f32 v139, v202, v203
v_mfma_f32_16x16x32_bf16 v[208:211], a[224:227], a[48:51], 0
v_exp_f32 v204, v204
v_mfma_f32_16x16x32_bf16 v[208:211], a[228:231], a[52:55], v[208:211]
v_mfma_f32_16x16x32_bf16 v[208:211], a[232:235], a[56:59], v[208:211]
v_exp_f32 v205, v205
v_mfma_f32_16x16x32_bf16 v[208:211], a[236:239], a[60:63], v[208:211]
v_cvt_pk_bf16_f32 v146, v204, v205
v_mfma_f32_16x16x32_bf16 v[108:111], a[248:251], v[188:191], v[108:111]
v_exp_f32 v206, v206
v_mfma_f32_16x16x32_bf16 v[108:111], a[252:255], v[192:195], v[108:111]
v_mfma_f32_16x16x32_bf16 a[172:175], a[248:251], v[196:199], a[172:175]
v_exp_f32 v207, v207
v_smfmac_f32_16x16x64_bf16 a[196:199], v[224:227], v[172:179], v228
ds_read_b64_tr_b16 a[248:249], v244 offset:17440
ds_read_b64_tr_b16 a[250:251], v244 offset:21664
v_mfma_f32_16x16x32_bf16 v[212:215], a[224:227], a[64:67], 0
v_exp_f32 v208, v208
v_mfma_f32_16x16x32_bf16 v[212:215], a[228:231], a[68:71], v[212:215]
ds_read_b64_tr_b16 a[252:253], v246 offset:17440
ds_read_b64_tr_b16 a[254:255], v246 offset:21664
v_mfma_f32_16x16x32_bf16 v[212:215], a[232:235], a[72:75], v[212:215]
s_add_u32 m0, s58, 64
v_exp_f32 v209, v209
v_mfma_f32_16x16x32_bf16 v[212:215], a[236:239], a[76:79], v[212:215]
s_waitcnt lgkmcnt(4)
ds_read_b128 a[224:227], v242 offset:4224
buffer_load_dwordx4 v248, s[36:39], s56 offen offset:2048 nt lds
v_cvt_pk_bf16_f32 v147, v206, v207
v_mfma_f32_16x16x32_bf16 v[16:19], a[240:243], v[164:167], v[16:19]
v_exp_f32 v210, v210
v_mfma_f32_16x16x32_bf16 v[16:19], a[244:247], v[168:171], v[16:19]
ds_read_b128 a[228:231], v243 offset:4224
v_cvt_pk_bf16_f32 v154, v208, v209
v_mfma_f32_16x16x32_bf16 v[48:51], a[240:243], v[172:175], v[48:51]
v_exp_f32 v211, v211
v_mfma_f32_16x16x32_bf16 v[48:51], a[244:247], v[176:179], v[48:51]
ds_read_b128 a[232:235], v242 offset:4736
v_cvt_pk_bf16_f32 v155, v210, v211
v_mfma_f32_16x16x32_bf16 v[216:219], a[208:211], a[0:3], 0
v_exp_f32 v212, v212
v_mfma_f32_16x16x32_bf16 v[216:219], a[212:215], a[4:7], v[216:219]
ds_read_b128 a[236:239], v243 offset:4736
v_add_f32 v229, v229, v212
v_mfma_f32_16x16x32_bf16 v[216:219], a[216:219], a[8:11], v[216:219]
v_exp_f32 v213, v213
v_mfma_f32_16x16x32_bf16 v[216:219], a[220:223], a[12:15], v[216:219]
v_cvt_pk_bf16_f32 v162, v212, v213
v_add_f32 v229, v229, v213
v_mfma_f32_16x16x32_bf16 v[80:83], a[240:243], v[180:183], v[80:83]
v_exp_f32 v214, v214
v_mfma_f32_16x16x32_bf16 v[80:83], a[244:247], v[184:187], v[80:83]
v_add_f32 v229, v229, v214
v_add_u32 v244, s61, v244
v_mfma_f32_16x16x32_bf16 v[112:115], a[240:243], v[188:191], v[112:115]
v_exp_f32 v215, v215
v_mfma_f32_16x16x32_bf16 v[112:115], a[244:247], v[192:195], v[112:115]
v_cvt_pk_bf16_f32 v163, v214, v215
v_add_f32 v229, v229, v215
v_mfma_f32_16x16x32_bf16 v[220:223], a[208:211], a[16:19], 0
v_exp_f32 v216, v216
v_mfma_f32_16x16x32_bf16 v[220:223], a[212:215], a[20:23], v[220:223]
v_add_u32 v246, s61, v246
v_mfma_f32_16x16x32_bf16 v[220:223], a[216:219], a[24:27], v[220:223]
v_exp_f32 v217, v217
v_mfma_f32_16x16x32_bf16 v[220:223], a[220:223], a[28:31], v[220:223]
v_cvt_pk_bf16_f32 v132, v216, v217
v_mfma_f32_16x16x32_bf16 a[176:179], a[240:243], v[196:199], a[176:179]
s_waitcnt lgkmcnt(4)
v_exp_f32 v218, v218
v_mfma_f32_16x16x32_bf16 v[20:23], a[248:251], v[164:167], v[20:23]
s_add_u32 m0, s58, 96
ds_read_b64_tr_b16 a[240:241], v245 offset:17408
ds_read_b64_tr_b16 a[242:243], v245 offset:21632
v_mfma_f32_16x16x32_bf16 v[20:23], a[252:255], v[168:171], v[20:23]
v_exp_f32_e64 v219, v219
v_mfma_f32_16x16x32_bf16 v[52:55], a[248:251], v[172:175], v[52:55]
ds_read_b64_tr_b16 a[244:245], v247 offset:17408
ds_read_b64_tr_b16 a[246:247], v247 offset:21632
v_mfma_f32_16x16x32_bf16 v[52:55], a[252:255], v[176:179], v[52:55]
buffer_load_dwordx4 v248, s[36:39], s56 offen offset:3072 nt lds
v_cvt_pk_bf16_f32 v133, v218, v219
v_mfma_f32_16x16x32_bf16 v[200:203], a[208:211], a[32:35], 0
v_exp_f32 v220, v220
v_mfma_f32_16x16x32_bf16 v[200:203], a[212:215], a[36:39], v[200:203]
v_mfma_f32_16x16x32_bf16 v[200:203], a[216:219], a[40:43], v[200:203]
v_exp_f32 v221, v221
v_mfma_f32_16x16x32_bf16 v[200:203], a[220:223], a[44:47], v[200:203]
v_cvt_pk_bf16_f32 v140, v220, v221
v_mfma_f32_16x16x32_bf16 v[84:87], a[248:251], v[180:183], v[84:87]
v_exp_f32 v222, v222
v_mfma_f32_16x16x32_bf16 v[84:87], a[252:255], v[184:187], v[84:87]
v_mfma_f32_16x16x32_bf16 v[116:119], a[248:251], v[188:191], v[116:119]
v_exp_f32 v223, v223
v_mfma_f32_16x16x32_bf16 v[116:119], a[252:255], v[192:195], v[116:119]
v_cvt_pk_bf16_f32 v141, v222, v223
v_mfma_f32_16x16x32_bf16 v[204:207], a[208:211], a[48:51], 0
v_exp_f32 v200, v200
v_mfma_f32_16x16x32_bf16 v[204:207], a[212:215], a[52:55], v[204:207]
v_mfma_f32_16x16x32_bf16 v[204:207], a[216:219], a[56:59], v[204:207]
v_exp_f32 v201, v201
v_mfma_f32_16x16x32_bf16 v[204:207], a[220:223], a[60:63], v[204:207]
v_cvt_pk_bf16_f32 v148, v200, v201
v_mfma_f32_16x16x32_bf16 a[180:183], a[248:251], v[196:199], a[180:183]
v_exp_f32 v202, v202
v_smfmac_f32_16x16x64_bf16 a[200:203], v[224:227], v[180:187], v228
s_waitcnt lgkmcnt(0)
ds_read_b64_tr_b16 a[248:249], v245 offset:17440
ds_read_b64_tr_b16 a[250:251], v245 offset:21664
v_mfma_f32_16x16x32_bf16 v[24:27], a[240:243], v[164:167], v[24:27]
v_exp_f32 v203, v203
v_mfma_f32_16x16x32_bf16 v[24:27], a[244:247], v[168:171], v[24:27]
ds_read_b64_tr_b16 a[252:253], v247 offset:17440
ds_read_b64_tr_b16 a[254:255], v247 offset:21664
v_mfma_f32_16x16x32_bf16 v[208:211], a[224:227], a[0:3], 0
v_exp_f32 v204, v204
v_mfma_f32_16x16x32_bf16 v[208:211], a[228:231], a[4:7], v[208:211]
v_cvt_pk_bf16_f32 v149, v202, v203
v_add_u32 v245, s61, v245
v_mfma_f32_16x16x32_bf16 v[208:211], a[232:235], a[8:11], v[208:211]
s_waitcnt vmcnt(12)
v_exp_f32 v205, v205
v_mfma_f32_16x16x32_bf16 v[208:211], a[236:239], a[12:15], v[208:211]
s_barrier
v_mfma_f32_16x16x32_bf16 v[56:59], a[240:243], v[172:175], v[56:59]
s_mov_b32 m0, s59
v_exp_f32 v206, v206
v_mfma_f32_16x16x32_bf16 v[56:59], a[244:247], v[176:179], v[56:59]
ds_read_b128 a[208:211], v240 offset:16896
buffer_load_dwordx4 v248, s[40:43], s57 offen offset:0 nt lds
v_cvt_pk_bf16_f32 v156, v204, v205
v_mfma_f32_16x16x32_bf16 v[88:91], a[240:243], v[180:183], v[88:91]
v_exp_f32 v207, v207
v_mfma_f32_16x16x32_bf16 v[88:91], a[244:247], v[184:187], v[88:91]
ds_read_b128 a[212:215], v241 offset:16896
v_cvt_pk_bf16_f32 v157, v206, v207
v_mfma_f32_16x16x32_bf16 v[212:215], a[224:227], a[16:19], 0
v_exp_f32 v208, v208
v_mfma_f32_16x16x32_bf16 v[212:215], a[228:231], a[20:23], v[212:215]
ds_read_b128 a[216:219], v240 offset:17408
v_add_u32 v247, s61, v247
v_mfma_f32_16x16x32_bf16 v[212:215], a[232:235], a[24:27], v[212:215]
s_mul_i32 s61, s61, -1
v_exp_f32 v209, v209
v_mfma_f32_16x16x32_bf16 v[212:215], a[236:239], a[28:31], v[212:215]
ds_read_b128 a[220:223], v241 offset:17408
v_cvt_pk_bf16_f32 v134, v208, v209
v_mfma_f32_16x16x32_bf16 v[120:123], a[240:243], v[188:191], v[120:123]
v_exp_f32 v210, v210
v_mfma_f32_16x16x32_bf16 v[120:123], a[244:247], v[192:195], v[120:123]
v_mfma_f32_16x16x32_bf16 a[184:187], a[240:243], v[196:199], a[184:187]
v_exp_f32 v211, v211
v_smfmac_f32_16x16x64_bf16 a[204:207], v[224:227], v[188:195], v228
ds_read_b64_tr_b16 a[240:241], v244 offset:0
ds_read_b64_tr_b16 a[242:243], v244 offset:4224
v_mfma_f32_16x16x32_bf16 v[216:219], a[224:227], a[32:35], 0
v_exp_f32 v212, v212
v_mfma_f32_16x16x32_bf16 v[216:219], a[228:231], a[36:39], v[216:219]
ds_read_b64_tr_b16 a[244:245], v246 offset:0
ds_read_b64_tr_b16 a[246:247], v246 offset:4224
v_mfma_f32_16x16x32_bf16 v[216:219], a[232:235], a[40:43], v[216:219]
v_exp_f32 v213, v213
v_mfma_f32_16x16x32_bf16 v[216:219], a[236:239], a[44:47], v[216:219]
s_waitcnt lgkmcnt(8)
v_cvt_pk_bf16_f32 v135, v210, v211
v_cvt_pk_bf16_f32 v142, v212, v213
v_mfma_f32_16x16x32_bf16 v[28:31], a[248:251], v[164:167], v[28:31]
v_exp_f32 v214, v214
v_mfma_f32_16x16x32_bf16 v[28:31], a[252:255], v[168:171], v[28:31]
v_mfma_f32_16x16x32_bf16 v[60:63], a[248:251], v[172:175], v[60:63]
s_add_u32 m0, s59, 32
v_exp_f32 v215, v215
v_mfma_f32_16x16x32_bf16 v[60:63], a[252:255], v[176:179], v[60:63]
buffer_load_dwordx4 v248, s[40:43], s57 offen offset:1024 nt lds
v_cvt_pk_bf16_f32 v143, v214, v215
v_mfma_f32_16x16x32_bf16 v[220:223], a[224:227], a[48:51], 0
v_exp_f32 v216, v216
v_mfma_f32_16x16x32_bf16 v[220:223], a[228:231], a[52:55], v[220:223]
v_mfma_f32_16x16x32_bf16 v[220:223], a[232:235], a[56:59], v[220:223]
v_exp_f32 v217, v217
v_mfma_f32_16x16x32_bf16 v[220:223], a[236:239], a[60:63], v[220:223]
v_cvt_pk_bf16_f32 v150, v216, v217
v_mfma_f32_16x16x32_bf16 v[92:95], a[248:251], v[180:183], v[92:95]
v_exp_f32 v218, v218
v_mfma_f32_16x16x32_bf16 v[92:95], a[252:255], v[184:187], v[92:95]
v_mfma_f32_16x16x32_bf16 v[124:127], a[248:251], v[188:191], v[124:127]
v_exp_f32 v219, v219
v_mfma_f32_16x16x32_bf16 v[124:127], a[252:255], v[192:195], v[124:127]
s_waitcnt lgkmcnt(4)
v_cvt_pk_bf16_f32 v151, v218, v219
v_mfma_f32_16x16x32_bf16 a[188:191], a[248:251], v[196:199], a[188:191]
v_mfma_f32_16x16x32_bf16 v[200:203], a[208:211], a[0:3], 0
v_exp_f32 v220, v220
v_mfma_f32_16x16x32_bf16 v[200:203], a[212:215], a[4:7], v[200:203]
ds_read_b64_tr_b16 a[248:249], v244 offset:32
ds_read_b64_tr_b16 a[250:251], v244 offset:4256
v_mfma_f32_16x16x32_bf16 v[200:203], a[216:219], a[8:11], v[200:203]
s_add_u32 m0, s59, 64
v_exp_f32 v221, v221
v_mfma_f32_16x16x32_bf16 v[200:203], a[220:223], a[12:15], v[200:203]
s_waitcnt lgkmcnt(2)
ds_read_b64_tr_b16 a[252:253], v246 offset:32
ds_read_b64_tr_b16 a[254:255], v246 offset:4256
buffer_load_dwordx4 v248, s[40:43], s57 offen offset:2048 nt lds
v_mfma_f32_16x16x32_bf16 v[0:3], a[240:243], v[128:131], v[0:3]
v_exp_f32 v222, v222
v_mfma_f32_16x16x32_bf16 v[0:3], a[244:247], v[132:135], v[0:3]
ds_read_b128 a[224:227], v240 offset:21120
v_cvt_pk_bf16_f32 v158, v220, v221
v_mfma_f32_16x16x32_bf16 v[32:35], a[240:243], v[136:139], v[32:35]
s_add_u32 m0, s59, 96
v_exp_f32 v223, v223
v_mfma_f32_16x16x32_bf16 v[32:35], a[244:247], v[140:143], v[32:35]
ds_read_b128 a[228:231], v241 offset:21120
v_cvt_pk_bf16_f32 v159, v222, v223
v_mfma_f32_16x16x32_bf16 v[204:207], a[208:211], a[16:19], 0
v_exp_f32 v200, v200
v_mfma_f32_16x16x32_bf16 v[204:207], a[212:215], a[20:23], v[204:207]
ds_read_b128 a[232:235], v240 offset:21632
buffer_load_dwordx4 v248, s[40:43], s57 offen offset:3072 nt lds
v_mfma_f32_16x16x32_bf16 v[204:207], a[216:219], a[24:27], v[204:207]
s_add_u32 s57, s57, 16384
v_exp_f32 v201, v201
v_mfma_f32_16x16x32_bf16 v[204:207], a[220:223], a[28:31], v[204:207]
s_add_u32 s59, s59, 16896
ds_read_b128 a[236:239], v241 offset:21632
v_cvt_pk_bf16_f32 v164, v200, v201
v_mfma_f32_16x16x32_bf16 v[64:67], a[240:243], v[144:147], v[64:67]
s_cmp_eq_u32 s59, s70
v_exp_f32 v202, v202
v_mfma_f32_16x16x32_bf16 v[64:67], a[244:247], v[148:151], v[64:67]
s_cselect_b32 s59, s68, s59
v_add_u32 v240, s60, v240
v_add_u32 v241, s60, v241
v_mfma_f32_16x16x32_bf16 a[160:163], a[240:243], v[160:163], a[160:163]
s_add_u32 s50, s65, 4096
v_exp_f32 v203, v203
v_mfma_f32_16x16x32_bf16 v[96:99], a[240:243], v[152:155], v[96:99]
buffer_store_dwordx4 a[104:107], v249, s[44:47], s50 offen offset:0 sc1
v_cvt_pk_bf16_f32 v165, v202, v203
v_mfma_f32_16x16x32_bf16 v[96:99], a[244:247], v[156:159], v[96:99]
ds_read_b64_tr_b16 a[240:241], v245 offset:0
v_mfma_f32_16x16x32_bf16 v[208:211], a[208:211], a[32:35], 0
v_exp_f32 v204, v204
v_mfma_f32_16x16x32_bf16 v[208:211], a[212:215], a[36:39], v[208:211]
ds_read_b64_tr_b16 a[242:243], v245 offset:4224
ds_read_b64_tr_b16 a[244:245], v247 offset:0
v_mfma_f32_16x16x32_bf16 v[208:211], a[216:219], a[40:43], v[208:211]
v_exp_f32 v205, v205
v_mfma_f32_16x16x32_bf16 v[208:211], a[220:223], a[44:47], v[208:211]
s_waitcnt lgkmcnt(7)
ds_read_b64_tr_b16 a[246:247], v247 offset:4224
v_cvt_pk_bf16_f32 v172, v204, v205
v_mfma_f32_16x16x32_bf16 v[4:7], a[248:251], v[128:131], v[4:7]
v_exp_f32 v206, v206
v_mfma_f32_16x16x32_bf16 v[4:7], a[252:255], v[132:135], v[4:7]
v_mfma_f32_16x16x32_bf16 v[36:39], a[248:251], v[136:139], v[36:39]
v_exp_f32 v207, v207
v_mfma_f32_16x16x32_bf16 v[36:39], a[252:255], v[140:143], v[36:39]
v_cvt_pk_bf16_f32 v173, v206, v207
v_mfma_f32_16x16x32_bf16 v[212:215], a[208:211], a[48:51], 0
v_exp_f32 v208, v208
v_mfma_f32_16x16x32_bf16 v[212:215], a[212:215], a[52:55], v[212:215]
v_mfma_f32_16x16x32_bf16 v[212:215], a[216:219], a[56:59], v[212:215]
v_exp_f32 v209, v209
v_mfma_f32_16x16x32_bf16 v[212:215], a[220:223], a[60:63], v[212:215]
v_cvt_pk_bf16_f32 v180, v208, v209
v_mfma_f32_16x16x32_bf16 v[68:71], a[248:251], v[144:147], v[68:71]
v_exp_f32 v210, v210
v_mfma_f32_16x16x32_bf16 v[68:71], a[252:255], v[148:151], v[68:71]
v_mfma_f32_16x16x32_bf16 v[100:103], a[248:251], v[152:155], v[100:103]
v_exp_f32 v211, v211
v_mfma_f32_16x16x32_bf16 v[100:103], a[252:255], v[156:159], v[100:103]
v_cvt_pk_bf16_f32 v181, v210, v211
v_mfma_f32_16x16x32_bf16 v[216:219], a[208:211], a[64:67], 0
v_exp_f32 v212, v212
v_mfma_f32_16x16x32_bf16 v[216:219], a[212:215], a[68:71], v[216:219]
v_mfma_f32_16x16x32_bf16 v[216:219], a[216:219], a[72:75], v[216:219]
s_add_u32 s50, s65, 6144
v_exp_f32 v213, v213
v_mfma_f32_16x16x32_bf16 v[216:219], a[220:223], a[76:79], v[216:219]
ds_read_b128 a[208:211], v242 offset:16896
v_cvt_pk_bf16_f32 v188, v212, v213
v_mfma_f32_16x16x32_bf16 a[164:167], a[248:251], v[160:163], a[164:167]
v_exp_f32 v214, v214
v_smfmac_f32_16x16x64_bf16 a[192:195], v[224:227], v[128:135], v228
s_waitcnt lgkmcnt(1)
ds_read_b64_tr_b16 a[248:249], v245 offset:32
ds_read_b64_tr_b16 a[250:251], v245 offset:4256
v_mfma_f32_16x16x32_bf16 v[8:11], a[240:243], v[128:131], v[8:11]
v_exp_f32 v215, v215
v_mfma_f32_16x16x32_bf16 v[8:11], a[244:247], v[132:135], v[8:11]
ds_read_b64_tr_b16 a[252:253], v247 offset:32
ds_read_b64_tr_b16 a[254:255], v247 offset:4256
v_mfma_f32_16x16x32_bf16 v[220:223], a[224:227], a[0:3], 0
v_exp_f32 v216, v216
v_mfma_f32_16x16x32_bf16 v[220:223], a[228:231], a[4:7], v[220:223]
ds_read_b128 a[212:215], v243 offset:16896
v_cvt_pk_bf16_f32 v189, v214, v215
v_mfma_f32_16x16x32_bf16 v[220:223], a[232:235], a[8:11], v[220:223]
v_exp_f32 v217, v217
v_mfma_f32_16x16x32_bf16 v[220:223], a[236:239], a[12:15], v[220:223]
ds_read_b128 a[216:219], v242 offset:17408
v_cvt_pk_bf16_f32 v196, v216, v217
v_mfma_f32_16x16x32_bf16 v[40:43], a[240:243], v[136:139], v[40:43]
v_exp_f32 v218, v218
v_mfma_f32_16x16x32_bf16 v[40:43], a[244:247], v[140:143], v[40:43]
ds_read_b128 a[220:223], v243 offset:17408
v_add_f32 v229, v229, v216
v_mfma_f32_16x16x32_bf16 v[72:75], a[240:243], v[144:147], v[72:75]
v_exp_f32 v219, v219
v_mfma_f32_16x16x32_bf16 v[72:75], a[244:247], v[148:151], v[72:75]
v_cvt_pk_bf16_f32 v197, v218, v219
v_add_f32 v229, v229, v217
v_mfma_f32_16x16x32_bf16 v[200:203], a[224:227], a[16:19], 0
v_exp_f32 v220, v220
v_mfma_f32_16x16x32_bf16 v[200:203], a[228:231], a[20:23], v[200:203]
v_add_f32 v229, v229, v218
v_add_f32 v229, v229, v219
v_mfma_f32_16x16x32_bf16 v[200:203], a[232:235], a[24:27], v[200:203]
v_exp_f32 v221, v221
v_mfma_f32_16x16x32_bf16 v[200:203], a[236:239], a[28:31], v[200:203]
buffer_store_dwordx4 a[108:111], v249, s[44:47], s50 offen offset:0 sc1
v_cvt_pk_bf16_f32 v166, v220, v221
v_mfma_f32_16x16x32_bf16 v[104:107], a[240:243], v[152:155], v[104:107]
v_exp_f32 v222, v222
v_mfma_f32_16x16x32_bf16 v[104:107], a[244:247], v[156:159], v[104:107]
v_mfma_f32_16x16x32_bf16 a[168:171], a[240:243], v[160:163], a[168:171]
s_waitcnt lgkmcnt(3)
v_exp_f32_e64 v223, v223
v_mfma_f32_16x16x32_bf16 v[12:15], a[248:251], v[128:131], v[12:15]
s_add_u32 s50, s64, 294912
ds_read_b64_tr_b16 a[240:241], v244 offset:512
ds_read_b64_tr_b16 a[242:243], v244 offset:4736
v_mfma_f32_16x16x32_bf16 v[12:15], a[252:255], v[132:135], v[12:15]
ds_read_b64_tr_b16 a[244:245], v246 offset:512
v_cvt_pk_bf16_f32 v167, v222, v223
v_mfma_f32_16x16x32_bf16 v[204:207], a[224:227], a[32:35], 0
v_exp_f32 v200, v200
v_mfma_f32_16x16x32_bf16 v[204:207], a[228:231], a[36:39], v[204:207]
ds_read_b64_tr_b16 a[246:247], v246 offset:4736
buffer_store_dwordx4 a[112:115], v249, s[44:47], s50 offen offset:0 sc1
v_mfma_f32_16x16x32_bf16 v[204:207], a[232:235], a[40:43], v[204:207]
v_exp_f32 v201, v201
v_mfma_f32_16x16x32_bf16 v[204:207], a[236:239], a[44:47], v[204:207]
v_cvt_pk_bf16_f32 v174, v200, v201
v_mfma_f32_16x16x32_bf16 v[44:47], a[248:251], v[136:139], v[44:47]
v_exp_f32 v202, v202
v_mfma_f32_16x16x32_bf16 v[44:47], a[252:255], v[140:143], v[44:47]
v_mfma_f32_16x16x32_bf16 v[76:79], a[248:251], v[144:147], v[76:79]
v_exp_f32 v203, v203
v_mfma_f32_16x16x32_bf16 v[76:79], a[252:255], v[148:151], v[76:79]
v_cvt_pk_bf16_f32 v175, v202, v203
v_mfma_f32_16x16x32_bf16 v[208:211], a[224:227], a[48:51], 0
v_exp_f32 v204, v204
v_mfma_f32_16x16x32_bf16 v[208:211], a[228:231], a[52:55], v[208:211]
v_mfma_f32_16x16x32_bf16 v[208:211], a[232:235], a[56:59], v[208:211]
v_exp_f32 v205, v205
v_mfma_f32_16x16x32_bf16 v[208:211], a[236:239], a[60:63], v[208:211]
v_cvt_pk_bf16_f32 v182, v204, v205
v_mfma_f32_16x16x32_bf16 v[108:111], a[248:251], v[152:155], v[108:111]
v_exp_f32 v206, v206
v_mfma_f32_16x16x32_bf16 v[108:111], a[252:255], v[156:159], v[108:111]
v_mfma_f32_16x16x32_bf16 a[172:175], a[248:251], v[160:163], a[172:175]
v_exp_f32 v207, v207
v_smfmac_f32_16x16x64_bf16 a[196:199], v[224:227], v[136:143], v228
ds_read_b64_tr_b16 a[248:249], v244 offset:544
ds_read_b64_tr_b16 a[250:251], v244 offset:4768
v_mfma_f32_16x16x32_bf16 v[212:215], a[224:227], a[64:67], 0
v_exp_f32 v208, v208
v_mfma_f32_16x16x32_bf16 v[212:215], a[228:231], a[68:71], v[212:215]
ds_read_b64_tr_b16 a[252:253], v246 offset:544
ds_read_b64_tr_b16 a[254:255], v246 offset:4768
v_mfma_f32_16x16x32_bf16 v[212:215], a[232:235], a[72:75], v[212:215]
v_exp_f32 v209, v209
v_mfma_f32_16x16x32_bf16 v[212:215], a[236:239], a[76:79], v[212:215]
s_waitcnt lgkmcnt(4)
ds_read_b128 a[224:227], v242 offset:21120
v_cvt_pk_bf16_f32 v183, v206, v207
v_mfma_f32_16x16x32_bf16 v[16:19], a[240:243], v[128:131], v[16:19]
s_add_u32 s50, s64, 296960
v_exp_f32 v210, v210
v_mfma_f32_16x16x32_bf16 v[16:19], a[244:247], v[132:135], v[16:19]
ds_read_b128 a[228:231], v243 offset:21120
v_cvt_pk_bf16_f32 v190, v208, v209
v_mfma_f32_16x16x32_bf16 v[48:51], a[240:243], v[136:139], v[48:51]
v_exp_f32 v211, v211
v_mfma_f32_16x16x32_bf16 v[48:51], a[244:247], v[140:143], v[48:51]
ds_read_b128 a[232:235], v242 offset:21632
v_cvt_pk_bf16_f32 v191, v210, v211
v_mfma_f32_16x16x32_bf16 v[216:219], a[208:211], a[0:3], 0
v_exp_f32 v212, v212
v_mfma_f32_16x16x32_bf16 v[216:219], a[212:215], a[4:7], v[216:219]
ds_read_b128 a[236:239], v243 offset:21632
v_add_f32 v229, v229, v212
v_mfma_f32_16x16x32_bf16 v[216:219], a[216:219], a[8:11], v[216:219]
v_exp_f32 v213, v213
v_mfma_f32_16x16x32_bf16 v[216:219], a[220:223], a[12:15], v[216:219]
v_cvt_pk_bf16_f32 v198, v212, v213
v_add_f32 v229, v229, v213
v_mfma_f32_16x16x32_bf16 v[80:83], a[240:243], v[144:147], v[80:83]
v_exp_f32 v214, v214
v_mfma_f32_16x16x32_bf16 v[80:83], a[244:247], v[148:151], v[80:83]
v_add_f32 v229, v229, v214
v_add_u32 v242, s60, v242
v_mfma_f32_16x16x32_bf16 v[112:115], a[240:243], v[152:155], v[112:115]
v_exp_f32 v215, v215
v_mfma_f32_16x16x32_bf16 v[112:115], a[244:247], v[156:159], v[112:115]
v_cvt_pk_bf16_f32 v199, v214, v215
v_add_f32 v229, v229, v215
v_mfma_f32_16x16x32_bf16 v[220:223], a[208:211], a[16:19], 0
v_exp_f32 v216, v216
v_mfma_f32_16x16x32_bf16 v[220:223], a[212:215], a[20:23], v[220:223]
buffer_store_dwordx4 a[116:119], v249, s[44:47], s50 offen offset:0 sc1
v_add_u32 v243, s60, v243
v_mfma_f32_16x16x32_bf16 v[220:223], a[216:219], a[24:27], v[220:223]
s_mul_i32 s60, s60, -1
v_exp_f32 v217, v217
v_mfma_f32_16x16x32_bf16 v[220:223], a[220:223], a[28:31], v[220:223]
v_cvt_pk_bf16_f32 v168, v216, v217
v_mfma_f32_16x16x32_bf16 a[176:179], a[240:243], v[160:163], a[176:179]
s_waitcnt lgkmcnt(4)
v_exp_f32 v218, v218
v_mfma_f32_16x16x32_bf16 v[20:23], a[248:251], v[128:131], v[20:23]
ds_read_b64_tr_b16 a[240:241], v245 offset:512
ds_read_b64_tr_b16 a[242:243], v245 offset:4736
v_mfma_f32_16x16x32_bf16 v[20:23], a[252:255], v[132:135], v[20:23]
v_exp_f32_e64 v219, v219
v_mfma_f32_16x16x32_bf16 v[52:55], a[248:251], v[136:139], v[52:55]
ds_read_b64_tr_b16 a[244:245], v247 offset:512
ds_read_b64_tr_b16 a[246:247], v247 offset:4736
v_mfma_f32_16x16x32_bf16 v[52:55], a[252:255], v[140:143], v[52:55]
s_add_u32 s50, s64, 299008
v_cvt_pk_bf16_f32 v169, v218, v219
v_mfma_f32_16x16x32_bf16 v[200:203], a[208:211], a[32:35], 0
v_exp_f32 v220, v220
v_mfma_f32_16x16x32_bf16 v[200:203], a[212:215], a[36:39], v[200:203]
buffer_store_dwordx4 a[120:123], v249, s[44:47], s50 offen offset:0 sc1
v_mfma_f32_16x16x32_bf16 v[200:203], a[216:219], a[40:43], v[200:203]
v_exp_f32 v221, v221
v_mfma_f32_16x16x32_bf16 v[200:203], a[220:223], a[44:47], v[200:203]
v_cvt_pk_bf16_f32 v176, v220, v221
v_mfma_f32_16x16x32_bf16 v[84:87], a[248:251], v[144:147], v[84:87]
v_exp_f32 v222, v222
v_mfma_f32_16x16x32_bf16 v[84:87], a[252:255], v[148:151], v[84:87]
v_mfma_f32_16x16x32_bf16 v[116:119], a[248:251], v[152:155], v[116:119]
v_exp_f32 v223, v223
v_mfma_f32_16x16x32_bf16 v[116:119], a[252:255], v[156:159], v[116:119]
v_cvt_pk_bf16_f32 v177, v222, v223
v_mfma_f32_16x16x32_bf16 v[204:207], a[208:211], a[48:51], 0
v_exp_f32 v200, v200
v_mfma_f32_16x16x32_bf16 v[204:207], a[212:215], a[52:55], v[204:207]
v_mfma_f32_16x16x32_bf16 v[204:207], a[216:219], a[56:59], v[204:207]
v_exp_f32 v201, v201
v_mfma_f32_16x16x32_bf16 v[204:207], a[220:223], a[60:63], v[204:207]
v_cvt_pk_bf16_f32 v184, v200, v201
v_mfma_f32_16x16x32_bf16 a[180:183], a[248:251], v[160:163], a[180:183]
v_exp_f32 v202, v202
v_smfmac_f32_16x16x64_bf16 a[200:203], v[224:227], v[144:151], v228
s_waitcnt lgkmcnt(0)
ds_read_b64_tr_b16 a[248:249], v245 offset:544
ds_read_b64_tr_b16 a[250:251], v245 offset:4768
v_mfma_f32_16x16x32_bf16 v[24:27], a[240:243], v[128:131], v[24:27]
v_exp_f32 v203, v203
v_mfma_f32_16x16x32_bf16 v[24:27], a[244:247], v[132:135], v[24:27]
ds_read_b64_tr_b16 a[252:253], v247 offset:544
ds_read_b64_tr_b16 a[254:255], v247 offset:4768
v_mfma_f32_16x16x32_bf16 v[208:211], a[224:227], a[0:3], 0
v_exp_f32 v204, v204
v_mfma_f32_16x16x32_bf16 v[208:211], a[228:231], a[4:7], v[208:211]
v_cvt_pk_bf16_f32 v185, v202, v203
v_mfma_f32_16x16x32_bf16 v[208:211], a[232:235], a[8:11], v[208:211]
s_waitcnt vmcnt(13)
v_exp_f32 v205, v205
v_mfma_f32_16x16x32_bf16 v[208:211], a[236:239], a[12:15], v[208:211]
s_barrier
v_mfma_f32_16x16x32_bf16 v[56:59], a[240:243], v[136:139], v[56:59]
s_mov_b32 m0, s59
v_exp_f32_e64 v206, v206
v_mfma_f32_16x16x32_bf16 v[56:59], a[244:247], v[140:143], v[56:59]
ds_read_b128 a[208:211], v240 offset:0
buffer_load_dwordx4 v248, s[40:43], s57 offen offset:0 nt lds
v_cvt_pk_bf16_f32 v192, v204, v205
v_mfma_f32_16x16x32_bf16 v[88:91], a[240:243], v[144:147], v[88:91]
s_add_u32 s50, s64, 301056
v_exp_f32 v207, v207
v_mfma_f32_16x16x32_bf16 v[88:91], a[244:247], v[148:151], v[88:91]
ds_read_b128 a[212:215], v241 offset:0
v_cvt_pk_bf16_f32 v193, v206, v207
v_mfma_f32_16x16x32_bf16 v[212:215], a[224:227], a[16:19], 0
v_exp_f32 v208, v208
v_mfma_f32_16x16x32_bf16 v[212:215], a[228:231], a[20:23], v[212:215]
ds_read_b128 a[216:219], v240 offset:512
buffer_store_dwordx4 a[124:127], v249, s[44:47], s50 offen offset:0 sc1
v_mfma_f32_16x16x32_bf16 v[212:215], a[232:235], a[24:27], v[212:215]
v_exp_f32 v209, v209
v_mfma_f32_16x16x32_bf16 v[212:215], a[236:239], a[28:31], v[212:215]
ds_read_b128 a[220:223], v241 offset:512
v_cvt_pk_bf16_f32 v170, v208, v209
v_mfma_f32_16x16x32_bf16 v[120:123], a[240:243], v[152:155], v[120:123]
v_exp_f32 v210, v210
v_mfma_f32_16x16x32_bf16 v[120:123], a[244:247], v[156:159], v[120:123]
v_mfma_f32_16x16x32_bf16 a[184:187], a[240:243], v[160:163], a[184:187]
v_exp_f32 v211, v211
v_smfmac_f32_16x16x64_bf16 a[204:207], v[224:227], v[152:159], v228
ds_read_b64_tr_b16 a[240:241], v244 offset:16896
ds_read_b64_tr_b16 a[242:243], v244 offset:21120
v_mfma_f32_16x16x32_bf16 v[216:219], a[224:227], a[32:35], 0
v_exp_f32 v212, v212
v_mfma_f32_16x16x32_bf16 v[216:219], a[228:231], a[36:39], v[216:219]
ds_read_b64_tr_b16 a[244:245], v246 offset:16896
ds_read_b64_tr_b16 a[246:247], v246 offset:21120
v_mfma_f32_16x16x32_bf16 v[216:219], a[232:235], a[40:43], v[216:219]
v_exp_f32 v213, v213
v_mfma_f32_16x16x32_bf16 v[216:219], a[236:239], a[44:47], v[216:219]
s_waitcnt lgkmcnt(8)
v_cvt_pk_bf16_f32 v171, v210, v211
v_cvt_pk_bf16_f32 v178, v212, v213
v_mfma_f32_16x16x32_bf16 v[28:31], a[248:251], v[128:131], v[28:31]
v_exp_f32 v214, v214
v_mfma_f32_16x16x32_bf16 v[28:31], a[252:255], v[132:135], v[28:31]
v_mfma_f32_16x16x32_bf16 v[60:63], a[248:251], v[136:139], v[60:63]
s_add_u32 m0, s59, 32
v_exp_f32 v215, v215
v_mfma_f32_16x16x32_bf16 v[60:63], a[252:255], v[140:143], v[60:63]
buffer_load_dwordx4 v248, s[40:43], s57 offen offset:1024 nt lds
v_cvt_pk_bf16_f32 v179, v214, v215
v_mfma_f32_16x16x32_bf16 v[220:223], a[224:227], a[48:51], 0
v_exp_f32 v216, v216
v_mfma_f32_16x16x32_bf16 v[220:223], a[228:231], a[52:55], v[220:223]
v_mfma_f32_16x16x32_bf16 v[220:223], a[232:235], a[56:59], v[220:223]
v_exp_f32 v217, v217
v_mfma_f32_16x16x32_bf16 v[220:223], a[236:239], a[60:63], v[220:223]
v_cvt_pk_bf16_f32 v186, v216, v217
v_mfma_f32_16x16x32_bf16 v[92:95], a[248:251], v[144:147], v[92:95]
v_exp_f32 v218, v218
v_mfma_f32_16x16x32_bf16 v[92:95], a[252:255], v[148:151], v[92:95]
v_mfma_f32_16x16x32_bf16 v[124:127], a[248:251], v[152:155], v[124:127]
v_exp_f32 v219, v219
v_mfma_f32_16x16x32_bf16 v[124:127], a[252:255], v[156:159], v[124:127]
s_waitcnt lgkmcnt(4)
v_cvt_pk_bf16_f32 v187, v218, v219
v_mfma_f32_16x16x32_bf16 a[188:191], a[248:251], v[160:163], a[188:191]
v_mfma_f32_16x16x32_bf16 v[200:203], a[208:211], a[0:3], 0
v_exp_f32 v220, v220
v_mfma_f32_16x16x32_bf16 v[200:203], a[212:215], a[4:7], v[200:203]
ds_read_b64_tr_b16 a[248:249], v244 offset:16928
ds_read_b64_tr_b16 a[250:251], v244 offset:21152
v_mfma_f32_16x16x32_bf16 v[200:203], a[216:219], a[8:11], v[200:203]
s_add_u32 m0, s59, 64
v_exp_f32 v221, v221
v_mfma_f32_16x16x32_bf16 v[200:203], a[220:223], a[12:15], v[200:203]
s_waitcnt lgkmcnt(2)
ds_read_b64_tr_b16 a[252:253], v246 offset:16928
ds_read_b64_tr_b16 a[254:255], v246 offset:21152
buffer_load_dwordx4 v248, s[40:43], s57 offen offset:2048 nt lds
v_mfma_f32_16x16x32_bf16 v[0:3], a[240:243], v[164:167], v[0:3]
v_exp_f32 v222, v222
v_mfma_f32_16x16x32_bf16 v[0:3], a[244:247], v[168:171], v[0:3]
ds_read_b128 a[224:227], v240 offset:4224
v_cvt_pk_bf16_f32 v194, v220, v221
v_mfma_f32_16x16x32_bf16 v[32:35], a[240:243], v[172:175], v[32:35]
s_add_u32 m0, s59, 96
v_exp_f32 v223, v223
v_mfma_f32_16x16x32_bf16 v[32:35], a[244:247], v[176:179], v[32:35]
ds_read_b128 a[228:231], v241 offset:4224
v_cvt_pk_bf16_f32 v195, v222, v223
v_mfma_f32_16x16x32_bf16 v[204:207], a[208:211], a[16:19], 0
v_exp_f32 v200, v200
v_mfma_f32_16x16x32_bf16 v[204:207], a[212:215], a[20:23], v[204:207]
ds_read_b128 a[232:235], v240 offset:4736
buffer_load_dwordx4 v248, s[40:43], s57 offen offset:3072 nt lds
v_mfma_f32_16x16x32_bf16 v[204:207], a[216:219], a[24:27], v[204:207]
s_mov_b32 s36, s80
v_exp_f32 v201, v201
v_mfma_f32_16x16x32_bf16 v[204:207], a[220:223], a[28:31], v[204:207]
ds_read_b128 a[236:239], v241 offset:4736
v_cvt_pk_bf16_f32 v128, v200, v201
v_mfma_f32_16x16x32_bf16 v[64:67], a[240:243], v[180:183], v[64:67]
v_exp_f32 v202, v202
v_mfma_f32_16x16x32_bf16 v[64:67], a[244:247], v[184:187], v[64:67]
v_bfe_u32 v254, v249, 4, 4
v_mfma_f32_16x16x32_bf16 a[160:163], a[240:243], v[196:199], a[160:163]
s_and_b32 s37, s81, 0xffff
v_exp_f32 v203, v203
v_mfma_f32_16x16x32_bf16 v[96:99], a[240:243], v[188:191], v[96:99]
s_mov_b32 s38, 64
s_mov_b32 s39, 0x20000
v_cvt_pk_bf16_f32 v129, v202, v203
v_mfma_f32_16x16x32_bf16 v[96:99], a[244:247], v[192:195], v[96:99]
ds_read_b64_tr_b16 a[240:241], v245 offset:16896
v_lshlrev_b32 v254, 2, v254
v_mfma_f32_16x16x32_bf16 v[208:211], a[208:211], a[32:35], 0
v_exp_f32 v204, v204
v_mfma_f32_16x16x32_bf16 v[208:211], a[212:215], a[36:39], v[208:211]
s_add_u32 s50, s65, 294912
ds_read_b64_tr_b16 a[242:243], v245 offset:21120
ds_read_b64_tr_b16 a[244:245], v247 offset:16896
v_mfma_f32_16x16x32_bf16 v[208:211], a[216:219], a[40:43], v[208:211]
v_exp_f32 v205, v205
v_mfma_f32_16x16x32_bf16 v[208:211], a[220:223], a[44:47], v[208:211]
s_waitcnt lgkmcnt(7)
ds_read_b64_tr_b16 a[246:247], v247 offset:21120
v_cvt_pk_bf16_f32 v136, v204, v205
v_mfma_f32_16x16x32_bf16 v[4:7], a[248:251], v[164:167], v[4:7]
v_exp_f32 v206, v206
v_mfma_f32_16x16x32_bf16 v[4:7], a[252:255], v[168:171], v[4:7]
buffer_load_dword v255, v254, s[36:39], 0 offen sc1
v_mfma_f32_16x16x32_bf16 v[36:39], a[248:251], v[172:175], v[36:39]
v_exp_f32 v207, v207
v_mfma_f32_16x16x32_bf16 v[36:39], a[252:255], v[176:179], v[36:39]
buffer_store_dwordx4 a[128:131], v249, s[44:47], s50 offen offset:0 sc1
v_cvt_pk_bf16_f32 v137, v206, v207
v_mfma_f32_16x16x32_bf16 v[212:215], a[208:211], a[48:51], 0
s_sub_u32 s28, s12, 2048
v_exp_f32 v208, v208
v_mfma_f32_16x16x32_bf16 v[212:215], a[212:215], a[52:55], v[212:215]
s_subb_u32 s29, s13, 0
s_and_b32 s29, s29, 0xffff
s_mov_b32 s30, 4720640
v_mfma_f32_16x16x32_bf16 v[212:215], a[216:219], a[56:59], v[212:215]
s_mov_b32 s31, 0x20000
v_exp_f32 v209, v209
v_mfma_f32_16x16x32_bf16 v[212:215], a[220:223], a[60:63], v[212:215]
s_mul_i32 s51, s26, 18874368
s_add_u32 s32, s24, s51
v_cvt_pk_bf16_f32 v144, v208, v209
v_mfma_f32_16x16x32_bf16 v[68:71], a[248:251], v[180:183], v[68:71]
s_addc_u32 s33, s25, 0
v_exp_f32 v210, v210
v_mfma_f32_16x16x32_bf16 v[68:71], a[252:255], v[184:187], v[68:71]
s_sub_u32 s32, s32, 4096
s_subb_u32 s33, s33, 0
s_and_b32 s33, s33, 0xffff
v_mfma_f32_16x16x32_bf16 v[100:103], a[248:251], v[188:191], v[100:103]
s_mov_b32 s34, 18878464
v_exp_f32 v211, v211
v_mfma_f32_16x16x32_bf16 v[100:103], a[252:255], v[192:195], v[100:103]
s_mov_b32 s35, 0x20000
s_add_u32 s40, s24, 41943040
v_cvt_pk_bf16_f32 v145, v210, v211
v_mfma_f32_16x16x32_bf16 v[216:219], a[208:211], a[64:67], 0
s_addc_u32 s41, s25, 0
v_exp_f32 v212, v212
v_mfma_f32_16x16x32_bf16 v[216:219], a[212:215], a[68:71], v[216:219]
s_and_b32 s41, s41, 0xffff
s_mov_b32 s42, 8554496
s_add_u32 s50, s65, 296960
v_mfma_f32_16x16x32_bf16 v[216:219], a[216:219], a[72:75], v[216:219]
v_exp_f32 v213, v213
v_mfma_f32_16x16x32_bf16 v[216:219], a[220:223], a[76:79], v[216:219]
ds_read_b128 a[208:211], v242 offset:0
v_cvt_pk_bf16_f32 v152, v212, v213
v_mfma_f32_16x16x32_bf16 a[164:167], a[248:251], v[196:199], a[164:167]
v_exp_f32 v214, v214
v_smfmac_f32_16x16x64_bf16 a[192:195], v[224:227], v[164:171], v228
s_waitcnt lgkmcnt(1)
ds_read_b64_tr_b16 a[248:249], v245 offset:16928
ds_read_b64_tr_b16 a[250:251], v245 offset:21152
v_mfma_f32_16x16x32_bf16 v[8:11], a[240:243], v[164:167], v[8:11]
v_exp_f32 v215, v215
v_mfma_f32_16x16x32_bf16 v[8:11], a[244:247], v[168:171], v[8:11]
ds_read_b64_tr_b16 a[252:253], v247 offset:16928
ds_read_b64_tr_b16 a[254:255], v247 offset:21152
v_mfma_f32_16x16x32_bf16 v[220:223], a[224:227], a[0:3], 0
v_exp_f32 v216, v216
v_mfma_f32_16x16x32_bf16 v[220:223], a[228:231], a[4:7], v[220:223]
ds_read_b128 a[212:215], v243 offset:0
v_cvt_pk_bf16_f32 v153, v214, v215
v_mfma_f32_16x16x32_bf16 v[220:223], a[232:235], a[8:11], v[220:223]
v_exp_f32 v217, v217
v_mfma_f32_16x16x32_bf16 v[220:223], a[236:239], a[12:15], v[220:223]
ds_read_b128 a[216:219], v242 offset:512
v_cvt_pk_bf16_f32 v160, v216, v217
v_mfma_f32_16x16x32_bf16 v[40:43], a[240:243], v[172:175], v[40:43]
v_exp_f32 v218, v218
v_mfma_f32_16x16x32_bf16 v[40:43], a[244:247], v[176:179], v[40:43]
ds_read_b128 a[220:223], v243 offset:512
v_add_f32 v229, v229, v216
v_mfma_f32_16x16x32_bf16 v[72:75], a[240:243], v[180:183], v[72:75]
v_exp_f32 v219, v219
v_mfma_f32_16x16x32_bf16 v[72:75], a[244:247], v[184:187], v[72:75]
v_cvt_pk_bf16_f32 v161, v218, v219
v_add_f32 v229, v229, v217
v_mfma_f32_16x16x32_bf16 v[200:203], a[224:227], a[16:19], 0
v_exp_f32 v220, v220
v_mfma_f32_16x16x32_bf16 v[200:203], a[228:231], a[20:23], v[200:203]
v_add_f32 v229, v229, v218
v_add_f32 v229, v229, v219
v_mfma_f32_16x16x32_bf16 v[200:203], a[232:235], a[24:27], v[200:203]
v_exp_f32 v221, v221
v_mfma_f32_16x16x32_bf16 v[200:203], a[236:239], a[28:31], v[200:203]
buffer_store_dwordx4 a[132:135], v249, s[44:47], s50 offen offset:0 sc1
v_cvt_pk_bf16_f32 v130, v220, v221
v_mfma_f32_16x16x32_bf16 v[104:107], a[240:243], v[188:191], v[104:107]
s_mov_b32 s43, 0x20000
v_exp_f32 v222, v222
v_mfma_f32_16x16x32_bf16 v[104:107], a[244:247], v[192:195], v[104:107]
s_lshl_b32 s51, s26, 3
s_add_u32 s51, s51, s27
s_lshl_b32 s51, s51, 5
v_mfma_f32_16x16x32_bf16 a[168:171], a[240:243], v[196:199], a[168:171]
s_waitcnt lgkmcnt(3)
v_exp_f32 v223, v223
v_mfma_f32_16x16x32_bf16 v[12:15], a[248:251], v[164:167], v[12:15]
s_add_u32 s51, s51, s3
ds_read_b64_tr_b16 a[240:241], v244 offset:17408
ds_read_b64_tr_b16 a[242:243], v244 offset:21632
v_mfma_f32_16x16x32_bf16 v[12:15], a[252:255], v[168:171], v[12:15]
s_lshl_b32 s51, s51, 2
ds_read_b64_tr_b16 a[244:245], v246 offset:17408
v_cvt_pk_bf16_f32 v131, v222, v223
v_mfma_f32_16x16x32_bf16 v[204:207], a[224:227], a[32:35], 0
s_add_u32 s51, s51, 8519680
v_exp_f32 v200, v200
v_mfma_f32_16x16x32_bf16 v[204:207], a[228:231], a[36:39], v[204:207]
s_xor_b32 s100, s51, 32
s_cmp_eq_u32 s48, 0
ds_read_b64_tr_b16 a[246:247], v246 offset:21632
v_mfma_f32_16x16x32_bf16 v[204:207], a[232:235], a[40:43], v[204:207]
s_cselect_b32 s67, s51, 1073741824
v_exp_f32 v201, v201
v_mfma_f32_16x16x32_bf16 v[204:207], a[236:239], a[44:47], v[204:207]
s_and_b32 s51, s2, 2
s_lshl_b32 s51, s51, 4
v_cvt_pk_bf16_f32 v138, v200, v201
v_mfma_f32_16x16x32_bf16 v[44:47], a[248:251], v[172:175], v[44:47]
s_lshr_b32 s55, s2, 3
v_exp_f32 v202, v202
v_mfma_f32_16x16x32_bf16 v[44:47], a[252:255], v[176:179], v[44:47]
s_add_u32 s55, s55, s51
s_and_b32 s4, s2, 1
s_mul_i32 s60, s55, 43691
v_mfma_f32_16x16x32_bf16 v[76:79], a[248:251], v[180:183], v[76:79]
s_lshr_b32 s60, s60, 17
v_exp_f32 v203, v203
v_mfma_f32_16x16x32_bf16 v[76:79], a[252:255], v[184:187], v[76:79]
s_add_u32 s50, s65, 299008
v_cvt_pk_bf16_f32 v139, v202, v203
v_lshrrev_b32 v230, 8, v249
v_mfma_f32_16x16x32_bf16 v[208:211], a[224:227], a[48:51], 0
v_exp_f32 v204, v204
v_mfma_f32_16x16x32_bf16 v[208:211], a[228:231], a[52:55], v[208:211]
buffer_store_dwordx4 a[136:139], v249, s[44:47], s50 offen offset:0 sc1
v_mfma_f32_16x16x32_bf16 v[208:211], a[232:235], a[56:59], v[208:211]
s_mul_i32 s71, s60, 3
v_exp_f32 v205, v205
v_mfma_f32_16x16x32_bf16 v[208:211], a[236:239], a[60:63], v[208:211]
s_sub_u32 s71, s55, s71
s_lshr_b32 s19, s48, 1
v_cvt_pk_bf16_f32 v146, v204, v205
v_mfma_f32_16x16x32_bf16 v[108:111], a[248:251], v[188:191], v[108:111]
s_and_b32 s70, s48, 1
v_exp_f32 v206, v206
v_mfma_f32_16x16x32_bf16 v[108:111], a[252:255], v[192:195], v[108:111]
s_cmp_eq_u32 s4, 0
s_cselect_b32 s6, 1, -1
s_cselect_b32 s15, 0, 6
v_mfma_f32_16x16x32_bf16 a[172:175], a[248:251], v[196:199], a[172:175]
s_mul_i32 s52, s60, 7
v_exp_f32 v207, v207
v_smfmac_f32_16x16x64_bf16 a[196:199], v[224:227], v[172:179], v228
s_add_u32 s15, s15, s52
ds_read_b64_tr_b16 a[248:249], v244 offset:17440
ds_read_b64_tr_b16 a[250:251], v244 offset:21664
v_mfma_f32_16x16x32_bf16 v[212:215], a[224:227], a[64:67], 0
s_mul_i32 s53, s52, 3641
v_exp_f32 v208, v208
v_mfma_f32_16x16x32_bf16 v[212:215], a[228:231], a[68:71], v[212:215]
s_lshr_b32 s53, s53, 16
ds_read_b64_tr_b16 a[252:253], v246 offset:17440
ds_read_b64_tr_b16 a[254:255], v246 offset:21664
v_mfma_f32_16x16x32_bf16 v[212:215], a[232:235], a[72:75], v[212:215]
s_min_u32 s53, s53, 7
v_exp_f32 v209, v209
v_mfma_f32_16x16x32_bf16 v[212:215], a[236:239], a[76:79], v[212:215]
s_waitcnt lgkmcnt(4)
ds_read_b128 a[224:227], v242 offset:4224
v_cvt_pk_bf16_f32 v147, v206, v207
v_mfma_f32_16x16x32_bf16 v[16:19], a[240:243], v[164:167], v[16:19]
s_add_u32 s54, s52, 6
v_exp_f32 v210, v210
v_mfma_f32_16x16x32_bf16 v[16:19], a[244:247], v[168:171], v[16:19]
s_mul_i32 s54, s54, 3641
ds_read_b128 a[228:231], v243 offset:4224
v_cvt_pk_bf16_f32 v154, v208, v209
v_mfma_f32_16x16x32_bf16 v[48:51], a[240:243], v[172:175], v[48:51]
s_lshr_b32 s54, s54, 16
v_exp_f32 v211, v211
v_mfma_f32_16x16x32_bf16 v[48:51], a[244:247], v[176:179], v[48:51]
ds_read_b128 a[232:235], v242 offset:4736
v_cvt_pk_bf16_f32 v155, v210, v211
v_mfma_f32_16x16x32_bf16 v[216:219], a[208:211], a[0:3], 0
s_min_u32 s54, s54, 7
v_exp_f32 v212, v212
v_mfma_f32_16x16x32_bf16 v[216:219], a[212:215], a[4:7], v[216:219]
s_sub_u32 s54, s54, s53
ds_read_b128 a[236:239], v243 offset:4736
v_add_f32 v229, v229, v212
v_mfma_f32_16x16x32_bf16 v[216:219], a[216:219], a[8:11], v[216:219]
s_add_u32 s50, s65, 301056
v_exp_f32 v213, v213
v_mfma_f32_16x16x32_bf16 v[216:219], a[220:223], a[12:15], v[216:219]
v_cvt_pk_bf16_f32 v162, v212, v213
v_add_f32 v229, v229, v213
v_mfma_f32_16x16x32_bf16 v[80:83], a[240:243], v[180:183], v[80:83]
v_exp_f32 v214, v214
v_mfma_f32_16x16x32_bf16 v[80:83], a[244:247], v[184:187], v[80:83]
v_add_f32 v229, v229, v214
v_add_u32 v244, s61, v244
v_mfma_f32_16x16x32_bf16 v[112:115], a[240:243], v[188:191], v[112:115]
v_exp_f32 v215, v215
v_mfma_f32_16x16x32_bf16 v[112:115], a[244:247], v[192:195], v[112:115]
v_cvt_pk_bf16_f32 v163, v214, v215
v_add_f32 v229, v229, v215
v_mfma_f32_16x16x32_bf16 v[220:223], a[208:211], a[16:19], 0
v_exp_f32 v216, v216
v_mfma_f32_16x16x32_bf16 v[220:223], a[212:215], a[20:23], v[220:223]
buffer_store_dwordx4 a[140:143], v249, s[44:47], s50 offen offset:0 sc1
v_add_u32 v246, s61, v246
v_mfma_f32_16x16x32_bf16 v[220:223], a[216:219], a[24:27], v[220:223]
s_lshl_b32 s54, s54, 7
v_exp_f32 v217, v217
v_mfma_f32_16x16x32_bf16 v[220:223], a[220:223], a[28:31], v[220:223]
s_lshl_b32 s51, s26, 3
s_add_u32 s53, s53, s51
v_cvt_pk_bf16_f32 v132, v216, v217
v_mfma_f32_16x16x32_bf16 a[176:179], a[240:243], v[196:199], a[176:179]
s_waitcnt lgkmcnt(4)
v_exp_f32 v218, v218
v_mfma_f32_16x16x32_bf16 v[20:23], a[248:251], v[164:167], v[20:23]
s_lshl_b32 s53, s53, 7
ds_read_b64_tr_b16 a[240:241], v245 offset:17408
ds_read_b64_tr_b16 a[242:243], v245 offset:21632
v_mfma_f32_16x16x32_bf16 v[20:23], a[252:255], v[168:171], v[20:23]
s_lshl_b32 s51, s4, 5
v_exp_f32 v219, v219
v_mfma_f32_16x16x32_bf16 v[52:55], a[248:251], v[172:175], v[52:55]
s_add_u32 s53, s53, s51
ds_read_b64_tr_b16 a[244:245], v247 offset:17408
ds_read_b64_tr_b16 a[246:247], v247 offset:21632
v_mfma_f32_16x16x32_bf16 v[52:55], a[252:255], v[176:179], v[52:55]
s_add_u32 s69, s53, 8519680
s_lshl_b32 s16, s70, 10
v_cvt_pk_bf16_f32 v133, v218, v219
v_mfma_f32_16x16x32_bf16 v[200:203], a[208:211], a[32:35], 0
s_lshl_b32 s51, s15, 11
v_exp_f32 v220, v220
v_mfma_f32_16x16x32_bf16 v[200:203], a[212:215], a[36:39], v[200:203]
s_add_u32 s16, s16, s51
s_add_u32 s16, s16, 4096
s_lshl_b32 s52, s6, 11
v_mfma_f32_16x16x32_bf16 v[200:203], a[216:219], a[40:43], v[200:203]
s_mul_i32 s51, s52, 6
v_exp_f32 v221, v221
v_mfma_f32_16x16x32_bf16 v[200:203], a[220:223], a[44:47], v[200:203]
s_add_u32 s59, s16, s51
s_lshl_b32 s51, s19, 9
v_cvt_pk_bf16_f32 v140, v220, v221
v_mfma_f32_16x16x32_bf16 v[84:87], a[248:251], v[180:183], v[84:87]
s_add_u32 s59, s59, s51
v_exp_f32 v222, v222
v_mfma_f32_16x16x32_bf16 v[84:87], a[252:255], v[184:187], v[84:87]
s_mul_i32 s51, s19, 3
s_add_u32 s50, s66, 0
v_bfe_u32 v231, v249, 6, 2
v_mfma_f32_16x16x32_bf16 v[116:119], a[248:251], v[188:191], v[116:119]
v_exp_f32 v223, v223
v_mfma_f32_16x16x32_bf16 v[116:119], a[252:255], v[192:195], v[116:119]
buffer_store_dwordx4 a[144:147], v249, s[44:47], s50 offen offset:0 sc1
v_cvt_pk_bf16_f32 v141, v222, v223
v_mfma_f32_16x16x32_bf16 v[204:207], a[208:211], a[48:51], 0
s_mul_i32 s51, s51, s52
v_exp_f32 v200, v200
v_mfma_f32_16x16x32_bf16 v[204:207], a[212:215], a[52:55], v[204:207]
s_add_u32 s56, s16, s51
s_sub_u32 s52, s52, 1024
s_add_u32 s57, s56, s52
v_mfma_f32_16x16x32_bf16 v[204:207], a[216:219], a[56:59], v[204:207]
s_add_u32 s58, s57, s52
v_exp_f32 v201, v201
v_mfma_f32_16x16x32_bf16 v[204:207], a[220:223], a[60:63], v[204:207]
s_mul_i32 s9, s70, 7168
s_mul_i32 s51, s19, 3072
v_cvt_pk_bf16_f32 v148, v200, v201
v_mfma_f32_16x16x32_bf16 a[180:183], a[248:251], v[196:199], a[180:183]
s_add_u32 s9, s9, s51
v_exp_f32 v202, v202
v_smfmac_f32_16x16x64_bf16 a[200:203], v[224:227], v[180:187], v228
s_waitcnt lgkmcnt(0)
ds_read_b64_tr_b16 a[248:249], v245 offset:17440
ds_read_b64_tr_b16 a[250:251], v245 offset:21664
v_mfma_f32_16x16x32_bf16 v[24:27], a[240:243], v[164:167], v[24:27]
s_mul_i32 s14, s19, 4294964736
v_exp_f32 v203, v203
v_mfma_f32_16x16x32_bf16 v[24:27], a[244:247], v[168:171], v[24:27]
ds_read_b64_tr_b16 a[252:253], v247 offset:17440
ds_read_b64_tr_b16 a[254:255], v247 offset:21664
v_mfma_f32_16x16x32_bf16 v[208:211], a[224:227], a[0:3], 0
s_add_u32 s14, s14, 6144
v_exp_f32 v204, v204
v_mfma_f32_16x16x32_bf16 v[208:211], a[228:231], a[4:7], v[208:211]
s_mul_i32 s7, s70, 5152
v_cvt_pk_bf16_f32 v149, v202, v203
v_add_u32 v245, s61, v245
v_mfma_f32_16x16x32_bf16 v[208:211], a[232:235], a[8:11], v[208:211]
s_waitcnt vmcnt(16)
v_exp_f32 v205, v205
v_mfma_f32_16x16x32_bf16 v[208:211], a[236:239], a[12:15], v[208:211]
s_barrier
v_mfma_f32_16x16x32_bf16 v[56:59], a[240:243], v[172:175], v[56:59]
s_add_u32 s7, s7, s51
v_exp_f32 v206, v206
v_mfma_f32_16x16x32_bf16 v[56:59], a[244:247], v[176:179], v[56:59]
s_add_u32 s7, s7, 14336
ds_read_b128 a[208:211], v240 offset:16896
v_cvt_pk_bf16_f32 v156, v204, v205
v_mfma_f32_16x16x32_bf16 v[88:91], a[240:243], v[180:183], v[88:91]
s_add_u32 s10, s9, 155904
v_exp_f32 v207, v207
v_mfma_f32_16x16x32_bf16 v[88:91], a[244:247], v[184:187], v[88:91]
s_lshl_b32 s18, s19, 3
ds_read_b128 a[212:215], v241 offset:16896
v_cvt_pk_bf16_f32 v157, v206, v207
v_mfma_f32_16x16x32_bf16 v[212:215], a[224:227], a[16:19], 0
s_add_u32 s18, s18, s70
v_exp_f32 v208, v208
v_mfma_f32_16x16x32_bf16 v[212:215], a[228:231], a[20:23], v[212:215]
s_mul_i32 s18, s18, 4608
ds_read_b128 a[216:219], v240 offset:17408
v_add_u32 v247, s61, v247
v_mfma_f32_16x16x32_bf16 v[212:215], a[232:235], a[24:27], v[212:215]
s_mul_i32 s61, s61, -1
v_exp_f32 v209, v209
v_mfma_f32_16x16x32_bf16 v[212:215], a[236:239], a[28:31], v[212:215]
s_add_u32 s50, s66, 294912
ds_read_b128 a[220:223], v241 offset:17408
v_cvt_pk_bf16_f32 v134, v208, v209
v_mfma_f32_16x16x32_bf16 v[120:123], a[240:243], v[188:191], v[120:123]
v_exp_f32 v210, v210
v_mfma_f32_16x16x32_bf16 v[120:123], a[244:247], v[192:195], v[120:123]
buffer_store_dwordx4 a[148:151], v249, s[44:47], s50 offen offset:0 sc1
v_mfma_f32_16x16x32_bf16 a[184:187], a[240:243], v[196:199], a[184:187]
s_mul_i32 s51, s71, 384
v_exp_f32 v211, v211
v_smfmac_f32_16x16x64_bf16 a[204:207], v[224:227], v[188:195], v228
s_add_u32 s18, s18, s51
ds_read_b64_tr_b16 a[240:241], v244 offset:0
ds_read_b64_tr_b16 a[242:243], v244 offset:4224
v_mfma_f32_16x16x32_bf16 v[216:219], a[224:227], a[32:35], 0
s_mul_i32 s5, s19, 1536
v_exp_f32 v212, v212
v_mfma_f32_16x16x32_bf16 v[216:219], a[228:231], a[36:39], v[216:219]
s_lshl_b32 s8, s70, 5
ds_read_b64_tr_b16 a[244:245], v246 offset:0
ds_read_b64_tr_b16 a[246:247], v246 offset:4224
v_mfma_f32_16x16x32_bf16 v[216:219], a[232:235], a[40:43], v[216:219]
s_add_u32 s5, s5, s8
v_exp_f32 v213, v213
v_mfma_f32_16x16x32_bf16 v[216:219], a[236:239], a[44:47], v[216:219]
s_waitcnt lgkmcnt(8)
v_cvt_pk_bf16_f32 v135, v210, v211
v_cvt_pk_bf16_f32 v142, v212, v213
v_mfma_f32_16x16x32_bf16 v[28:31], a[248:251], v[164:167], v[28:31]
s_add_u32 s5, s5, 14336
v_exp_f32 v214, v214
v_mfma_f32_16x16x32_bf16 v[28:31], a[252:255], v[168:171], v[28:31]
s_mul_i32 s101, s26, 1152
s_add_u32 s101, s101, s51
s_mul_i32 s51, s19, 192
v_mfma_f32_16x16x32_bf16 v[60:63], a[248:251], v[172:175], v[60:63]
s_add_u32 s8, s8, s51
v_exp_f32 v215, v215
v_mfma_f32_16x16x32_bf16 v[60:63], a[252:255], v[176:179], v[60:63]
s_xor_b32 s70, s69, 32
s_andn2_b32 s51, s2, 1
v_cvt_pk_bf16_f32 v143, v214, v215
v_mfma_f32_16x16x32_bf16 v[220:223], a[224:227], a[48:51], 0
s_lshl_b32 s51, s51, 7
v_exp_f32 v216, v216
v_mfma_f32_16x16x32_bf16 v[220:223], a[228:231], a[52:55], v[220:223]
s_mul_i32 s71, s4, 68
s_add_u32 s51, s51, 8521740
s_add_u32 s71, s71, s51
v_mfma_f32_16x16x32_bf16 v[220:223], a[232:235], a[56:59], v[220:223]
s_lshl_b32 s16, s4, 5
v_exp_f32 v217, v217
v_mfma_f32_16x16x32_bf16 v[220:223], a[236:239], a[60:63], v[220:223]
v_cvt_pk_bf16_f32 v150, v216, v217
v_bfe_u32 v232, v249, 4, 2
v_mfma_f32_16x16x32_bf16 v[92:95], a[248:251], v[180:183], v[92:95]
v_exp_f32 v218, v218
v_mfma_f32_16x16x32_bf16 v[92:95], a[252:255], v[184:187], v[92:95]
v_and_b32 v233, 1, v230
v_lshrrev_b32 v234, 1, v230
v_mfma_f32_16x16x32_bf16 v[124:127], a[248:251], v[188:191], v[124:127]
v_exp_f32 v219, v219
v_mfma_f32_16x16x32_bf16 v[124:127], a[252:255], v[192:195], v[124:127]
s_waitcnt lgkmcnt(4)
v_cvt_pk_bf16_f32 v151, v218, v219
v_lshl_add_u32 v248, v233, 3, v231
v_mfma_f32_16x16x32_bf16 a[188:191], a[248:251], v[196:199], a[188:191]
v_mul_u32_u24 v248, 1152, v248
v_lshl_add_u32 v248, v234, 6, v248
v_mfma_f32_16x16x32_bf16 v[200:203], a[208:211], a[0:3], 0
s_add_u32 s64, s64, 589824
v_exp_f32 v220, v220
v_mfma_f32_16x16x32_bf16 v[200:203], a[212:215], a[4:7], v[200:203]
s_add_u32 s65, s65, 589824
ds_read_b64_tr_b16 a[248:249], v244 offset:32
ds_read_b64_tr_b16 a[250:251], v244 offset:4256
v_mfma_f32_16x16x32_bf16 v[200:203], a[216:219], a[8:11], v[200:203]
s_add_u32 s66, s66, 589824
v_exp_f32 v221, v221
v_mfma_f32_16x16x32_bf16 v[200:203], a[220:223], a[12:15], v[200:203]
s_waitcnt lgkmcnt(2)
ds_read_b64_tr_b16 a[252:253], v246 offset:32
ds_read_b64_tr_b16 a[254:255], v246 offset:4256
v_mfma_f32_16x16x32_bf16 v[0:3], a[240:243], v[128:131], v[0:3]
s_lshl_b32 s53, s2, 2
v_exp_f32 v222, v222
v_mfma_f32_16x16x32_bf16 v[0:3], a[244:247], v[132:135], v[0:3]
s_add_u32 s53, s53, s48
ds_read_b128 a[224:227], v240 offset:21120
v_cvt_pk_bf16_f32 v158, v220, v221
v_mfma_f32_16x16x32_bf16 v[32:35], a[240:243], v[136:139], v[32:35]
s_mov_b32 s17, 4
v_exp_f32 v223, v223
v_mfma_f32_16x16x32_bf16 v[32:35], a[244:247], v[140:143], v[32:35]
s_mov_b32 s11, 77952
ds_read_b128 a[228:231], v241 offset:21120
v_cvt_pk_bf16_f32 v159, v222, v223
v_mfma_f32_16x16x32_bf16 v[204:207], a[208:211], a[16:19], 0
s_mov_b32 s62, 8
v_exp_f32 v200, v200
v_mfma_f32_16x16x32_bf16 v[204:207], a[212:215], a[20:23], v[204:207]
s_mov_b32 s63, 24
ds_read_b128 a[232:235], v240 offset:21632
v_lshl_add_u32 v248, v232, 4, v248
v_mfma_f32_16x16x32_bf16 v[204:207], a[216:219], a[24:27], v[204:207]
v_exp_f32 v201, v201
v_mfma_f32_16x16x32_bf16 v[204:207], a[220:223], a[28:31], v[204:207]
ds_read_b128 a[236:239], v241 offset:21632
v_cvt_pk_bf16_f32 v164, v200, v201
v_mfma_f32_16x16x32_bf16 v[64:67], a[240:243], v[144:147], v[64:67]
v_exp_f32 v202, v202
v_mfma_f32_16x16x32_bf16 v[64:67], a[244:247], v[148:151], v[64:67]
v_mul_u32_u24 v254, 12320, v233
v_lshl_add_u32 v231, v231, 6, v254
v_mfma_f32_16x16x32_bf16 a[160:163], a[240:243], v[160:163], a[160:163]
v_exp_f32_e64 v203, v203
v_mfma_f32_16x16x32_bf16 v[96:99], a[240:243], v[152:155], v[96:99]
v_cvt_pk_bf16_f32 v165, v202, v203
v_lshl_add_u32 v231, v234, 8, v231
v_mfma_f32_16x16x32_bf16 v[96:99], a[244:247], v[156:159], v[96:99]
ds_read_b64_tr_b16 a[240:241], v245 offset:0
v_lshl_add_u32 v231, v232, 3, v231
v_mfma_f32_16x16x32_bf16 v[208:211], a[208:211], a[32:35], 0
v_exp_f32 v204, v204
v_mfma_f32_16x16x32_bf16 v[208:211], a[212:215], a[36:39], v[208:211]
ds_read_b64_tr_b16 a[242:243], v245 offset:4224
ds_read_b64_tr_b16 a[244:245], v247 offset:0
v_mfma_f32_16x16x32_bf16 v[208:211], a[216:219], a[40:43], v[208:211]
v_exp_f32 v205, v205
v_mfma_f32_16x16x32_bf16 v[208:211], a[220:223], a[44:47], v[208:211]
s_waitcnt lgkmcnt(7)
ds_read_b64_tr_b16 a[246:247], v247 offset:4224
v_cvt_pk_bf16_f32 v172, v204, v205
v_mfma_f32_16x16x32_bf16 v[4:7], a[248:251], v[128:131], v[4:7]
v_exp_f32 v206, v206
v_mfma_f32_16x16x32_bf16 v[4:7], a[252:255], v[132:135], v[4:7]
v_bfe_u32 v232, v249, 4, 4
v_mul_u32_u24 v254, 400, v232
v_mfma_f32_16x16x32_bf16 v[36:39], a[248:251], v[136:139], v[36:39]
v_exp_f32 v207, v207
v_mfma_f32_16x16x32_bf16 v[36:39], a[252:255], v[140:143], v[36:39]
v_cvt_pk_bf16_f32 v173, v206, v207
v_lshl_add_u32 v230, v230, 3, v254
v_mfma_f32_16x16x32_bf16 v[212:215], a[208:211], a[48:51], 0
s_waitcnt vmcnt(0)
v_exp_f32 v208, v208
v_mfma_f32_16x16x32_bf16 v[212:215], a[212:215], a[52:55], v[212:215]
s_barrier
v_mfma_f32_16x16x32_bf16 v[212:215], a[216:219], a[56:59], v[212:215]
v_exp_f32 v209, v209
v_mfma_f32_16x16x32_bf16 v[212:215], a[220:223], a[60:63], v[212:215]
buffer_store_dword v228, off, s[40:43], s67 sc1
v_cvt_pk_bf16_f32 v180, v208, v209
v_mfma_f32_16x16x32_bf16 v[68:71], a[248:251], v[144:147], v[68:71]
v_exp_f32 v210, v210
v_mfma_f32_16x16x32_bf16 v[68:71], a[252:255], v[148:151], v[68:71]
v_cmp_gt_u32 vcc, 16, v255
v_mul_u32_u24 v254, 15, v234
v_mfma_f32_16x16x32_bf16 v[100:103], a[248:251], v[152:155], v[100:103]
v_exp_f32 v211, v211
v_mfma_f32_16x16x32_bf16 v[100:103], a[252:255], v[156:159], v[100:103]
v_cvt_pk_bf16_f32 v181, v210, v211
v_xor_b32 v232, v232, v254
v_mfma_f32_16x16x32_bf16 v[216:219], a[208:211], a[64:67], 0
s_cbranch_vccnz L_h_spin0
L_h_back0:
v_exp_f32 v212, v212
v_mfma_f32_16x16x32_bf16 v[216:219], a[212:215], a[68:71], v[216:219]
v_and_b32 v254, 14, v232
v_add_u32 v232, v232, v254
v_mfma_f32_16x16x32_bf16 v[216:219], a[216:219], a[72:75], v[216:219]
v_exp_f32 v213, v213
v_mfma_f32_16x16x32_bf16 v[216:219], a[220:223], a[76:79], v[216:219]
ds_read_b128 a[208:211], v242 offset:16896
v_cvt_pk_bf16_f32 v188, v212, v213
v_mfma_f32_16x16x32_bf16 a[164:167], a[248:251], v[160:163], a[164:167]
v_exp_f32 v214, v214
v_smfmac_f32_16x16x64_bf16 a[192:195], v[224:227], v[128:135], v228
s_waitcnt lgkmcnt(1)
ds_read_b64_tr_b16 a[248:249], v245 offset:32
ds_read_b64_tr_b16 a[250:251], v245 offset:4256
v_mfma_f32_16x16x32_bf16 v[8:11], a[240:243], v[128:131], v[8:11]
v_exp_f32 v215, v215
v_mfma_f32_16x16x32_bf16 v[8:11], a[244:247], v[132:135], v[8:11]
ds_read_b64_tr_b16 a[252:253], v247 offset:32
ds_read_b64_tr_b16 a[254:255], v247 offset:4256
v_mfma_f32_16x16x32_bf16 v[220:223], a[224:227], a[0:3], 0
v_exp_f32 v216, v216
v_mfma_f32_16x16x32_bf16 v[220:223], a[228:231], a[4:7], v[220:223]
ds_read_b128 a[212:215], v243 offset:16896
v_cvt_pk_bf16_f32 v189, v214, v215
v_mfma_f32_16x16x32_bf16 v[220:223], a[232:235], a[8:11], v[220:223]
v_exp_f32 v217, v217
v_mfma_f32_16x16x32_bf16 v[220:223], a[236:239], a[12:15], v[220:223]
ds_read_b128 a[216:219], v242 offset:17408
v_cvt_pk_bf16_f32 v196, v216, v217
v_mfma_f32_16x16x32_bf16 v[40:43], a[240:243], v[136:139], v[40:43]
v_exp_f32 v218, v218
v_mfma_f32_16x16x32_bf16 v[40:43], a[244:247], v[140:143], v[40:43]
ds_read_b128 a[220:223], v243 offset:17408
v_add_f32 v229, v229, v216
v_mfma_f32_16x16x32_bf16 v[72:75], a[240:243], v[144:147], v[72:75]
v_exp_f32 v219, v219
v_mfma_f32_16x16x32_bf16 v[72:75], a[244:247], v[148:151], v[72:75]
v_cvt_pk_bf16_f32 v197, v218, v219
v_add_f32 v229, v229, v217
v_mfma_f32_16x16x32_bf16 v[200:203], a[224:227], a[16:19], 0
v_exp_f32 v220, v220
v_mfma_f32_16x16x32_bf16 v[200:203], a[228:231], a[20:23], v[200:203]
v_add_f32 v229, v229, v218
v_add_f32 v229, v229, v219
v_mfma_f32_16x16x32_bf16 v[200:203], a[232:235], a[24:27], v[200:203]
v_exp_f32 v221, v221
v_mfma_f32_16x16x32_bf16 v[200:203], a[236:239], a[28:31], v[200:203]
v_cvt_pk_bf16_f32 v166, v220, v221
v_or_b32 v254, v233, v234
v_mfma_f32_16x16x32_bf16 v[104:107], a[240:243], v[152:155], v[104:107]
v_exp_f32 v222, v222
v_mfma_f32_16x16x32_bf16 v[104:107], a[244:247], v[156:159], v[104:107]
v_lshl_add_u32 v232, v254, 1, v232
v_and_b32 v254, v233, v234
v_mfma_f32_16x16x32_bf16 a[168:171], a[240:243], v[160:163], a[168:171]
s_waitcnt lgkmcnt(3)
v_exp_f32_e64 v223, v223
v_mfma_f32_16x16x32_bf16 v[12:15], a[248:251], v[128:131], v[12:15]
ds_read_b64_tr_b16 a[240:241], v244 offset:512
ds_read_b64_tr_b16 a[242:243], v244 offset:4736
v_mfma_f32_16x16x32_bf16 v[12:15], a[252:255], v[132:135], v[12:15]
ds_read_b64_tr_b16 a[244:245], v246 offset:512
v_cvt_pk_bf16_f32 v167, v222, v223
v_mfma_f32_16x16x32_bf16 v[204:207], a[224:227], a[32:35], 0
v_exp_f32 v200, v200
v_mfma_f32_16x16x32_bf16 v[204:207], a[228:231], a[36:39], v[204:207]
ds_read_b64_tr_b16 a[246:247], v246 offset:4736
v_lshl_add_u32 v232, v254, 6, v232
v_mfma_f32_16x16x32_bf16 v[204:207], a[232:235], a[40:43], v[204:207]
v_exp_f32 v201, v201
v_mfma_f32_16x16x32_bf16 v[204:207], a[236:239], a[44:47], v[204:207]
v_cvt_pk_bf16_f32 v174, v200, v201
v_lshl_add_u32 v232, v234, 5, v232
v_mfma_f32_16x16x32_bf16 v[44:47], a[248:251], v[136:139], v[44:47]
v_exp_f32 v202, v202
v_mfma_f32_16x16x32_bf16 v[44:47], a[252:255], v[140:143], v[44:47]
v_bfe_u32 v234, v249, 4, 3
v_mul_u32_u24 v254, s54, v233
v_mfma_f32_16x16x32_bf16 v[76:79], a[248:251], v[144:147], v[76:79]
v_exp_f32 v203, v203
v_mfma_f32_16x16x32_bf16 v[76:79], a[252:255], v[148:151], v[76:79]
v_cvt_pk_bf16_f32 v175, v202, v203
v_lshl_add_u32 v254, v234, 2, v254
v_mfma_f32_16x16x32_bf16 v[208:211], a[224:227], a[48:51], 0
s_xor_b32 s54, s53, 4
v_exp_f32 v204, v204
v_mfma_f32_16x16x32_bf16 v[208:211], a[228:231], a[52:55], v[208:211]
v_add_u32 v241, s5, v231
v_mov_b32 v240, v249
v_mfma_f32_16x16x32_bf16 v[208:211], a[232:235], a[56:59], v[208:211]
v_exp_f32 v205, v205
v_mfma_f32_16x16x32_bf16 v[208:211], a[236:239], a[60:63], v[208:211]
v_cvt_pk_bf16_f32 v182, v204, v205
v_mfma_f32_16x16x32_bf16 v[108:111], a[248:251], v[152:155], v[108:111]
v_exp_f32 v206, v206
v_mfma_f32_16x16x32_bf16 v[108:111], a[252:255], v[156:159], v[108:111]
v_mfma_f32_16x16x32_bf16 a[172:175], a[248:251], v[160:163], a[172:175]
v_exp_f32 v207, v207
v_smfmac_f32_16x16x64_bf16 a[196:199], v[224:227], v[136:143], v228
ds_read_b64_tr_b16 a[248:249], v244 offset:544
ds_read_b64_tr_b16 a[250:251], v244 offset:4768
v_mfma_f32_16x16x32_bf16 v[212:215], a[224:227], a[64:67], 0
v_exp_f32 v208, v208
v_mfma_f32_16x16x32_bf16 v[212:215], a[228:231], a[68:71], v[212:215]
ds_read_b64_tr_b16 a[252:253], v246 offset:544
ds_read_b64_tr_b16 a[254:255], v246 offset:4768
v_mfma_f32_16x16x32_bf16 v[212:215], a[232:235], a[72:75], v[212:215]
v_exp_f32 v209, v209
v_mfma_f32_16x16x32_bf16 v[212:215], a[236:239], a[76:79], v[212:215]
s_waitcnt lgkmcnt(4)
ds_read_b128 a[224:227], v242 offset:21120
v_cvt_pk_bf16_f32 v183, v206, v207
v_mfma_f32_16x16x32_bf16 v[16:19], a[240:243], v[128:131], v[16:19]
v_exp_f32 v210, v210
v_mfma_f32_16x16x32_bf16 v[16:19], a[244:247], v[132:135], v[16:19]
ds_read_b128 a[228:231], v243 offset:21120
v_cvt_pk_bf16_f32 v190, v208, v209
v_mfma_f32_16x16x32_bf16 v[48:51], a[240:243], v[136:139], v[48:51]
v_exp_f32 v211, v211
v_mfma_f32_16x16x32_bf16 v[48:51], a[244:247], v[140:143], v[48:51]
ds_read_b128 a[232:235], v242 offset:21632
v_cvt_pk_bf16_f32 v191, v210, v211
v_mfma_f32_16x16x32_bf16 v[216:219], a[208:211], a[0:3], 0
v_exp_f32 v212, v212
v_mfma_f32_16x16x32_bf16 v[216:219], a[212:215], a[4:7], v[216:219]
ds_read_b128 a[236:239], v243 offset:21632
v_add_f32 v229, v229, v212
v_mfma_f32_16x16x32_bf16 v[216:219], a[216:219], a[8:11], v[216:219]
v_exp_f32 v213, v213
v_mfma_f32_16x16x32_bf16 v[216:219], a[220:223], a[12:15], v[216:219]
v_cvt_pk_bf16_f32 v198, v212, v213
v_add_f32 v229, v229, v213
v_mfma_f32_16x16x32_bf16 v[80:83], a[240:243], v[144:147], v[80:83]
v_exp_f32 v214, v214
v_mfma_f32_16x16x32_bf16 v[80:83], a[244:247], v[148:151], v[80:83]
v_add_f32 v229, v229, v214
v_add_u32 v242, s8, v230
v_mfma_f32_16x16x32_bf16 v[112:115], a[240:243], v[152:155], v[112:115]
v_exp_f32 v215, v215
v_mfma_f32_16x16x32_bf16 v[112:115], a[244:247], v[156:159], v[112:115]
v_cvt_pk_bf16_f32 v199, v214, v215
v_add_f32 v229, v229, v215
v_mfma_f32_16x16x32_bf16 v[220:223], a[208:211], a[16:19], 0
v_exp_f32 v216, v216
v_mfma_f32_16x16x32_bf16 v[220:223], a[212:215], a[20:23], v[220:223]
v_xor_b32 v243, s16, v232
s_nop 0
v_readlane_b32 s16, v243, 0
v_mfma_f32_16x16x32_bf16 v[220:223], a[216:219], a[24:27], v[220:223]
s_add_u32 s8, s9, 0
v_exp_f32 v217, v217
v_mfma_f32_16x16x32_bf16 v[220:223], a[220:223], a[28:31], v[220:223]
s_mul_i32 s5, s16, 294912
s_mul_i32 s16, s16, 73728
v_cvt_pk_bf16_f32 v168, v216, v217
v_mfma_f32_16x16x32_bf16 a[176:179], a[240:243], v[160:163], a[176:179]
s_waitcnt lgkmcnt(4)
v_exp_f32 v218, v218
v_mfma_f32_16x16x32_bf16 v[20:23], a[248:251], v[128:131], v[20:23]
s_add_u32 s52, s16, s18
ds_read_b64_tr_b16 a[240:241], v245 offset:512
ds_read_b64_tr_b16 a[242:243], v245 offset:4736
v_mfma_f32_16x16x32_bf16 v[20:23], a[252:255], v[132:135], v[20:23]
v_exp_f32_e64 v219, v219
v_mfma_f32_16x16x32_bf16 v[52:55], a[248:251], v[136:139], v[52:55]
ds_read_b64_tr_b16 a[244:245], v247 offset:512
ds_read_b64_tr_b16 a[246:247], v247 offset:4736
v_mfma_f32_16x16x32_bf16 v[52:55], a[252:255], v[140:143], v[52:55]
v_cvt_pk_bf16_f32 v169, v218, v219
v_mfma_f32_16x16x32_bf16 v[200:203], a[208:211], a[32:35], 0
v_exp_f32 v220, v220
v_mfma_f32_16x16x32_bf16 v[200:203], a[212:215], a[36:39], v[200:203]
buffer_load_dword v255, v254, s[40:43], s69 offen sc1
v_mfma_f32_16x16x32_bf16 v[200:203], a[216:219], a[40:43], v[200:203]
v_exp_f32 v221, v221
v_mfma_f32_16x16x32_bf16 v[200:203], a[220:223], a[44:47], v[200:203]
v_cvt_pk_bf16_f32 v176, v220, v221
v_mfma_f32_16x16x32_bf16 v[84:87], a[248:251], v[144:147], v[84:87]
v_exp_f32 v222, v222
v_mfma_f32_16x16x32_bf16 v[84:87], a[252:255], v[148:151], v[84:87]
v_mfma_f32_16x16x32_bf16 v[116:119], a[248:251], v[152:155], v[116:119]
v_exp_f32 v223, v223
v_mfma_f32_16x16x32_bf16 v[116:119], a[252:255], v[156:159], v[116:119]
v_cvt_pk_bf16_f32 v177, v222, v223
v_mfma_f32_16x16x32_bf16 v[204:207], a[208:211], a[48:51], 0
v_exp_f32 v200, v200
v_mfma_f32_16x16x32_bf16 v[204:207], a[212:215], a[52:55], v[204:207]
v_mfma_f32_16x16x32_bf16 v[204:207], a[216:219], a[56:59], v[204:207]
v_exp_f32 v201, v201
v_mfma_f32_16x16x32_bf16 v[204:207], a[220:223], a[60:63], v[204:207]
v_cvt_pk_bf16_f32 v184, v200, v201
v_mfma_f32_16x16x32_bf16 a[180:183], a[248:251], v[160:163], a[180:183]
v_exp_f32 v202, v202
v_smfmac_f32_16x16x64_bf16 a[200:203], v[224:227], v[144:151], v228
s_waitcnt lgkmcnt(0)
ds_read_b64_tr_b16 a[248:249], v245 offset:544
ds_read_b64_tr_b16 a[250:251], v245 offset:4768
v_mfma_f32_16x16x32_bf16 v[24:27], a[240:243], v[128:131], v[24:27]
v_exp_f32 v203, v203
v_mfma_f32_16x16x32_bf16 v[24:27], a[244:247], v[132:135], v[24:27]
ds_read_b64_tr_b16 a[252:253], v247 offset:544
ds_read_b64_tr_b16 a[254:255], v247 offset:4768
v_mfma_f32_16x16x32_bf16 v[208:211], a[224:227], a[0:3], 0
v_exp_f32 v204, v204
v_mfma_f32_16x16x32_bf16 v[208:211], a[228:231], a[4:7], v[208:211]
v_cvt_pk_bf16_f32 v185, v202, v203
v_mfma_f32_16x16x32_bf16 v[208:211], a[232:235], a[8:11], v[208:211]
v_exp_f32 v205, v205
v_mfma_f32_16x16x32_bf16 v[208:211], a[236:239], a[12:15], v[208:211]
s_barrier
v_mfma_f32_16x16x32_bf16 v[56:59], a[240:243], v[136:139], v[56:59]
s_add_u32 m0, s8, s7
v_exp_f32 v206, v206
v_mfma_f32_16x16x32_bf16 v[56:59], a[244:247], v[140:143], v[56:59]
s_add_u32 s51, s52, 2048
v_cvt_pk_bf16_f32 v192, v204, v205
v_mfma_f32_16x16x32_bf16 v[88:91], a[240:243], v[144:147], v[88:91]
v_exp_f32 v207, v207
v_mfma_f32_16x16x32_bf16 v[88:91], a[244:247], v[148:151], v[88:91]
buffer_load_dwordx4 v248, s[28:31], s51 offen offset:0 lds
v_cvt_pk_bf16_f32 v193, v206, v207
v_mfma_f32_16x16x32_bf16 v[212:215], a[224:227], a[16:19], 0
s_add_u32 s51, s52, 1152
v_exp_f32 v208, v208
v_mfma_f32_16x16x32_bf16 v[212:215], a[228:231], a[20:23], v[212:215]
buffer_load_dwordx4 v248, s[28:31], s51 offen offset:1024 lds
v_mfma_f32_16x16x32_bf16 v[212:215], a[232:235], a[24:27], v[212:215]
s_add_u32 s51, s52, 256
v_exp_f32 v209, v209
v_mfma_f32_16x16x32_bf16 v[212:215], a[236:239], a[28:31], v[212:215]
buffer_load_dwordx4 v248, s[28:31], s51 offen offset:2048 lds
v_cvt_pk_bf16_f32 v170, v208, v209
v_mfma_f32_16x16x32_bf16 v[120:123], a[240:243], v[152:155], v[120:123]
s_add_u32 m0, m0, 3072
v_exp_f32 v210, v210
v_mfma_f32_16x16x32_bf16 v[120:123], a[244:247], v[156:159], v[120:123]
s_add_u32 s51, s52, 20480
v_mfma_f32_16x16x32_bf16 a[184:187], a[240:243], v[160:163], a[184:187]
v_exp_f32 v211, v211
v_smfmac_f32_16x16x64_bf16 a[204:207], v[224:227], v[152:159], v228
ds_read_b64_tr_b16 a[240:241], v244 offset:16896
ds_read_b64_tr_b16 a[242:243], v244 offset:21120
v_mfma_f32_16x16x32_bf16 v[216:219], a[224:227], a[32:35], 0
v_exp_f32 v212, v212
v_mfma_f32_16x16x32_bf16 v[216:219], a[228:231], a[36:39], v[216:219]
ds_read_b64_tr_b16 a[244:245], v246 offset:16896
ds_read_b64_tr_b16 a[246:247], v246 offset:21120
v_mfma_f32_16x16x32_bf16 v[216:219], a[232:235], a[40:43], v[216:219]
v_exp_f32 v213, v213
v_mfma_f32_16x16x32_bf16 v[216:219], a[236:239], a[44:47], v[216:219]
s_waitcnt lgkmcnt(4)
v_cvt_pk_bf16_f32 v171, v210, v211
v_cvt_pk_bf16_f32 v178, v212, v213
v_mfma_f32_16x16x32_bf16 v[28:31], a[248:251], v[128:131], v[28:31]
v_exp_f32 v214, v214
v_mfma_f32_16x16x32_bf16 v[28:31], a[252:255], v[132:135], v[28:31]
buffer_load_dwordx4 v248, s[28:31], s51 offen offset:0 lds
v_mfma_f32_16x16x32_bf16 v[60:63], a[248:251], v[136:139], v[60:63]
s_add_u32 s51, s52, 19584
v_exp_f32 v215, v215
v_mfma_f32_16x16x32_bf16 v[60:63], a[252:255], v[140:143], v[60:63]
buffer_load_dwordx4 v248, s[28:31], s51 offen offset:1024 lds
v_cvt_pk_bf16_f32 v179, v214, v215
v_mfma_f32_16x16x32_bf16 v[220:223], a[224:227], a[48:51], 0
s_add_u32 s51, s52, 18688
v_exp_f32 v216, v216
v_mfma_f32_16x16x32_bf16 v[220:223], a[228:231], a[52:55], v[220:223]
buffer_load_dwordx4 v248, s[28:31], s51 offen offset:2048 lds
v_mfma_f32_16x16x32_bf16 v[220:223], a[232:235], a[56:59], v[220:223]
v_exp_f32 v217, v217
v_mfma_f32_16x16x32_bf16 v[220:223], a[236:239], a[60:63], v[220:223]
v_cvt_pk_bf16_f32 v186, v216, v217
v_mfma_f32_16x16x32_bf16 v[92:95], a[248:251], v[144:147], v[92:95]
v_exp_f32 v218, v218
v_mfma_f32_16x16x32_bf16 v[92:95], a[252:255], v[148:151], v[92:95]
v_mfma_f32_16x16x32_bf16 v[124:127], a[248:251], v[152:155], v[124:127]
v_exp_f32 v219, v219
v_mfma_f32_16x16x32_bf16 v[124:127], a[252:255], v[156:159], v[124:127]
v_cvt_pk_bf16_f32 v187, v218, v219
v_mfma_f32_16x16x32_bf16 a[188:191], a[248:251], v[160:163], a[188:191]
s_waitcnt vmcnt(6)
v_cmp_eq_u32 vcc, 0, v255
s_nop 4
s_cbranch_vccnz L_h_spin1
L_h_back1:
s_waitcnt lgkmcnt(2)
v_mfma_f32_16x16x32_bf16 v[0:3], a[240:243], v[164:167], v[0:3]
s_waitcnt lgkmcnt(0)
s_mov_b32 m0, s8
v_exp_f32 v220, v220
v_mfma_f32_16x16x32_bf16 v[0:3], a[244:247], v[168:171], v[0:3]
s_add_u32 s51, s5, s56
v_exp_f32 v221, v221
v_mfma_f32_16x16x32_bf16 v[32:35], a[240:243], v[172:175], v[32:35]
v_exp_f32 v222, v222
v_mfma_f32_16x16x32_bf16 v[32:35], a[244:247], v[176:179], v[32:35]
v_exp_f32 v223, v223
v_mfma_f32_16x16x32_bf16 v[64:67], a[240:243], v[180:183], v[64:67]
ds_read_b64_tr_b16 a[248:249], v244 offset:16928
v_cvt_pk_bf16_f32 v194, v220, v221
v_mfma_f32_16x16x32_bf16 v[64:67], a[244:247], v[184:187], v[64:67]
ds_read_b64_tr_b16 a[250:251], v244 offset:21152
v_cvt_pk_bf16_f32 v195, v222, v223
v_mfma_f32_16x16x32_bf16 a[160:163], a[240:243], v[196:199], a[160:163]
ds_read_b64_tr_b16 a[252:253], v246 offset:16928
buffer_load_dwordx4 v249, s[32:35], s51 offen offset:0 sc1 lds
v_mfma_f32_16x16x32_bf16 v[96:99], a[240:243], v[188:191], v[96:99]
s_add_u32 s51, s5, s57
ds_read_b64_tr_b16 a[254:255], v246 offset:21152
v_mfma_f32_16x16x32_bf16 v[96:99], a[244:247], v[192:195], v[96:99]
ds_read_b64_tr_b16 a[240:241], v245 offset:16896
buffer_load_dwordx4 v249, s[32:35], s51 offen offset:1024 sc1 lds
v_smfmac_f32_16x16x64_bf16 a[192:195], v[224:227], v[164:171], v228
s_add_u32 s51, s5, s58
ds_read_b64_tr_b16 a[242:243], v245 offset:21120
v_smfmac_f32_16x16x64_bf16 a[196:199], v[224:227], v[172:179], v228
ds_read_b64_tr_b16 a[244:245], v247 offset:16896
buffer_load_dwordx4 v249, s[32:35], s51 offen offset:2048 sc1 lds
v_smfmac_f32_16x16x64_bf16 a[200:203], v[224:227], v[180:187], v228
s_add_u32 m0, s8, s14
ds_read_b64_tr_b16 a[246:247], v247 offset:21120
v_smfmac_f32_16x16x64_bf16 a[204:207], v[224:227], v[188:195], v228
s_waitcnt lgkmcnt(4)
v_mfma_f32_16x16x32_bf16 v[4:7], a[248:251], v[164:167], v[4:7]
s_barrier
v_mfma_f32_16x16x32_bf16 v[4:7], a[252:255], v[168:171], v[4:7]
s_add_u32 s51, s5, s59
v_mfma_f32_16x16x32_bf16 v[36:39], a[248:251], v[172:175], v[36:39]
s_mov_b32 exec_hi, 0
buffer_load_dwordx4 v249, s[32:35], s51 offen sc1 lds
s_mov_b32 exec_hi, -1
v_mfma_f32_16x16x32_bf16 v[36:39], a[252:255], v[176:179], v[36:39]
v_readlane_b32 s16, v243, 1
v_mfma_f32_16x16x32_bf16 v[68:71], a[248:251], v[180:183], v[68:71]
s_add_u32 s8, s9, 38976
v_mfma_f32_16x16x32_bf16 v[68:71], a[252:255], v[184:187], v[68:71]
s_mul_i32 s5, s16, 294912
v_mfma_f32_16x16x32_bf16 v[100:103], a[248:251], v[188:191], v[100:103]
s_mul_i32 s16, s16, 73728
v_mfma_f32_16x16x32_bf16 v[100:103], a[252:255], v[192:195], v[100:103]
s_add_u32 s52, s16, s18
v_accvgpr_read_b32 v200, a192
v_accvgpr_read_b32 v201, a193
v_mfma_f32_16x16x32_bf16 a[164:167], a[248:251], v[196:199], a[164:167]
s_waitcnt lgkmcnt(0)
ds_read_b64_tr_b16 a[248:249], v245 offset:16928
v_accvgpr_read_b32 v202, a196
v_mfma_f32_16x16x32_bf16 v[8:11], a[240:243], v[164:167], v[8:11]
s_mov_b32 m0, s8
ds_read_b64_tr_b16 a[250:251], v245 offset:21152
v_accvgpr_read_b32 v203, a197
v_mfma_f32_16x16x32_bf16 v[8:11], a[244:247], v[168:171], v[8:11]
s_add_u32 s51, s5, s56
ds_read_b64_tr_b16 a[252:253], v247 offset:16928
v_accvgpr_read_b32 v204, a200
v_mfma_f32_16x16x32_bf16 v[40:43], a[240:243], v[172:175], v[40:43]
ds_read_b64_tr_b16 a[254:255], v247 offset:21152
buffer_load_dwordx4 v249, s[32:35], s51 offen offset:0 sc1 lds
v_mfma_f32_16x16x32_bf16 v[40:43], a[244:247], v[176:179], v[40:43]
s_add_u32 s51, s5, s57
v_accvgpr_read_b32 v205, a201
v_accvgpr_read_b32 v206, a204
v_mfma_f32_16x16x32_bf16 v[72:75], a[240:243], v[180:183], v[72:75]
buffer_load_dwordx4 v249, s[32:35], s51 offen offset:1024 sc1 lds
v_accvgpr_read_b32 v207, a205
v_mfma_f32_16x16x32_bf16 v[72:75], a[244:247], v[184:187], v[72:75]
s_add_u32 s51, s5, s58
v_add_f32 v200, v200, v201
v_add_f32 v202, v202, v203
v_mfma_f32_16x16x32_bf16 v[104:107], a[240:243], v[188:191], v[104:107]
buffer_load_dwordx4 v249, s[32:35], s51 offen offset:2048 sc1 lds
v_add_f32 v204, v204, v205
v_mfma_f32_16x16x32_bf16 v[104:107], a[244:247], v[192:195], v[104:107]
s_add_u32 m0, s8, s14
v_add_f32 v206, v206, v207
v_mfma_f32_16x16x32_bf16 a[168:171], a[240:243], v[196:199], a[168:171]
s_waitcnt lgkmcnt(0)
ds_read_b64_tr_b16 a[240:241], v244 offset:17408
v_mfma_f32_16x16x32_bf16 v[12:15], a[248:251], v[164:167], v[12:15]
s_add_u32 s51, s5, s59
ds_read_b64_tr_b16 a[242:243], v244 offset:21632
v_mfma_f32_16x16x32_bf16 v[12:15], a[252:255], v[168:171], v[12:15]
ds_read_b64_tr_b16 a[244:245], v246 offset:17408
v_mfma_f32_16x16x32_bf16 v[44:47], a[248:251], v[172:175], v[44:47]
ds_read_b64_tr_b16 a[246:247], v246 offset:21632
v_mfma_f32_16x16x32_bf16 v[44:47], a[252:255], v[176:179], v[44:47]
s_mov_b32 exec_hi, 0
buffer_load_dwordx4 v249, s[32:35], s51 offen sc1 lds
s_mov_b32 exec_hi, -1
v_mfma_f32_16x16x32_bf16 v[76:79], a[248:251], v[180:183], v[76:79]
s_add_u32 m0, s8, s7
v_rcp_f32 v230, v200
v_mfma_f32_16x16x32_bf16 v[76:79], a[252:255], v[184:187], v[76:79]
s_add_u32 s51, s52, 2048
v_rcp_f32 v231, v202
v_mfma_f32_16x16x32_bf16 v[108:111], a[248:251], v[188:191], v[108:111]
buffer_load_dwordx4 v248, s[28:31], s51 offen offset:0 lds
v_mfma_f32_16x16x32_bf16 v[108:111], a[252:255], v[192:195], v[108:111]
s_add_u32 s51, s52, 1152
v_rcp_f32 v232, v204
v_mfma_f32_16x16x32_bf16 a[172:175], a[248:251], v[196:199], a[172:175]
s_waitcnt lgkmcnt(0)
ds_read_b64_tr_b16 a[248:249], v244 offset:17440
buffer_load_dwordx4 v248, s[28:31], s51 offen offset:1024 lds
v_mfma_f32_16x16x32_bf16 v[16:19], a[240:243], v[164:167], v[16:19]
s_add_u32 s51, s52, 256
ds_read_b64_tr_b16 a[250:251], v244 offset:21664
v_mfma_f32_16x16x32_bf16 v[16:19], a[244:247], v[168:171], v[16:19]
ds_read_b64_tr_b16 a[252:253], v246 offset:17440
buffer_load_dwordx4 v248, s[28:31], s51 offen offset:2048 lds
v_mfma_f32_16x16x32_bf16 v[48:51], a[240:243], v[172:175], v[48:51]
s_add_u32 m0, m0, 3072
ds_read_b64_tr_b16 a[254:255], v246 offset:21664
v_mfma_f32_16x16x32_bf16 v[48:51], a[244:247], v[176:179], v[48:51]
s_add_u32 s51, s52, 20480
v_rcp_f32_e64 v233, v206
v_mfma_f32_16x16x32_bf16 v[80:83], a[240:243], v[180:183], v[80:83]
buffer_load_dwordx4 v248, s[28:31], s51 offen offset:0 lds
v_min3_u32 v201, v200, v202, v204
v_mfma_f32_16x16x32_bf16 v[80:83], a[244:247], v[184:187], v[80:83]
s_add_u32 s51, s52, 19584
v_max3_u32 v203, v200, v202, v204
v_min_u32 v201, v201, v206
v_mfma_f32_16x16x32_bf16 v[112:115], a[240:243], v[188:191], v[112:115]
buffer_load_dwordx4 v248, s[28:31], s51 offen offset:1024 lds
v_max_u32 v203, v203, v206
v_mfma_f32_16x16x32_bf16 v[112:115], a[244:247], v[192:195], v[112:115]
s_add_u32 s51, s52, 18688
v_cmp_gt_u32 s[72:73], s74, v201
v_cmp_lt_u32 vcc, s75, v203
v_mfma_f32_16x16x32_bf16 a[176:179], a[240:243], v[196:199], a[176:179]
s_waitcnt lgkmcnt(0)
ds_read_b64_tr_b16 a[240:241], v245 offset:17408
buffer_load_dwordx4 v248, s[28:31], s51 offen offset:2048 lds
v_mfma_f32_16x16x32_bf16 v[20:23], a[248:251], v[164:167], v[20:23]
s_lshl_b32 s50, s48, 2
ds_read_b64_tr_b16 a[242:243], v245 offset:21632
v_readlane_b32 s16, v243, 2
v_mfma_f32_16x16x32_bf16 v[20:23], a[252:255], v[168:171], v[20:23]
s_add_u32 s8, s9, 77952
s_add_u32 s50, s50, 152576
ds_read_b64_tr_b16 a[244:245], v247 offset:17408
v_mfma_f32_16x16x32_bf16 v[52:55], a[248:251], v[172:175], v[52:55]
s_mul_i32 s5, s16, 294912
s_or_b64 s[72:73], s[72:73], vcc
ds_read_b64_tr_b16 a[246:247], v247 offset:21632
v_mfma_f32_16x16x32_bf16 v[52:55], a[252:255], v[176:179], v[52:55]
s_mul_i32 s16, s16, 73728
s_or_b32 s72, s72, s73
v_mov_b32 v201, s50
v_mfma_f32_16x16x32_bf16 v[84:87], a[248:251], v[180:183], v[84:87]
s_add_u32 s52, s16, s18
v_mov_b32 v200, s72
v_mul_f32 v0, v230, v0
v_mfma_f32_16x16x32_bf16 v[84:87], a[252:255], v[184:187], v[84:87]
s_mov_b32 m0, s8
v_mul_f32 v1, v230, v1
v_mul_f32 v2, v230, v2
v_mfma_f32_16x16x32_bf16 v[116:119], a[248:251], v[188:191], v[116:119]
s_add_u32 s51, s5, s56
v_mul_f32 v3, v230, v3
v_mul_f32 v4, v230, v4
v_mfma_f32_16x16x32_bf16 v[116:119], a[252:255], v[192:195], v[116:119]
buffer_load_dwordx4 v249, s[32:35], s51 offen offset:0 sc1 lds
v_mul_f32 v5, v230, v5
v_mfma_f32_16x16x32_bf16 a[180:183], a[248:251], v[196:199], a[180:183]
s_waitcnt lgkmcnt(0)
ds_read_b64_tr_b16 a[248:249], v245 offset:17440
v_mul_f32 v6, v230, v6
v_mfma_f32_16x16x32_bf16 v[24:27], a[240:243], v[164:167], v[24:27]
s_add_u32 s51, s5, s57
ds_read_b64_tr_b16 a[250:251], v245 offset:21664
v_mul_f32 v7, v230, v7
v_mfma_f32_16x16x32_bf16 v[24:27], a[244:247], v[168:171], v[24:27]
s_add_u32 s50, s64, 0
ds_read_b64_tr_b16 a[252:253], v247 offset:17440
buffer_load_dwordx4 v249, s[32:35], s51 offen offset:1024 sc1 lds
v_mfma_f32_16x16x32_bf16 v[56:59], a[240:243], v[172:175], v[56:59]
s_add_u32 s51, s5, s58
ds_read_b64_tr_b16 a[254:255], v247 offset:21664
v_cvt_pk_bf16_f32 v0, v0, v1
v_mfma_f32_16x16x32_bf16 v[56:59], a[244:247], v[176:179], v[56:59]
buffer_load_dwordx4 v249, s[32:35], s51 offen offset:2048 sc1 lds
v_cvt_pk_bf16_f32 v1, v2, v3
v_mfma_f32_16x16x32_bf16 v[88:91], a[240:243], v[180:183], v[88:91]
s_add_u32 m0, s8, s14
v_cvt_pk_bf16_f32 v2, v4, v5
v_cvt_pk_bf16_f32 v3, v6, v7
v_mfma_f32_16x16x32_bf16 v[88:91], a[244:247], v[184:187], v[88:91]
s_add_u32 s51, s5, s59
v_mfma_f32_16x16x32_bf16 v[120:123], a[240:243], v[188:191], v[120:123]
s_mov_b32 exec_hi, 0
buffer_load_dwordx4 v249, s[32:35], s51 offen sc1 lds
s_mov_b32 exec_hi, -1
v_mfma_f32_16x16x32_bf16 v[120:123], a[244:247], v[192:195], v[120:123]
s_add_u32 m0, s8, s7
v_mfma_f32_16x16x32_bf16 a[184:187], a[240:243], v[196:199], a[184:187]
s_waitcnt lgkmcnt(0)
buffer_store_dwordx4 v[0:3], v249, s[44:47], s50 offen offset:0 sc1
v_mfma_f32_16x16x32_bf16 v[28:31], a[248:251], v[164:167], v[28:31]
s_add_u32 s51, s52, 2048
v_mul_f32 v32, v231, v32
v_mul_f32 v33, v231, v33
v_mfma_f32_16x16x32_bf16 v[28:31], a[252:255], v[168:171], v[28:31]
buffer_load_dwordx4 v248, s[28:31], s51 offen offset:0 lds
v_mul_f32 v34, v231, v34
v_mfma_f32_16x16x32_bf16 v[60:63], a[248:251], v[172:175], v[60:63]
s_add_u32 s51, s52, 1152
v_mul_f32 v35, v231, v35
v_mul_f32 v36, v231, v36
v_mfma_f32_16x16x32_bf16 v[60:63], a[252:255], v[176:179], v[60:63]
buffer_load_dwordx4 v248, s[28:31], s51 offen offset:1024 lds
v_mul_f32 v37, v231, v37
v_mfma_f32_16x16x32_bf16 v[92:95], a[248:251], v[180:183], v[92:95]
v_mul_f32 v38, v231, v38
v_mul_f32 v39, v231, v39
v_mfma_f32_16x16x32_bf16 v[92:95], a[252:255], v[184:187], v[92:95]
s_add_u32 s50, s64, 2048
v_cvt_pk_bf16_f32 v32, v32, v33
v_cvt_pk_bf16_f32 v33, v34, v35
v_mfma_f32_16x16x32_bf16 v[124:127], a[248:251], v[188:191], v[124:127]
v_cvt_pk_bf16_f32 v34, v36, v37
v_cvt_pk_bf16_f32 v35, v38, v39
v_mfma_f32_16x16x32_bf16 v[124:127], a[252:255], v[192:195], v[124:127]
buffer_store_dwordx4 v[32:35], v249, s[44:47], s50 offen offset:0 sc1
v_mfma_f32_16x16x32_bf16 a[188:191], a[248:251], v[196:199], a[188:191]
v_mul_f32 v64, v232, v64
v_mul_f32 v65, v232, v65
s_add_u32 s51, s52, 256
v_pk_mul_f32 v[66:67], v[66:67], v[232:233] op_sel:[0,0] op_sel_hi:[1,0]
v_pk_mul_f32 v[68:69], v[68:69], v[232:233] op_sel:[0,0] op_sel_hi:[1,0]
v_pk_mul_f32 v[70:71], v[70:71], v[232:233] op_sel:[0,0] op_sel_hi:[1,0]
s_add_u32 s50, s64, 4096
v_cvt_pk_bf16_f32 v64, v64, v65
v_cvt_pk_bf16_f32 v65, v66, v67
buffer_load_dwordx4 v248, s[28:31], s51 offen offset:2048 lds
s_add_u32 m0, m0, 3072
s_add_u32 s51, s52, 20480
v_cvt_pk_bf16_f32 v66, v68, v69
v_cvt_pk_bf16_f32 v67, v70, v71
buffer_store_dwordx4 v[64:67], v249, s[44:47], s50 offen offset:0 sc1
v_pk_mul_f32 v[96:97], v[96:97], v[232:233] op_sel:[0,1] op_sel_hi:[1,1]
v_pk_mul_f32 v[98:99], v[98:99], v[232:233] op_sel:[0,1] op_sel_hi:[1,1]
v_pk_mul_f32 v[100:101], v[100:101], v[232:233] op_sel:[0,1] op_sel_hi:[1,1]
buffer_load_dwordx4 v248, s[28:31], s51 offen offset:0 lds
s_add_u32 s51, s52, 19584
v_pk_mul_f32 v[102:103], v[102:103], v[232:233] op_sel:[0,1] op_sel_hi:[1,1]
s_add_u32 s50, s64, 6144
v_cvt_pk_bf16_f32 v96, v96, v97
v_cvt_pk_bf16_f32 v97, v98, v99
v_cvt_pk_bf16_f32 v98, v100, v101
v_cvt_pk_bf16_f32 v99, v102, v103
buffer_load_dwordx4 v248, s[28:31], s51 offen offset:1024 lds
s_add_u32 s51, s52, 18688
buffer_store_dwordx4 v[96:99], v249, s[44:47], s50 offen offset:0 sc1
v_pk_mul_f32 v[8:9], v[8:9], v[230:231] op_sel:[0,0] op_sel_hi:[1,0]
v_pk_mul_f32 v[10:11], v[10:11], v[230:231] op_sel:[0,0] op_sel_hi:[1,0]
v_pk_mul_f32 v[12:13], v[12:13], v[230:231] op_sel:[0,0] op_sel_hi:[1,0]
v_pk_mul_f32 v[14:15], v[14:15], v[230:231] op_sel:[0,0] op_sel_hi:[1,0]
s_add_u32 s50, s65, 0
s_nop 0
buffer_load_dwordx4 v248, s[28:31], s51 offen offset:2048 lds
v_cvt_pk_bf16_f32 v8, v8, v9
v_cvt_pk_bf16_f32 v9, v10, v11
v_cvt_pk_bf16_f32 v10, v12, v13
v_cvt_pk_bf16_f32 v11, v14, v15
buffer_store_dwordx4 v[8:11], v249, s[44:47], s50 offen offset:0 sc1
v_pk_mul_f32 v[40:41], v[40:41], v[230:231] op_sel:[0,1] op_sel_hi:[1,1]
v_pk_mul_f32 v[42:43], v[42:43], v[230:231] op_sel:[0,1] op_sel_hi:[1,1]
v_pk_mul_f32 v[44:45], v[44:45], v[230:231] op_sel:[0,1] op_sel_hi:[1,1]
v_pk_mul_f32 v[46:47], v[46:47], v[230:231] op_sel:[0,1] op_sel_hi:[1,1]
s_add_u32 s50, s65, 2048
v_cvt_pk_bf16_f32 v40, v40, v41
v_cvt_pk_bf16_f32 v41, v42, v43
v_cvt_pk_bf16_f32 v42, v44, v45
v_cvt_pk_bf16_f32 v43, v46, v47
buffer_store_dwordx4 v[40:43], v249, s[44:47], s50 offen offset:0 sc1
v_pk_mul_f32 v[72:73], v[72:73], v[232:233] op_sel:[0,0] op_sel_hi:[1,0]
v_pk_mul_f32 v[74:75], v[74:75], v[232:233] op_sel:[0,0] op_sel_hi:[1,0]
v_pk_mul_f32 v[76:77], v[76:77], v[232:233] op_sel:[0,0] op_sel_hi:[1,0]
v_pk_mul_f32 v[78:79], v[78:79], v[232:233] op_sel:[0,0] op_sel_hi:[1,0]
s_add_u32 s50, s65, 4096
v_cvt_pk_bf16_f32 v72, v72, v73
v_cvt_pk_bf16_f32 v73, v74, v75
v_cvt_pk_bf16_f32 v74, v76, v77
v_cvt_pk_bf16_f32 v75, v78, v79
buffer_store_dwordx4 v[72:75], v249, s[44:47], s50 offen offset:0 sc1
v_pk_mul_f32 v[104:105], v[104:105], v[232:233] op_sel:[0,1] op_sel_hi:[1,1]
v_pk_mul_f32 v[106:107], v[106:107], v[232:233] op_sel:[0,1] op_sel_hi:[1,1]
v_pk_mul_f32 v[108:109], v[108:109], v[232:233] op_sel:[0,1] op_sel_hi:[1,1]
v_pk_mul_f32 v[110:111], v[110:111], v[232:233] op_sel:[0,1] op_sel_hi:[1,1]
s_add_u32 s50, s65, 6144
v_cvt_pk_bf16_f32 v104, v104, v105
v_cvt_pk_bf16_f32 v105, v106, v107
v_cvt_pk_bf16_f32 v106, v108, v109
v_cvt_pk_bf16_f32 v107, v110, v111
buffer_store_dwordx4 v[104:107], v249, s[44:47], s50 offen offset:0 sc1
v_pk_mul_f32 v[16:17], v[16:17], v[230:231] op_sel:[0,0] op_sel_hi:[1,0]
v_pk_mul_f32 v[18:19], v[18:19], v[230:231] op_sel:[0,0] op_sel_hi:[1,0]
v_pk_mul_f32 v[20:21], v[20:21], v[230:231] op_sel:[0,0] op_sel_hi:[1,0]
v_pk_mul_f32 v[22:23], v[22:23], v[230:231] op_sel:[0,0] op_sel_hi:[1,0]
s_add_u32 s50, s64, 294912
v_cvt_pk_bf16_f32 v16, v16, v17
v_cvt_pk_bf16_f32 v17, v18, v19
v_cvt_pk_bf16_f32 v18, v20, v21
v_cvt_pk_bf16_f32 v19, v22, v23
buffer_store_dwordx4 v[16:19], v249, s[44:47], s50 offen offset:0 sc1
v_pk_mul_f32 v[48:49], v[48:49], v[230:231] op_sel:[0,1] op_sel_hi:[1,1]
v_pk_mul_f32 v[50:51], v[50:51], v[230:231] op_sel:[0,1] op_sel_hi:[1,1]
v_pk_mul_f32 v[52:53], v[52:53], v[230:231] op_sel:[0,1] op_sel_hi:[1,1]
v_pk_mul_f32 v[54:55], v[54:55], v[230:231] op_sel:[0,1] op_sel_hi:[1,1]
s_add_u32 s50, s64, 296960
v_cvt_pk_bf16_f32 v48, v48, v49
v_cvt_pk_bf16_f32 v49, v50, v51
v_cvt_pk_bf16_f32 v50, v52, v53
v_cvt_pk_bf16_f32 v51, v54, v55
buffer_store_dwordx4 v[48:51], v249, s[44:47], s50 offen offset:0 sc1
v_pk_mul_f32 v[80:81], v[80:81], v[232:233] op_sel:[0,0] op_sel_hi:[1,0]
v_pk_mul_f32 v[82:83], v[82:83], v[232:233] op_sel:[0,0] op_sel_hi:[1,0]
v_readlane_b32 s16, v243, 3
s_add_u32 s8, s9, 116928
s_mul_i32 s5, s16, 294912
s_mul_i32 s16, s16, 73728
s_add_u32 s52, s16, s18
s_nop 0
ds_write_b128 v250, a[168:171] offset:0
ds_write_b128 v250, a[172:175] offset:1024
ds_write_b128 v250, a[184:187] offset:2048
ds_write_b128 v250, a[188:191] offset:3072
ds_write_b32 v252, v229
ds_write_b32 v201, v200
v_pk_mul_f32 v[84:85], v[84:85], v[232:233] op_sel:[0,0] op_sel_hi:[1,0]
v_pk_mul_f32 v[86:87], v[86:87], v[232:233] op_sel:[0,0] op_sel_hi:[1,0]
s_add_u32 s50, s64, 299008
v_cvt_pk_bf16_f32 v80, v80, v81
v_cvt_pk_bf16_f32 v81, v82, v83
v_cvt_pk_bf16_f32 v82, v84, v85
v_cvt_pk_bf16_f32 v83, v86, v87
buffer_store_dwordx4 v[80:83], v249, s[44:47], s50 offen offset:0 sc1
v_pk_mul_f32 v[112:113], v[112:113], v[232:233] op_sel:[0,1] op_sel_hi:[1,1]
v_pk_mul_f32 v[114:115], v[114:115], v[232:233] op_sel:[0,1] op_sel_hi:[1,1]
v_pk_mul_f32 v[116:117], v[116:117], v[232:233] op_sel:[0,1] op_sel_hi:[1,1]
v_pk_mul_f32 v[118:119], v[118:119], v[232:233] op_sel:[0,1] op_sel_hi:[1,1]
s_add_u32 s50, s64, 301056
v_cvt_pk_bf16_f32 v112, v112, v113
v_cvt_pk_bf16_f32 v113, v114, v115
v_cvt_pk_bf16_f32 v114, v116, v117
v_cvt_pk_bf16_f32 v115, v118, v119
buffer_store_dwordx4 v[112:115], v249, s[44:47], s50 offen offset:0 sc1
v_pk_mul_f32 v[24:25], v[24:25], v[230:231] op_sel:[0,0] op_sel_hi:[1,0]
v_pk_mul_f32 v[26:27], v[26:27], v[230:231] op_sel:[0,0] op_sel_hi:[1,0]
v_pk_mul_f32 v[28:29], v[28:29], v[230:231] op_sel:[0,0] op_sel_hi:[1,0]
v_pk_mul_f32 v[30:31], v[30:31], v[230:231] op_sel:[0,0] op_sel_hi:[1,0]
v_cvt_pk_bf16_f32 v24, v24, v25
v_cvt_pk_bf16_f32 v25, v26, v27
v_cvt_pk_bf16_f32 v26, v28, v29
v_cvt_pk_bf16_f32 v27, v30, v31
v_pk_mul_f32 v[56:57], v[56:57], v[230:231] op_sel:[0,1] op_sel_hi:[1,1]
v_pk_mul_f32 v[58:59], v[58:59], v[230:231] op_sel:[0,1] op_sel_hi:[1,1]
v_pk_mul_f32 v[60:61], v[60:61], v[230:231] op_sel:[0,1] op_sel_hi:[1,1]
v_pk_mul_f32 v[62:63], v[62:63], v[230:231] op_sel:[0,1] op_sel_hi:[1,1]
v_cvt_pk_bf16_f32 v56, v56, v57
v_cvt_pk_bf16_f32 v57, v58, v59
v_cvt_pk_bf16_f32 v58, v60, v61
v_cvt_pk_bf16_f32 v59, v62, v63
v_mov_b32 v208, 152576
s_waitcnt vmcnt(32) lgkmcnt(0)
s_barrier
ds_read_b128 v[180:183], v253 offset:0
ds_read_b128 v[184:187], v253 offset:16
ds_read_b128 v[188:191], v253 offset:512
ds_read_b128 v[192:195], v253 offset:528
ds_read_b128 v[196:199], v208
ds_read_b128 v[164:167], v251 offset:0
ds_read_b128 v[168:171], v251 offset:1024
ds_read_b128 v[172:175], v251 offset:2048
ds_read_b128 v[176:179], v251 offset:3072
ds_read_b64_tr_b16 a[56:57], v241 offset:0
ds_read_b64_tr_b16 a[58:59], v241 offset:3072
ds_read_b64_tr_b16 a[64:65], v241 offset:512
ds_read_b64_tr_b16 a[66:67], v241 offset:3584
ds_read_b64_tr_b16 a[72:73], v241 offset:1024
ds_read_b64_tr_b16 a[74:75], v241 offset:4096
v_pk_mul_f32 v[88:89], v[88:89], v[232:233] op_sel:[0,0] op_sel_hi:[1,0]
v_pk_mul_f32 v[90:91], v[90:91], v[232:233] op_sel:[0,0] op_sel_hi:[1,0]
v_pk_mul_f32 v[92:93], v[92:93], v[232:233] op_sel:[0,0] op_sel_hi:[1,0]
v_pk_mul_f32 v[94:95], v[94:95], v[232:233] op_sel:[0,0] op_sel_hi:[1,0]
v_cvt_pk_bf16_f32 v88, v88, v89
v_cvt_pk_bf16_f32 v89, v90, v91
v_cvt_pk_bf16_f32 v90, v92, v93
v_cvt_pk_bf16_f32 v91, v94, v95
v_pk_mul_f32 v[120:121], v[120:121], v[232:233] op_sel:[0,1] op_sel_hi:[1,1]
v_pk_mul_f32 v[122:123], v[122:123], v[232:233] op_sel:[0,1] op_sel_hi:[1,1]
v_pk_mul_f32 v[124:125], v[124:125], v[232:233] op_sel:[0,1] op_sel_hi:[1,1]
v_pk_mul_f32 v[126:127], v[126:127], v[232:233] op_sel:[0,1] op_sel_hi:[1,1]
v_cvt_pk_bf16_f32 v120, v120, v121
v_cvt_pk_bf16_f32 v121, v122, v123
v_cvt_pk_bf16_f32 v122, v124, v125
v_cvt_pk_bf16_f32 v123, v126, v127
s_waitcnt lgkmcnt(14)
v_pk_add_f32 v[180:181], v[180:181], v[182:183]
s_waitcnt lgkmcnt(13)
v_pk_add_f32 v[184:185], v[184:185], v[186:187]
v_pk_add_f32 v[180:181], v[180:181], v[184:185]
v_add_f32 v180, v180, v181
s_waitcnt lgkmcnt(12)
v_pk_add_f32 v[188:189], v[188:189], v[190:191]
s_waitcnt lgkmcnt(11)
v_pk_add_f32 v[192:193], v[192:193], v[194:195]
v_pk_add_f32 v[188:189], v[188:189], v[192:193]
v_add_f32 v188, v188, v189
s_cmp_lt_u32 s48, 2
s_cselect_b64 vcc, -1, 0
v_cndmask_b32 v200, v188, v180, vcc
v_rcp_f32 v234, v200
s_waitcnt lgkmcnt(10)
v_or3_b32 v196, v196, v197, v198
v_or_b32 v196, v196, v199
v_min_u32 v181, v180, v188
v_max_u32 v182, v180, v188
v_cmp_ne_u32 s[72:73], 0, v196
v_cmp_gt_u32 s[96:97], s74, v181
v_cmp_lt_u32 vcc, s75, v182
s_nop 0
v_accvgpr_read_b32 v200, a160
v_accvgpr_read_b32 v201, a161
v_accvgpr_read_b32 v202, a162
v_accvgpr_read_b32 v203, a163
v_accvgpr_read_b32 v204, a164
v_accvgpr_read_b32 v205, a165
v_accvgpr_read_b32 v206, a166
v_accvgpr_read_b32 v207, a167
s_or_b64 s[72:73], s[72:73], vcc
s_or_b64 s[72:73], s[72:73], s[96:97]
s_waitcnt lgkmcnt(9)
v_pk_add_f32 v[164:165], v[164:165], v[200:201]
v_pk_add_f32 v[166:167], v[166:167], v[202:203]
s_waitcnt lgkmcnt(8)
v_pk_add_f32 v[168:169], v[168:169], v[204:205]
v_pk_add_f32 v[170:171], v[170:171], v[206:207]
ds_read_b64_tr_b16 a[60:61], v241 offset:6144
ds_read_b64_tr_b16 a[62:63], v241 offset:9216
ds_read_b64_tr_b16 a[68:69], v241 offset:6656
ds_read_b64_tr_b16 a[70:71], v241 offset:9728
ds_read_b64_tr_b16 a[76:77], v241 offset:7168
ds_read_b64_tr_b16 a[78:79], v241 offset:10240
ds_read_b128 a[0:3], v240 offset:0
ds_read_b128 a[4:7], v240 offset:7168
ds_read_b128 a[8:11], v240 offset:1024
ds_read_b128 a[12:15], v240 offset:8192
v_pk_mul_f32 v[164:165], v[164:165], v[234:235] op_sel:[0,0] op_sel_hi:[1,0]
v_pk_mul_f32 v[166:167], v[166:167], v[234:235] op_sel:[0,0] op_sel_hi:[1,0]
v_pk_mul_f32 v[168:169], v[168:169], v[234:235] op_sel:[0,0] op_sel_hi:[1,0]
v_pk_mul_f32 v[170:171], v[170:171], v[234:235] op_sel:[0,0] op_sel_hi:[1,0]
v_cvt_pk_bf16_f32 v164, v164, v165
v_cvt_pk_bf16_f32 v165, v166, v167
v_cvt_pk_bf16_f32 v166, v168, v169
v_cvt_pk_bf16_f32 v167, v170, v171
v_accvgpr_read_b32 v200, a176
v_accvgpr_read_b32 v201, a177
v_accvgpr_read_b32 v202, a178
v_accvgpr_read_b32 v203, a179
v_accvgpr_read_b32 v204, a180
v_accvgpr_read_b32 v205, a181
v_accvgpr_read_b32 v206, a182
v_accvgpr_read_b32 v207, a183
s_waitcnt lgkmcnt(15)
v_pk_add_f32 v[172:173], v[172:173], v[200:201]
v_pk_add_f32 v[174:175], v[174:175], v[202:203]
s_waitcnt lgkmcnt(15)
v_pk_add_f32 v[176:177], v[176:177], v[204:205]
v_pk_add_f32 v[178:179], v[178:179], v[206:207]
ds_read_b128 a[16:19], v240 offset:2048
ds_read_b128 a[20:23], v240 offset:9216
ds_read_b128 a[24:27], v240 offset:3072
ds_read_b128 a[28:31], v240 offset:10240
ds_read_b128 a[32:35], v240 offset:4096
ds_read_b128 a[36:39], v240 offset:11264
ds_read_b128 a[40:43], v240 offset:5120
ds_read_b128 a[44:47], v240 offset:12288
ds_read_b128 a[48:51], v240 offset:6144
ds_read_b128 a[52:55], v240 offset:13312
v_pk_mul_f32 v[172:173], v[172:173], v[234:235] op_sel:[0,0] op_sel_hi:[1,0]
v_pk_mul_f32 v[174:175], v[174:175], v[234:235] op_sel:[0,0] op_sel_hi:[1,0]
v_pk_mul_f32 v[176:177], v[176:177], v[234:235] op_sel:[0,0] op_sel_hi:[1,0]
v_pk_mul_f32 v[178:179], v[178:179], v[234:235] op_sel:[0,0] op_sel_hi:[1,0]
v_cvt_pk_bf16_f32 v172, v172, v173
v_cvt_pk_bf16_f32 v173, v174, v175
v_cvt_pk_bf16_f32 v174, v176, v177
v_cvt_pk_bf16_f32 v175, v178, v179
s_cmp_lg_u64 s[72:73], 0
s_cbranch_scc1 L_restart
L_join:
s_cmp_eq_u32 s55, 63
s_cbranch_scc1 L_idle
s_mov_b32 s36, s78
s_and_b32 s37, s79, 0xffff
s_mov_b32 s38, 5308416
s_mov_b32 s39, 0x20000
v_mov_b32 v244, 2
s_waitcnt vmcnt(22) lgkmcnt(0)
v_mfma_f32_16x16x32_bf16 v[128:131], a[56:59], a[0:3], 0
s_barrier
v_mfma_f32_16x16x32_bf16 v[128:131], a[60:63], a[4:7], v[128:131]
s_mov_b32 m0, s8
ds_read_b128 a[80:83], v240 offset:38976
v_mfma_f32_16x16x32_bf16 v[132:135], a[64:67], a[0:3], 0
s_add_u32 s51, s5, s56
ds_read_b64_tr_b16 a[136:137], v241 offset:38976
v_mfma_f32_16x16x32_bf16 v[132:135], a[68:71], a[4:7], v[132:135]
buffer_load_dwordx4 v249, s[32:35], s51 offen offset:0 sc1 lds
v_mfma_f32_16x16x32_bf16 v[136:139], a[72:75], a[0:3], 0
s_cmp_lt_u32 s17, s63
ds_read_b128 a[84:87], v240 offset:46144
v_mfma_f32_16x16x32_bf16 v[136:139], a[76:79], a[4:7], v[136:139]
s_cselect_b32 s49, s17, 63
ds_read_b64_tr_b16 a[138:139], v241 offset:42048
v_mfma_f32_16x16x32_bf16 v[140:143], a[56:59], a[8:11], 0
s_add_u32 s51, s5, s57
ds_read_b128 a[88:91], v240 offset:40000
v_mfma_f32_16x16x32_bf16 v[140:143], a[60:63], a[12:15], v[140:143]
buffer_load_dwordx4 v249, s[32:35], s51 offen offset:1024 sc1 lds
v_mfma_f32_16x16x32_bf16 v[144:147], a[64:67], a[8:11], 0
ds_read_b64_tr_b16 a[144:145], v241 offset:39488
v_readlane_b32 s16, v243, s49
v_mfma_f32_16x16x32_bf16 v[144:147], a[68:71], a[12:15], v[144:147]
s_add_u32 s17, s17, 1
ds_read_b128 a[92:95], v240 offset:47168
v_mfma_f32_16x16x32_bf16 v[148:151], a[72:75], a[8:11], 0
s_add_u32 s51, s5, s58
ds_read_b64_tr_b16 a[146:147], v241 offset:42560
v_mfma_f32_16x16x32_bf16 v[148:151], a[76:79], a[12:15], v[148:151]
buffer_load_dwordx4 v249, s[32:35], s51 offen offset:2048 sc1 lds
v_mfma_f32_16x16x32_bf16 v[152:155], a[56:59], a[16:19], 0
ds_read_b128 a[96:99], v240 offset:41024
v_mfma_f32_16x16x32_bf16 v[152:155], a[60:63], a[20:23], v[152:155]
s_add_u32 m0, s8, s14
ds_read_b64_tr_b16 a[152:153], v241 offset:40000
v_mfma_f32_16x16x32_bf16 v[156:159], a[64:67], a[16:19], 0
s_add_u32 s51, s5, s59
ds_read_b128 a[100:103], v240 offset:48192
v_mfma_f32_16x16x32_bf16 v[156:159], a[68:71], a[20:23], v[156:159]
s_mov_b32 exec_hi, 0
buffer_load_dwordx4 v249, s[32:35], s51 offen sc1 lds
s_mov_b32 exec_hi, -1
v_mfma_f32_16x16x32_bf16 v[160:163], a[72:75], a[16:19], 0
s_mul_i32 s5, s16, 294912
ds_read_b64_tr_b16 a[154:155], v241 offset:43072
v_mfma_f32_16x16x32_bf16 v[160:163], a[76:79], a[20:23], v[160:163]
s_add_u32 m0, s8, s7
ds_read_b128 a[104:107], v240 offset:42048
v_mfma_f32_16x16x32_bf16 v[176:179], a[56:59], a[24:27], 0
s_add_u32 s51, s52, 2048
ds_read_b64_tr_b16 a[140:141], v241 offset:45120
v_mfma_f32_16x16x32_bf16 v[176:179], a[60:63], a[28:31], v[176:179]
buffer_load_dwordx4 v248, s[28:31], s51 offen offset:0 lds
v_mfma_f32_16x16x32_bf16 v[180:183], a[64:67], a[24:27], 0
s_mul_i32 s16, s16, 73728
ds_read_b128 a[108:111], v240 offset:49216
v_mfma_f32_16x16x32_bf16 v[180:183], a[68:71], a[28:31], v[180:183]
s_add_u32 s8, s8, 38976
ds_read_b64_tr_b16 a[142:143], v241 offset:48192
v_mfma_f32_16x16x32_bf16 v[184:187], a[72:75], a[24:27], 0
s_add_u32 s51, s52, 1152
ds_read_b128 a[112:115], v240 offset:43072
v_mfma_f32_16x16x32_bf16 v[184:187], a[76:79], a[28:31], v[184:187]
buffer_load_dwordx4 v248, s[28:31], s51 offen offset:1024 lds
v_mfma_f32_16x16x32_bf16 v[188:191], a[56:59], a[32:35], 0
s_add_u32 s50, s65, 294912
ds_read_b64_tr_b16 a[148:149], v241 offset:45632
v_mfma_f32_16x16x32_bf16 v[188:191], a[60:63], a[36:39], v[188:191]
buffer_store_dwordx4 v[24:27], v249, s[44:47], s50 offen offset:0 sc1
v_mfma_f32_16x16x32_bf16 v[192:195], a[64:67], a[32:35], 0
s_add_u32 s51, s52, 256
ds_read_b128 a[116:119], v240 offset:50240
v_mfma_f32_16x16x32_bf16 v[192:195], a[68:71], a[36:39], v[192:195]
buffer_load_dwordx4 v248, s[28:31], s51 offen offset:2048 lds
v_mfma_f32_16x16x32_bf16 v[196:199], a[72:75], a[32:35], 0
ds_read_b64_tr_b16 a[150:151], v241 offset:48704
v_mfma_f32_16x16x32_bf16 v[196:199], a[76:79], a[36:39], v[196:199]
s_add_u32 m0, m0, 3072
ds_read_b128 a[120:123], v240 offset:44096
v_mfma_f32_16x16x32_bf16 v[200:203], a[56:59], a[40:43], 0
s_add_u32 s51, s52, 20480
ds_read_b64_tr_b16 a[156:157], v241 offset:46144
v_mfma_f32_16x16x32_bf16 v[200:203], a[60:63], a[44:47], v[200:203]
buffer_load_dwordx4 v248, s[28:31], s51 offen offset:0 lds
v_mfma_f32_16x16x32_bf16 v[204:207], a[64:67], a[40:43], 0
s_cmp_eq_u32 s8, s10
ds_read_b128 a[124:127], v240 offset:51264
v_mfma_f32_16x16x32_bf16 v[204:207], a[68:71], a[44:47], v[204:207]
s_cselect_b32 s8, s9, s8
ds_read_b64_tr_b16 a[158:159], v241 offset:49216
v_mfma_f32_16x16x32_bf16 v[208:211], a[72:75], a[40:43], 0
s_add_u32 s51, s52, 19584
ds_read_b128 a[128:131], v240 offset:45120
v_mfma_f32_16x16x32_bf16 v[208:211], a[76:79], a[44:47], v[208:211]
buffer_load_dwordx4 v248, s[28:31], s51 offen offset:1024 lds
v_mfma_f32_16x16x32_bf16 v[212:215], a[56:59], a[48:51], 0
ds_read_b128 a[132:135], v240 offset:52288
v_mfma_f32_16x16x32_bf16 v[212:215], a[60:63], a[52:55], v[212:215]
v_add_u32 v240, s11, v240
v_add_u32 v241, s11, v241
v_mfma_f32_16x16x32_bf16 v[216:219], a[64:67], a[48:51], 0
s_add_u32 s51, s52, 18688
v_mfma_f32_16x16x32_bf16 v[216:219], a[68:71], a[52:55], v[216:219]
buffer_load_dwordx4 v248, s[28:31], s51 offen offset:2048 lds
v_mfma_f32_16x16x32_bf16 v[220:223], a[72:75], a[48:51], 0
s_add_u32 s52, s16, s18
v_mfma_f32_16x16x32_bf16 v[220:223], a[76:79], a[52:55], v[220:223]
s_waitcnt vmcnt(19) lgkmcnt(0)
v_mfma_f32_16x16x32_bf16 v[128:131], a[136:139], a[80:83], v[128:131]
s_barrier
v_mfma_f32_16x16x32_bf16 v[128:131], a[140:143], a[84:87], v[128:131]
s_mov_b32 m0, s8
ds_read_b128 a[0:3], v240 offset:0
v_mfma_f32_16x16x32_bf16 v[132:135], a[144:147], a[80:83], v[132:135]
s_add_u32 s51, s5, s56
ds_read_b64_tr_b16 a[56:57], v241 offset:0
v_mfma_f32_16x16x32_bf16 v[132:135], a[148:151], a[84:87], v[132:135]
buffer_load_dwordx4 v249, s[32:35], s51 offen offset:0 sc1 lds
v_mfma_f32_16x16x32_bf16 v[136:139], a[152:155], a[80:83], v[136:139]
s_cmp_lt_u32 s17, s63
ds_read_b128 a[4:7], v240 offset:7168
v_mfma_f32_16x16x32_bf16 v[136:139], a[156:159], a[84:87], v[136:139]
s_cselect_b32 s49, s17, 63
ds_read_b64_tr_b16 a[58:59], v241 offset:3072
v_mfma_f32_16x16x32_bf16 v[140:143], a[136:139], a[88:91], v[140:143]
s_add_u32 s51, s5, s57
ds_read_b128 a[8:11], v240 offset:1024
v_mfma_f32_16x16x32_bf16 v[140:143], a[140:143], a[92:95], v[140:143]
buffer_load_dwordx4 v249, s[32:35], s51 offen offset:1024 sc1 lds
v_mfma_f32_16x16x32_bf16 v[144:147], a[144:147], a[88:91], v[144:147]
ds_read_b64_tr_b16 a[64:65], v241 offset:512
v_readlane_b32 s16, v243, s49
v_mfma_f32_16x16x32_bf16 v[144:147], a[148:151], a[92:95], v[144:147]
s_add_u32 s17, s17, 1
ds_read_b128 a[12:15], v240 offset:8192
v_mfma_f32_16x16x32_bf16 v[148:151], a[152:155], a[88:91], v[148:151]
s_add_u32 s51, s5, s58
ds_read_b64_tr_b16 a[66:67], v241 offset:3584
v_mfma_f32_16x16x32_bf16 v[148:151], a[156:159], a[92:95], v[148:151]
buffer_load_dwordx4 v249, s[32:35], s51 offen offset:2048 sc1 lds
v_mfma_f32_16x16x32_bf16 v[152:155], a[136:139], a[96:99], v[152:155]
s_mul_i32 s11, s11, -1
ds_read_b128 a[16:19], v240 offset:2048
v_mfma_f32_16x16x32_bf16 v[152:155], a[140:143], a[100:103], v[152:155]
s_add_u32 m0, s8, s14
ds_read_b64_tr_b16 a[72:73], v241 offset:1024
v_mfma_f32_16x16x32_bf16 v[156:159], a[144:147], a[96:99], v[156:159]
s_add_u32 s51, s5, s59
ds_read_b128 a[20:23], v240 offset:9216
v_mfma_f32_16x16x32_bf16 v[156:159], a[148:151], a[100:103], v[156:159]
s_mov_b32 exec_hi, 0
buffer_load_dwordx4 v249, s[32:35], s51 offen sc1 lds
s_mov_b32 exec_hi, -1
v_mfma_f32_16x16x32_bf16 v[160:163], a[152:155], a[96:99], v[160:163]
s_mul_i32 s5, s16, 294912
ds_read_b64_tr_b16 a[74:75], v241 offset:4096
v_mfma_f32_16x16x32_bf16 v[160:163], a[156:159], a[100:103], v[160:163]
s_add_u32 m0, s8, s7
ds_read_b128 a[24:27], v240 offset:3072
v_mfma_f32_16x16x32_bf16 v[176:179], a[136:139], a[104:107], v[176:179]
s_add_u32 s51, s52, 2048
ds_read_b64_tr_b16 a[60:61], v241 offset:6144
v_mfma_f32_16x16x32_bf16 v[176:179], a[140:143], a[108:111], v[176:179]
buffer_load_dwordx4 v248, s[28:31], s51 offen offset:0 lds
v_mfma_f32_16x16x32_bf16 v[180:183], a[144:147], a[104:107], v[180:183]
s_mul_i32 s16, s16, 73728
ds_read_b128 a[28:31], v240 offset:10240
v_mfma_f32_16x16x32_bf16 v[180:183], a[148:151], a[108:111], v[180:183]
s_add_u32 s8, s8, 38976
ds_read_b64_tr_b16 a[62:63], v241 offset:9216
v_mfma_f32_16x16x32_bf16 v[184:187], a[152:155], a[104:107], v[184:187]
s_add_u32 s51, s52, 1152
ds_read_b128 a[32:35], v240 offset:4096
v_mfma_f32_16x16x32_bf16 v[184:187], a[156:159], a[108:111], v[184:187]
buffer_load_dwordx4 v248, s[28:31], s51 offen offset:1024 lds
v_mfma_f32_16x16x32_bf16 v[188:191], a[136:139], a[112:115], v[188:191]
s_add_u32 s50, s65, 296960
ds_read_b64_tr_b16 a[68:69], v241 offset:6656
v_mfma_f32_16x16x32_bf16 v[188:191], a[140:143], a[116:119], v[188:191]
buffer_store_dwordx4 v[56:59], v249, s[44:47], s50 offen offset:0 sc1
v_mfma_f32_16x16x32_bf16 v[192:195], a[144:147], a[112:115], v[192:195]
s_add_u32 s51, s52, 256
ds_read_b128 a[36:39], v240 offset:11264
v_mfma_f32_16x16x32_bf16 v[192:195], a[148:151], a[116:119], v[192:195]
buffer_load_dwordx4 v248, s[28:31], s51 offen offset:2048 lds
v_mfma_f32_16x16x32_bf16 v[196:199], a[152:155], a[112:115], v[196:199]
ds_read_b64_tr_b16 a[70:71], v241 offset:9728
v_mfma_f32_16x16x32_bf16 v[196:199], a[156:159], a[116:119], v[196:199]
s_add_u32 m0, m0, 3072
ds_read_b128 a[40:43], v240 offset:5120
v_mfma_f32_16x16x32_bf16 v[200:203], a[136:139], a[120:123], v[200:203]
s_add_u32 s51, s52, 20480
ds_read_b64_tr_b16 a[76:77], v241 offset:7168
v_mfma_f32_16x16x32_bf16 v[200:203], a[140:143], a[124:127], v[200:203]
buffer_load_dwordx4 v248, s[28:31], s51 offen offset:0 lds
v_mfma_f32_16x16x32_bf16 v[204:207], a[144:147], a[120:123], v[204:207]
s_cmp_eq_u32 s8, s10
ds_read_b128 a[44:47], v240 offset:12288
v_mfma_f32_16x16x32_bf16 v[204:207], a[148:151], a[124:127], v[204:207]
s_cselect_b32 s8, s9, s8
ds_read_b64_tr_b16 a[78:79], v241 offset:10240
v_mfma_f32_16x16x32_bf16 v[208:211], a[152:155], a[120:123], v[208:211]
s_add_u32 s51, s52, 19584
ds_read_b128 a[48:51], v240 offset:6144
v_mfma_f32_16x16x32_bf16 v[208:211], a[156:159], a[124:127], v[208:211]
buffer_load_dwordx4 v248, s[28:31], s51 offen offset:1024 lds
v_mfma_f32_16x16x32_bf16 v[212:215], a[136:139], a[128:131], v[212:215]
ds_read_b128 a[52:55], v240 offset:13312
v_mfma_f32_16x16x32_bf16 v[212:215], a[140:143], a[132:135], v[212:215]
v_mfma_f32_16x16x32_bf16 v[216:219], a[144:147], a[128:131], v[216:219]
s_add_u32 s51, s52, 18688
v_mfma_f32_16x16x32_bf16 v[216:219], a[148:151], a[132:135], v[216:219]
buffer_load_dwordx4 v248, s[28:31], s51 offen offset:2048 lds
v_mfma_f32_16x16x32_bf16 v[220:223], a[152:155], a[128:131], v[220:223]
s_add_u32 s52, s16, s18
v_mfma_f32_16x16x32_bf16 v[220:223], a[156:159], a[132:135], v[220:223]
s_waitcnt vmcnt(11) lgkmcnt(0)
v_mfma_f32_16x16x32_bf16 v[128:131], a[56:59], a[0:3], v[128:131]
s_barrier
v_mfma_f32_16x16x32_bf16 v[128:131], a[60:63], a[4:7], v[128:131]
s_mov_b32 m0, s8
ds_read_b128 a[80:83], v240 offset:38976
v_mfma_f32_16x16x32_bf16 v[132:135], a[64:67], a[0:3], v[132:135]
s_add_u32 s51, s5, s56
ds_read_b64_tr_b16 a[136:137], v241 offset:38976
v_mfma_f32_16x16x32_bf16 v[132:135], a[68:71], a[4:7], v[132:135]
buffer_load_dwordx4 v249, s[32:35], s51 offen offset:0 sc1 lds
v_mfma_f32_16x16x32_bf16 v[136:139], a[72:75], a[0:3], v[136:139]
s_cmp_lt_u32 s17, s63
ds_read_b128 a[84:87], v240 offset:46144
v_mfma_f32_16x16x32_bf16 v[136:139], a[76:79], a[4:7], v[136:139]
s_cselect_b32 s49, s17, 63
ds_read_b64_tr_b16 a[138:139], v241 offset:42048
v_mfma_f32_16x16x32_bf16 v[140:143], a[56:59], a[8:11], v[140:143]
s_add_u32 s51, s5, s57
ds_read_b128 a[88:91], v240 offset:40000
v_mfma_f32_16x16x32_bf16 v[140:143], a[60:63], a[12:15], v[140:143]
buffer_load_dwordx4 v249, s[32:35], s51 offen offset:1024 sc1 lds
v_mfma_f32_16x16x32_bf16 v[144:147], a[64:67], a[8:11], v[144:147]
ds_read_b64_tr_b16 a[144:145], v241 offset:39488
v_readlane_b32 s16, v243, s49
v_mfma_f32_16x16x32_bf16 v[144:147], a[68:71], a[12:15], v[144:147]
s_add_u32 s17, s17, 1
ds_read_b128 a[92:95], v240 offset:47168
v_mfma_f32_16x16x32_bf16 v[148:151], a[72:75], a[8:11], v[148:151]
s_add_u32 s51, s5, s58
ds_read_b64_tr_b16 a[146:147], v241 offset:42560
v_mfma_f32_16x16x32_bf16 v[148:151], a[76:79], a[12:15], v[148:151]
buffer_load_dwordx4 v249, s[32:35], s51 offen offset:2048 sc1 lds
v_mfma_f32_16x16x32_bf16 v[152:155], a[56:59], a[16:19], v[152:155]
ds_read_b128 a[96:99], v240 offset:41024
v_mfma_f32_16x16x32_bf16 v[152:155], a[60:63], a[20:23], v[152:155]
s_add_u32 m0, s8, s14
ds_read_b64_tr_b16 a[152:153], v241 offset:40000
v_mfma_f32_16x16x32_bf16 v[156:159], a[64:67], a[16:19], v[156:159]
s_add_u32 s51, s5, s59
ds_read_b128 a[100:103], v240 offset:48192
v_mfma_f32_16x16x32_bf16 v[156:159], a[68:71], a[20:23], v[156:159]
s_mov_b32 exec_hi, 0
buffer_load_dwordx4 v249, s[32:35], s51 offen sc1 lds
s_mov_b32 exec_hi, -1
v_mfma_f32_16x16x32_bf16 v[160:163], a[72:75], a[16:19], v[160:163]
s_mul_i32 s5, s16, 294912
ds_read_b64_tr_b16 a[154:155], v241 offset:43072
v_mfma_f32_16x16x32_bf16 v[160:163], a[76:79], a[20:23], v[160:163]
s_add_u32 m0, s8, s7
ds_read_b128 a[104:107], v240 offset:42048
v_mfma_f32_16x16x32_bf16 v[176:179], a[56:59], a[24:27], v[176:179]
s_add_u32 s51, s52, 2048
ds_read_b64_tr_b16 a[140:141], v241 offset:45120
v_mfma_f32_16x16x32_bf16 v[176:179], a[60:63], a[28:31], v[176:179]
buffer_load_dwordx4 v248, s[28:31], s51 offen offset:0 lds
v_mfma_f32_16x16x32_bf16 v[180:183], a[64:67], a[24:27], v[180:183]
s_mul_i32 s16, s16, 73728
ds_read_b128 a[108:111], v240 offset:49216
v_mfma_f32_16x16x32_bf16 v[180:183], a[68:71], a[28:31], v[180:183]
s_add_u32 s8, s8, 38976
ds_read_b64_tr_b16 a[142:143], v241 offset:48192
v_mfma_f32_16x16x32_bf16 v[184:187], a[72:75], a[24:27], v[184:187]
s_add_u32 s51, s52, 1152
ds_read_b128 a[112:115], v240 offset:43072
v_mfma_f32_16x16x32_bf16 v[184:187], a[76:79], a[28:31], v[184:187]
buffer_load_dwordx4 v248, s[28:31], s51 offen offset:1024 lds
v_mfma_f32_16x16x32_bf16 v[188:191], a[56:59], a[32:35], v[188:191]
s_add_u32 s50, s65, 299008
ds_read_b64_tr_b16 a[148:149], v241 offset:45632
v_mfma_f32_16x16x32_bf16 v[188:191], a[60:63], a[36:39], v[188:191]
buffer_store_dwordx4 v[88:91], v249, s[44:47], s50 offen offset:0 sc1
v_mfma_f32_16x16x32_bf16 v[192:195], a[64:67], a[32:35], v[192:195]
s_add_u32 s51, s52, 256
ds_read_b128 a[116:119], v240 offset:50240
v_mfma_f32_16x16x32_bf16 v[192:195], a[68:71], a[36:39], v[192:195]
buffer_load_dwordx4 v248, s[28:31], s51 offen offset:2048 lds
v_mfma_f32_16x16x32_bf16 v[196:199], a[72:75], a[32:35], v[196:199]
ds_read_b64_tr_b16 a[150:151], v241 offset:48704
v_mfma_f32_16x16x32_bf16 v[196:199], a[76:79], a[36:39], v[196:199]
s_add_u32 m0, m0, 3072
ds_read_b128 a[120:123], v240 offset:44096
v_mfma_f32_16x16x32_bf16 v[200:203], a[56:59], a[40:43], v[200:203]
s_add_u32 s51, s52, 20480
ds_read_b64_tr_b16 a[156:157], v241 offset:46144
v_mfma_f32_16x16x32_bf16 v[200:203], a[60:63], a[44:47], v[200:203]
buffer_load_dwordx4 v248, s[28:31], s51 offen offset:0 lds
v_mfma_f32_16x16x32_bf16 v[204:207], a[64:67], a[40:43], v[204:207]
s_cmp_eq_u32 s8, s10
ds_read_b128 a[124:127], v240 offset:51264
v_mfma_f32_16x16x32_bf16 v[204:207], a[68:71], a[44:47], v[204:207]
s_cselect_b32 s8, s9, s8
ds_read_b64_tr_b16 a[158:159], v241 offset:49216
v_mfma_f32_16x16x32_bf16 v[208:211], a[72:75], a[40:43], v[208:211]
s_add_u32 s51, s52, 19584
ds_read_b128 a[128:131], v240 offset:45120
v_mfma_f32_16x16x32_bf16 v[208:211], a[76:79], a[44:47], v[208:211]
buffer_load_dwordx4 v248, s[28:31], s51 offen offset:1024 lds
v_mfma_f32_16x16x32_bf16 v[212:215], a[56:59], a[48:51], v[212:215]
ds_read_b128 a[132:135], v240 offset:52288
v_mfma_f32_16x16x32_bf16 v[212:215], a[60:63], a[52:55], v[212:215]
v_add_u32 v240, s11, v240
v_add_u32 v241, s11, v241
v_mfma_f32_16x16x32_bf16 v[216:219], a[64:67], a[48:51], v[216:219]
s_add_u32 s51, s52, 18688
v_mfma_f32_16x16x32_bf16 v[216:219], a[68:71], a[52:55], v[216:219]
buffer_load_dwordx4 v248, s[28:31], s51 offen offset:2048 lds
v_mfma_f32_16x16x32_bf16 v[220:223], a[72:75], a[48:51], v[220:223]
s_add_u32 s52, s16, s18
v_mfma_f32_16x16x32_bf16 v[220:223], a[76:79], a[52:55], v[220:223]
s_waitcnt vmcnt(11) lgkmcnt(0)
v_mfma_f32_16x16x32_bf16 v[128:131], a[136:139], a[80:83], v[128:131]
s_barrier
v_mfma_f32_16x16x32_bf16 v[128:131], a[140:143], a[84:87], v[128:131]
s_mov_b32 m0, s8
ds_read_b128 a[0:3], v240 offset:0
v_mfma_f32_16x16x32_bf16 v[132:135], a[144:147], a[80:83], v[132:135]
s_add_u32 s51, s5, s56
ds_read_b64_tr_b16 a[56:57], v241 offset:0
v_mfma_f32_16x16x32_bf16 v[132:135], a[148:151], a[84:87], v[132:135]
buffer_load_dwordx4 v249, s[32:35], s51 offen offset:0 sc1 lds
v_mfma_f32_16x16x32_bf16 v[136:139], a[152:155], a[80:83], v[136:139]
s_cmp_lt_u32 s17, s63
ds_read_b128 a[4:7], v240 offset:7168
v_mfma_f32_16x16x32_bf16 v[136:139], a[156:159], a[84:87], v[136:139]
s_cselect_b32 s49, s17, 63
ds_read_b64_tr_b16 a[58:59], v241 offset:3072
v_mfma_f32_16x16x32_bf16 v[140:143], a[136:139], a[88:91], v[140:143]
s_add_u32 s51, s5, s57
ds_read_b128 a[8:11], v240 offset:1024
v_mfma_f32_16x16x32_bf16 v[140:143], a[140:143], a[92:95], v[140:143]
buffer_load_dwordx4 v249, s[32:35], s51 offen offset:1024 sc1 lds
v_mfma_f32_16x16x32_bf16 v[144:147], a[144:147], a[88:91], v[144:147]
ds_read_b64_tr_b16 a[64:65], v241 offset:512
v_readlane_b32 s16, v243, s49
v_mfma_f32_16x16x32_bf16 v[144:147], a[148:151], a[92:95], v[144:147]
s_add_u32 s17, s17, 1
ds_read_b128 a[12:15], v240 offset:8192
v_mfma_f32_16x16x32_bf16 v[148:151], a[152:155], a[88:91], v[148:151]
s_add_u32 s51, s5, s58
ds_read_b64_tr_b16 a[66:67], v241 offset:3584
v_mfma_f32_16x16x32_bf16 v[148:151], a[156:159], a[92:95], v[148:151]
buffer_load_dwordx4 v249, s[32:35], s51 offen offset:2048 sc1 lds
v_mfma_f32_16x16x32_bf16 v[152:155], a[136:139], a[96:99], v[152:155]
s_mul_i32 s11, s11, -1
ds_read_b128 a[16:19], v240 offset:2048
v_mfma_f32_16x16x32_bf16 v[152:155], a[140:143], a[100:103], v[152:155]
s_add_u32 m0, s8, s14
ds_read_b64_tr_b16 a[72:73], v241 offset:1024
v_mfma_f32_16x16x32_bf16 v[156:159], a[144:147], a[96:99], v[156:159]
s_add_u32 s51, s5, s59
ds_read_b128 a[20:23], v240 offset:9216
v_mfma_f32_16x16x32_bf16 v[156:159], a[148:151], a[100:103], v[156:159]
s_mov_b32 exec_hi, 0
buffer_load_dwordx4 v249, s[32:35], s51 offen sc1 lds
s_mov_b32 exec_hi, -1
v_mfma_f32_16x16x32_bf16 v[160:163], a[152:155], a[96:99], v[160:163]
s_mul_i32 s5, s16, 294912
ds_read_b64_tr_b16 a[74:75], v241 offset:4096
v_mfma_f32_16x16x32_bf16 v[160:163], a[156:159], a[100:103], v[160:163]
s_add_u32 m0, s8, s7
ds_read_b128 a[24:27], v240 offset:3072
v_mfma_f32_16x16x32_bf16 v[176:179], a[136:139], a[104:107], v[176:179]
s_add_u32 s51, s52, 2048
ds_read_b64_tr_b16 a[60:61], v241 offset:6144
v_mfma_f32_16x16x32_bf16 v[176:179], a[140:143], a[108:111], v[176:179]
buffer_load_dwordx4 v248, s[28:31], s51 offen offset:0 lds
v_mfma_f32_16x16x32_bf16 v[180:183], a[144:147], a[104:107], v[180:183]
s_mul_i32 s16, s16, 73728
ds_read_b128 a[28:31], v240 offset:10240
v_mfma_f32_16x16x32_bf16 v[180:183], a[148:151], a[108:111], v[180:183]
s_add_u32 s8, s8, 38976
ds_read_b64_tr_b16 a[62:63], v241 offset:9216
v_mfma_f32_16x16x32_bf16 v[184:187], a[152:155], a[104:107], v[184:187]
s_add_u32 s51, s52, 1152
ds_read_b128 a[32:35], v240 offset:4096
v_mfma_f32_16x16x32_bf16 v[184:187], a[156:159], a[108:111], v[184:187]
buffer_load_dwordx4 v248, s[28:31], s51 offen offset:1024 lds
v_mfma_f32_16x16x32_bf16 v[188:191], a[136:139], a[112:115], v[188:191]
s_add_u32 s50, s65, 301056
ds_read_b64_tr_b16 a[68:69], v241 offset:6656
v_mfma_f32_16x16x32_bf16 v[188:191], a[140:143], a[116:119], v[188:191]
buffer_store_dwordx4 v[120:123], v249, s[44:47], s50 offen offset:0 sc1
v_mfma_f32_16x16x32_bf16 v[192:195], a[144:147], a[112:115], v[192:195]
s_add_u32 s51, s52, 256
ds_read_b128 a[36:39], v240 offset:11264
v_mfma_f32_16x16x32_bf16 v[192:195], a[148:151], a[116:119], v[192:195]
buffer_load_dwordx4 v248, s[28:31], s51 offen offset:2048 lds
v_mfma_f32_16x16x32_bf16 v[196:199], a[152:155], a[112:115], v[196:199]
ds_read_b64_tr_b16 a[70:71], v241 offset:9728
v_mfma_f32_16x16x32_bf16 v[196:199], a[156:159], a[116:119], v[196:199]
s_add_u32 m0, m0, 3072
ds_read_b128 a[40:43], v240 offset:5120
v_mfma_f32_16x16x32_bf16 v[200:203], a[136:139], a[120:123], v[200:203]
s_add_u32 s51, s52, 20480
ds_read_b64_tr_b16 a[76:77], v241 offset:7168
v_mfma_f32_16x16x32_bf16 v[200:203], a[140:143], a[124:127], v[200:203]
buffer_load_dwordx4 v248, s[28:31], s51 offen offset:0 lds
v_mfma_f32_16x16x32_bf16 v[204:207], a[144:147], a[120:123], v[204:207]
s_cmp_eq_u32 s8, s10
ds_read_b128 a[44:47], v240 offset:12288
v_mfma_f32_16x16x32_bf16 v[204:207], a[148:151], a[124:127], v[204:207]
s_cselect_b32 s8, s9, s8
ds_read_b64_tr_b16 a[78:79], v241 offset:10240
v_mfma_f32_16x16x32_bf16 v[208:211], a[152:155], a[120:123], v[208:211]
s_add_u32 s51, s52, 19584
ds_read_b128 a[48:51], v240 offset:6144
v_mfma_f32_16x16x32_bf16 v[208:211], a[156:159], a[124:127], v[208:211]
buffer_load_dwordx4 v248, s[28:31], s51 offen offset:1024 lds
v_mfma_f32_16x16x32_bf16 v[212:215], a[136:139], a[128:131], v[212:215]
ds_read_b128 a[52:55], v240 offset:13312
v_mfma_f32_16x16x32_bf16 v[212:215], a[140:143], a[132:135], v[212:215]
v_mfma_f32_16x16x32_bf16 v[216:219], a[144:147], a[128:131], v[216:219]
s_add_u32 s51, s52, 18688
v_mfma_f32_16x16x32_bf16 v[216:219], a[148:151], a[132:135], v[216:219]
buffer_load_dwordx4 v248, s[28:31], s51 offen offset:2048 lds
v_mfma_f32_16x16x32_bf16 v[220:223], a[152:155], a[128:131], v[220:223]
s_add_u32 s52, s16, s18
v_mfma_f32_16x16x32_bf16 v[220:223], a[156:159], a[132:135], v[220:223]
s_waitcnt vmcnt(11) lgkmcnt(0)
v_mfma_f32_16x16x32_bf16 v[128:131], a[56:59], a[0:3], v[128:131]
s_barrier
v_mfma_f32_16x16x32_bf16 v[128:131], a[60:63], a[4:7], v[128:131]
s_mov_b32 m0, s8
ds_read_b128 a[80:83], v240 offset:38976
v_mfma_f32_16x16x32_bf16 v[132:135], a[64:67], a[0:3], v[132:135]
s_add_u32 s51, s5, s56
ds_read_b64_tr_b16 a[136:137], v241 offset:38976
v_mfma_f32_16x16x32_bf16 v[132:135], a[68:71], a[4:7], v[132:135]
buffer_load_dwordx4 v249, s[32:35], s51 offen offset:0 sc1 lds
v_mfma_f32_16x16x32_bf16 v[136:139], a[72:75], a[0:3], v[136:139]
s_cmp_lt_u32 s17, s63
ds_read_b128 a[84:87], v240 offset:46144
v_mfma_f32_16x16x32_bf16 v[136:139], a[76:79], a[4:7], v[136:139]
s_cselect_b32 s49, s17, 63
ds_read_b64_tr_b16 a[138:139], v241 offset:42048
v_mfma_f32_16x16x32_bf16 v[140:143], a[56:59], a[8:11], v[140:143]
s_add_u32 s51, s5, s57
ds_read_b128 a[88:91], v240 offset:40000
v_mfma_f32_16x16x32_bf16 v[140:143], a[60:63], a[12:15], v[140:143]
buffer_load_dwordx4 v249, s[32:35], s51 offen offset:1024 sc1 lds
v_mfma_f32_16x16x32_bf16 v[144:147], a[64:67], a[8:11], v[144:147]
ds_read_b64_tr_b16 a[144:145], v241 offset:39488
v_readlane_b32 s16, v243, s49
v_mfma_f32_16x16x32_bf16 v[144:147], a[68:71], a[12:15], v[144:147]
s_add_u32 s17, s17, 1
ds_read_b128 a[92:95], v240 offset:47168
v_mfma_f32_16x16x32_bf16 v[148:151], a[72:75], a[8:11], v[148:151]
s_add_u32 s51, s5, s58
ds_read_b64_tr_b16 a[146:147], v241 offset:42560
v_mfma_f32_16x16x32_bf16 v[148:151], a[76:79], a[12:15], v[148:151]
buffer_load_dwordx4 v249, s[32:35], s51 offen offset:2048 sc1 lds
v_mfma_f32_16x16x32_bf16 v[152:155], a[56:59], a[16:19], v[152:155]
ds_read_b128 a[96:99], v240 offset:41024
v_mfma_f32_16x16x32_bf16 v[152:155], a[60:63], a[20:23], v[152:155]
s_add_u32 m0, s8, s14
ds_read_b64_tr_b16 a[152:153], v241 offset:40000
v_mfma_f32_16x16x32_bf16 v[156:159], a[64:67], a[16:19], v[156:159]
s_add_u32 s51, s5, s59
ds_read_b128 a[100:103], v240 offset:48192
v_mfma_f32_16x16x32_bf16 v[156:159], a[68:71], a[20:23], v[156:159]
s_mov_b32 exec_hi, 0
buffer_load_dwordx4 v249, s[32:35], s51 offen sc1 lds
s_mov_b32 exec_hi, -1
v_mfma_f32_16x16x32_bf16 v[160:163], a[72:75], a[16:19], v[160:163]
s_mul_i32 s5, s16, 294912
ds_read_b64_tr_b16 a[154:155], v241 offset:43072
v_mfma_f32_16x16x32_bf16 v[160:163], a[76:79], a[20:23], v[160:163]
s_add_u32 m0, s8, s7
ds_read_b128 a[104:107], v240 offset:42048
v_mfma_f32_16x16x32_bf16 v[176:179], a[56:59], a[24:27], v[176:179]
s_add_u32 s51, s52, 2048
ds_read_b64_tr_b16 a[140:141], v241 offset:45120
v_mfma_f32_16x16x32_bf16 v[176:179], a[60:63], a[28:31], v[176:179]
buffer_load_dwordx4 v248, s[28:31], s51 offen offset:0 lds
v_mfma_f32_16x16x32_bf16 v[180:183], a[64:67], a[24:27], v[180:183]
s_mul_i32 s16, s16, 73728
ds_read_b128 a[108:111], v240 offset:49216
v_mfma_f32_16x16x32_bf16 v[180:183], a[68:71], a[28:31], v[180:183]
s_add_u32 s8, s8, 38976
ds_read_b64_tr_b16 a[142:143], v241 offset:48192
v_mfma_f32_16x16x32_bf16 v[184:187], a[72:75], a[24:27], v[184:187]
s_add_u32 s51, s52, 1152
ds_read_b128 a[112:115], v240 offset:43072
v_mfma_f32_16x16x32_bf16 v[184:187], a[76:79], a[28:31], v[184:187]
buffer_load_dwordx4 v248, s[28:31], s51 offen offset:1024 lds
v_mfma_f32_16x16x32_bf16 v[188:191], a[56:59], a[32:35], v[188:191]
s_add_u32 s50, s66, 0
ds_read_b64_tr_b16 a[148:149], v241 offset:45632
v_mfma_f32_16x16x32_bf16 v[188:191], a[60:63], a[36:39], v[188:191]
buffer_store_dwordx4 v[164:167], v249, s[44:47], s50 offen offset:0 sc1
v_mfma_f32_16x16x32_bf16 v[192:195], a[64:67], a[32:35], v[192:195]
s_add_u32 s51, s52, 256
ds_read_b128 a[116:119], v240 offset:50240
v_mfma_f32_16x16x32_bf16 v[192:195], a[68:71], a[36:39], v[192:195]
buffer_load_dwordx4 v248, s[28:31], s51 offen offset:2048 lds
v_mfma_f32_16x16x32_bf16 v[196:199], a[72:75], a[32:35], v[196:199]
ds_read_b64_tr_b16 a[150:151], v241 offset:48704
v_mfma_f32_16x16x32_bf16 v[196:199], a[76:79], a[36:39], v[196:199]
s_add_u32 m0, m0, 3072
ds_read_b128 a[120:123], v240 offset:44096
v_mfma_f32_16x16x32_bf16 v[200:203], a[56:59], a[40:43], v[200:203]
s_add_u32 s51, s52, 20480
ds_read_b64_tr_b16 a[156:157], v241 offset:46144
v_mfma_f32_16x16x32_bf16 v[200:203], a[60:63], a[44:47], v[200:203]
buffer_load_dwordx4 v248, s[28:31], s51 offen offset:0 lds
v_mfma_f32_16x16x32_bf16 v[204:207], a[64:67], a[40:43], v[204:207]
s_cmp_eq_u32 s8, s10
ds_read_b128 a[124:127], v240 offset:51264
v_mfma_f32_16x16x32_bf16 v[204:207], a[68:71], a[44:47], v[204:207]
s_cselect_b32 s8, s9, s8
ds_read_b64_tr_b16 a[158:159], v241 offset:49216
v_mfma_f32_16x16x32_bf16 v[208:211], a[72:75], a[40:43], v[208:211]
s_add_u32 s51, s52, 19584
ds_read_b128 a[128:131], v240 offset:45120
v_mfma_f32_16x16x32_bf16 v[208:211], a[76:79], a[44:47], v[208:211]
buffer_load_dwordx4 v248, s[28:31], s51 offen offset:1024 lds
v_mfma_f32_16x16x32_bf16 v[212:215], a[56:59], a[48:51], v[212:215]
ds_read_b128 a[132:135], v240 offset:52288
v_mfma_f32_16x16x32_bf16 v[212:215], a[60:63], a[52:55], v[212:215]
v_add_u32 v240, s11, v240
v_add_u32 v241, s11, v241
v_mfma_f32_16x16x32_bf16 v[216:219], a[64:67], a[48:51], v[216:219]
s_add_u32 s51, s52, 18688
v_mfma_f32_16x16x32_bf16 v[216:219], a[68:71], a[52:55], v[216:219]
buffer_load_dwordx4 v248, s[28:31], s51 offen offset:2048 lds
v_mfma_f32_16x16x32_bf16 v[220:223], a[72:75], a[48:51], v[220:223]
s_add_u32 s52, s16, s18
v_mfma_f32_16x16x32_bf16 v[220:223], a[76:79], a[52:55], v[220:223]
s_waitcnt vmcnt(11) lgkmcnt(0)
v_mfma_f32_16x16x32_bf16 v[128:131], a[136:139], a[80:83], v[128:131]
s_barrier
v_mfma_f32_16x16x32_bf16 v[128:131], a[140:143], a[84:87], v[128:131]
s_mov_b32 m0, s8
ds_read_b128 a[0:3], v240 offset:0
v_mfma_f32_16x16x32_bf16 v[132:135], a[144:147], a[80:83], v[132:135]
s_add_u32 s51, s5, s56
ds_read_b64_tr_b16 a[56:57], v241 offset:0
v_mfma_f32_16x16x32_bf16 v[132:135], a[148:151], a[84:87], v[132:135]
buffer_load_dwordx4 v249, s[32:35], s51 offen offset:0 sc1 lds
v_mfma_f32_16x16x32_bf16 v[136:139], a[152:155], a[80:83], v[136:139]
s_cmp_lt_u32 s17, s63
ds_read_b128 a[4:7], v240 offset:7168
v_mfma_f32_16x16x32_bf16 v[136:139], a[156:159], a[84:87], v[136:139]
s_cselect_b32 s49, s17, 63
ds_read_b64_tr_b16 a[58:59], v241 offset:3072
v_mfma_f32_16x16x32_bf16 v[140:143], a[136:139], a[88:91], v[140:143]
s_add_u32 s51, s5, s57
ds_read_b128 a[8:11], v240 offset:1024
v_mfma_f32_16x16x32_bf16 v[140:143], a[140:143], a[92:95], v[140:143]
buffer_load_dwordx4 v249, s[32:35], s51 offen offset:1024 sc1 lds
v_mfma_f32_16x16x32_bf16 v[144:147], a[144:147], a[88:91], v[144:147]
ds_read_b64_tr_b16 a[64:65], v241 offset:512
v_readlane_b32 s16, v243, s49
v_mfma_f32_16x16x32_bf16 v[144:147], a[148:151], a[92:95], v[144:147]
s_add_u32 s17, s17, 1
ds_read_b128 a[12:15], v240 offset:8192
v_mfma_f32_16x16x32_bf16 v[148:151], a[152:155], a[88:91], v[148:151]
s_add_u32 s51, s5, s58
ds_read_b64_tr_b16 a[66:67], v241 offset:3584
v_mfma_f32_16x16x32_bf16 v[148:151], a[156:159], a[92:95], v[148:151]
buffer_load_dwordx4 v249, s[32:35], s51 offen offset:2048 sc1 lds
v_mfma_f32_16x16x32_bf16 v[152:155], a[136:139], a[96:99], v[152:155]
s_mul_i32 s11, s11, -1
ds_read_b128 a[16:19], v240 offset:2048
v_mfma_f32_16x16x32_bf16 v[152:155], a[140:143], a[100:103], v[152:155]
s_add_u32 m0, s8, s14
ds_read_b64_tr_b16 a[72:73], v241 offset:1024
v_mfma_f32_16x16x32_bf16 v[156:159], a[144:147], a[96:99], v[156:159]
s_add_u32 s51, s5, s59
ds_read_b128 a[20:23], v240 offset:9216
v_mfma_f32_16x16x32_bf16 v[156:159], a[148:151], a[100:103], v[156:159]
s_mov_b32 exec_hi, 0
buffer_load_dwordx4 v249, s[32:35], s51 offen sc1 lds
s_mov_b32 exec_hi, -1
v_mfma_f32_16x16x32_bf16 v[160:163], a[152:155], a[96:99], v[160:163]
s_mul_i32 s5, s16, 294912
ds_read_b64_tr_b16 a[74:75], v241 offset:4096
v_mfma_f32_16x16x32_bf16 v[160:163], a[156:159], a[100:103], v[160:163]
s_add_u32 m0, s8, s7
ds_read_b128 a[24:27], v240 offset:3072
v_mfma_f32_16x16x32_bf16 v[176:179], a[136:139], a[104:107], v[176:179]
s_add_u32 s51, s52, 2048
ds_read_b64_tr_b16 a[60:61], v241 offset:6144
v_mfma_f32_16x16x32_bf16 v[176:179], a[140:143], a[108:111], v[176:179]
buffer_load_dwordx4 v248, s[28:31], s51 offen offset:0 lds
v_mfma_f32_16x16x32_bf16 v[180:183], a[144:147], a[104:107], v[180:183]
s_mul_i32 s16, s16, 73728
ds_read_b128 a[28:31], v240 offset:10240
v_mfma_f32_16x16x32_bf16 v[180:183], a[148:151], a[108:111], v[180:183]
s_add_u32 s8, s8, 38976
ds_read_b64_tr_b16 a[62:63], v241 offset:9216
v_mfma_f32_16x16x32_bf16 v[184:187], a[152:155], a[104:107], v[184:187]
s_add_u32 s51, s52, 1152
ds_read_b128 a[32:35], v240 offset:4096
v_mfma_f32_16x16x32_bf16 v[184:187], a[156:159], a[108:111], v[184:187]
buffer_load_dwordx4 v248, s[28:31], s51 offen offset:1024 lds
v_mfma_f32_16x16x32_bf16 v[188:191], a[136:139], a[112:115], v[188:191]
s_add_u32 s50, s66, 294912
ds_read_b64_tr_b16 a[68:69], v241 offset:6656
v_mfma_f32_16x16x32_bf16 v[188:191], a[140:143], a[116:119], v[188:191]
buffer_store_dwordx4 v[172:175], v249, s[44:47], s50 offen offset:0 sc1
v_mfma_f32_16x16x32_bf16 v[192:195], a[144:147], a[112:115], v[192:195]
s_add_u32 s51, s52, 256
ds_read_b128 a[36:39], v240 offset:11264
v_mfma_f32_16x16x32_bf16 v[192:195], a[148:151], a[116:119], v[192:195]
buffer_load_dwordx4 v248, s[28:31], s51 offen offset:2048 lds
v_mfma_f32_16x16x32_bf16 v[196:199], a[152:155], a[112:115], v[196:199]
ds_read_b64_tr_b16 a[70:71], v241 offset:9728
v_mfma_f32_16x16x32_bf16 v[196:199], a[156:159], a[116:119], v[196:199]
s_add_u32 m0, m0, 3072
ds_read_b128 a[40:43], v240 offset:5120
v_mfma_f32_16x16x32_bf16 v[200:203], a[136:139], a[120:123], v[200:203]
s_add_u32 s51, s52, 20480
ds_read_b64_tr_b16 a[76:77], v241 offset:7168
v_mfma_f32_16x16x32_bf16 v[200:203], a[140:143], a[124:127], v[200:203]
buffer_load_dwordx4 v248, s[28:31], s51 offen offset:0 lds
v_mfma_f32_16x16x32_bf16 v[204:207], a[144:147], a[120:123], v[204:207]
s_cmp_eq_u32 s8, s10
ds_read_b128 a[44:47], v240 offset:12288
v_mfma_f32_16x16x32_bf16 v[204:207], a[148:151], a[124:127], v[204:207]
s_cselect_b32 s8, s9, s8
ds_read_b64_tr_b16 a[78:79], v241 offset:10240
v_mfma_f32_16x16x32_bf16 v[208:211], a[152:155], a[120:123], v[208:211]
s_add_u32 s51, s52, 19584
ds_read_b128 a[48:51], v240 offset:6144
v_mfma_f32_16x16x32_bf16 v[208:211], a[156:159], a[124:127], v[208:211]
buffer_load_dwordx4 v248, s[28:31], s51 offen offset:1024 lds
v_mfma_f32_16x16x32_bf16 v[212:215], a[136:139], a[128:131], v[212:215]
ds_read_b128 a[52:55], v240 offset:13312
v_mfma_f32_16x16x32_bf16 v[212:215], a[140:143], a[132:135], v[212:215]
v_mfma_f32_16x16x32_bf16 v[216:219], a[144:147], a[128:131], v[216:219]
s_add_u32 s51, s52, 18688
v_mfma_f32_16x16x32_bf16 v[216:219], a[148:151], a[132:135], v[216:219]
buffer_load_dwordx4 v248, s[28:31], s51 offen offset:2048 lds
v_mfma_f32_16x16x32_bf16 v[220:223], a[152:155], a[128:131], v[220:223]
s_add_u32 s52, s16, s18
v_mfma_f32_16x16x32_bf16 v[220:223], a[156:159], a[132:135], v[220:223]
s_waitcnt vmcnt(11) lgkmcnt(0)
v_mfma_f32_16x16x32_bf16 v[128:131], a[56:59], a[0:3], v[128:131]
s_barrier
v_mfma_f32_16x16x32_bf16 v[128:131], a[60:63], a[4:7], v[128:131]
s_mov_b32 m0, s8
ds_read_b128 a[80:83], v240 offset:38976
v_mfma_f32_16x16x32_bf16 v[132:135], a[64:67], a[0:3], v[132:135]
s_add_u32 s51, s5, s56
ds_read_b64_tr_b16 a[136:137], v241 offset:38976
v_mfma_f32_16x16x32_bf16 v[132:135], a[68:71], a[4:7], v[132:135]
buffer_load_dwordx4 v249, s[32:35], s51 offen offset:0 sc1 lds
v_mfma_f32_16x16x32_bf16 v[136:139], a[72:75], a[0:3], v[136:139]
s_cmp_lt_u32 s17, s63
ds_read_b128 a[84:87], v240 offset:46144
v_mfma_f32_16x16x32_bf16 v[136:139], a[76:79], a[4:7], v[136:139]
s_cselect_b32 s49, s17, 63
ds_read_b64_tr_b16 a[138:139], v241 offset:42048
v_mfma_f32_16x16x32_bf16 v[140:143], a[56:59], a[8:11], v[140:143]
s_add_u32 s51, s5, s57
ds_read_b128 a[88:91], v240 offset:40000
v_mfma_f32_16x16x32_bf16 v[140:143], a[60:63], a[12:15], v[140:143]
buffer_load_dwordx4 v249, s[32:35], s51 offen offset:1024 sc1 lds
v_mfma_f32_16x16x32_bf16 v[144:147], a[64:67], a[8:11], v[144:147]
ds_read_b64_tr_b16 a[144:145], v241 offset:39488
v_readlane_b32 s16, v243, s49
v_mfma_f32_16x16x32_bf16 v[144:147], a[68:71], a[12:15], v[144:147]
s_add_u32 s17, s17, 1
ds_read_b128 a[92:95], v240 offset:47168
v_mfma_f32_16x16x32_bf16 v[148:151], a[72:75], a[8:11], v[148:151]
s_add_u32 s51, s5, s58
ds_read_b64_tr_b16 a[146:147], v241 offset:42560
v_mfma_f32_16x16x32_bf16 v[148:151], a[76:79], a[12:15], v[148:151]
buffer_load_dwordx4 v249, s[32:35], s51 offen offset:2048 sc1 lds
v_mfma_f32_16x16x32_bf16 v[152:155], a[56:59], a[16:19], v[152:155]
ds_read_b128 a[96:99], v240 offset:41024
v_mfma_f32_16x16x32_bf16 v[152:155], a[60:63], a[20:23], v[152:155]
s_add_u32 m0, s8, s14
ds_read_b64_tr_b16 a[152:153], v241 offset:40000
v_mfma_f32_16x16x32_bf16 v[156:159], a[64:67], a[16:19], v[156:159]
s_add_u32 s51, s5, s59
ds_read_b128 a[100:103], v240 offset:48192
v_mfma_f32_16x16x32_bf16 v[156:159], a[68:71], a[20:23], v[156:159]
s_mov_b32 exec_hi, 0
buffer_load_dwordx4 v249, s[32:35], s51 offen sc1 lds
s_mov_b32 exec_hi, -1
v_mfma_f32_16x16x32_bf16 v[160:163], a[72:75], a[16:19], v[160:163]
s_mul_i32 s5, s16, 294912
ds_read_b64_tr_b16 a[154:155], v241 offset:43072
v_mfma_f32_16x16x32_bf16 v[160:163], a[76:79], a[20:23], v[160:163]
s_add_u32 m0, s8, s7
ds_read_b128 a[104:107], v240 offset:42048
v_mfma_f32_16x16x32_bf16 v[176:179], a[56:59], a[24:27], v[176:179]
s_add_u32 s51, s52, 2048
ds_read_b64_tr_b16 a[140:141], v241 offset:45120
v_mfma_f32_16x16x32_bf16 v[176:179], a[60:63], a[28:31], v[176:179]
buffer_load_dwordx4 v248, s[28:31], s51 offen offset:0 lds
v_mfma_f32_16x16x32_bf16 v[180:183], a[64:67], a[24:27], v[180:183]
s_mul_i32 s16, s16, 73728
ds_read_b128 a[108:111], v240 offset:49216
v_mfma_f32_16x16x32_bf16 v[180:183], a[68:71], a[28:31], v[180:183]
s_add_u32 s8, s8, 38976
ds_read_b64_tr_b16 a[142:143], v241 offset:48192
v_mfma_f32_16x16x32_bf16 v[184:187], a[72:75], a[24:27], v[184:187]
s_add_u32 s51, s52, 1152
ds_read_b128 a[112:115], v240 offset:43072
v_mfma_f32_16x16x32_bf16 v[184:187], a[76:79], a[28:31], v[184:187]
buffer_load_dwordx4 v248, s[28:31], s51 offen offset:1024 lds
v_mfma_f32_16x16x32_bf16 v[188:191], a[56:59], a[32:35], v[188:191]
s_lshl_b32 s77, s6, 2
ds_read_b64_tr_b16 a[148:149], v241 offset:45632
v_mfma_f32_16x16x32_bf16 v[188:191], a[60:63], a[36:39], v[188:191]
ds_read_b128 a[116:119], v240 offset:50240
v_mfma_f32_16x16x32_bf16 v[192:195], a[64:67], a[32:35], v[192:195]
s_add_u32 s51, s52, 256
ds_read_b64_tr_b16 a[150:151], v241 offset:48704
v_mfma_f32_16x16x32_bf16 v[192:195], a[68:71], a[36:39], v[192:195]
buffer_load_dwordx4 v248, s[28:31], s51 offen offset:2048 lds
v_mfma_f32_16x16x32_bf16 v[196:199], a[72:75], a[32:35], v[196:199]
s_add_u32 s68, s4, 1
ds_read_b128 a[120:123], v240 offset:44096
v_mfma_f32_16x16x32_bf16 v[196:199], a[76:79], a[36:39], v[196:199]
s_add_u32 m0, m0, 3072
ds_read_b64_tr_b16 a[156:157], v241 offset:46144
v_mov_b32 v246, 0
v_mfma_f32_16x16x32_bf16 v[200:203], a[56:59], a[40:43], v[200:203]
s_add_u32 s51, s52, 20480
ds_read_b128 a[124:127], v240 offset:51264
v_mov_b32 v247, 3
v_mfma_f32_16x16x32_bf16 v[200:203], a[60:63], a[44:47], v[200:203]
buffer_load_dwordx4 v248, s[28:31], s51 offen offset:0 lds
v_mfma_f32_16x16x32_bf16 v[204:207], a[64:67], a[40:43], v[204:207]
s_cmp_eq_u32 s8, s10
ds_read_b64_tr_b16 a[158:159], v241 offset:49216
v_mfma_f32_16x16x32_bf16 v[204:207], a[68:71], a[44:47], v[204:207]
s_cselect_b32 s8, s9, s8
ds_read_b128 a[128:131], v240 offset:45120
v_mfma_f32_16x16x32_bf16 v[208:211], a[72:75], a[40:43], v[208:211]
s_add_u32 s51, s52, 19584
ds_read_b128 a[132:135], v240 offset:52288
v_mfma_f32_16x16x32_bf16 v[208:211], a[76:79], a[44:47], v[208:211]
buffer_load_dwordx4 v248, s[28:31], s51 offen offset:1024 lds
v_mfma_f32_16x16x32_bf16 v[212:215], a[56:59], a[48:51], v[212:215]
s_mov_b32 s55, 1073741824
v_add_u32 v240, s11, v240
v_add_u32_e64 v241, s11, v241
v_mfma_f32_16x16x32_bf16 v[212:215], a[60:63], a[52:55], v[212:215]
v_mfma_f32_16x16x32_bf16 v[216:219], a[64:67], a[48:51], v[216:219]
s_add_u32 s51, s52, 18688
v_mfma_f32_16x16x32_bf16 v[216:219], a[68:71], a[52:55], v[216:219]
buffer_load_dwordx4 v248, s[28:31], s51 offen offset:2048 lds
v_mfma_f32_16x16x32_bf16 v[220:223], a[72:75], a[48:51], v[220:223]
s_add_u32 s52, s16, s18
v_mfma_f32_16x16x32_bf16 v[220:223], a[76:79], a[52:55], v[220:223]
s_waitcnt vmcnt(10) lgkmcnt(0)
L_op_loop:
v_mfma_f32_16x16x32_bf16 v[128:131], a[136:139], a[80:83], v[128:131]
s_barrier
v_mfma_f32_16x16x32_bf16 v[128:131], a[140:143], a[84:87], v[128:131]
s_mov_b32 m0, s8
v_readfirstlane_b32 s60, v246
v_mov_b32 v246, s68
v_mfma_f32_16x16x32_bf16 v[132:135], a[144:147], a[80:83], v[132:135]
s_add_u32 s51, s5, s56
s_mov_b64 exec, 1
buffer_atomic_cmpswap v[246:247], off, s[40:43], s55 sc0 sc1
s_mov_b64 exec, -1
v_mfma_f32_16x16x32_bf16 v[132:135], a[148:151], a[84:87], v[132:135]
buffer_load_dwordx4 v249, s[32:35], s51 offen offset:0 sc1 lds
v_mfma_f32_16x16x32_bf16 v[136:139], a[152:155], a[80:83], v[136:139]
s_cmp_lt_u32 s17, s63
ds_read_b128 a[0:3], v240 offset:0
v_mfma_f32_16x16x32_bf16 v[136:139], a[156:159], a[84:87], v[136:139]
s_cselect_b32 s49, s17, 63
ds_read_b64_tr_b16 a[56:57], v241 offset:0
v_mfma_f32_16x16x32_bf16 v[140:143], a[136:139], a[88:91], v[140:143]
s_add_u32 s51, s5, s57
ds_read_b128 a[4:7], v240 offset:7168
v_mfma_f32_16x16x32_bf16 v[140:143], a[140:143], a[92:95], v[140:143]
buffer_load_dwordx4 v249, s[32:35], s51 offen offset:1024 sc1 lds
v_mfma_f32_16x16x32_bf16 v[144:147], a[144:147], a[88:91], v[144:147]
ds_read_b64_tr_b16 a[58:59], v241 offset:3072
v_readlane_b32 s16, v243, s49
v_mfma_f32_16x16x32_bf16 v[144:147], a[148:151], a[92:95], v[144:147]
s_add_u32 s17, s17, 1
ds_read_b128 a[8:11], v240 offset:1024
v_mfma_f32_16x16x32_bf16 v[148:151], a[152:155], a[88:91], v[148:151]
s_add_u32 s51, s5, s58
ds_read_b64_tr_b16 a[64:65], v241 offset:512
v_mfma_f32_16x16x32_bf16 v[148:151], a[156:159], a[92:95], v[148:151]
buffer_load_dwordx4 v249, s[32:35], s51 offen offset:2048 sc1 lds
v_mfma_f32_16x16x32_bf16 v[152:155], a[136:139], a[96:99], v[152:155]
s_mul_i32 s11, s11, -1
ds_read_b128 a[12:15], v240 offset:8192
v_mfma_f32_16x16x32_bf16 v[152:155], a[140:143], a[100:103], v[152:155]
s_add_u32 m0, s8, s14
ds_read_b64_tr_b16 a[66:67], v241 offset:3584
v_mfma_f32_16x16x32_bf16 v[156:159], a[144:147], a[96:99], v[156:159]
s_add_u32 s51, s5, s59
ds_read_b128 a[16:19], v240 offset:2048
v_mfma_f32_16x16x32_bf16 v[156:159], a[148:151], a[100:103], v[156:159]
s_mov_b32 exec_hi, 0
buffer_load_dwordx4 v249, s[32:35], s51 offen sc1 lds
s_mov_b32 exec_hi, -1
v_mfma_f32_16x16x32_bf16 v[160:163], a[152:155], a[96:99], v[160:163]
s_mul_i32 s5, s16, 294912
ds_read_b64_tr_b16 a[72:73], v241 offset:1024
v_mfma_f32_16x16x32_bf16 v[160:163], a[156:159], a[100:103], v[160:163]
s_add_u32 m0, s8, s7
ds_read_b128 a[20:23], v240 offset:9216
v_mfma_f32_16x16x32_bf16 v[176:179], a[136:139], a[104:107], v[176:179]
s_add_u32 s51, s52, 2048
ds_read_b64_tr_b16 a[74:75], v241 offset:4096
v_mfma_f32_16x16x32_bf16 v[176:179], a[140:143], a[108:111], v[176:179]
buffer_load_dwordx4 v248, s[28:31], s51 offen offset:0 lds
v_mfma_f32_16x16x32_bf16 v[180:183], a[144:147], a[104:107], v[180:183]
s_mul_i32 s16, s16, 73728
s_add_u32 s8, s8, 38976
ds_read_b128 a[24:27], v240 offset:3072
v_mfma_f32_16x16x32_bf16 v[180:183], a[148:151], a[108:111], v[180:183]
s_add_u32 s71, s71, s77
ds_read_b64_tr_b16 a[60:61], v241 offset:6144
v_mfma_f32_16x16x32_bf16 v[184:187], a[152:155], a[104:107], v[184:187]
s_add_u32 s51, s52, 1152
ds_read_b128 a[28:31], v240 offset:10240
v_mfma_f32_16x16x32_bf16 v[184:187], a[156:159], a[108:111], v[184:187]
buffer_load_dwordx4 v248, s[28:31], s51 offen offset:1024 lds
v_mfma_f32_16x16x32_bf16 v[188:191], a[136:139], a[112:115], v[188:191]
s_bitcmp1_b32 s60, s4
s_cselect_b32 s60, 2, 0
ds_read_b64_tr_b16 a[62:63], v241 offset:9216
v_mfma_f32_16x16x32_bf16 v[188:191], a[140:143], a[116:119], v[188:191]
s_add_u32 s63, s63, s60
ds_read_b128 a[32:35], v240 offset:4096
v_mfma_f32_16x16x32_bf16 v[192:195], a[144:147], a[112:115], v[192:195]
s_add_u32 s51, s52, 256
ds_read_b64_tr_b16 a[68:69], v241 offset:6656
v_mfma_f32_16x16x32_bf16 v[192:195], a[148:151], a[116:119], v[192:195]
buffer_load_dwordx4 v248, s[28:31], s51 offen offset:2048 lds
v_mfma_f32_16x16x32_bf16 v[196:199], a[152:155], a[112:115], v[196:199]
ds_read_b128 a[36:39], v240 offset:11264
v_mfma_f32_16x16x32_bf16 v[196:199], a[156:159], a[116:119], v[196:199]
s_add_u32 m0, m0, 3072
ds_read_b64_tr_b16 a[70:71], v241 offset:9728
v_mfma_f32_16x16x32_bf16 v[200:203], a[136:139], a[120:123], v[200:203]
s_add_u32 s51, s52, 20480
ds_read_b128 a[40:43], v240 offset:5120
v_mfma_f32_16x16x32_bf16 v[200:203], a[140:143], a[124:127], v[200:203]
buffer_load_dwordx4 v248, s[28:31], s51 offen offset:0 lds
v_mfma_f32_16x16x32_bf16 v[204:207], a[144:147], a[120:123], v[204:207]
s_cmp_eq_u32 s8, s10
ds_read_b64_tr_b16 a[76:77], v241 offset:7168
v_mfma_f32_16x16x32_bf16 v[204:207], a[148:151], a[124:127], v[204:207]
s_cselect_b32 s8, s9, s8
ds_read_b128 a[44:47], v240 offset:12288
v_mfma_f32_16x16x32_bf16 v[208:211], a[152:155], a[120:123], v[208:211]
s_add_u32 s51, s52, 19584
ds_read_b64_tr_b16 a[78:79], v241 offset:10240
v_mfma_f32_16x16x32_bf16 v[208:211], a[156:159], a[124:127], v[208:211]
buffer_load_dwordx4 v248, s[28:31], s51 offen offset:1024 lds
v_mfma_f32_16x16x32_bf16 v[212:215], a[136:139], a[128:131], v[212:215]
ds_read_b128 a[48:51], v240 offset:6144
v_mfma_f32_16x16x32_bf16 v[212:215], a[140:143], a[132:135], v[212:215]
ds_read_b128 a[52:55], v240 offset:13312
v_mfma_f32_16x16x32_bf16 v[216:219], a[144:147], a[128:131], v[216:219]
s_add_u32 s51, s52, 18688
v_mfma_f32_16x16x32_bf16 v[216:219], a[148:151], a[132:135], v[216:219]
buffer_load_dwordx4 v248, s[28:31], s51 offen offset:2048 lds
v_mfma_f32_16x16x32_bf16 v[220:223], a[152:155], a[128:131], v[220:223]
s_add_u32 s52, s16, s18
v_mfma_f32_16x16x32_bf16 v[220:223], a[156:159], a[132:135], v[220:223]
s_waitcnt vmcnt(11) lgkmcnt(0)
s_bitcmp1_b32 0x14001500, s62
v_mfma_f32_16x16x32_bf16 v[128:131], a[56:59], a[0:3], v[128:131]
s_barrier
v_mfma_f32_16x16x32_bf16 v[128:131], a[60:63], a[4:7], v[128:131]
s_cbranch_scc1 L_op_hook
L_op_back:
s_mov_b32 m0, s8
ds_read_b128 a[80:83], v240 offset:38976
v_mfma_f32_16x16x32_bf16 v[132:135], a[64:67], a[0:3], v[132:135]
s_add_u32 s51, s5, s56
ds_read_b64_tr_b16 a[136:137], v241 offset:38976
v_mfma_f32_16x16x32_bf16 v[132:135], a[68:71], a[4:7], v[132:135]
buffer_load_dwordx4 v249, s[32:35], s51 offen offset:0 sc1 lds
v_mfma_f32_16x16x32_bf16 v[136:139], a[72:75], a[0:3], v[136:139]
s_cmp_lt_u32 s17, s63
ds_read_b128 a[84:87], v240 offset:46144
v_mfma_f32_16x16x32_bf16 v[136:139], a[76:79], a[4:7], v[136:139]
s_cselect_b32 s49, s17, 63
ds_read_b64_tr_b16 a[138:139], v241 offset:42048
v_mfma_f32_16x16x32_bf16 v[140:143], a[56:59], a[8:11], v[140:143]
s_add_u32 s51, s5, s57
ds_read_b128 a[88:91], v240 offset:40000
v_mfma_f32_16x16x32_bf16 v[140:143], a[60:63], a[12:15], v[140:143]
buffer_load_dwordx4 v249, s[32:35], s51 offen offset:1024 sc1 lds
v_mfma_f32_16x16x32_bf16 v[144:147], a[64:67], a[8:11], v[144:147]
ds_read_b64_tr_b16 a[144:145], v241 offset:39488
v_readlane_b32 s16, v243, s49
v_mfma_f32_16x16x32_bf16 v[144:147], a[68:71], a[12:15], v[144:147]
s_add_u32 s17, s17, 1
ds_read_b128 a[92:95], v240 offset:47168
v_mfma_f32_16x16x32_bf16 v[148:151], a[72:75], a[8:11], v[148:151]
s_add_u32 s51, s5, s58
ds_read_b64_tr_b16 a[146:147], v241 offset:42560
v_mfma_f32_16x16x32_bf16 v[148:151], a[76:79], a[12:15], v[148:151]
buffer_load_dwordx4 v249, s[32:35], s51 offen offset:2048 sc1 lds
v_mfma_f32_16x16x32_bf16 v[152:155], a[56:59], a[16:19], v[152:155]
s_add_u32 s62, s62, 2
ds_read_b128 a[96:99], v240 offset:41024
v_mfma_f32_16x16x32_bf16 v[152:155], a[60:63], a[20:23], v[152:155]
s_add_u32 m0, s8, s14
ds_read_b64_tr_b16 a[152:153], v241 offset:40000
v_mfma_f32_16x16x32_bf16 v[156:159], a[64:67], a[16:19], v[156:159]
s_add_u32 s51, s5, s59
ds_read_b128 a[100:103], v240 offset:48192
v_mfma_f32_16x16x32_bf16 v[156:159], a[68:71], a[20:23], v[156:159]
s_mov_b32 exec_hi, 0
buffer_load_dwordx4 v249, s[32:35], s51 offen sc1 lds
s_mov_b32 exec_hi, -1
v_mfma_f32_16x16x32_bf16 v[160:163], a[72:75], a[16:19], v[160:163]
s_mul_i32 s5, s16, 294912
ds_read_b64_tr_b16 a[154:155], v241 offset:43072
v_mfma_f32_16x16x32_bf16 v[160:163], a[76:79], a[20:23], v[160:163]
s_add_u32 m0, s8, s7
ds_read_b128 a[104:107], v240 offset:42048
v_mfma_f32_16x16x32_bf16 v[176:179], a[56:59], a[24:27], v[176:179]
s_add_u32 s51, s52, 2048
ds_read_b64_tr_b16 a[140:141], v241 offset:45120
v_mfma_f32_16x16x32_bf16 v[176:179], a[60:63], a[28:31], v[176:179]
buffer_load_dwordx4 v248, s[28:31], s51 offen offset:0 lds
v_mfma_f32_16x16x32_bf16 v[180:183], a[64:67], a[24:27], v[180:183]
s_mul_i32 s16, s16, 73728
s_add_u32 s8, s8, 38976
ds_read_b128 a[108:111], v240 offset:49216
v_mfma_f32_16x16x32_bf16 v[180:183], a[68:71], a[28:31], v[180:183]
s_sub_u32 s55, s63, s62
ds_read_b64_tr_b16 a[142:143], v241 offset:48192
v_mfma_f32_16x16x32_bf16 v[184:187], a[72:75], a[24:27], v[184:187]
s_add_u32 s51, s52, 1152
ds_read_b128 a[112:115], v240 offset:43072
v_mfma_f32_16x16x32_bf16 v[184:187], a[76:79], a[28:31], v[184:187]
buffer_load_dwordx4 v248, s[28:31], s51 offen offset:1024 lds
v_mfma_f32_16x16x32_bf16 v[188:191], a[56:59], a[32:35], v[188:191]
s_sub_u32 s55, s55, 4
s_cmp_lt_u32 s55, 3
ds_read_b64_tr_b16 a[148:149], v241 offset:45632
v_mfma_f32_16x16x32_bf16 v[188:191], a[60:63], a[36:39], v[188:191]
s_cselect_b32 s55, s71, 1073741824
ds_read_b128 a[116:119], v240 offset:50240
v_mfma_f32_16x16x32_bf16 v[192:195], a[64:67], a[32:35], v[192:195]
s_add_u32 s51, s52, 256
ds_read_b64_tr_b16 a[150:151], v241 offset:48704
v_mfma_f32_16x16x32_bf16 v[192:195], a[68:71], a[36:39], v[192:195]
buffer_load_dwordx4 v248, s[28:31], s51 offen offset:2048 lds
v_mfma_f32_16x16x32_bf16 v[196:199], a[72:75], a[32:35], v[196:199]
ds_read_b128 a[120:123], v240 offset:44096
v_mfma_f32_16x16x32_bf16 v[196:199], a[76:79], a[36:39], v[196:199]
s_add_u32 m0, m0, 3072
ds_read_b64_tr_b16 a[156:157], v241 offset:46144
v_mfma_f32_16x16x32_bf16 v[200:203], a[56:59], a[40:43], v[200:203]
s_add_u32 s51, s52, 20480
ds_read_b128 a[124:127], v240 offset:51264
v_mfma_f32_16x16x32_bf16 v[200:203], a[60:63], a[44:47], v[200:203]
buffer_load_dwordx4 v248, s[28:31], s51 offen offset:0 lds
v_mfma_f32_16x16x32_bf16 v[204:207], a[64:67], a[40:43], v[204:207]
s_cmp_eq_u32 s8, s10
ds_read_b64_tr_b16 a[158:159], v241 offset:49216
v_mfma_f32_16x16x32_bf16 v[204:207], a[68:71], a[44:47], v[204:207]
s_cselect_b32 s8, s9, s8
ds_read_b128 a[128:131], v240 offset:45120
v_mfma_f32_16x16x32_bf16 v[208:211], a[72:75], a[40:43], v[208:211]
s_add_u32 s51, s52, 19584
ds_read_b128 a[132:135], v240 offset:52288
v_mfma_f32_16x16x32_bf16 v[208:211], a[76:79], a[44:47], v[208:211]
buffer_load_dwordx4 v248, s[28:31], s51 offen offset:1024 lds
v_mfma_f32_16x16x32_bf16 v[212:215], a[56:59], a[48:51], v[212:215]
v_add_u32 v240, s11, v240
v_add_u32_e64 v241, s11, v241
v_mfma_f32_16x16x32_bf16 v[212:215], a[60:63], a[52:55], v[212:215]
v_mfma_f32_16x16x32_bf16 v[216:219], a[64:67], a[48:51], v[216:219]
s_add_u32 s51, s52, 18688
v_mfma_f32_16x16x32_bf16 v[216:219], a[68:71], a[52:55], v[216:219]
buffer_load_dwordx4 v248, s[28:31], s51 offen offset:2048 lds
v_mfma_f32_16x16x32_bf16 v[220:223], a[72:75], a[48:51], v[220:223]
s_add_u32 s52, s16, s18
v_mfma_f32_16x16x32_bf16 v[220:223], a[76:79], a[52:55], v[220:223]
s_waitcnt vmcnt(10) lgkmcnt(0)
s_cmp_lt_u32 s62, s63
s_cbranch_scc1 L_op_loop
v_mfma_f32_16x16x32_bf16 v[212:215], a[136:139], a[128:131], v[212:215]
s_mul_i32 s51, s53, 6144
v_mfma_f32_16x16x32_bf16 v[212:215], a[140:143], a[132:135], v[212:215]
s_add_u32 s52, s51, 4096
v_mfma_f32_16x16x32_bf16 v[216:219], a[144:147], a[128:131], v[216:219]
s_mul_i32 s5, s54, 6144
v_mfma_f32_16x16x32_bf16 v[216:219], a[148:151], a[132:135], v[216:219]
s_add_u32 s8, s5, 4096
v_lshrrev_b32 v90, 7, v249
v_mfma_f32_16x16x32_bf16 v[220:223], a[152:155], a[128:131], v[220:223]
s_mul_i32 s16, s48, 6400
v_and_b32 v91, 0x70, v249
v_mfma_f32_16x16x32_bf16 v[220:223], a[156:159], a[132:135], v[220:223]
s_mul_i32 s17, s6, s48
v_mul_u32_u24 v92, 400, v90
v_mfma_f32_16x16x32_bf16 v[200:203], a[136:139], a[120:123], v[200:203]
s_add_u32 s17, s17, s15
v_mul_u32_u24 v90, 2304, v90
v_mfma_f32_16x16x32_bf16 v[200:203], a[140:143], a[124:127], v[200:203]
s_mul_i32 s17, s17, 36864
v_add3_u32 v92, v92, v91, s16
v_mfma_f32_16x16x32_bf16 v[204:207], a[144:147], a[120:123], v[204:207]
s_add_u32 s17, s17, s101
v_add_u32 v90, v90, v91
v_mfma_f32_16x16x32_bf16 v[204:207], a[148:151], a[124:127], v[204:207]
s_add_u32 s18, s17, 18432
v_cvt_pk_bf16_f32 v0, v212, v213
v_cvt_pk_bf16_f32 v1, v214, v215
v_mfma_f32_16x16x32_bf16 v[208:211], a[152:155], a[120:123], v[208:211]
s_lshl_b32 s49, s48, 1
v_mfma_f32_16x16x32_bf16 v[208:211], a[156:159], a[124:127], v[208:211]
s_add_u32 s49, s49, s4
v_cvt_pk_bf16_f32 v2, v216, v217
v_cvt_pk_bf16_f32 v3, v218, v219
v_mfma_f32_16x16x32_bf16 v[188:191], a[136:139], a[112:115], v[188:191]
s_cmp_eq_u32 s49, 7
buffer_store_dwordx4 v[0:3], v249, s[40:43], s51 offen offset:0 sc1
v_mfma_f32_16x16x32_bf16 v[188:191], a[140:143], a[116:119], v[188:191]
s_cselect_b32 s17, 1073741824, s17
v_cvt_pk_bf16_f32 v4, v220, v221
v_cvt_pk_bf16_f32 v5, v222, v223
v_mfma_f32_16x16x32_bf16 v[192:195], a[144:147], a[112:115], v[192:195]
s_cmp_eq_u32 s49, 6
v_mfma_f32_16x16x32_bf16 v[192:195], a[148:151], a[116:119], v[192:195]
s_cselect_b32 s18, 1073741824, s18
v_cvt_pk_bf16_f32 v6, v200, v201
v_cvt_pk_bf16_f32 v7, v202, v203
v_mfma_f32_16x16x32_bf16 v[196:199], a[152:155], a[112:115], v[196:199]
buffer_store_dwordx4 v[4:7], v249, s[40:43], s51 offen offset:1024 sc1
v_mfma_f32_16x16x32_bf16 v[196:199], a[156:159], a[116:119], v[196:199]
v_cvt_pk_bf16_f32 v8, v204, v205
v_cvt_pk_bf16_f32 v9, v206, v207
v_mfma_f32_16x16x32_bf16 v[176:179], a[136:139], a[104:107], v[176:179]
v_mfma_f32_16x16x32_bf16 v[176:179], a[140:143], a[108:111], v[176:179]
v_cvt_pk_bf16_f32 v10, v208, v209
v_cvt_pk_bf16_f32 v11, v210, v211
v_mfma_f32_16x16x32_bf16 v[180:183], a[144:147], a[104:107], v[180:183]
buffer_store_dwordx4 v[8:11], v249, s[40:43], s51 offen offset:2048 sc1
v_mfma_f32_16x16x32_bf16 v[180:183], a[148:151], a[108:111], v[180:183]
v_cvt_pk_bf16_f32 v12, v188, v189
v_cvt_pk_bf16_f32 v13, v190, v191
v_mfma_f32_16x16x32_bf16 v[184:187], a[152:155], a[104:107], v[184:187]
v_mfma_f32_16x16x32_bf16 v[184:187], a[156:159], a[108:111], v[184:187]
v_cvt_pk_bf16_f32 v14, v192, v193
v_cvt_pk_bf16_f32 v15, v194, v195
v_mfma_f32_16x16x32_bf16 v[128:131], a[136:139], a[80:83], v[128:131]
buffer_store_dwordx4 v[12:15], v249, s[40:43], s51 offen offset:3072 sc1
v_mfma_f32_16x16x32_bf16 v[128:131], a[140:143], a[84:87], v[128:131]
v_cvt_pk_bf16_f32 v16, v196, v197
v_cvt_pk_bf16_f32 v17, v198, v199
v_mfma_f32_16x16x32_bf16 v[132:135], a[144:147], a[80:83], v[132:135]
v_mfma_f32_16x16x32_bf16 v[132:135], a[148:151], a[84:87], v[132:135]
v_cvt_pk_bf16_f32 v18, v176, v177
v_cvt_pk_bf16_f32 v19, v178, v179
v_mfma_f32_16x16x32_bf16 v[136:139], a[152:155], a[80:83], v[136:139]
buffer_store_dwordx4 v[16:19], v249, s[40:43], s52 offen offset:0 sc1
v_mfma_f32_16x16x32_bf16 v[136:139], a[156:159], a[84:87], v[136:139]
v_cvt_pk_bf16_f32 v20, v180, v181
v_cvt_pk_bf16_f32 v21, v182, v183
v_mfma_f32_16x16x32_bf16 v[140:143], a[136:139], a[88:91], v[140:143]
v_mfma_f32_16x16x32_bf16 v[140:143], a[140:143], a[92:95], v[140:143]
v_cvt_pk_bf16_f32 v22, v184, v185
v_cvt_pk_bf16_f32 v23, v186, v187
v_mfma_f32_16x16x32_bf16 v[144:147], a[144:147], a[88:91], v[144:147]
buffer_store_dwordx4 v[20:23], v249, s[40:43], s52 offen offset:1024 sc1
v_mfma_f32_16x16x32_bf16 v[144:147], a[148:151], a[92:95], v[144:147]
v_mfma_f32_16x16x32_bf16 v[148:151], a[152:155], a[88:91], v[148:151]
v_mfma_f32_16x16x32_bf16 v[148:151], a[156:159], a[92:95], v[148:151]
v_mfma_f32_16x16x32_bf16 v[152:155], a[136:139], a[96:99], v[152:155]
v_mfma_f32_16x16x32_bf16 v[152:155], a[140:143], a[100:103], v[152:155]
v_mfma_f32_16x16x32_bf16 v[156:159], a[144:147], a[96:99], v[156:159]
v_mfma_f32_16x16x32_bf16 v[156:159], a[148:151], a[100:103], v[156:159]
v_mfma_f32_16x16x32_bf16 v[160:163], a[152:155], a[96:99], v[160:163]
v_mfma_f32_16x16x32_bf16 v[160:163], a[156:159], a[100:103], v[160:163]
s_mov_b32 s62, 4194304
s_lshl_b32 s51, s53, 7
s_add_u32 s51, s51, 8388608
s_lshl_b32 s52, s54, 7
s_add_u32 s52, s52, 8388608
s_waitcnt vmcnt(0)
s_mov_b64 exec, 1
buffer_store_dword v244, off, s[40:43], s51 sc1
L_op_poll:
s_sub_u32 s62, s62, 1
s_cmp_eq_u32 s62, 0
s_cbranch_scc1 L_op_go
buffer_load_dword v93, off, s[40:43], s52 sc1
s_waitcnt vmcnt(0)
v_readfirstlane_b32 s51, v93
s_nop 0
s_cmp_eq_u32 s51, 2
s_cbranch_scc0 L_op_poll
L_op_go:
s_mov_b64 exec, -1
buffer_load_dwordx4 v[32:35], v249, s[40:43], s5 offen offset:0 sc1
buffer_load_dwordx4 v[36:39], v249, s[40:43], s5 offen offset:1024 sc1
buffer_load_dwordx4 v[40:43], v249, s[40:43], s5 offen offset:2048 sc1
buffer_load_dwordx4 v[44:47], v249, s[40:43], s5 offen offset:3072 sc1
buffer_load_dwordx4 v[48:51], v249, s[40:43], s8 offen offset:0 sc1
buffer_load_dwordx4 v[52:55], v249, s[40:43], s8 offen offset:1024 sc1
s_waitcnt vmcnt(0)
s_barrier
v_lshlrev_b32 v64, 16, v32
v_and_b32 v65, 0xffff0000, v32
v_lshlrev_b32 v66, 16, v33
v_and_b32 v67, 0xffff0000, v33
v_pk_add_f32 v[128:129], v[128:129], v[64:65]
v_pk_add_f32 v[130:131], v[130:131], v[66:67]
v_cvt_pk_bf16_f32 v128, v128, v129
v_cvt_pk_bf16_f32 v129, v130, v131
v_lshlrev_b32 v68, 16, v34
v_and_b32 v69, 0xffff0000, v34
v_lshlrev_b32 v70, 16, v35
v_and_b32 v71, 0xffff0000, v35
v_pk_add_f32 v[132:133], v[132:133], v[68:69]
v_pk_add_f32 v[134:135], v[134:135], v[70:71]
v_cvt_pk_bf16_f32 v132, v132, v133
v_cvt_pk_bf16_f32 v133, v134, v135
v_lshlrev_b32 v64, 16, v36
v_and_b32 v65, 0xffff0000, v36
v_lshlrev_b32 v66, 16, v37
v_and_b32 v67, 0xffff0000, v37
v_pk_add_f32 v[136:137], v[136:137], v[64:65]
v_pk_add_f32 v[138:139], v[138:139], v[66:67]
v_cvt_pk_bf16_f32 v136, v136, v137
v_cvt_pk_bf16_f32 v137, v138, v139
ds_write_b64 v242, v[128:129] offset:0
ds_write_b64 v242, v[132:133] offset:64
ds_write_b64 v242, v[136:137] offset:128
v_lshlrev_b32 v68, 16, v38
v_and_b32 v69, 0xffff0000, v38
v_lshlrev_b32 v70, 16, v39
v_and_b32 v71, 0xffff0000, v39
v_pk_add_f32 v[140:141], v[140:141], v[68:69]
v_pk_add_f32 v[142:143], v[142:143], v[70:71]
v_cvt_pk_bf16_f32 v140, v140, v141
v_cvt_pk_bf16_f32 v141, v142, v143
v_lshlrev_b32 v64, 16, v40
v_and_b32 v65, 0xffff0000, v40
v_lshlrev_b32 v66, 16, v41
v_and_b32 v67, 0xffff0000, v41
v_pk_add_f32 v[144:145], v[144:145], v[64:65]
v_pk_add_f32 v[146:147], v[146:147], v[66:67]
v_cvt_pk_bf16_f32 v144, v144, v145
v_cvt_pk_bf16_f32 v145, v146, v147
v_lshlrev_b32 v68, 16, v42
v_and_b32 v69, 0xffff0000, v42
v_lshlrev_b32 v70, 16, v43
v_and_b32 v71, 0xffff0000, v43
v_pk_add_f32 v[148:149], v[148:149], v[68:69]
v_pk_add_f32 v[150:151], v[150:151], v[70:71]
v_cvt_pk_bf16_f32 v148, v148, v149
v_cvt_pk_bf16_f32 v149, v150, v151
ds_write_b64 v242, v[140:141] offset:6400
ds_write_b64 v242, v[144:145] offset:6464
ds_write_b64 v242, v[148:149] offset:6528
v_lshlrev_b32 v64, 16, v44
v_and_b32 v65, 0xffff0000, v44
v_lshlrev_b32 v66, 16, v45
v_and_b32 v67, 0xffff0000, v45
v_pk_add_f32 v[152:153], v[152:153], v[64:65]
v_pk_add_f32 v[154:155], v[154:155], v[66:67]
v_cvt_pk_bf16_f32 v152, v152, v153
v_cvt_pk_bf16_f32 v153, v154, v155
v_lshlrev_b32 v68, 16, v46
v_and_b32 v69, 0xffff0000, v46
v_lshlrev_b32 v70, 16, v47
v_and_b32 v71, 0xffff0000, v47
v_pk_add_f32 v[156:157], v[156:157], v[68:69]
v_pk_add_f32 v[158:159], v[158:159], v[70:71]
v_cvt_pk_bf16_f32 v156, v156, v157
v_cvt_pk_bf16_f32 v157, v158, v159
v_lshlrev_b32 v64, 16, v48
v_and_b32 v65, 0xffff0000, v48
v_lshlrev_b32 v66, 16, v49
v_and_b32 v67, 0xffff0000, v49
v_pk_add_f32 v[160:161], v[160:161], v[64:65]
v_pk_add_f32 v[162:163], v[162:163], v[66:67]
v_cvt_pk_bf16_f32 v160, v160, v161
v_cvt_pk_bf16_f32 v161, v162, v163
ds_write_b64 v242, v[152:153] offset:12800
ds_write_b64 v242, v[156:157] offset:12864
ds_write_b64 v242, v[160:161] offset:12928
v_lshlrev_b32 v68, 16, v50
v_and_b32 v69, 0xffff0000, v50
v_lshlrev_b32 v70, 16, v51
v_and_b32 v71, 0xffff0000, v51
v_pk_add_f32 v[176:177], v[176:177], v[68:69]
v_pk_add_f32 v[178:179], v[178:179], v[70:71]
v_cvt_pk_bf16_f32 v176, v176, v177
v_cvt_pk_bf16_f32 v177, v178, v179
v_lshlrev_b32 v64, 16, v52
v_and_b32 v65, 0xffff0000, v52
v_lshlrev_b32 v66, 16, v53
v_and_b32 v67, 0xffff0000, v53
v_pk_add_f32 v[180:181], v[180:181], v[64:65]
v_pk_add_f32 v[182:183], v[182:183], v[66:67]
v_cvt_pk_bf16_f32 v180, v180, v181
v_cvt_pk_bf16_f32 v181, v182, v183
v_lshlrev_b32 v68, 16, v54
v_and_b32 v69, 0xffff0000, v54
v_lshlrev_b32 v70, 16, v55
v_and_b32 v71, 0xffff0000, v55
v_pk_add_f32 v[184:185], v[184:185], v[68:69]
v_pk_add_f32 v[186:187], v[186:187], v[70:71]
v_cvt_pk_bf16_f32 v184, v184, v185
v_cvt_pk_bf16_f32 v185, v186, v187
ds_write_b64 v242, v[176:177] offset:19200
ds_write_b64 v242, v[180:181] offset:19264
ds_write_b64 v242, v[184:185] offset:19328
s_waitcnt lgkmcnt(0)
s_barrier
ds_read_b128 v[0:3], v92 offset:0
ds_read_b128 v[4:7], v92 offset:3200
ds_read_b128 v[8:11], v92 offset:128
ds_read_b128 v[12:15], v92 offset:3328
ds_read_b128 v[16:19], v92 offset:256
ds_read_b128 v[20:23], v92 offset:3456
s_waitcnt lgkmcnt(5)
buffer_store_dwordx4 v[0:3], v90, s[36:39], s17 offen offset:0 sc1
s_waitcnt lgkmcnt(4)
buffer_store_dwordx4 v[4:7], v90, s[36:39], s18 offen offset:0 sc1
s_waitcnt lgkmcnt(3)
buffer_store_dwordx4 v[8:11], v90, s[36:39], s17 offen offset:128 sc1
s_waitcnt lgkmcnt(2)
buffer_store_dwordx4 v[12:15], v90, s[36:39], s18 offen offset:128 sc1
s_waitcnt lgkmcnt(1)
buffer_store_dwordx4 v[16:19], v90, s[36:39], s17 offen offset:256 sc1
s_waitcnt lgkmcnt(0)
buffer_store_dwordx4 v[20:23], v90, s[36:39], s18 offen offset:256 sc1
L_attn_end:
s_endpgm
L_op_hook:
s_cmp_lt_u32 s62, 16
s_cselect_b32 s51, s69, s70
s_bitcmp1_b32 s62, 2
s_cbranch_scc1 L_op_chk
s_bitcmp1_b32 s62, 1
s_cbranch_scc1 L_op_pl
buffer_store_dword v244, off, s[40:43], s67 sc1
s_branch L_op_back
L_op_pl:
buffer_load_dword v255, v254, s[40:43], s51 offen sc1
s_branch L_op_back
L_op_chk:
v_cmp_ne_u32 vcc, 2, v255
s_nop 4
s_cbranch_vccz L_op_back
L_op_spin2:
s_cselect_b32 s98, 1, 0
s_mov_b32 s99, 4194304
L_op_spin2_l:
s_sub_u32 s99, s99, 1
s_cmp_eq_u32 s99, 0
s_cbranch_scc1 L_op_spin2_e
buffer_load_dword v255, v254, s[40:43], s51 offen sc1
s_waitcnt vmcnt(0)
v_cmp_ne_u32 vcc, 2, v255
s_nop 4
s_cbranch_vccnz L_op_spin2_l
L_op_spin2_e:
s_cmp_eq_u32 s98, 1
s_branch L_op_back
L_op_spin3:
s_cselect_b32 s98, 1, 0
s_mov_b32 s99, 4194304
L_op_spin3_l:
s_sub_u32 s99, s99, 1
s_cmp_eq_u32 s99, 0
s_cbranch_scc1 L_op_spin3_e
buffer_load_dword v255, off, s[40:43], s100 sc1
s_waitcnt vmcnt(0)
v_cmp_ne_u32 vcc, 2, v255
s_nop 4
s_cbranch_vccnz L_op_spin3_l
L_op_spin3_e:
s_cmp_eq_u32 s98, 1
s_branch L_op_poll
L_h_spin0:
s_cselect_b32 s98, 1, 0
s_mov_b32 s99, 4194304
L_h_spin0_l:
s_sub_u32 s99, s99, 1
s_cmp_eq_u32 s99, 0
s_cbranch_scc1 L_h_spin0_e
v_bfe_u32 v255, v249, 4, 4
v_lshlrev_b32 v255, 2, v255
buffer_load_dword v255, v255, s[36:39], 0 offen sc1
s_waitcnt vmcnt(0)
v_cmp_gt_u32 vcc, 16, v255
s_nop 4
s_cbranch_vccnz L_h_spin0_l
L_h_spin0_e:
s_cmp_eq_u32 s98, 1
s_branch L_h_back0
L_h_spin1:
s_cselect_b32 s98, 1, 0
s_mov_b32 s99, 4194304
L_h_spin1_l:
s_sub_u32 s99, s99, 1
s_cmp_eq_u32 s99, 0
s_cbranch_scc1 L_h_spin1_e
buffer_load_dword v255, v254, s[40:43], s69 offen sc1
s_waitcnt vmcnt(0)
v_cmp_eq_u32 vcc, 0, v255
s_nop 4
s_cbranch_vccnz L_h_spin1_l
L_h_spin1_e:
s_cmp_eq_u32 s98, 1
s_nop 0
s_branch L_h_back1
L_idle:
s_add_u32 s50, s65, 294912
buffer_store_dwordx4 v[24:27], v249, s[44:47], s50 offen offset:0 sc1
s_add_u32 s50, s65, 296960
buffer_store_dwordx4 v[56:59], v249, s[44:47], s50 offen offset:0 sc1
s_add_u32 s50, s65, 299008
buffer_store_dwordx4 v[88:91], v249, s[44:47], s50 offen offset:0 sc1
s_add_u32 s50, s65, 301056
buffer_store_dwordx4 v[120:123], v249, s[44:47], s50 offen offset:0 sc1
s_add_u32 s50, s66, 0
buffer_store_dwordx4 v[164:167], v249, s[44:47], s50 offen offset:0 sc1
s_add_u32 s50, s66, 294912
buffer_store_dwordx4 v[172:175], v249, s[44:47], s50 offen offset:0 sc1
v_mov_b32 v244, 2
s_waitcnt vmcnt(0)
s_barrier
buffer_store_dword v244, off, s[40:43], s67 sc1
s_endpgm
L_hot_end:
L_restart:
s_waitcnt vmcnt(0) lgkmcnt(0)
s_barrier
s_mov_b32 s76, 1
s_lshl_b32 s50, s48, 6
v_lshrrev_b32 v0, 4, v249
v_add_u32 v0, s50, v0
s_branch L_start
L_s_head:
s_nop 1
v_bfe_u32 v40, v249, 4, 4
v_lshlrev_b32 v40, 8, v40
v_lshrrev_b32 v41, 8, v249
v_lshl_add_u32 v40, v41, 4, v40
s_lshl_b32 s50, s49, 6
v_add_u32 v40, s50, v40
v_xor_b32 v41, 64, v40
v_mov_b32 v235, 0xff800000
v_mov_b32 v236, 0xff800000
v_mov_b32 v237, 0xff800000
v_mov_b32 v238, 0xff800000
v_mov_b32 v239, 0xff800000
s_lshl_b32 s50, s63, 18
s_mov_b32 s62, 64
L_max_loop:
buffer_load_dwordx4 v[0:3], v40, s[36:39], s50 offen offset:0
buffer_load_dwordx4 v[4:7], v41, s[36:39], s50 offen offset:0
buffer_load_dwordx4 v[8:11], v40, s[36:39], s50 offen offset:128
buffer_load_dwordx4 v[12:15], v41, s[36:39], s50 offen offset:128
s_waitcnt vmcnt(0)
v_mfma_f32_16x16x32_bf16 v[16:19], v[0:3], a[0:3], 0
v_mfma_f32_16x16x32_bf16 v[16:19], v[4:7], a[4:7], v[16:19]
v_mfma_f32_16x16x32_bf16 v[16:19], v[8:11], a[8:11], v[16:19]
v_mfma_f32_16x16x32_bf16 v[16:19], v[12:15], a[12:15], v[16:19]
v_mfma_f32_16x16x32_bf16 v[20:23], v[0:3], a[16:19], 0
v_mfma_f32_16x16x32_bf16 v[20:23], v[4:7], a[20:23], v[20:23]
v_mfma_f32_16x16x32_bf16 v[20:23], v[8:11], a[24:27], v[20:23]
v_mfma_f32_16x16x32_bf16 v[20:23], v[12:15], a[28:31], v[20:23]
v_mfma_f32_16x16x32_bf16 v[24:27], v[0:3], a[32:35], 0
v_mfma_f32_16x16x32_bf16 v[24:27], v[4:7], a[36:39], v[24:27]
v_mfma_f32_16x16x32_bf16 v[24:27], v[8:11], a[40:43], v[24:27]
v_mfma_f32_16x16x32_bf16 v[24:27], v[12:15], a[44:47], v[24:27]
v_mfma_f32_16x16x32_bf16 v[28:31], v[0:3], a[48:51], 0
v_mfma_f32_16x16x32_bf16 v[28:31], v[4:7], a[52:55], v[28:31]
v_mfma_f32_16x16x32_bf16 v[28:31], v[8:11], a[56:59], v[28:31]
v_mfma_f32_16x16x32_bf16 v[28:31], v[12:15], a[60:63], v[28:31]
v_mfma_f32_16x16x32_bf16 v[32:35], v[0:3], a[64:67], 0
v_mfma_f32_16x16x32_bf16 v[32:35], v[4:7], a[68:71], v[32:35]
v_mfma_f32_16x16x32_bf16 v[32:35], v[8:11], a[72:75], v[32:35]
v_mfma_f32_16x16x32_bf16 v[32:35], v[12:15], a[76:79], v[32:35]
v_max3_f32 v235, v235, v16, v17
v_max3_f32 v235, v235, v18, v19
v_max3_f32 v236, v236, v20, v21
v_max3_f32 v236, v236, v22, v23
v_max3_f32 v237, v237, v24, v25
v_max3_f32 v237, v237, v26, v27
v_max3_f32 v238, v238, v28, v29
v_max3_f32 v238, v238, v30, v31
v_max3_f32 v239, v239, v32, v33
v_max3_f32 v239, v239, v34, v35
s_add_u32 s50, s50, 4096
s_sub_u32 s62, s62, 1
s_cmp_lg_u32 s62, 0
s_cbranch_scc1 L_max_loop
v_mov_b32 v0, v235
s_nop 1
v_permlane32_swap_b32 v0, v235
v_max_f32 v235, v0, v235
v_mov_b32 v0, v235
s_nop 1
v_permlane16_swap_b32 v0, v235
v_max_f32 v235, v0, v235
v_xor_b32 v235, 0x80000000, v235
v_mov_b32 v0, v236
s_nop 1
v_permlane32_swap_b32 v0, v236
v_max_f32 v236, v0, v236
v_mov_b32 v0, v236
s_nop 1
v_permlane16_swap_b32 v0, v236
v_max_f32 v236, v0, v236
v_xor_b32 v236, 0x80000000, v236
v_mov_b32 v0, v237
s_nop 1
v_permlane32_swap_b32 v0, v237
v_max_f32 v237, v0, v237
v_mov_b32 v0, v237
s_nop 1
v_permlane16_swap_b32 v0, v237
v_max_f32 v237, v0, v237
v_xor_b32 v237, 0x80000000, v237
v_mov_b32 v0, v238
s_nop 1
v_permlane32_swap_b32 v0, v238
v_max_f32 v238, v0, v238
v_mov_b32 v0, v238
s_nop 1
v_permlane16_swap_b32 v0, v238
v_max_f32 v238, v0, v238
v_xor_b32 v238, 0x80000000, v238
v_mov_b32 v0, v239
s_nop 1
v_permlane32_swap_b32 v0, v239
v_max_f32 v239, v0, v239
v_mov_b32 v0, v239
s_nop 1
v_permlane16_swap_b32 v0, v239
v_max_f32 v239, v0, v239
v_xor_b32 v239, 0x80000000, v239
v_mfma_f32_16x16x32_bf16 v[200:203], a[208:211], a[0:3], 0
ds_read_b128 a[224:227], v240 offset:4224
v_mfma_f32_16x16x32_bf16 v[200:203], a[212:215], a[4:7], v[200:203]
ds_read_b128 a[228:231], v241 offset:4224
v_mfma_f32_16x16x32_bf16 v[200:203], a[216:219], a[8:11], v[200:203]
s_add_u32 m0, s59, 64
ds_read_b128 a[232:235], v240 offset:4736
v_mfma_f32_16x16x32_bf16 v[200:203], a[220:223], a[12:15], v[200:203]
ds_read_b128 a[236:239], v241 offset:4736
buffer_load_dwordx4 v248, s[40:43], s57 offen offset:2048 nt lds
v_mfma_f32_16x16x32_bf16 v[204:207], a[208:211], a[16:19], 0
v_mfma_f32_16x16x32_bf16 v[204:207], a[212:215], a[20:23], v[204:207]
v_mfma_f32_16x16x32_bf16 v[204:207], a[216:219], a[24:27], v[204:207]
v_mfma_f32_16x16x32_bf16 v[204:207], a[220:223], a[28:31], v[204:207]
v_mfma_f32_16x16x32_bf16 v[208:211], a[208:211], a[32:35], 0
s_add_u32 m0, s59, 96
v_add_f32 v200, v235, v200
v_exp_f32 v200, v200
v_mfma_f32_16x16x32_bf16 v[208:211], a[212:215], a[36:39], v[208:211]
buffer_load_dwordx4 v248, s[40:43], s57 offen offset:3072 nt lds
v_add_f32 v201, v235, v201
v_exp_f32 v201, v201
v_mfma_f32_16x16x32_bf16 v[208:211], a[216:219], a[40:43], v[208:211]
s_add_u32 s57, s57, 16384
v_add_f32 v202, v235, v202
v_exp_f32 v202, v202
v_cvt_pk_bf16_f32 v128, v200, v201
v_mfma_f32_16x16x32_bf16 v[208:211], a[220:223], a[44:47], v[208:211]
s_add_u32 s59, s59, 16896
v_add_f32 v203, v235, v203
v_exp_f32 v203, v203
v_mfma_f32_16x16x32_bf16 v[212:215], a[208:211], a[48:51], 0
s_cmp_eq_u32 s59, s70
v_add_f32 v204, v236, v204
v_exp_f32 v204, v204
v_cvt_pk_bf16_f32 v129, v202, v203
v_mfma_f32_16x16x32_bf16 v[212:215], a[212:215], a[52:55], v[212:215]
s_cselect_b32 s59, s68, s59
v_add_f32 v205, v236, v205
v_exp_f32 v205, v205
v_mfma_f32_16x16x32_bf16 v[212:215], a[216:219], a[56:59], v[212:215]
s_mov_b32 m0, s58
v_add_f32 v206, v236, v206
v_exp_f32 v206, v206
v_cvt_pk_bf16_f32 v136, v204, v205
v_mfma_f32_16x16x32_bf16 v[212:215], a[220:223], a[60:63], v[212:215]
buffer_load_dwordx4 v248, s[36:39], s56 offen offset:0 nt lds
v_add_f32 v207, v236, v207
v_exp_f32 v207, v207
v_mfma_f32_16x16x32_bf16 v[216:219], a[208:211], a[64:67], 0
v_add_f32 v208, v237, v208
v_exp_f32 v208, v208
v_cvt_pk_bf16_f32 v137, v206, v207
v_mfma_f32_16x16x32_bf16 v[216:219], a[212:215], a[68:71], v[216:219]
v_add_f32 v209, v237, v209
v_exp_f32 v209, v209
v_mfma_f32_16x16x32_bf16 v[216:219], a[216:219], a[72:75], v[216:219]
v_add_f32 v210, v237, v210
v_exp_f32 v210, v210
v_cvt_pk_bf16_f32 v144, v208, v209
v_mfma_f32_16x16x32_bf16 v[216:219], a[220:223], a[76:79], v[216:219]
s_waitcnt lgkmcnt(0)
ds_read_b128 a[208:211], v242 offset:0
v_add_f32 v211, v237, v211
v_exp_f32 v211, v211
v_mfma_f32_16x16x32_bf16 v[220:223], a[224:227], a[0:3], 0
s_add_u32 m0, s58, 32
ds_read_b128 a[212:215], v243 offset:0
v_add_f32 v212, v238, v212
v_exp_f32 v212, v212
v_cvt_pk_bf16_f32 v145, v210, v211
v_mfma_f32_16x16x32_bf16 v[220:223], a[228:231], a[4:7], v[220:223]
ds_read_b128 a[216:219], v242 offset:512
buffer_load_dwordx4 v248, s[36:39], s56 offen offset:1024 nt lds
v_add_f32 v213, v238, v213
v_exp_f32 v213, v213
v_mfma_f32_16x16x32_bf16 v[220:223], a[232:235], a[8:11], v[220:223]
ds_read_b128 a[220:223], v243 offset:512
v_add_f32 v214, v238, v214
v_exp_f32 v214, v214
v_cvt_pk_bf16_f32 v152, v212, v213
v_mfma_f32_16x16x32_bf16 v[220:223], a[236:239], a[12:15], v[220:223]
v_add_f32 v215, v238, v215
v_exp_f32 v215, v215
v_mfma_f32_16x16x32_bf16 v[200:203], a[224:227], a[16:19], 0
v_add_f32 v216, v239, v216
v_exp_f32 v216, v216
v_cvt_pk_bf16_f32 v153, v214, v215
v_mfma_f32_16x16x32_bf16 v[200:203], a[228:231], a[20:23], v[200:203]
v_add_f32 v217, v239, v217
v_exp_f32 v217, v217
v_add_f32 v229, v229, v216
v_mfma_f32_16x16x32_bf16 v[200:203], a[232:235], a[24:27], v[200:203]
s_add_u32 m0, s58, 64
v_add_f32 v218, v239, v218
v_exp_f32 v218, v218
v_cvt_pk_bf16_f32 v160, v216, v217
v_add_f32 v229, v229, v217
v_mfma_f32_16x16x32_bf16 v[200:203], a[236:239], a[28:31], v[200:203]
buffer_load_dwordx4 v248, s[36:39], s56 offen offset:2048 nt lds
v_add_f32 v219, v239, v219
v_exp_f32 v219, v219
v_add_f32 v229, v229, v218
v_mfma_f32_16x16x32_bf16 v[204:207], a[224:227], a[32:35], 0
v_add_f32 v220, v235, v220
v_exp_f32 v220, v220
v_cvt_pk_bf16_f32 v161, v218, v219
v_add_f32 v229, v229, v219
v_mfma_f32_16x16x32_bf16 v[204:207], a[228:231], a[36:39], v[204:207]
v_add_f32 v221, v235, v221
v_exp_f32 v221, v221
v_mfma_f32_16x16x32_bf16 v[204:207], a[232:235], a[40:43], v[204:207]
v_add_f32 v222, v235, v222
v_exp_f32 v222, v222
v_cvt_pk_bf16_f32 v130, v220, v221
v_mfma_f32_16x16x32_bf16 v[204:207], a[236:239], a[44:47], v[204:207]
v_add_f32 v223, v235, v223
v_exp_f32 v223, v223
v_mfma_f32_16x16x32_bf16 v[208:211], a[224:227], a[48:51], 0
s_add_u32 m0, s58, 96
v_add_f32 v200, v236, v200
v_exp_f32 v200, v200
v_cvt_pk_bf16_f32 v131, v222, v223
v_mfma_f32_16x16x32_bf16 v[208:211], a[228:231], a[52:55], v[208:211]
buffer_load_dwordx4 v248, s[36:39], s56 offen offset:3072 nt lds
v_add_f32 v201, v236, v201
v_exp_f32 v201, v201
v_mfma_f32_16x16x32_bf16 v[208:211], a[232:235], a[56:59], v[208:211]
s_add_u32 s56, s56, 16384
v_add_f32 v202, v236, v202
v_exp_f32 v202, v202
v_cvt_pk_bf16_f32 v138, v200, v201
v_mfma_f32_16x16x32_bf16 v[208:211], a[236:239], a[60:63], v[208:211]
s_add_u32 s58, s58, 16896
v_add_f32 v203, v236, v203
v_exp_f32 v203, v203
v_mfma_f32_16x16x32_bf16 v[212:215], a[224:227], a[64:67], 0
s_cmp_eq_u32 s58, s69
v_add_f32 v204, v237, v204
v_exp_f32 v204, v204
v_cvt_pk_bf16_f32 v139, v202, v203
v_mfma_f32_16x16x32_bf16 v[212:215], a[228:231], a[68:71], v[212:215]
s_cselect_b32 s58, s67, s58
v_add_f32 v205, v237, v205
v_exp_f32 v205, v205
v_mfma_f32_16x16x32_bf16 v[212:215], a[232:235], a[72:75], v[212:215]
v_add_f32 v206, v237, v206
v_exp_f32 v206, v206
v_cvt_pk_bf16_f32 v146, v204, v205
v_mfma_f32_16x16x32_bf16 v[212:215], a[236:239], a[76:79], v[212:215]
s_waitcnt lgkmcnt(0)
ds_read_b128 a[224:227], v242 offset:4224
v_add_f32 v207, v237, v207
v_exp_f32 v207, v207
v_mfma_f32_16x16x32_bf16 v[216:219], a[208:211], a[0:3], 0
ds_read_b128 a[228:231], v243 offset:4224
v_add_f32 v208, v238, v208
v_exp_f32 v208, v208
v_cvt_pk_bf16_f32 v147, v206, v207
v_mfma_f32_16x16x32_bf16 v[216:219], a[212:215], a[4:7], v[216:219]
ds_read_b128 a[232:235], v242 offset:4736
v_add_f32 v209, v238, v209
v_exp_f32 v209, v209
v_mfma_f32_16x16x32_bf16 v[216:219], a[216:219], a[8:11], v[216:219]
ds_read_b128 a[236:239], v243 offset:4736
v_add_f32 v210, v238, v210
v_exp_f32 v210, v210
v_cvt_pk_bf16_f32 v154, v208, v209
v_mfma_f32_16x16x32_bf16 v[216:219], a[220:223], a[12:15], v[216:219]
v_add_f32 v211, v238, v211
v_exp_f32 v211, v211
v_mfma_f32_16x16x32_bf16 v[220:223], a[208:211], a[16:19], 0
v_add_f32 v212, v239, v212
v_exp_f32 v212, v212
v_cvt_pk_bf16_f32 v155, v210, v211
v_mfma_f32_16x16x32_bf16 v[220:223], a[212:215], a[20:23], v[220:223]
v_add_f32 v213, v239, v213
v_exp_f32 v213, v213
v_add_f32 v229, v229, v212
v_mfma_f32_16x16x32_bf16 v[220:223], a[216:219], a[24:27], v[220:223]
v_add_f32 v214, v239, v214
v_exp_f32 v214, v214
v_cvt_pk_bf16_f32 v162, v212, v213
v_add_f32 v229, v229, v213
v_mfma_f32_16x16x32_bf16 v[220:223], a[220:223], a[28:31], v[220:223]
v_add_f32 v215, v239, v215
v_exp_f32 v215, v215
v_add_f32 v229, v229, v214
v_mfma_f32_16x16x32_bf16 v[200:203], a[208:211], a[32:35], 0
v_add_f32 v216, v235, v216
v_exp_f32 v216, v216
v_cvt_pk_bf16_f32 v163, v214, v215
v_add_f32 v229, v229, v215
v_mfma_f32_16x16x32_bf16 v[200:203], a[212:215], a[36:39], v[200:203]
v_add_f32 v217, v235, v217
v_exp_f32 v217, v217
v_mfma_f32_16x16x32_bf16 v[200:203], a[216:219], a[40:43], v[200:203]
v_add_f32 v218, v235, v218
v_exp_f32 v218, v218
v_cvt_pk_bf16_f32 v132, v216, v217
v_mfma_f32_16x16x32_bf16 v[200:203], a[220:223], a[44:47], v[200:203]
v_add_f32 v219, v235, v219
v_exp_f32 v219, v219
v_mfma_f32_16x16x32_bf16 v[204:207], a[208:211], a[48:51], 0
v_add_f32 v220, v236, v220
v_exp_f32 v220, v220
v_cvt_pk_bf16_f32 v133, v218, v219
v_mfma_f32_16x16x32_bf16 v[204:207], a[212:215], a[52:55], v[204:207]
v_add_f32 v221, v236, v221
v_exp_f32 v221, v221
v_mfma_f32_16x16x32_bf16 v[204:207], a[216:219], a[56:59], v[204:207]
v_add_f32 v222, v236, v222
v_exp_f32 v222, v222
v_cvt_pk_bf16_f32 v140, v220, v221
v_mfma_f32_16x16x32_bf16 v[204:207], a[220:223], a[60:63], v[204:207]
s_waitcnt lgkmcnt(0)
v_add_f32 v223, v236, v223
v_exp_f32 v223, v223
v_mfma_f32_16x16x32_bf16 v[208:211], a[224:227], a[0:3], 0
v_add_f32 v200, v237, v200
v_exp_f32 v200, v200
v_cvt_pk_bf16_f32 v141, v222, v223
v_mfma_f32_16x16x32_bf16 v[208:211], a[228:231], a[4:7], v[208:211]
v_add_f32 v201, v237, v201
v_exp_f32 v201, v201
v_mfma_f32_16x16x32_bf16 v[208:211], a[232:235], a[8:11], v[208:211]
v_add_f32 v202, v237, v202
v_exp_f32 v202, v202
v_cvt_pk_bf16_f32 v148, v200, v201
v_mfma_f32_16x16x32_bf16 v[208:211], a[236:239], a[12:15], v[208:211]
s_waitcnt vmcnt(12)
s_barrier
v_add_f32 v203, v237, v203
v_exp_f32 v203, v203
v_mfma_f32_16x16x32_bf16 v[212:215], a[224:227], a[16:19], 0
s_mov_b32 m0, s59
ds_read_b128 a[208:211], v240 offset:16896
v_add_f32 v204, v238, v204
v_exp_f32 v204, v204
v_cvt_pk_bf16_f32 v149, v202, v203
v_mfma_f32_16x16x32_bf16 v[212:215], a[228:231], a[20:23], v[212:215]
ds_read_b128 a[212:215], v241 offset:16896
buffer_load_dwordx4 v248, s[40:43], s57 offen offset:0 nt lds
v_add_f32 v205, v238, v205
v_exp_f32 v205, v205
v_mfma_f32_16x16x32_bf16 v[212:215], a[232:235], a[24:27], v[212:215]
ds_read_b128 a[216:219], v240 offset:17408
v_add_f32 v206, v238, v206
v_exp_f32 v206, v206
v_cvt_pk_bf16_f32 v156, v204, v205
v_mfma_f32_16x16x32_bf16 v[212:215], a[236:239], a[28:31], v[212:215]
ds_read_b128 a[220:223], v241 offset:17408
v_add_f32 v207, v238, v207
v_exp_f32 v207, v207
v_mfma_f32_16x16x32_bf16 v[216:219], a[224:227], a[32:35], 0
s_add_u32 m0, s59, 32
ds_read_b64_tr_b16 a[240:241], v244 offset:0
v_add_f32 v208, v235, v208
v_exp_f32 v208, v208
v_cvt_pk_bf16_f32 v157, v206, v207
v_mfma_f32_16x16x32_bf16 v[216:219], a[228:231], a[36:39], v[216:219]
ds_read_b64_tr_b16 a[242:243], v244 offset:4224
buffer_load_dwordx4 v248, s[40:43], s57 offen offset:1024 nt lds
v_add_f32 v209, v235, v209
v_exp_f32 v209, v209
v_mfma_f32_16x16x32_bf16 v[216:219], a[232:235], a[40:43], v[216:219]
ds_read_b64_tr_b16 a[244:245], v246 offset:0
v_add_f32 v210, v235, v210
v_exp_f32 v210, v210
v_cvt_pk_bf16_f32 v134, v208, v209
v_mfma_f32_16x16x32_bf16 v[216:219], a[236:239], a[44:47], v[216:219]
ds_read_b64_tr_b16 a[246:247], v246 offset:4224
v_add_f32 v211, v235, v211
v_exp_f32 v211, v211
v_mfma_f32_16x16x32_bf16 v[220:223], a[224:227], a[48:51], 0
v_add_f32 v212, v236, v212
v_exp_f32 v212, v212
v_cvt_pk_bf16_f32 v135, v210, v211
v_mfma_f32_16x16x32_bf16 v[220:223], a[228:231], a[52:55], v[220:223]
v_add_f32 v213, v236, v213
v_exp_f32 v213, v213
v_mfma_f32_16x16x32_bf16 v[220:223], a[232:235], a[56:59], v[220:223]
s_waitcnt lgkmcnt(4)
v_add_f32 v214, v236, v214
v_exp_f32 v214, v214
v_cvt_pk_bf16_f32 v142, v212, v213
v_mfma_f32_16x16x32_bf16 v[220:223], a[236:239], a[60:63], v[220:223]
v_add_f32 v215, v236, v215
v_exp_f32 v215, v215
v_add_f32 v216, v237, v216
v_cvt_pk_bf16_f32 v143, v214, v215
v_add_f32 v217, v237, v217
v_add_f32 v218, v237, v218
v_add_f32 v219, v237, v219
v_exp_f32 v216, v216
v_exp_f32 v217, v217
v_exp_f32 v218, v218
v_exp_f32 v219, v219
v_cvt_pk_bf16_f32 v150, v216, v217
v_cvt_pk_bf16_f32 v151, v218, v219
v_mfma_f32_16x16x32_bf16 v[200:203], a[208:211], a[0:3], 0
v_add_f32 v220, v238, v220
v_exp_f32 v220, v220
v_mfma_f32_16x16x32_bf16 v[200:203], a[212:215], a[4:7], v[200:203]
ds_read_b64_tr_b16 a[248:249], v244 offset:32
ds_read_b64_tr_b16 a[250:251], v244 offset:4256
v_mfma_f32_16x16x32_bf16 v[200:203], a[216:219], a[8:11], v[200:203]
v_add_f32 v221, v238, v221
v_exp_f32 v221, v221
v_mfma_f32_16x16x32_bf16 v[200:203], a[220:223], a[12:15], v[200:203]
s_waitcnt lgkmcnt(2)
ds_read_b64_tr_b16 a[252:253], v246 offset:32
ds_read_b64_tr_b16 a[254:255], v246 offset:4256
v_mfma_f32_16x16x32_bf16 v[0:3], a[240:243], v[128:131], 0
v_add_f32 v222, v238, v222
v_exp_f32 v222, v222
v_mfma_f32_16x16x32_bf16 v[0:3], a[244:247], v[132:135], v[0:3]
ds_read_b128 a[224:227], v240 offset:21120
v_cvt_pk_bf16_f32 v158, v220, v221
v_mfma_f32_16x16x32_bf16 v[32:35], a[240:243], v[136:139], 0
v_add_f32 v223, v238, v223
v_exp_f32 v223, v223
v_mfma_f32_16x16x32_bf16 v[32:35], a[244:247], v[140:143], v[32:35]
ds_read_b128 a[228:231], v241 offset:21120
v_cvt_pk_bf16_f32 v159, v222, v223
v_mfma_f32_16x16x32_bf16 v[204:207], a[208:211], a[16:19], 0
s_add_u32 m0, s59, 64
v_add_f32 v200, v235, v200
v_exp_f32 v200, v200
v_mfma_f32_16x16x32_bf16 v[204:207], a[212:215], a[20:23], v[204:207]
ds_read_b128 a[232:235], v240 offset:21632
buffer_load_dwordx4 v248, s[40:43], s57 offen offset:2048 nt lds
v_mfma_f32_16x16x32_bf16 v[204:207], a[216:219], a[24:27], v[204:207]
v_add_f32 v201, v235, v201
v_exp_f32 v201, v201
v_mfma_f32_16x16x32_bf16 v[204:207], a[220:223], a[28:31], v[204:207]
ds_read_b128 a[236:239], v241 offset:21632
v_cvt_pk_bf16_f32 v164, v200, v201
v_mfma_f32_16x16x32_bf16 v[64:67], a[240:243], v[144:147], 0
v_add_f32 v202, v235, v202
v_exp_f32 v202, v202
v_mfma_f32_16x16x32_bf16 v[64:67], a[244:247], v[148:151], v[64:67]
v_add_u32 v240, s60, v240
v_add_u32 v241, s60, v241
v_mfma_f32_16x16x32_bf16 a[160:163], a[240:243], v[160:163], 0
v_add_f32 v203, v235, v203
v_exp_f32 v203, v203
v_mfma_f32_16x16x32_bf16 v[96:99], a[240:243], v[152:155], 0
v_cvt_pk_bf16_f32 v165, v202, v203
v_mfma_f32_16x16x32_bf16 v[96:99], a[244:247], v[156:159], v[96:99]
ds_read_b64_tr_b16 a[240:241], v245 offset:0
v_mfma_f32_16x16x32_bf16 v[208:211], a[208:211], a[32:35], 0
v_add_f32 v204, v236, v204
v_exp_f32 v204, v204
v_mfma_f32_16x16x32_bf16 v[208:211], a[212:215], a[36:39], v[208:211]
ds_read_b64_tr_b16 a[242:243], v245 offset:4224
ds_read_b64_tr_b16 a[244:245], v247 offset:0
v_mfma_f32_16x16x32_bf16 v[208:211], a[216:219], a[40:43], v[208:211]
v_add_f32 v205, v236, v205
v_exp_f32 v205, v205
v_mfma_f32_16x16x32_bf16 v[208:211], a[220:223], a[44:47], v[208:211]
s_waitcnt lgkmcnt(7)
ds_read_b64_tr_b16 a[246:247], v247 offset:4224
v_cvt_pk_bf16_f32 v172, v204, v205
v_mfma_f32_16x16x32_bf16 v[4:7], a[248:251], v[128:131], 0
v_add_f32 v206, v236, v206
v_exp_f32 v206, v206
v_mfma_f32_16x16x32_bf16 v[4:7], a[252:255], v[132:135], v[4:7]
v_mfma_f32_16x16x32_bf16 v[36:39], a[248:251], v[136:139], 0
v_add_f32 v207, v236, v207
v_exp_f32 v207, v207
v_mfma_f32_16x16x32_bf16 v[36:39], a[252:255], v[140:143], v[36:39]
v_cvt_pk_bf16_f32 v173, v206, v207
v_mfma_f32_16x16x32_bf16 v[212:215], a[208:211], a[48:51], 0
v_add_f32 v208, v237, v208
v_exp_f32 v208, v208
v_mfma_f32_16x16x32_bf16 v[212:215], a[212:215], a[52:55], v[212:215]
s_add_u32 m0, s59, 96
v_mfma_f32_16x16x32_bf16 v[212:215], a[216:219], a[56:59], v[212:215]
v_add_f32 v209, v237, v209
v_exp_f32 v209, v209
v_mfma_f32_16x16x32_bf16 v[212:215], a[220:223], a[60:63], v[212:215]
buffer_load_dwordx4 v248, s[40:43], s57 offen offset:3072 nt lds
v_cvt_pk_bf16_f32 v180, v208, v209
v_mfma_f32_16x16x32_bf16 v[68:71], a[248:251], v[144:147], 0
s_add_u32 s57, s57, 16384
v_add_f32 v210, v237, v210
v_exp_f32 v210, v210
v_mfma_f32_16x16x32_bf16 v[68:71], a[252:255], v[148:151], v[68:71]
s_add_u32 s59, s59, 16896
v_mfma_f32_16x16x32_bf16 v[100:103], a[248:251], v[152:155], 0
s_cmp_eq_u32 s59, s70
v_add_f32 v211, v237, v211
v_exp_f32 v211, v211
v_mfma_f32_16x16x32_bf16 v[100:103], a[252:255], v[156:159], v[100:103]
s_cselect_b32 s59, s68, s59
v_cvt_pk_bf16_f32 v181, v210, v211
v_mfma_f32_16x16x32_bf16 v[216:219], a[208:211], a[64:67], 0
v_add_f32 v212, v238, v212
v_exp_f32 v212, v212
v_mfma_f32_16x16x32_bf16 v[216:219], a[212:215], a[68:71], v[216:219]
v_mfma_f32_16x16x32_bf16 v[216:219], a[216:219], a[72:75], v[216:219]
v_add_f32 v213, v238, v213
v_exp_f32 v213, v213
v_mfma_f32_16x16x32_bf16 v[216:219], a[220:223], a[76:79], v[216:219]
ds_read_b128 a[208:211], v242 offset:16896
v_cvt_pk_bf16_f32 v188, v212, v213
v_mfma_f32_16x16x32_bf16 a[164:167], a[248:251], v[160:163], 0
v_add_f32 v214, v238, v214
v_exp_f32 v214, v214
v_smfmac_f32_16x16x64_bf16 a[192:195], v[224:227], v[128:135], v228
s_waitcnt lgkmcnt(1)
ds_read_b64_tr_b16 a[248:249], v245 offset:32
ds_read_b64_tr_b16 a[250:251], v245 offset:4256
v_mfma_f32_16x16x32_bf16 v[8:11], a[240:243], v[128:131], 0
v_add_f32 v215, v238, v215
v_exp_f32 v215, v215
v_mfma_f32_16x16x32_bf16 v[8:11], a[244:247], v[132:135], v[8:11]
ds_read_b64_tr_b16 a[252:253], v247 offset:32
ds_read_b64_tr_b16 a[254:255], v247 offset:4256
v_mfma_f32_16x16x32_bf16 v[220:223], a[224:227], a[0:3], 0
v_add_f32 v216, v239, v216
v_exp_f32 v216, v216
v_mfma_f32_16x16x32_bf16 v[220:223], a[228:231], a[4:7], v[220:223]
ds_read_b128 a[212:215], v243 offset:16896
v_cvt_pk_bf16_f32 v189, v214, v215
v_mfma_f32_16x16x32_bf16 v[220:223], a[232:235], a[8:11], v[220:223]
v_add_f32 v217, v239, v217
v_exp_f32 v217, v217
v_mfma_f32_16x16x32_bf16 v[220:223], a[236:239], a[12:15], v[220:223]
ds_read_b128 a[216:219], v242 offset:17408
v_cvt_pk_bf16_f32 v196, v216, v217
v_mfma_f32_16x16x32_bf16 v[40:43], a[240:243], v[136:139], 0
s_mov_b32 m0, s58
v_add_f32 v218, v239, v218
v_exp_f32 v218, v218
v_mfma_f32_16x16x32_bf16 v[40:43], a[244:247], v[140:143], v[40:43]
ds_read_b128 a[220:223], v243 offset:17408
buffer_load_dwordx4 v248, s[36:39], s56 offen offset:0 nt lds
v_mfma_f32_16x16x32_bf16 v[72:75], a[240:243], v[144:147], 0
v_add_f32 v219, v239, v219
v_exp_f32 v219, v219
v_mfma_f32_16x16x32_bf16 v[72:75], a[244:247], v[148:151], v[72:75]
v_cvt_pk_bf16_f32 v197, v218, v219
v_add_f32 v229, v229, v216
v_mfma_f32_16x16x32_bf16 v[200:203], a[224:227], a[16:19], 0
v_add_f32 v220, v235, v220
v_exp_f32 v220, v220
v_mfma_f32_16x16x32_bf16 v[200:203], a[228:231], a[20:23], v[200:203]
v_add_f32 v229, v229, v217
v_add_f32 v229, v229, v218
v_mfma_f32_16x16x32_bf16 v[200:203], a[232:235], a[24:27], v[200:203]
v_add_f32 v221, v235, v221
v_exp_f32 v221, v221
v_mfma_f32_16x16x32_bf16 v[200:203], a[236:239], a[28:31], v[200:203]
v_cvt_pk_bf16_f32 v166, v220, v221
v_add_f32 v229, v229, v219
v_mfma_f32_16x16x32_bf16 v[104:107], a[240:243], v[152:155], 0
v_add_f32 v222, v235, v222
v_exp_f32 v222, v222
v_mfma_f32_16x16x32_bf16 v[104:107], a[244:247], v[156:159], v[104:107]
v_mfma_f32_16x16x32_bf16 a[168:171], a[240:243], v[160:163], 0
s_waitcnt lgkmcnt(3)
v_add_f32 v223, v235, v223
v_exp_f32 v223, v223
v_mfma_f32_16x16x32_bf16 v[12:15], a[248:251], v[128:131], 0
ds_read_b64_tr_b16 a[240:241], v244 offset:512
ds_read_b64_tr_b16 a[242:243], v244 offset:4736
v_mfma_f32_16x16x32_bf16 v[12:15], a[252:255], v[132:135], v[12:15]
ds_read_b64_tr_b16 a[244:245], v246 offset:512
v_cvt_pk_bf16_f32 v167, v222, v223
v_mfma_f32_16x16x32_bf16 v[204:207], a[224:227], a[32:35], 0
v_add_f32 v200, v236, v200
v_exp_f32 v200, v200
v_mfma_f32_16x16x32_bf16 v[204:207], a[228:231], a[36:39], v[204:207]
ds_read_b64_tr_b16 a[246:247], v246 offset:4736
v_mfma_f32_16x16x32_bf16 v[204:207], a[232:235], a[40:43], v[204:207]
v_add_f32 v201, v236, v201
v_exp_f32 v201, v201
v_mfma_f32_16x16x32_bf16 v[204:207], a[236:239], a[44:47], v[204:207]
v_cvt_pk_bf16_f32 v174, v200, v201
v_mfma_f32_16x16x32_bf16 v[44:47], a[248:251], v[136:139], 0
v_add_f32 v202, v236, v202
v_exp_f32 v202, v202
v_mfma_f32_16x16x32_bf16 v[44:47], a[252:255], v[140:143], v[44:47]
s_add_u32 m0, s58, 32
v_mfma_f32_16x16x32_bf16 v[76:79], a[248:251], v[144:147], 0
v_add_f32 v203, v236, v203
v_exp_f32 v203, v203
v_mfma_f32_16x16x32_bf16 v[76:79], a[252:255], v[148:151], v[76:79]
buffer_load_dwordx4 v248, s[36:39], s56 offen offset:1024 nt lds
v_cvt_pk_bf16_f32 v175, v202, v203
v_mfma_f32_16x16x32_bf16 v[208:211], a[224:227], a[48:51], 0
v_add_f32 v204, v237, v204
v_exp_f32 v204, v204
v_mfma_f32_16x16x32_bf16 v[208:211], a[228:231], a[52:55], v[208:211]
v_mfma_f32_16x16x32_bf16 v[208:211], a[232:235], a[56:59], v[208:211]
v_add_f32 v205, v237, v205
v_exp_f32 v205, v205
v_mfma_f32_16x16x32_bf16 v[208:211], a[236:239], a[60:63], v[208:211]
v_cvt_pk_bf16_f32 v182, v204, v205
v_mfma_f32_16x16x32_bf16 v[108:111], a[248:251], v[152:155], 0
v_add_f32 v206, v237, v206
v_exp_f32 v206, v206
v_mfma_f32_16x16x32_bf16 v[108:111], a[252:255], v[156:159], v[108:111]
v_mfma_f32_16x16x32_bf16 a[172:175], a[248:251], v[160:163], 0
v_add_f32 v207, v237, v207
v_exp_f32 v207, v207
v_smfmac_f32_16x16x64_bf16 a[196:199], v[224:227], v[136:143], v228
ds_read_b64_tr_b16 a[248:249], v244 offset:544
ds_read_b64_tr_b16 a[250:251], v244 offset:4768
v_mfma_f32_16x16x32_bf16 v[212:215], a[224:227], a[64:67], 0
v_add_f32 v208, v238, v208
v_exp_f32 v208, v208
v_mfma_f32_16x16x32_bf16 v[212:215], a[228:231], a[68:71], v[212:215]
ds_read_b64_tr_b16 a[252:253], v246 offset:544
ds_read_b64_tr_b16 a[254:255], v246 offset:4768
v_mfma_f32_16x16x32_bf16 v[212:215], a[232:235], a[72:75], v[212:215]
v_add_f32 v209, v238, v209
v_exp_f32 v209, v209
v_mfma_f32_16x16x32_bf16 v[212:215], a[236:239], a[76:79], v[212:215]
s_waitcnt lgkmcnt(4)
ds_read_b128 a[224:227], v242 offset:21120
v_cvt_pk_bf16_f32 v183, v206, v207
v_mfma_f32_16x16x32_bf16 v[16:19], a[240:243], v[128:131], 0
v_add_f32 v210, v238, v210
v_exp_f32 v210, v210
v_mfma_f32_16x16x32_bf16 v[16:19], a[244:247], v[132:135], v[16:19]
ds_read_b128 a[228:231], v243 offset:21120
v_cvt_pk_bf16_f32 v190, v208, v209
v_mfma_f32_16x16x32_bf16 v[48:51], a[240:243], v[136:139], 0
v_add_f32 v211, v238, v211
v_exp_f32 v211, v211
v_mfma_f32_16x16x32_bf16 v[48:51], a[244:247], v[140:143], v[48:51]
ds_read_b128 a[232:235], v242 offset:21632
v_cvt_pk_bf16_f32 v191, v210, v211
v_mfma_f32_16x16x32_bf16 v[216:219], a[208:211], a[0:3], 0
s_add_u32 m0, s58, 64
v_add_f32 v212, v239, v212
v_exp_f32 v212, v212
v_mfma_f32_16x16x32_bf16 v[216:219], a[212:215], a[4:7], v[216:219]
ds_read_b128 a[236:239], v243 offset:21632
buffer_load_dwordx4 v248, s[36:39], s56 offen offset:2048 nt lds
v_mfma_f32_16x16x32_bf16 v[216:219], a[216:219], a[8:11], v[216:219]
v_add_f32 v213, v239, v213
v_exp_f32 v213, v213
v_mfma_f32_16x16x32_bf16 v[216:219], a[220:223], a[12:15], v[216:219]
v_cvt_pk_bf16_f32 v198, v212, v213
v_add_f32 v229, v229, v212
v_mfma_f32_16x16x32_bf16 v[80:83], a[240:243], v[144:147], 0
v_add_f32 v214, v239, v214
v_exp_f32 v214, v214
v_mfma_f32_16x16x32_bf16 v[80:83], a[244:247], v[148:151], v[80:83]
v_add_f32 v229, v229, v213
v_add_f32 v229, v229, v214
v_mfma_f32_16x16x32_bf16 v[112:115], a[240:243], v[152:155], 0
v_add_f32 v215, v239, v215
v_exp_f32 v215, v215
v_mfma_f32_16x16x32_bf16 v[112:115], a[244:247], v[156:159], v[112:115]
v_cvt_pk_bf16_f32 v199, v214, v215
v_add_f32 v229, v229, v215
v_mfma_f32_16x16x32_bf16 v[220:223], a[208:211], a[16:19], 0
v_add_f32 v216, v235, v216
v_exp_f32 v216, v216
v_mfma_f32_16x16x32_bf16 v[220:223], a[212:215], a[20:23], v[220:223]
v_add_u32 v242, s60, v242
v_add_u32 v243, s60, v243
v_mfma_f32_16x16x32_bf16 v[220:223], a[216:219], a[24:27], v[220:223]
s_mul_i32 s60, s60, -1
v_add_f32 v217, v235, v217
v_exp_f32 v217, v217
v_mfma_f32_16x16x32_bf16 v[220:223], a[220:223], a[28:31], v[220:223]
v_cvt_pk_bf16_f32 v168, v216, v217
v_mfma_f32_16x16x32_bf16 a[176:179], a[240:243], v[160:163], 0
s_waitcnt lgkmcnt(4)
v_add_f32 v218, v235, v218
v_exp_f32 v218, v218
v_mfma_f32_16x16x32_bf16 v[20:23], a[248:251], v[128:131], 0
ds_read_b64_tr_b16 a[240:241], v245 offset:512
ds_read_b64_tr_b16 a[242:243], v245 offset:4736
v_mfma_f32_16x16x32_bf16 v[20:23], a[252:255], v[132:135], v[20:23]
v_add_f32 v219, v235, v219
v_exp_f32_e64 v219, v219
v_mfma_f32_16x16x32_bf16 v[52:55], a[248:251], v[136:139], 0
ds_read_b64_tr_b16 a[244:245], v247 offset:512
ds_read_b64_tr_b16 a[246:247], v247 offset:4736
v_mfma_f32_16x16x32_bf16 v[52:55], a[252:255], v[140:143], v[52:55]
v_cvt_pk_bf16_f32 v169, v218, v219
v_mfma_f32_16x16x32_bf16 v[200:203], a[208:211], a[32:35], 0
v_add_f32 v220, v236, v220
v_exp_f32 v220, v220
v_mfma_f32_16x16x32_bf16 v[200:203], a[212:215], a[36:39], v[200:203]
s_add_u32 m0, s58, 96
v_mfma_f32_16x16x32_bf16 v[200:203], a[216:219], a[40:43], v[200:203]
v_add_f32 v221, v236, v221
v_exp_f32 v221, v221
v_mfma_f32_16x16x32_bf16 v[200:203], a[220:223], a[44:47], v[200:203]
buffer_load_dwordx4 v248, s[36:39], s56 offen offset:3072 nt lds
v_cvt_pk_bf16_f32 v176, v220, v221
v_mfma_f32_16x16x32_bf16 v[84:87], a[248:251], v[144:147], 0
s_add_u32 s56, s56, 16384
v_add_f32 v222, v236, v222
v_exp_f32 v222, v222
v_mfma_f32_16x16x32_bf16 v[84:87], a[252:255], v[148:151], v[84:87]
s_add_u32 s58, s58, 16896
v_mfma_f32_16x16x32_bf16 v[116:119], a[248:251], v[152:155], 0
s_cmp_eq_u32 s58, s69
v_add_f32 v223, v236, v223
v_exp_f32 v223, v223
v_mfma_f32_16x16x32_bf16 v[116:119], a[252:255], v[156:159], v[116:119]
s_cselect_b32 s58, s67, s58
v_cvt_pk_bf16_f32 v177, v222, v223
v_mfma_f32_16x16x32_bf16 v[204:207], a[208:211], a[48:51], 0
v_add_f32 v200, v237, v200
v_exp_f32 v200, v200
v_mfma_f32_16x16x32_bf16 v[204:207], a[212:215], a[52:55], v[204:207]
v_mfma_f32_16x16x32_bf16 v[204:207], a[216:219], a[56:59], v[204:207]
v_add_f32 v201, v237, v201
v_exp_f32 v201, v201
v_mfma_f32_16x16x32_bf16 v[204:207], a[220:223], a[60:63], v[204:207]
v_cvt_pk_bf16_f32 v184, v200, v201
v_mfma_f32_16x16x32_bf16 a[180:183], a[248:251], v[160:163], 0
v_add_f32 v202, v237, v202
v_exp_f32 v202, v202
v_smfmac_f32_16x16x64_bf16 a[200:203], v[224:227], v[144:151], v228
s_waitcnt lgkmcnt(0)
ds_read_b64_tr_b16 a[248:249], v245 offset:544
ds_read_b64_tr_b16 a[250:251], v245 offset:4768
v_mfma_f32_16x16x32_bf16 v[24:27], a[240:243], v[128:131], 0
v_add_f32 v203, v237, v203
v_exp_f32 v203, v203
v_mfma_f32_16x16x32_bf16 v[24:27], a[244:247], v[132:135], v[24:27]
ds_read_b64_tr_b16 a[252:253], v247 offset:544
ds_read_b64_tr_b16 a[254:255], v247 offset:4768
v_mfma_f32_16x16x32_bf16 v[208:211], a[224:227], a[0:3], 0
v_add_f32 v204, v238, v204
v_exp_f32 v204, v204
v_mfma_f32_16x16x32_bf16 v[208:211], a[228:231], a[4:7], v[208:211]
v_cvt_pk_bf16_f32 v185, v202, v203
v_mfma_f32_16x16x32_bf16 v[208:211], a[232:235], a[8:11], v[208:211]
v_add_f32 v205, v238, v205
v_exp_f32 v205, v205
v_mfma_f32_16x16x32_bf16 v[208:211], a[236:239], a[12:15], v[208:211]
s_waitcnt vmcnt(12)
s_barrier
v_mfma_f32_16x16x32_bf16 v[56:59], a[240:243], v[136:139], 0
s_mov_b32 m0, s59
v_add_f32 v206, v238, v206
v_exp_f32 v206, v206
v_mfma_f32_16x16x32_bf16 v[56:59], a[244:247], v[140:143], v[56:59]
ds_read_b128 a[208:211], v240 offset:0
buffer_load_dwordx4 v248, s[40:43], s57 offen offset:0 nt lds
v_cvt_pk_bf16_f32 v192, v204, v205
v_mfma_f32_16x16x32_bf16 v[88:91], a[240:243], v[144:147], 0
v_add_f32 v207, v238, v207
v_exp_f32 v207, v207
v_mfma_f32_16x16x32_bf16 v[88:91], a[244:247], v[148:151], v[88:91]
ds_read_b128 a[212:215], v241 offset:0
v_cvt_pk_bf16_f32 v193, v206, v207
v_mfma_f32_16x16x32_bf16 v[212:215], a[224:227], a[16:19], 0
v_add_f32 v208, v235, v208
v_exp_f32 v208, v208
v_mfma_f32_16x16x32_bf16 v[212:215], a[228:231], a[20:23], v[212:215]
ds_read_b128 a[216:219], v240 offset:512
v_mfma_f32_16x16x32_bf16 v[212:215], a[232:235], a[24:27], v[212:215]
v_add_f32 v209, v235, v209
v_exp_f32 v209, v209
v_mfma_f32_16x16x32_bf16 v[212:215], a[236:239], a[28:31], v[212:215]
ds_read_b128 a[220:223], v241 offset:512
v_cvt_pk_bf16_f32 v170, v208, v209
v_mfma_f32_16x16x32_bf16 v[120:123], a[240:243], v[152:155], 0
v_add_f32 v210, v235, v210
v_exp_f32 v210, v210
v_mfma_f32_16x16x32_bf16 v[120:123], a[244:247], v[156:159], v[120:123]
v_mfma_f32_16x16x32_bf16 a[184:187], a[240:243], v[160:163], 0
v_add_f32 v211, v235, v211
v_exp_f32 v211, v211
v_smfmac_f32_16x16x64_bf16 a[204:207], v[224:227], v[152:159], v228
ds_read_b64_tr_b16 a[240:241], v244 offset:16896
ds_read_b64_tr_b16 a[242:243], v244 offset:21120
v_mfma_f32_16x16x32_bf16 v[216:219], a[224:227], a[32:35], 0
v_add_f32 v212, v236, v212
v_exp_f32 v212, v212
v_mfma_f32_16x16x32_bf16 v[216:219], a[228:231], a[36:39], v[216:219]
ds_read_b64_tr_b16 a[244:245], v246 offset:16896
ds_read_b64_tr_b16 a[246:247], v246 offset:21120
v_mfma_f32_16x16x32_bf16 v[216:219], a[232:235], a[40:43], v[216:219]
v_add_f32 v213, v236, v213
v_exp_f32 v213, v213
v_mfma_f32_16x16x32_bf16 v[216:219], a[236:239], a[44:47], v[216:219]
s_waitcnt lgkmcnt(8)
v_cvt_pk_bf16_f32 v171, v210, v211
v_cvt_pk_bf16_f32 v178, v212, v213
v_mfma_f32_16x16x32_bf16 v[28:31], a[248:251], v[128:131], 0
v_add_f32 v214, v236, v214
v_exp_f32 v214, v214
v_mfma_f32_16x16x32_bf16 v[28:31], a[252:255], v[132:135], v[28:31]
v_mfma_f32_16x16x32_bf16 v[60:63], a[248:251], v[136:139], 0
s_add_u32 m0, s59, 32
v_add_f32 v215, v236, v215
v_exp_f32 v215, v215
v_mfma_f32_16x16x32_bf16 v[60:63], a[252:255], v[140:143], v[60:63]
buffer_load_dwordx4 v248, s[40:43], s57 offen offset:1024 nt lds
v_cvt_pk_bf16_f32 v179, v214, v215
v_mfma_f32_16x16x32_bf16 v[220:223], a[224:227], a[48:51], 0
v_add_f32 v216, v237, v216
v_exp_f32 v216, v216
v_mfma_f32_16x16x32_bf16 v[220:223], a[228:231], a[52:55], v[220:223]
v_mfma_f32_16x16x32_bf16 v[220:223], a[232:235], a[56:59], v[220:223]
v_add_f32 v217, v237, v217
v_exp_f32 v217, v217
v_mfma_f32_16x16x32_bf16 v[220:223], a[236:239], a[60:63], v[220:223]
v_cvt_pk_bf16_f32 v186, v216, v217
v_mfma_f32_16x16x32_bf16 v[92:95], a[248:251], v[144:147], 0
s_mul_i32 s62, s63, -2
v_add_f32 v218, v237, v218
v_exp_f32 v218, v218
v_mfma_f32_16x16x32_bf16 v[92:95], a[252:255], v[148:151], v[92:95]
s_add_u32 s62, s62, 7
v_mfma_f32_16x16x32_bf16 v[124:127], a[248:251], v[152:155], 0
v_add_f32 v219, v237, v219
v_exp_f32 v219, v219
v_mfma_f32_16x16x32_bf16 v[124:127], a[252:255], v[156:159], v[124:127]
s_waitcnt lgkmcnt(4)
v_cvt_pk_bf16_f32 v187, v218, v219
v_mfma_f32_16x16x32_bf16 a[188:191], a[248:251], v[160:163], 0
L_s_loop:
v_mfma_f32_16x16x32_bf16 v[200:203], a[208:211], a[0:3], 0
v_add_f32 v220, v238, v220
v_exp_f32 v220, v220
v_mfma_f32_16x16x32_bf16 v[200:203], a[212:215], a[4:7], v[200:203]
ds_read_b64_tr_b16 a[248:249], v244 offset:16928
ds_read_b64_tr_b16 a[250:251], v244 offset:21152
v_mfma_f32_16x16x32_bf16 v[200:203], a[216:219], a[8:11], v[200:203]
v_add_f32 v221, v238, v221
v_exp_f32 v221, v221
v_mfma_f32_16x16x32_bf16 v[200:203], a[220:223], a[12:15], v[200:203]
s_waitcnt lgkmcnt(2)
ds_read_b64_tr_b16 a[252:253], v246 offset:16928
ds_read_b64_tr_b16 a[254:255], v246 offset:21152
v_mfma_f32_16x16x32_bf16 v[0:3], a[240:243], v[164:167], v[0:3]
v_add_f32 v222, v238, v222
v_exp_f32 v222, v222
v_mfma_f32_16x16x32_bf16 v[0:3], a[244:247], v[168:171], v[0:3]
ds_read_b128 a[224:227], v240 offset:4224
v_cvt_pk_bf16_f32 v194, v220, v221
v_mfma_f32_16x16x32_bf16 v[32:35], a[240:243], v[172:175], v[32:35]
v_add_f32 v223, v238, v223
v_exp_f32 v223, v223
v_mfma_f32_16x16x32_bf16 v[32:35], a[244:247], v[176:179], v[32:35]
ds_read_b128 a[228:231], v241 offset:4224
v_cvt_pk_bf16_f32 v195, v222, v223
v_mfma_f32_16x16x32_bf16 v[204:207], a[208:211], a[16:19], 0
s_add_u32 m0, s59, 64
v_add_f32 v200, v235, v200
v_exp_f32 v200, v200
v_mfma_f32_16x16x32_bf16 v[204:207], a[212:215], a[20:23], v[204:207]
ds_read_b128 a[232:235], v240 offset:4736
buffer_load_dwordx4 v248, s[40:43], s57 offen offset:2048 nt lds
v_mfma_f32_16x16x32_bf16 v[204:207], a[216:219], a[24:27], v[204:207]
v_add_f32 v201, v235, v201
v_exp_f32 v201, v201
v_mfma_f32_16x16x32_bf16 v[204:207], a[220:223], a[28:31], v[204:207]
ds_read_b128 a[236:239], v241 offset:4736
v_cvt_pk_bf16_f32 v128, v200, v201
v_mfma_f32_16x16x32_bf16 v[64:67], a[240:243], v[180:183], v[64:67]
v_add_f32 v202, v235, v202
v_exp_f32 v202, v202
v_mfma_f32_16x16x32_bf16 v[64:67], a[244:247], v[184:187], v[64:67]
v_mfma_f32_16x16x32_bf16 a[160:163], a[240:243], v[196:199], a[160:163]
v_add_f32 v203, v235, v203
v_exp_f32 v203, v203
v_mfma_f32_16x16x32_bf16 v[96:99], a[240:243], v[188:191], v[96:99]
v_cvt_pk_bf16_f32 v129, v202, v203
v_mfma_f32_16x16x32_bf16 v[96:99], a[244:247], v[192:195], v[96:99]
ds_read_b64_tr_b16 a[240:241], v245 offset:16896
v_mfma_f32_16x16x32_bf16 v[208:211], a[208:211], a[32:35], 0
v_add_f32 v204, v236, v204
v_exp_f32 v204, v204
v_mfma_f32_16x16x32_bf16 v[208:211], a[212:215], a[36:39], v[208:211]
ds_read_b64_tr_b16 a[242:243], v245 offset:21120
ds_read_b64_tr_b16 a[244:245], v247 offset:16896
v_mfma_f32_16x16x32_bf16 v[208:211], a[216:219], a[40:43], v[208:211]
v_add_f32 v205, v236, v205
v_exp_f32 v205, v205
v_mfma_f32_16x16x32_bf16 v[208:211], a[220:223], a[44:47], v[208:211]
s_waitcnt lgkmcnt(7)
ds_read_b64_tr_b16 a[246:247], v247 offset:21120
v_cvt_pk_bf16_f32 v136, v204, v205
v_mfma_f32_16x16x32_bf16 v[4:7], a[248:251], v[164:167], v[4:7]
v_add_f32 v206, v236, v206
v_exp_f32 v206, v206
v_mfma_f32_16x16x32_bf16 v[4:7], a[252:255], v[168:171], v[4:7]
v_mfma_f32_16x16x32_bf16 v[36:39], a[248:251], v[172:175], v[36:39]
v_add_f32 v207, v236, v207
v_exp_f32 v207, v207
v_mfma_f32_16x16x32_bf16 v[36:39], a[252:255], v[176:179], v[36:39]
v_cvt_pk_bf16_f32 v137, v206, v207
v_mfma_f32_16x16x32_bf16 v[212:215], a[208:211], a[48:51], 0
v_add_f32 v208, v237, v208
v_exp_f32 v208, v208
v_mfma_f32_16x16x32_bf16 v[212:215], a[212:215], a[52:55], v[212:215]
s_add_u32 m0, s59, 96
v_mfma_f32_16x16x32_bf16 v[212:215], a[216:219], a[56:59], v[212:215]
v_add_f32 v209, v237, v209
v_exp_f32 v209, v209
v_mfma_f32_16x16x32_bf16 v[212:215], a[220:223], a[60:63], v[212:215]
buffer_load_dwordx4 v248, s[40:43], s57 offen offset:3072 nt lds
v_cvt_pk_bf16_f32 v144, v208, v209
v_mfma_f32_16x16x32_bf16 v[68:71], a[248:251], v[180:183], v[68:71]
s_add_u32 s57, s57, 16384
v_add_f32 v210, v237, v210
v_exp_f32 v210, v210
v_mfma_f32_16x16x32_bf16 v[68:71], a[252:255], v[184:187], v[68:71]
s_add_u32 s59, s59, 16896
v_mfma_f32_16x16x32_bf16 v[100:103], a[248:251], v[188:191], v[100:103]
s_cmp_eq_u32 s59, s70
v_add_f32 v211, v237, v211
v_exp_f32 v211, v211
v_mfma_f32_16x16x32_bf16 v[100:103], a[252:255], v[192:195], v[100:103]
s_cselect_b32 s59, s68, s59
v_cvt_pk_bf16_f32 v145, v210, v211
v_mfma_f32_16x16x32_bf16 v[216:219], a[208:211], a[64:67], 0
v_add_f32 v212, v238, v212
v_exp_f32 v212, v212
v_mfma_f32_16x16x32_bf16 v[216:219], a[212:215], a[68:71], v[216:219]
v_mfma_f32_16x16x32_bf16 v[216:219], a[216:219], a[72:75], v[216:219]
v_add_f32 v213, v238, v213
v_exp_f32 v213, v213
v_mfma_f32_16x16x32_bf16 v[216:219], a[220:223], a[76:79], v[216:219]
ds_read_b128 a[208:211], v242 offset:0
v_cvt_pk_bf16_f32 v152, v212, v213
v_mfma_f32_16x16x32_bf16 a[164:167], a[248:251], v[196:199], a[164:167]
v_add_f32 v214, v238, v214
v_exp_f32 v214, v214
v_smfmac_f32_16x16x64_bf16 a[192:195], v[224:227], v[164:171], v228
s_waitcnt lgkmcnt(1)
ds_read_b64_tr_b16 a[248:249], v245 offset:16928
ds_read_b64_tr_b16 a[250:251], v245 offset:21152
v_mfma_f32_16x16x32_bf16 v[8:11], a[240:243], v[164:167], v[8:11]
v_add_f32 v215, v238, v215
v_exp_f32 v215, v215
v_mfma_f32_16x16x32_bf16 v[8:11], a[244:247], v[168:171], v[8:11]
ds_read_b64_tr_b16 a[252:253], v247 offset:16928
ds_read_b64_tr_b16 a[254:255], v247 offset:21152
v_mfma_f32_16x16x32_bf16 v[220:223], a[224:227], a[0:3], 0
v_add_f32 v216, v239, v216
v_exp_f32 v216, v216
v_mfma_f32_16x16x32_bf16 v[220:223], a[228:231], a[4:7], v[220:223]
ds_read_b128 a[212:215], v243 offset:0
v_cvt_pk_bf16_f32 v153, v214, v215
v_mfma_f32_16x16x32_bf16 v[220:223], a[232:235], a[8:11], v[220:223]
v_add_f32 v217, v239, v217
v_exp_f32 v217, v217
v_mfma_f32_16x16x32_bf16 v[220:223], a[236:239], a[12:15], v[220:223]
ds_read_b128 a[216:219], v242 offset:512
v_cvt_pk_bf16_f32 v160, v216, v217
v_mfma_f32_16x16x32_bf16 v[40:43], a[240:243], v[172:175], v[40:43]
s_mov_b32 m0, s58
v_add_f32 v218, v239, v218
v_exp_f32 v218, v218
v_mfma_f32_16x16x32_bf16 v[40:43], a[244:247], v[176:179], v[40:43]
ds_read_b128 a[220:223], v243 offset:512
buffer_load_dwordx4 v248, s[36:39], s56 offen offset:0 nt lds
v_mfma_f32_16x16x32_bf16 v[72:75], a[240:243], v[180:183], v[72:75]
v_add_f32 v219, v239, v219
v_exp_f32 v219, v219
v_mfma_f32_16x16x32_bf16 v[72:75], a[244:247], v[184:187], v[72:75]
v_cvt_pk_bf16_f32 v161, v218, v219
v_add_f32 v229, v229, v216
v_mfma_f32_16x16x32_bf16 v[200:203], a[224:227], a[16:19], 0
v_add_f32 v220, v235, v220
v_exp_f32 v220, v220
v_mfma_f32_16x16x32_bf16 v[200:203], a[228:231], a[20:23], v[200:203]
v_add_f32 v229, v229, v217
v_add_f32 v229, v229, v218
v_mfma_f32_16x16x32_bf16 v[200:203], a[232:235], a[24:27], v[200:203]
v_add_f32 v221, v235, v221
v_exp_f32 v221, v221
v_mfma_f32_16x16x32_bf16 v[200:203], a[236:239], a[28:31], v[200:203]
v_cvt_pk_bf16_f32 v130, v220, v221
v_add_f32 v229, v229, v219
v_mfma_f32_16x16x32_bf16 v[104:107], a[240:243], v[188:191], v[104:107]
v_add_f32 v222, v235, v222
v_exp_f32 v222, v222
v_mfma_f32_16x16x32_bf16 v[104:107], a[244:247], v[192:195], v[104:107]
v_mfma_f32_16x16x32_bf16 a[168:171], a[240:243], v[196:199], a[168:171]
s_waitcnt lgkmcnt(3)
v_add_f32 v223, v235, v223
v_exp_f32_e64 v223, v223
v_mfma_f32_16x16x32_bf16 v[12:15], a[248:251], v[164:167], v[12:15]
ds_read_b64_tr_b16 a[240:241], v244 offset:17408
ds_read_b64_tr_b16 a[242:243], v244 offset:21632
v_mfma_f32_16x16x32_bf16 v[12:15], a[252:255], v[168:171], v[12:15]
ds_read_b64_tr_b16 a[244:245], v246 offset:17408
v_cvt_pk_bf16_f32 v131, v222, v223
v_mfma_f32_16x16x32_bf16 v[204:207], a[224:227], a[32:35], 0
v_add_f32 v200, v236, v200
v_exp_f32 v200, v200
v_mfma_f32_16x16x32_bf16 v[204:207], a[228:231], a[36:39], v[204:207]
ds_read_b64_tr_b16 a[246:247], v246 offset:21632
v_mfma_f32_16x16x32_bf16 v[204:207], a[232:235], a[40:43], v[204:207]
v_add_f32 v201, v236, v201
v_exp_f32 v201, v201
v_mfma_f32_16x16x32_bf16 v[204:207], a[236:239], a[44:47], v[204:207]
v_cvt_pk_bf16_f32 v138, v200, v201
v_mfma_f32_16x16x32_bf16 v[44:47], a[248:251], v[172:175], v[44:47]
v_add_f32 v202, v236, v202
v_exp_f32 v202, v202
v_mfma_f32_16x16x32_bf16 v[44:47], a[252:255], v[176:179], v[44:47]
s_add_u32 m0, s58, 32
v_mfma_f32_16x16x32_bf16 v[76:79], a[248:251], v[180:183], v[76:79]
v_add_f32 v203, v236, v203
v_exp_f32 v203, v203
v_mfma_f32_16x16x32_bf16 v[76:79], a[252:255], v[184:187], v[76:79]
buffer_load_dwordx4 v248, s[36:39], s56 offen offset:1024 nt lds
v_cvt_pk_bf16_f32 v139, v202, v203
v_mfma_f32_16x16x32_bf16 v[208:211], a[224:227], a[48:51], 0
v_add_f32 v204, v237, v204
v_exp_f32 v204, v204
v_mfma_f32_16x16x32_bf16 v[208:211], a[228:231], a[52:55], v[208:211]
v_mfma_f32_16x16x32_bf16 v[208:211], a[232:235], a[56:59], v[208:211]
v_add_f32 v205, v237, v205
v_exp_f32 v205, v205
v_mfma_f32_16x16x32_bf16 v[208:211], a[236:239], a[60:63], v[208:211]
v_cvt_pk_bf16_f32 v146, v204, v205
v_mfma_f32_16x16x32_bf16 v[108:111], a[248:251], v[188:191], v[108:111]
v_add_f32 v206, v237, v206
v_exp_f32 v206, v206
v_mfma_f32_16x16x32_bf16 v[108:111], a[252:255], v[192:195], v[108:111]
v_mfma_f32_16x16x32_bf16 a[172:175], a[248:251], v[196:199], a[172:175]
v_add_f32 v207, v237, v207
v_exp_f32 v207, v207
v_smfmac_f32_16x16x64_bf16 a[196:199], v[224:227], v[172:179], v228
ds_read_b64_tr_b16 a[248:249], v244 offset:17440
ds_read_b64_tr_b16 a[250:251], v244 offset:21664
v_mfma_f32_16x16x32_bf16 v[212:215], a[224:227], a[64:67], 0
v_add_f32 v208, v238, v208
v_exp_f32 v208, v208
v_mfma_f32_16x16x32_bf16 v[212:215], a[228:231], a[68:71], v[212:215]
ds_read_b64_tr_b16 a[252:253], v246 offset:17440
ds_read_b64_tr_b16 a[254:255], v246 offset:21664
v_mfma_f32_16x16x32_bf16 v[212:215], a[232:235], a[72:75], v[212:215]
v_add_f32 v209, v238, v209
v_exp_f32 v209, v209
v_mfma_f32_16x16x32_bf16 v[212:215], a[236:239], a[76:79], v[212:215]
s_waitcnt lgkmcnt(4)
ds_read_b128 a[224:227], v242 offset:4224
v_cvt_pk_bf16_f32 v147, v206, v207
v_mfma_f32_16x16x32_bf16 v[16:19], a[240:243], v[164:167], v[16:19]
v_add_f32 v210, v238, v210
v_exp_f32 v210, v210
v_mfma_f32_16x16x32_bf16 v[16:19], a[244:247], v[168:171], v[16:19]
ds_read_b128 a[228:231], v243 offset:4224
v_cvt_pk_bf16_f32 v154, v208, v209
v_mfma_f32_16x16x32_bf16 v[48:51], a[240:243], v[172:175], v[48:51]
v_add_f32 v211, v238, v211
v_exp_f32 v211, v211
v_mfma_f32_16x16x32_bf16 v[48:51], a[244:247], v[176:179], v[48:51]
ds_read_b128 a[232:235], v242 offset:4736
v_cvt_pk_bf16_f32 v155, v210, v211
v_mfma_f32_16x16x32_bf16 v[216:219], a[208:211], a[0:3], 0
s_add_u32 m0, s58, 64
v_add_f32 v212, v239, v212
v_exp_f32 v212, v212
v_mfma_f32_16x16x32_bf16 v[216:219], a[212:215], a[4:7], v[216:219]
ds_read_b128 a[236:239], v243 offset:4736
buffer_load_dwordx4 v248, s[36:39], s56 offen offset:2048 nt lds
v_mfma_f32_16x16x32_bf16 v[216:219], a[216:219], a[8:11], v[216:219]
v_add_f32 v213, v239, v213
v_exp_f32 v213, v213
v_mfma_f32_16x16x32_bf16 v[216:219], a[220:223], a[12:15], v[216:219]
v_cvt_pk_bf16_f32 v162, v212, v213
v_add_f32 v229, v229, v212
v_mfma_f32_16x16x32_bf16 v[80:83], a[240:243], v[180:183], v[80:83]
v_add_f32 v214, v239, v214
v_exp_f32 v214, v214
v_mfma_f32_16x16x32_bf16 v[80:83], a[244:247], v[184:187], v[80:83]
v_add_f32 v229, v229, v213
v_add_f32 v229, v229, v214
v_mfma_f32_16x16x32_bf16 v[112:115], a[240:243], v[188:191], v[112:115]
v_add_f32 v215, v239, v215
v_exp_f32 v215, v215
v_mfma_f32_16x16x32_bf16 v[112:115], a[244:247], v[192:195], v[112:115]
v_cvt_pk_bf16_f32 v163, v214, v215
v_add_f32 v229, v229, v215
v_mfma_f32_16x16x32_bf16 v[220:223], a[208:211], a[16:19], 0
v_add_f32 v216, v235, v216
v_exp_f32 v216, v216
v_mfma_f32_16x16x32_bf16 v[220:223], a[212:215], a[20:23], v[220:223]
v_add_u32 v244, s61, v244
v_add_u32 v246, s61, v246
v_mfma_f32_16x16x32_bf16 v[220:223], a[216:219], a[24:27], v[220:223]
v_add_f32 v217, v235, v217
v_exp_f32 v217, v217
v_mfma_f32_16x16x32_bf16 v[220:223], a[220:223], a[28:31], v[220:223]
v_cvt_pk_bf16_f32 v132, v216, v217
v_mfma_f32_16x16x32_bf16 a[176:179], a[240:243], v[196:199], a[176:179]
s_waitcnt lgkmcnt(4)
v_add_f32 v218, v235, v218
v_exp_f32 v218, v218
v_mfma_f32_16x16x32_bf16 v[20:23], a[248:251], v[164:167], v[20:23]
ds_read_b64_tr_b16 a[240:241], v245 offset:17408
ds_read_b64_tr_b16 a[242:243], v245 offset:21632
v_mfma_f32_16x16x32_bf16 v[20:23], a[252:255], v[168:171], v[20:23]
v_add_f32 v219, v235, v219
v_exp_f32 v219, v219
v_mfma_f32_16x16x32_bf16 v[52:55], a[248:251], v[172:175], v[52:55]
ds_read_b64_tr_b16 a[244:245], v247 offset:17408
ds_read_b64_tr_b16 a[246:247], v247 offset:21632
v_mfma_f32_16x16x32_bf16 v[52:55], a[252:255], v[176:179], v[52:55]
v_cvt_pk_bf16_f32 v133, v218, v219
v_mfma_f32_16x16x32_bf16 v[200:203], a[208:211], a[32:35], 0
v_add_f32 v220, v236, v220
v_exp_f32 v220, v220
v_mfma_f32_16x16x32_bf16 v[200:203], a[212:215], a[36:39], v[200:203]
s_add_u32 m0, s58, 96
v_mfma_f32_16x16x32_bf16 v[200:203], a[216:219], a[40:43], v[200:203]
v_add_f32 v221, v236, v221
v_exp_f32 v221, v221
v_mfma_f32_16x16x32_bf16 v[200:203], a[220:223], a[44:47], v[200:203]
buffer_load_dwordx4 v248, s[36:39], s56 offen offset:3072 nt lds
v_cvt_pk_bf16_f32 v140, v220, v221
v_mfma_f32_16x16x32_bf16 v[84:87], a[248:251], v[180:183], v[84:87]
s_add_u32 s56, s56, 16384
v_add_f32 v222, v236, v222
v_exp_f32 v222, v222
v_mfma_f32_16x16x32_bf16 v[84:87], a[252:255], v[184:187], v[84:87]
s_add_u32 s58, s58, 16896
v_mfma_f32_16x16x32_bf16 v[116:119], a[248:251], v[188:191], v[116:119]
s_cmp_eq_u32 s58, s69
v_add_f32 v223, v236, v223
v_exp_f32 v223, v223
v_mfma_f32_16x16x32_bf16 v[116:119], a[252:255], v[192:195], v[116:119]
s_cselect_b32 s58, s67, s58
v_cvt_pk_bf16_f32 v141, v222, v223
v_mfma_f32_16x16x32_bf16 v[204:207], a[208:211], a[48:51], 0
v_add_f32 v200, v237, v200
v_exp_f32 v200, v200
v_mfma_f32_16x16x32_bf16 v[204:207], a[212:215], a[52:55], v[204:207]
v_mfma_f32_16x16x32_bf16 v[204:207], a[216:219], a[56:59], v[204:207]
v_add_f32 v201, v237, v201
v_exp_f32 v201, v201
v_mfma_f32_16x16x32_bf16 v[204:207], a[220:223], a[60:63], v[204:207]
v_cvt_pk_bf16_f32 v148, v200, v201
v_mfma_f32_16x16x32_bf16 a[180:183], a[248:251], v[196:199], a[180:183]
v_add_f32 v202, v237, v202
v_exp_f32 v202, v202
v_smfmac_f32_16x16x64_bf16 a[200:203], v[224:227], v[180:187], v228
s_waitcnt lgkmcnt(0)
ds_read_b64_tr_b16 a[248:249], v245 offset:17440
ds_read_b64_tr_b16 a[250:251], v245 offset:21664
v_mfma_f32_16x16x32_bf16 v[24:27], a[240:243], v[164:167], v[24:27]
v_add_f32 v203, v237, v203
v_exp_f32 v203, v203
v_mfma_f32_16x16x32_bf16 v[24:27], a[244:247], v[168:171], v[24:27]
ds_read_b64_tr_b16 a[252:253], v247 offset:17440
ds_read_b64_tr_b16 a[254:255], v247 offset:21664
v_mfma_f32_16x16x32_bf16 v[208:211], a[224:227], a[0:3], 0
v_add_f32 v204, v238, v204
v_exp_f32 v204, v204
v_mfma_f32_16x16x32_bf16 v[208:211], a[228:231], a[4:7], v[208:211]
v_cvt_pk_bf16_f32 v149, v202, v203
v_add_u32 v245, s61, v245
v_mfma_f32_16x16x32_bf16 v[208:211], a[232:235], a[8:11], v[208:211]
v_add_f32 v205, v238, v205
v_exp_f32 v205, v205
v_mfma_f32_16x16x32_bf16 v[208:211], a[236:239], a[12:15], v[208:211]
s_waitcnt vmcnt(12)
s_barrier
v_mfma_f32_16x16x32_bf16 v[56:59], a[240:243], v[172:175], v[56:59]
s_mov_b32 m0, s59
v_add_f32 v206, v238, v206
v_exp_f32 v206, v206
v_mfma_f32_16x16x32_bf16 v[56:59], a[244:247], v[176:179], v[56:59]
ds_read_b128 a[208:211], v240 offset:16896
buffer_load_dwordx4 v248, s[40:43], s57 offen offset:0 nt lds
v_cvt_pk_bf16_f32 v156, v204, v205
v_mfma_f32_16x16x32_bf16 v[88:91], a[240:243], v[180:183], v[88:91]
v_add_f32 v207, v238, v207
v_exp_f32 v207, v207
v_mfma_f32_16x16x32_bf16 v[88:91], a[244:247], v[184:187], v[88:91]
ds_read_b128 a[212:215], v241 offset:16896
v_cvt_pk_bf16_f32 v157, v206, v207
v_mfma_f32_16x16x32_bf16 v[212:215], a[224:227], a[16:19], 0
v_add_f32 v208, v235, v208
v_exp_f32 v208, v208
v_mfma_f32_16x16x32_bf16 v[212:215], a[228:231], a[20:23], v[212:215]
ds_read_b128 a[216:219], v240 offset:17408
v_add_u32 v247, s61, v247
v_mfma_f32_16x16x32_bf16 v[212:215], a[232:235], a[24:27], v[212:215]
s_mul_i32 s61, s61, -1
v_add_f32 v209, v235, v209
v_exp_f32 v209, v209
v_mfma_f32_16x16x32_bf16 v[212:215], a[236:239], a[28:31], v[212:215]
ds_read_b128 a[220:223], v241 offset:17408
v_cvt_pk_bf16_f32 v134, v208, v209
v_mfma_f32_16x16x32_bf16 v[120:123], a[240:243], v[188:191], v[120:123]
v_add_f32 v210, v235, v210
v_exp_f32 v210, v210
v_mfma_f32_16x16x32_bf16 v[120:123], a[244:247], v[192:195], v[120:123]
v_mfma_f32_16x16x32_bf16 a[184:187], a[240:243], v[196:199], a[184:187]
v_add_f32 v211, v235, v211
v_exp_f32 v211, v211
v_smfmac_f32_16x16x64_bf16 a[204:207], v[224:227], v[188:195], v228
ds_read_b64_tr_b16 a[240:241], v244 offset:0
ds_read_b64_tr_b16 a[242:243], v244 offset:4224
v_mfma_f32_16x16x32_bf16 v[216:219], a[224:227], a[32:35], 0
v_add_f32 v212, v236, v212
v_exp_f32 v212, v212
v_mfma_f32_16x16x32_bf16 v[216:219], a[228:231], a[36:39], v[216:219]
ds_read_b64_tr_b16 a[244:245], v246 offset:0
ds_read_b64_tr_b16 a[246:247], v246 offset:4224
v_mfma_f32_16x16x32_bf16 v[216:219], a[232:235], a[40:43], v[216:219]
v_add_f32 v213, v236, v213
v_exp_f32 v213, v213
v_mfma_f32_16x16x32_bf16 v[216:219], a[236:239], a[44:47], v[216:219]
s_waitcnt lgkmcnt(8)
v_cvt_pk_bf16_f32 v135, v210, v211
v_cvt_pk_bf16_f32 v142, v212, v213
v_mfma_f32_16x16x32_bf16 v[28:31], a[248:251], v[164:167], v[28:31]
v_add_f32 v214, v236, v214
v_exp_f32 v214, v214
v_mfma_f32_16x16x32_bf16 v[28:31], a[252:255], v[168:171], v[28:31]
v_mfma_f32_16x16x32_bf16 v[60:63], a[248:251], v[172:175], v[60:63]
s_add_u32 m0, s59, 32
v_add_f32 v215, v236, v215
v_exp_f32 v215, v215
v_mfma_f32_16x16x32_bf16 v[60:63], a[252:255], v[176:179], v[60:63]
buffer_load_dwordx4 v248, s[40:43], s57 offen offset:1024 nt lds
v_cvt_pk_bf16_f32 v143, v214, v215
v_mfma_f32_16x16x32_bf16 v[220:223], a[224:227], a[48:51], 0
v_add_f32 v216, v237, v216
v_exp_f32 v216, v216
v_mfma_f32_16x16x32_bf16 v[220:223], a[228:231], a[52:55], v[220:223]
v_mfma_f32_16x16x32_bf16 v[220:223], a[232:235], a[56:59], v[220:223]
v_add_f32 v217, v237, v217
v_exp_f32 v217, v217
v_mfma_f32_16x16x32_bf16 v[220:223], a[236:239], a[60:63], v[220:223]
v_cvt_pk_bf16_f32 v150, v216, v217
v_mfma_f32_16x16x32_bf16 v[92:95], a[248:251], v[180:183], v[92:95]
v_add_f32 v218, v237, v218
v_exp_f32 v218, v218
v_mfma_f32_16x16x32_bf16 v[92:95], a[252:255], v[184:187], v[92:95]
v_mfma_f32_16x16x32_bf16 v[124:127], a[248:251], v[188:191], v[124:127]
v_add_f32 v219, v237, v219
v_exp_f32 v219, v219
v_mfma_f32_16x16x32_bf16 v[124:127], a[252:255], v[192:195], v[124:127]
s_waitcnt lgkmcnt(4)
v_cvt_pk_bf16_f32 v151, v218, v219
v_mfma_f32_16x16x32_bf16 a[188:191], a[248:251], v[196:199], a[188:191]
v_mfma_f32_16x16x32_bf16 v[200:203], a[208:211], a[0:3], 0
v_add_f32 v220, v238, v220
v_exp_f32 v220, v220
v_mfma_f32_16x16x32_bf16 v[200:203], a[212:215], a[4:7], v[200:203]
ds_read_b64_tr_b16 a[248:249], v244 offset:32
ds_read_b64_tr_b16 a[250:251], v244 offset:4256
v_mfma_f32_16x16x32_bf16 v[200:203], a[216:219], a[8:11], v[200:203]
v_add_f32 v221, v238, v221
v_exp_f32 v221, v221
v_mfma_f32_16x16x32_bf16 v[200:203], a[220:223], a[12:15], v[200:203]
s_waitcnt lgkmcnt(2)
ds_read_b64_tr_b16 a[252:253], v246 offset:32
ds_read_b64_tr_b16 a[254:255], v246 offset:4256
v_mfma_f32_16x16x32_bf16 v[0:3], a[240:243], v[128:131], v[0:3]
v_add_f32 v222, v238, v222
v_exp_f32 v222, v222
v_mfma_f32_16x16x32_bf16 v[0:3], a[244:247], v[132:135], v[0:3]
ds_read_b128 a[224:227], v240 offset:21120
v_cvt_pk_bf16_f32 v158, v220, v221
v_mfma_f32_16x16x32_bf16 v[32:35], a[240:243], v[136:139], v[32:35]
v_add_f32 v223, v238, v223
v_exp_f32 v223, v223
v_mfma_f32_16x16x32_bf16 v[32:35], a[244:247], v[140:143], v[32:35]
ds_read_b128 a[228:231], v241 offset:21120
v_cvt_pk_bf16_f32 v159, v222, v223
v_mfma_f32_16x16x32_bf16 v[204:207], a[208:211], a[16:19], 0
s_add_u32 m0, s59, 64
v_add_f32 v200, v235, v200
v_exp_f32 v200, v200
v_mfma_f32_16x16x32_bf16 v[204:207], a[212:215], a[20:23], v[204:207]
ds_read_b128 a[232:235], v240 offset:21632
buffer_load_dwordx4 v248, s[40:43], s57 offen offset:2048 nt lds
v_mfma_f32_16x16x32_bf16 v[204:207], a[216:219], a[24:27], v[204:207]
v_add_f32 v201, v235, v201
v_exp_f32 v201, v201
v_mfma_f32_16x16x32_bf16 v[204:207], a[220:223], a[28:31], v[204:207]
ds_read_b128 a[236:239], v241 offset:21632
v_cvt_pk_bf16_f32 v164, v200, v201
v_mfma_f32_16x16x32_bf16 v[64:67], a[240:243], v[144:147], v[64:67]
v_add_f32 v202, v235, v202
v_exp_f32 v202, v202
v_mfma_f32_16x16x32_bf16 v[64:67], a[244:247], v[148:151], v[64:67]
v_add_u32 v240, s60, v240
v_add_u32 v241, s60, v241
v_mfma_f32_16x16x32_bf16 a[160:163], a[240:243], v[160:163], a[160:163]
v_add_f32 v203, v235, v203
v_exp_f32 v203, v203
v_mfma_f32_16x16x32_bf16 v[96:99], a[240:243], v[152:155], v[96:99]
v_cvt_pk_bf16_f32 v165, v202, v203
v_mfma_f32_16x16x32_bf16 v[96:99], a[244:247], v[156:159], v[96:99]
ds_read_b64_tr_b16 a[240:241], v245 offset:0
v_mfma_f32_16x16x32_bf16 v[208:211], a[208:211], a[32:35], 0
v_add_f32 v204, v236, v204
v_exp_f32 v204, v204
v_mfma_f32_16x16x32_bf16 v[208:211], a[212:215], a[36:39], v[208:211]
ds_read_b64_tr_b16 a[242:243], v245 offset:4224
ds_read_b64_tr_b16 a[244:245], v247 offset:0
v_mfma_f32_16x16x32_bf16 v[208:211], a[216:219], a[40:43], v[208:211]
v_add_f32 v205, v236, v205
v_exp_f32 v205, v205
v_mfma_f32_16x16x32_bf16 v[208:211], a[220:223], a[44:47], v[208:211]
s_waitcnt lgkmcnt(7)
ds_read_b64_tr_b16 a[246:247], v247 offset:4224
v_cvt_pk_bf16_f32 v172, v204, v205
v_mfma_f32_16x16x32_bf16 v[4:7], a[248:251], v[128:131], v[4:7]
v_add_f32 v206, v236, v206
v_exp_f32 v206, v206
v_mfma_f32_16x16x32_bf16 v[4:7], a[252:255], v[132:135], v[4:7]
v_mfma_f32_16x16x32_bf16 v[36:39], a[248:251], v[136:139], v[36:39]
v_add_f32 v207, v236, v207
v_exp_f32 v207, v207
v_mfma_f32_16x16x32_bf16 v[36:39], a[252:255], v[140:143], v[36:39]
v_cvt_pk_bf16_f32 v173, v206, v207
v_mfma_f32_16x16x32_bf16 v[212:215], a[208:211], a[48:51], 0
v_add_f32 v208, v237, v208
v_exp_f32 v208, v208
v_mfma_f32_16x16x32_bf16 v[212:215], a[212:215], a[52:55], v[212:215]
s_add_u32 m0, s59, 96
v_mfma_f32_16x16x32_bf16 v[212:215], a[216:219], a[56:59], v[212:215]
v_add_f32 v209, v237, v209
v_exp_f32 v209, v209
v_mfma_f32_16x16x32_bf16 v[212:215], a[220:223], a[60:63], v[212:215]
buffer_load_dwordx4 v248, s[40:43], s57 offen offset:3072 nt lds
v_cvt_pk_bf16_f32 v180, v208, v209
v_mfma_f32_16x16x32_bf16 v[68:71], a[248:251], v[144:147], v[68:71]
s_add_u32 s57, s57, 16384
v_add_f32 v210, v237, v210
v_exp_f32 v210, v210
v_mfma_f32_16x16x32_bf16 v[68:71], a[252:255], v[148:151], v[68:71]
s_add_u32 s59, s59, 16896
v_mfma_f32_16x16x32_bf16 v[100:103], a[248:251], v[152:155], v[100:103]
s_cmp_eq_u32 s59, s70
v_add_f32 v211, v237, v211
v_exp_f32 v211, v211
v_mfma_f32_16x16x32_bf16 v[100:103], a[252:255], v[156:159], v[100:103]
s_cselect_b32 s59, s68, s59
v_cvt_pk_bf16_f32 v181, v210, v211
v_mfma_f32_16x16x32_bf16 v[216:219], a[208:211], a[64:67], 0
v_add_f32 v212, v238, v212
v_exp_f32 v212, v212
v_mfma_f32_16x16x32_bf16 v[216:219], a[212:215], a[68:71], v[216:219]
v_mfma_f32_16x16x32_bf16 v[216:219], a[216:219], a[72:75], v[216:219]
v_add_f32 v213, v238, v213
v_exp_f32 v213, v213
v_mfma_f32_16x16x32_bf16 v[216:219], a[220:223], a[76:79], v[216:219]
ds_read_b128 a[208:211], v242 offset:16896
v_cvt_pk_bf16_f32 v188, v212, v213
v_mfma_f32_16x16x32_bf16 a[164:167], a[248:251], v[160:163], a[164:167]
v_add_f32 v214, v238, v214
v_exp_f32 v214, v214
v_smfmac_f32_16x16x64_bf16 a[192:195], v[224:227], v[128:135], v228
s_waitcnt lgkmcnt(1)
ds_read_b64_tr_b16 a[248:249], v245 offset:32
ds_read_b64_tr_b16 a[250:251], v245 offset:4256
v_mfma_f32_16x16x32_bf16 v[8:11], a[240:243], v[128:131], v[8:11]
v_add_f32 v215, v238, v215
v_exp_f32 v215, v215
v_mfma_f32_16x16x32_bf16 v[8:11], a[244:247], v[132:135], v[8:11]
ds_read_b64_tr_b16 a[252:253], v247 offset:32
ds_read_b64_tr_b16 a[254:255], v247 offset:4256
v_mfma_f32_16x16x32_bf16 v[220:223], a[224:227], a[0:3], 0
v_add_f32 v216, v239, v216
v_exp_f32 v216, v216
v_mfma_f32_16x16x32_bf16 v[220:223], a[228:231], a[4:7], v[220:223]
ds_read_b128 a[212:215], v243 offset:16896
v_cvt_pk_bf16_f32 v189, v214, v215
v_mfma_f32_16x16x32_bf16 v[220:223], a[232:235], a[8:11], v[220:223]
v_add_f32 v217, v239, v217
v_exp_f32 v217, v217
v_mfma_f32_16x16x32_bf16 v[220:223], a[236:239], a[12:15], v[220:223]
ds_read_b128 a[216:219], v242 offset:17408
v_cvt_pk_bf16_f32 v196, v216, v217
v_mfma_f32_16x16x32_bf16 v[40:43], a[240:243], v[136:139], v[40:43]
s_mov_b32 m0, s58
v_add_f32 v218, v239, v218
v_exp_f32 v218, v218
v_mfma_f32_16x16x32_bf16 v[40:43], a[244:247], v[140:143], v[40:43]
ds_read_b128 a[220:223], v243 offset:17408
buffer_load_dwordx4 v248, s[36:39], s56 offen offset:0 nt lds
v_mfma_f32_16x16x32_bf16 v[72:75], a[240:243], v[144:147], v[72:75]
v_add_f32 v219, v239, v219
v_exp_f32 v219, v219
v_mfma_f32_16x16x32_bf16 v[72:75], a[244:247], v[148:151], v[72:75]
v_cvt_pk_bf16_f32 v197, v218, v219
v_add_f32 v229, v229, v216
v_mfma_f32_16x16x32_bf16 v[200:203], a[224:227], a[16:19], 0
v_add_f32 v220, v235, v220
v_exp_f32 v220, v220
v_mfma_f32_16x16x32_bf16 v[200:203], a[228:231], a[20:23], v[200:203]
v_add_f32 v229, v229, v217
v_add_f32 v229, v229, v218
v_mfma_f32_16x16x32_bf16 v[200:203], a[232:235], a[24:27], v[200:203]
v_add_f32 v221, v235, v221
v_exp_f32 v221, v221
v_mfma_f32_16x16x32_bf16 v[200:203], a[236:239], a[28:31], v[200:203]
v_cvt_pk_bf16_f32 v166, v220, v221
v_add_f32 v229, v229, v219
v_mfma_f32_16x16x32_bf16 v[104:107], a[240:243], v[152:155], v[104:107]
v_add_f32 v222, v235, v222
v_exp_f32 v222, v222
v_mfma_f32_16x16x32_bf16 v[104:107], a[244:247], v[156:159], v[104:107]
v_mfma_f32_16x16x32_bf16 a[168:171], a[240:243], v[160:163], a[168:171]
s_waitcnt lgkmcnt(3)
v_add_f32 v223, v235, v223
v_exp_f32 v223, v223
v_mfma_f32_16x16x32_bf16 v[12:15], a[248:251], v[128:131], v[12:15]
ds_read_b64_tr_b16 a[240:241], v244 offset:512
ds_read_b64_tr_b16 a[242:243], v244 offset:4736
v_mfma_f32_16x16x32_bf16 v[12:15], a[252:255], v[132:135], v[12:15]
ds_read_b64_tr_b16 a[244:245], v246 offset:512
v_cvt_pk_bf16_f32 v167, v222, v223
v_mfma_f32_16x16x32_bf16 v[204:207], a[224:227], a[32:35], 0
v_add_f32 v200, v236, v200
v_exp_f32 v200, v200
v_mfma_f32_16x16x32_bf16 v[204:207], a[228:231], a[36:39], v[204:207]
ds_read_b64_tr_b16 a[246:247], v246 offset:4736
v_mfma_f32_16x16x32_bf16 v[204:207], a[232:235], a[40:43], v[204:207]
v_add_f32 v201, v236, v201
v_exp_f32 v201, v201
v_mfma_f32_16x16x32_bf16 v[204:207], a[236:239], a[44:47], v[204:207]
v_cvt_pk_bf16_f32 v174, v200, v201
v_mfma_f32_16x16x32_bf16 v[44:47], a[248:251], v[136:139], v[44:47]
v_add_f32 v202, v236, v202
v_exp_f32 v202, v202
v_mfma_f32_16x16x32_bf16 v[44:47], a[252:255], v[140:143], v[44:47]
s_add_u32 m0, s58, 32
v_mfma_f32_16x16x32_bf16 v[76:79], a[248:251], v[144:147], v[76:79]
v_add_f32 v203, v236, v203
v_exp_f32 v203, v203
v_mfma_f32_16x16x32_bf16 v[76:79], a[252:255], v[148:151], v[76:79]
buffer_load_dwordx4 v248, s[36:39], s56 offen offset:1024 nt lds
v_cvt_pk_bf16_f32 v175, v202, v203
v_mfma_f32_16x16x32_bf16 v[208:211], a[224:227], a[48:51], 0
v_add_f32 v204, v237, v204
v_exp_f32 v204, v204
v_mfma_f32_16x16x32_bf16 v[208:211], a[228:231], a[52:55], v[208:211]
v_mfma_f32_16x16x32_bf16 v[208:211], a[232:235], a[56:59], v[208:211]
v_add_f32 v205, v237, v205
v_exp_f32 v205, v205
v_mfma_f32_16x16x32_bf16 v[208:211], a[236:239], a[60:63], v[208:211]
v_cvt_pk_bf16_f32 v182, v204, v205
v_mfma_f32_16x16x32_bf16 v[108:111], a[248:251], v[152:155], v[108:111]
v_add_f32 v206, v237, v206
v_exp_f32 v206, v206
v_mfma_f32_16x16x32_bf16 v[108:111], a[252:255], v[156:159], v[108:111]
v_mfma_f32_16x16x32_bf16 a[172:175], a[248:251], v[160:163], a[172:175]
v_add_f32 v207, v237, v207
v_exp_f32 v207, v207
v_smfmac_f32_16x16x64_bf16 a[196:199], v[224:227], v[136:143], v228
ds_read_b64_tr_b16 a[248:249], v244 offset:544
ds_read_b64_tr_b16 a[250:251], v244 offset:4768
v_mfma_f32_16x16x32_bf16 v[212:215], a[224:227], a[64:67], 0
v_add_f32 v208, v238, v208
v_exp_f32 v208, v208
v_mfma_f32_16x16x32_bf16 v[212:215], a[228:231], a[68:71], v[212:215]
ds_read_b64_tr_b16 a[252:253], v246 offset:544
ds_read_b64_tr_b16 a[254:255], v246 offset:4768
v_mfma_f32_16x16x32_bf16 v[212:215], a[232:235], a[72:75], v[212:215]
v_add_f32 v209, v238, v209
v_exp_f32 v209, v209
v_mfma_f32_16x16x32_bf16 v[212:215], a[236:239], a[76:79], v[212:215]
s_waitcnt lgkmcnt(4)
ds_read_b128 a[224:227], v242 offset:21120
v_cvt_pk_bf16_f32 v183, v206, v207
v_mfma_f32_16x16x32_bf16 v[16:19], a[240:243], v[128:131], v[16:19]
v_add_f32 v210, v238, v210
v_exp_f32 v210, v210
v_mfma_f32_16x16x32_bf16 v[16:19], a[244:247], v[132:135], v[16:19]
ds_read_b128 a[228:231], v243 offset:21120
v_cvt_pk_bf16_f32 v190, v208, v209
v_mfma_f32_16x16x32_bf16 v[48:51], a[240:243], v[136:139], v[48:51]
v_add_f32 v211, v238, v211
v_exp_f32 v211, v211
v_mfma_f32_16x16x32_bf16 v[48:51], a[244:247], v[140:143], v[48:51]
ds_read_b128 a[232:235], v242 offset:21632
v_cvt_pk_bf16_f32 v191, v210, v211
v_mfma_f32_16x16x32_bf16 v[216:219], a[208:211], a[0:3], 0
s_add_u32 m0, s58, 64
v_add_f32 v212, v239, v212
v_exp_f32 v212, v212
v_mfma_f32_16x16x32_bf16 v[216:219], a[212:215], a[4:7], v[216:219]
ds_read_b128 a[236:239], v243 offset:21632
buffer_load_dwordx4 v248, s[36:39], s56 offen offset:2048 nt lds
v_mfma_f32_16x16x32_bf16 v[216:219], a[216:219], a[8:11], v[216:219]
v_add_f32 v213, v239, v213
v_exp_f32 v213, v213
v_mfma_f32_16x16x32_bf16 v[216:219], a[220:223], a[12:15], v[216:219]
v_cvt_pk_bf16_f32 v198, v212, v213
v_add_f32 v229, v229, v212
v_mfma_f32_16x16x32_bf16 v[80:83], a[240:243], v[144:147], v[80:83]
v_add_f32 v214, v239, v214
v_exp_f32 v214, v214
v_mfma_f32_16x16x32_bf16 v[80:83], a[244:247], v[148:151], v[80:83]
v_add_f32 v229, v229, v213
v_add_f32 v229, v229, v214
v_mfma_f32_16x16x32_bf16 v[112:115], a[240:243], v[152:155], v[112:115]
v_add_f32 v215, v239, v215
v_exp_f32 v215, v215
v_mfma_f32_16x16x32_bf16 v[112:115], a[244:247], v[156:159], v[112:115]
v_cvt_pk_bf16_f32 v199, v214, v215
v_add_f32 v229, v229, v215
v_mfma_f32_16x16x32_bf16 v[220:223], a[208:211], a[16:19], 0
v_add_f32 v216, v235, v216
v_exp_f32 v216, v216
v_mfma_f32_16x16x32_bf16 v[220:223], a[212:215], a[20:23], v[220:223]
v_add_u32 v242, s60, v242
v_add_u32 v243, s60, v243
v_mfma_f32_16x16x32_bf16 v[220:223], a[216:219], a[24:27], v[220:223]
s_mul_i32 s60, s60, -1
v_add_f32 v217, v235, v217
v_exp_f32 v217, v217
v_mfma_f32_16x16x32_bf16 v[220:223], a[220:223], a[28:31], v[220:223]
v_cvt_pk_bf16_f32 v168, v216, v217
v_mfma_f32_16x16x32_bf16 a[176:179], a[240:243], v[160:163], a[176:179]
s_waitcnt lgkmcnt(4)
v_add_f32 v218, v235, v218
v_exp_f32 v218, v218
v_mfma_f32_16x16x32_bf16 v[20:23], a[248:251], v[128:131], v[20:23]
ds_read_b64_tr_b16 a[240:241], v245 offset:512
ds_read_b64_tr_b16 a[242:243], v245 offset:4736
v_mfma_f32_16x16x32_bf16 v[20:23], a[252:255], v[132:135], v[20:23]
v_add_f32 v219, v235, v219
v_exp_f32_e64 v219, v219
v_mfma_f32_16x16x32_bf16 v[52:55], a[248:251], v[136:139], v[52:55]
ds_read_b64_tr_b16 a[244:245], v247 offset:512
ds_read_b64_tr_b16 a[246:247], v247 offset:4736
v_mfma_f32_16x16x32_bf16 v[52:55], a[252:255], v[140:143], v[52:55]
v_cvt_pk_bf16_f32 v169, v218, v219
v_mfma_f32_16x16x32_bf16 v[200:203], a[208:211], a[32:35], 0
v_add_f32 v220, v236, v220
v_exp_f32 v220, v220
v_mfma_f32_16x16x32_bf16 v[200:203], a[212:215], a[36:39], v[200:203]
s_add_u32 m0, s58, 96
v_mfma_f32_16x16x32_bf16 v[200:203], a[216:219], a[40:43], v[200:203]
v_add_f32 v221, v236, v221
v_exp_f32 v221, v221
v_mfma_f32_16x16x32_bf16 v[200:203], a[220:223], a[44:47], v[200:203]
buffer_load_dwordx4 v248, s[36:39], s56 offen offset:3072 nt lds
v_cvt_pk_bf16_f32 v176, v220, v221
v_mfma_f32_16x16x32_bf16 v[84:87], a[248:251], v[144:147], v[84:87]
s_add_u32 s56, s56, 16384
v_add_f32 v222, v236, v222
v_exp_f32 v222, v222
v_mfma_f32_16x16x32_bf16 v[84:87], a[252:255], v[148:151], v[84:87]
s_add_u32 s58, s58, 16896
v_mfma_f32_16x16x32_bf16 v[116:119], a[248:251], v[152:155], v[116:119]
s_cmp_eq_u32 s58, s69
v_add_f32 v223, v236, v223
v_exp_f32 v223, v223
v_mfma_f32_16x16x32_bf16 v[116:119], a[252:255], v[156:159], v[116:119]
s_cselect_b32 s58, s67, s58
v_cvt_pk_bf16_f32 v177, v222, v223
v_mfma_f32_16x16x32_bf16 v[204:207], a[208:211], a[48:51], 0
v_add_f32 v200, v237, v200
v_exp_f32 v200, v200
v_mfma_f32_16x16x32_bf16 v[204:207], a[212:215], a[52:55], v[204:207]
v_mfma_f32_16x16x32_bf16 v[204:207], a[216:219], a[56:59], v[204:207]
v_add_f32 v201, v237, v201
v_exp_f32 v201, v201
v_mfma_f32_16x16x32_bf16 v[204:207], a[220:223], a[60:63], v[204:207]
v_cvt_pk_bf16_f32 v184, v200, v201
v_mfma_f32_16x16x32_bf16 a[180:183], a[248:251], v[160:163], a[180:183]
v_add_f32 v202, v237, v202
v_exp_f32 v202, v202
v_smfmac_f32_16x16x64_bf16 a[200:203], v[224:227], v[144:151], v228
s_waitcnt lgkmcnt(0)
ds_read_b64_tr_b16 a[248:249], v245 offset:544
ds_read_b64_tr_b16 a[250:251], v245 offset:4768
v_mfma_f32_16x16x32_bf16 v[24:27], a[240:243], v[128:131], v[24:27]
v_add_f32 v203, v237, v203
v_exp_f32 v203, v203
v_mfma_f32_16x16x32_bf16 v[24:27], a[244:247], v[132:135], v[24:27]
ds_read_b64_tr_b16 a[252:253], v247 offset:544
ds_read_b64_tr_b16 a[254:255], v247 offset:4768
v_mfma_f32_16x16x32_bf16 v[208:211], a[224:227], a[0:3], 0
v_add_f32 v204, v238, v204
v_exp_f32 v204, v204
v_mfma_f32_16x16x32_bf16 v[208:211], a[228:231], a[4:7], v[208:211]
v_cvt_pk_bf16_f32 v185, v202, v203
v_mfma_f32_16x16x32_bf16 v[208:211], a[232:235], a[8:11], v[208:211]
v_add_f32 v205, v238, v205
v_exp_f32 v205, v205
v_mfma_f32_16x16x32_bf16 v[208:211], a[236:239], a[12:15], v[208:211]
s_waitcnt vmcnt(12)
s_barrier
v_mfma_f32_16x16x32_bf16 v[56:59], a[240:243], v[136:139], v[56:59]
s_mov_b32 m0, s59
v_add_f32 v206, v238, v206
v_exp_f32 v206, v206
v_mfma_f32_16x16x32_bf16 v[56:59], a[244:247], v[140:143], v[56:59]
ds_read_b128 a[208:211], v240 offset:0
buffer_load_dwordx4 v248, s[40:43], s57 offen offset:0 nt lds
v_cvt_pk_bf16_f32 v192, v204, v205
v_mfma_f32_16x16x32_bf16 v[88:91], a[240:243], v[144:147], v[88:91]
v_add_f32 v207, v238, v207
v_exp_f32 v207, v207
v_mfma_f32_16x16x32_bf16 v[88:91], a[244:247], v[148:151], v[88:91]
ds_read_b128 a[212:215], v241 offset:0
v_cvt_pk_bf16_f32 v193, v206, v207
v_mfma_f32_16x16x32_bf16 v[212:215], a[224:227], a[16:19], 0
v_add_f32 v208, v235, v208
v_exp_f32 v208, v208
v_mfma_f32_16x16x32_bf16 v[212:215], a[228:231], a[20:23], v[212:215]
ds_read_b128 a[216:219], v240 offset:512
v_mfma_f32_16x16x32_bf16 v[212:215], a[232:235], a[24:27], v[212:215]
v_add_f32 v209, v235, v209
v_exp_f32 v209, v209
v_mfma_f32_16x16x32_bf16 v[212:215], a[236:239], a[28:31], v[212:215]
ds_read_b128 a[220:223], v241 offset:512
v_cvt_pk_bf16_f32 v170, v208, v209
v_mfma_f32_16x16x32_bf16 v[120:123], a[240:243], v[152:155], v[120:123]
v_add_f32 v210, v235, v210
v_exp_f32 v210, v210
v_mfma_f32_16x16x32_bf16 v[120:123], a[244:247], v[156:159], v[120:123]
v_mfma_f32_16x16x32_bf16 a[184:187], a[240:243], v[160:163], a[184:187]
v_add_f32 v211, v235, v211
v_exp_f32 v211, v211
v_smfmac_f32_16x16x64_bf16 a[204:207], v[224:227], v[152:159], v228
ds_read_b64_tr_b16 a[240:241], v244 offset:16896
ds_read_b64_tr_b16 a[242:243], v244 offset:21120
v_mfma_f32_16x16x32_bf16 v[216:219], a[224:227], a[32:35], 0
v_add_f32 v212, v236, v212
v_exp_f32 v212, v212
v_mfma_f32_16x16x32_bf16 v[216:219], a[228:231], a[36:39], v[216:219]
ds_read_b64_tr_b16 a[244:245], v246 offset:16896
ds_read_b64_tr_b16 a[246:247], v246 offset:21120
v_mfma_f32_16x16x32_bf16 v[216:219], a[232:235], a[40:43], v[216:219]
v_add_f32 v213, v236, v213
v_exp_f32 v213, v213
v_mfma_f32_16x16x32_bf16 v[216:219], a[236:239], a[44:47], v[216:219]
s_waitcnt lgkmcnt(8)
v_cvt_pk_bf16_f32 v171, v210, v211
v_cvt_pk_bf16_f32 v178, v212, v213
v_mfma_f32_16x16x32_bf16 v[28:31], a[248:251], v[128:131], v[28:31]
v_add_f32 v214, v236, v214
v_exp_f32 v214, v214
v_mfma_f32_16x16x32_bf16 v[28:31], a[252:255], v[132:135], v[28:31]
v_mfma_f32_16x16x32_bf16 v[60:63], a[248:251], v[136:139], v[60:63]
s_add_u32 m0, s59, 32
v_add_f32 v215, v236, v215
v_exp_f32 v215, v215
v_mfma_f32_16x16x32_bf16 v[60:63], a[252:255], v[140:143], v[60:63]
buffer_load_dwordx4 v248, s[40:43], s57 offen offset:1024 nt lds
v_cvt_pk_bf16_f32 v179, v214, v215
v_mfma_f32_16x16x32_bf16 v[220:223], a[224:227], a[48:51], 0
v_add_f32 v216, v237, v216
v_exp_f32 v216, v216
v_mfma_f32_16x16x32_bf16 v[220:223], a[228:231], a[52:55], v[220:223]
v_mfma_f32_16x16x32_bf16 v[220:223], a[232:235], a[56:59], v[220:223]
v_add_f32 v217, v237, v217
v_exp_f32 v217, v217
v_mfma_f32_16x16x32_bf16 v[220:223], a[236:239], a[60:63], v[220:223]
v_cvt_pk_bf16_f32 v186, v216, v217
v_mfma_f32_16x16x32_bf16 v[92:95], a[248:251], v[144:147], v[92:95]
s_sub_u32 s62, s62, 1
v_add_f32 v218, v237, v218
v_exp_f32 v218, v218
v_mfma_f32_16x16x32_bf16 v[92:95], a[252:255], v[148:151], v[92:95]
s_cmp_lg_u32 s62, 0
v_mfma_f32_16x16x32_bf16 v[124:127], a[248:251], v[152:155], v[124:127]
v_add_f32 v219, v237, v219
v_exp_f32 v219, v219
v_mfma_f32_16x16x32_bf16 v[124:127], a[252:255], v[156:159], v[124:127]
s_waitcnt lgkmcnt(4)
v_cvt_pk_bf16_f32 v187, v218, v219
v_mfma_f32_16x16x32_bf16 a[188:191], a[248:251], v[160:163], a[188:191]
s_cbranch_scc1 L_s_loop
s_cmp_eq_u32 s63, 1
s_cbranch_scc1 L_s_last
L_s_tail:
s_waitcnt lgkmcnt(2)
v_mfma_f32_16x16x32_bf16 v[0:3], a[240:243], v[164:167], v[0:3]
s_waitcnt lgkmcnt(0)
v_add_f32 v220, v238, v220
v_exp_f32 v220, v220
v_mfma_f32_16x16x32_bf16 v[0:3], a[244:247], v[168:171], v[0:3]
v_add_f32 v221, v238, v221
v_exp_f32 v221, v221
v_mfma_f32_16x16x32_bf16 v[32:35], a[240:243], v[172:175], v[32:35]
v_add_f32 v222, v238, v222
v_exp_f32 v222, v222
v_mfma_f32_16x16x32_bf16 v[32:35], a[244:247], v[176:179], v[32:35]
v_add_f32 v223, v238, v223
v_exp_f32 v223, v223
v_mfma_f32_16x16x32_bf16 v[64:67], a[240:243], v[180:183], v[64:67]
ds_read_b64_tr_b16 a[248:249], v244 offset:16928
v_cvt_pk_bf16_f32 v194, v220, v221
v_mfma_f32_16x16x32_bf16 v[64:67], a[244:247], v[184:187], v[64:67]
ds_read_b64_tr_b16 a[250:251], v244 offset:21152
v_cvt_pk_bf16_f32 v195, v222, v223
v_mfma_f32_16x16x32_bf16 a[160:163], a[240:243], v[196:199], a[160:163]
ds_read_b64_tr_b16 a[252:253], v246 offset:16928
v_accvgpr_mov_b32 a0, a80
v_mfma_f32_16x16x32_bf16 v[96:99], a[240:243], v[188:191], v[96:99]
ds_read_b64_tr_b16 a[254:255], v246 offset:21152
v_accvgpr_mov_b32 a1, a81
v_mfma_f32_16x16x32_bf16 v[96:99], a[244:247], v[192:195], v[96:99]
ds_read_b64_tr_b16 a[240:241], v245 offset:16896
v_accvgpr_mov_b32 a2, a82
v_smfmac_f32_16x16x64_bf16 a[192:195], v[224:227], v[164:171], v228
ds_read_b64_tr_b16 a[242:243], v245 offset:21120
v_accvgpr_mov_b32 a3, a83
v_smfmac_f32_16x16x64_bf16 a[196:199], v[224:227], v[172:179], v228
ds_read_b64_tr_b16 a[244:245], v247 offset:16896
v_accvgpr_mov_b32 a4, a84
v_smfmac_f32_16x16x64_bf16 a[200:203], v[224:227], v[180:187], v228
ds_read_b64_tr_b16 a[246:247], v247 offset:21120
v_accvgpr_mov_b32 a5, a85
v_smfmac_f32_16x16x64_bf16 a[204:207], v[224:227], v[188:195], v228
s_waitcnt lgkmcnt(4)
v_accvgpr_mov_b32 a6, a86
v_accvgpr_mov_b32 a7, a87
v_mfma_f32_16x16x32_bf16 v[4:7], a[248:251], v[164:167], v[4:7]
v_accvgpr_mov_b32 a8, a88
v_accvgpr_mov_b32 a9, a89
v_mfma_f32_16x16x32_bf16 v[4:7], a[252:255], v[168:171], v[4:7]
v_accvgpr_mov_b32 a10, a90
v_accvgpr_mov_b32 a11, a91
v_mfma_f32_16x16x32_bf16 v[36:39], a[248:251], v[172:175], v[36:39]
v_accvgpr_mov_b32 a12, a92
v_accvgpr_mov_b32 a13, a93
v_mfma_f32_16x16x32_bf16 v[36:39], a[252:255], v[176:179], v[36:39]
v_accvgpr_mov_b32 a14, a94
v_accvgpr_mov_b32 a15, a95
v_mfma_f32_16x16x32_bf16 v[68:71], a[248:251], v[180:183], v[68:71]
v_accvgpr_mov_b32 a16, a96
v_accvgpr_mov_b32 a17, a97
v_mfma_f32_16x16x32_bf16 v[68:71], a[252:255], v[184:187], v[68:71]
v_accvgpr_mov_b32 a18, a98
v_accvgpr_mov_b32 a19, a99
v_mfma_f32_16x16x32_bf16 v[100:103], a[248:251], v[188:191], v[100:103]
v_accvgpr_mov_b32 a20, a100
v_accvgpr_mov_b32 a21, a101
v_mfma_f32_16x16x32_bf16 v[100:103], a[252:255], v[192:195], v[100:103]
v_accvgpr_mov_b32 a22, a102
v_accvgpr_mov_b32 a23, a103
v_mfma_f32_16x16x32_bf16 a[164:167], a[248:251], v[196:199], a[164:167]
s_waitcnt lgkmcnt(0)
ds_read_b64_tr_b16 a[248:249], v245 offset:16928
v_accvgpr_read_b32 v200, a192
v_mfma_f32_16x16x32_bf16 v[8:11], a[240:243], v[164:167], v[8:11]
ds_read_b64_tr_b16 a[250:251], v245 offset:21152
v_accvgpr_read_b32 v201, a193
v_mfma_f32_16x16x32_bf16 v[8:11], a[244:247], v[168:171], v[8:11]
ds_read_b64_tr_b16 a[252:253], v247 offset:16928
v_accvgpr_read_b32 v202, a196
v_mfma_f32_16x16x32_bf16 v[40:43], a[240:243], v[172:175], v[40:43]
ds_read_b64_tr_b16 a[254:255], v247 offset:21152
v_accvgpr_read_b32 v203, a197
v_mfma_f32_16x16x32_bf16 v[40:43], a[244:247], v[176:179], v[40:43]
v_accvgpr_read_b32 v204, a200
v_accvgpr_read_b32 v205, a201
v_mfma_f32_16x16x32_bf16 v[72:75], a[240:243], v[180:183], v[72:75]
v_accvgpr_read_b32 v206, a204
v_accvgpr_read_b32 v207, a205
v_mfma_f32_16x16x32_bf16 v[72:75], a[244:247], v[184:187], v[72:75]
v_add_f32 v200, v200, v201
v_add_f32 v202, v202, v203
v_mfma_f32_16x16x32_bf16 v[104:107], a[240:243], v[188:191], v[104:107]
v_add_f32 v204, v204, v205
v_add_f32 v206, v206, v207
v_mfma_f32_16x16x32_bf16 v[104:107], a[244:247], v[192:195], v[104:107]
v_rcp_f32 v230, v200
v_mfma_f32_16x16x32_bf16 a[168:171], a[240:243], v[196:199], a[168:171]
s_waitcnt lgkmcnt(0)
ds_read_b64_tr_b16 a[240:241], v244 offset:17408
v_mfma_f32_16x16x32_bf16 v[12:15], a[248:251], v[164:167], v[12:15]
ds_read_b64_tr_b16 a[242:243], v244 offset:21632
v_mfma_f32_16x16x32_bf16 v[12:15], a[252:255], v[168:171], v[12:15]
ds_read_b64_tr_b16 a[244:245], v246 offset:17408
v_mfma_f32_16x16x32_bf16 v[44:47], a[248:251], v[172:175], v[44:47]
ds_read_b64_tr_b16 a[246:247], v246 offset:21632
v_mfma_f32_16x16x32_bf16 v[44:47], a[252:255], v[176:179], v[44:47]
v_rcp_f32 v231, v202
v_mfma_f32_16x16x32_bf16 v[76:79], a[248:251], v[180:183], v[76:79]
v_rcp_f32 v232, v204
v_mfma_f32_16x16x32_bf16 v[76:79], a[252:255], v[184:187], v[76:79]
v_rcp_f32 v233, v206
v_mfma_f32_16x16x32_bf16 v[108:111], a[248:251], v[188:191], v[108:111]
v_min3_u32 v201, v200, v202, v204
v_max3_u32 v203, v200, v202, v204
v_mfma_f32_16x16x32_bf16 v[108:111], a[252:255], v[192:195], v[108:111]
v_min_u32 v201, v201, v206
v_max_u32 v203, v203, v206
v_mfma_f32_16x16x32_bf16 a[172:175], a[248:251], v[196:199], a[172:175]
s_waitcnt lgkmcnt(0)
ds_read_b64_tr_b16 a[248:249], v244 offset:17440
v_cmp_gt_u32 s[72:73], s74, v201
v_mfma_f32_16x16x32_bf16 v[16:19], a[240:243], v[164:167], v[16:19]
ds_read_b64_tr_b16 a[250:251], v244 offset:21664
v_cmp_lt_u32 vcc, s75, v203
v_mfma_f32_16x16x32_bf16 v[16:19], a[244:247], v[168:171], v[16:19]
s_lshl_b32 s50, s48, 2
s_add_u32 s50, s50, 152576
ds_read_b64_tr_b16 a[252:253], v246 offset:17440
v_mfma_f32_16x16x32_bf16 v[48:51], a[240:243], v[172:175], v[48:51]
s_or_b64 s[72:73], s[72:73], vcc
s_or_b32 s72, s72, s73
ds_read_b64_tr_b16 a[254:255], v246 offset:21664
v_mfma_f32_16x16x32_bf16 v[48:51], a[244:247], v[176:179], v[48:51]
v_mov_b32 v201, s50
v_mov_b32 v200, s72
v_mfma_f32_16x16x32_bf16 v[80:83], a[240:243], v[180:183], v[80:83]
v_add_u32 v244, s61, v244
v_add_u32 v246, s61, v246
v_mfma_f32_16x16x32_bf16 v[80:83], a[244:247], v[184:187], v[80:83]
v_accvgpr_write_b32 a192, 0
v_accvgpr_write_b32 a193, 0
v_mfma_f32_16x16x32_bf16 v[112:115], a[240:243], v[188:191], v[112:115]
v_accvgpr_write_b32 a196, 0
v_accvgpr_write_b32 a197, 0
v_mfma_f32_16x16x32_bf16 v[112:115], a[244:247], v[192:195], v[112:115]
v_accvgpr_write_b32 a200, 0
v_accvgpr_write_b32 a201, 0
v_mfma_f32_16x16x32_bf16 a[176:179], a[240:243], v[196:199], a[176:179]
s_waitcnt lgkmcnt(0)
ds_read_b64_tr_b16 a[240:241], v245 offset:17408
v_accvgpr_write_b32 a204, 0
v_mfma_f32_16x16x32_bf16 v[20:23], a[248:251], v[164:167], v[20:23]
ds_read_b64_tr_b16 a[242:243], v245 offset:21632
v_accvgpr_write_b32 a205, 0
v_mfma_f32_16x16x32_bf16 v[20:23], a[252:255], v[168:171], v[20:23]
ds_read_b64_tr_b16 a[244:245], v247 offset:17408
v_accvgpr_mov_b32 a24, a104
v_mfma_f32_16x16x32_bf16 v[52:55], a[248:251], v[172:175], v[52:55]
ds_read_b64_tr_b16 a[246:247], v247 offset:21632
v_accvgpr_mov_b32 a25, a105
v_mfma_f32_16x16x32_bf16 v[52:55], a[252:255], v[176:179], v[52:55]
v_accvgpr_mov_b32 a26, a106
v_accvgpr_mov_b32 a27, a107
v_mfma_f32_16x16x32_bf16 v[84:87], a[248:251], v[180:183], v[84:87]
v_accvgpr_mov_b32 a28, a108
v_accvgpr_mov_b32 a29, a109
v_mfma_f32_16x16x32_bf16 v[84:87], a[252:255], v[184:187], v[84:87]
v_accvgpr_mov_b32 a30, a110
v_accvgpr_mov_b32 a31, a111
v_mfma_f32_16x16x32_bf16 v[116:119], a[248:251], v[188:191], v[116:119]
v_accvgpr_mov_b32 a32, a112
v_accvgpr_mov_b32 a33, a113
v_mfma_f32_16x16x32_bf16 v[116:119], a[252:255], v[192:195], v[116:119]
v_accvgpr_mov_b32 a34, a114
v_accvgpr_mov_b32 a35, a115
v_mfma_f32_16x16x32_bf16 a[180:183], a[248:251], v[196:199], a[180:183]
s_waitcnt lgkmcnt(0)
ds_read_b64_tr_b16 a[248:249], v245 offset:17440
v_accvgpr_mov_b32 a36, a116
v_mfma_f32_16x16x32_bf16 v[24:27], a[240:243], v[164:167], v[24:27]
ds_read_b64_tr_b16 a[250:251], v245 offset:21664
v_accvgpr_mov_b32 a37, a117
v_mfma_f32_16x16x32_bf16 v[24:27], a[244:247], v[168:171], v[24:27]
ds_read_b64_tr_b16 a[252:253], v247 offset:17440
v_accvgpr_mov_b32 a38, a118
v_mfma_f32_16x16x32_bf16 v[56:59], a[240:243], v[172:175], v[56:59]
ds_read_b64_tr_b16 a[254:255], v247 offset:21664
v_accvgpr_mov_b32 a39, a119
v_mfma_f32_16x16x32_bf16 v[56:59], a[244:247], v[176:179], v[56:59]
v_accvgpr_mov_b32 a40, a120
v_accvgpr_mov_b32 a41, a121
v_mfma_f32_16x16x32_bf16 v[88:91], a[240:243], v[180:183], v[88:91]
v_add_u32 v245, s61, v245
v_add_u32 v247, s61, v247
v_mfma_f32_16x16x32_bf16 v[88:91], a[244:247], v[184:187], v[88:91]
s_mul_i32 s61, s61, -1
v_accvgpr_mov_b32 a42, a122
v_accvgpr_mov_b32 a43, a123
v_mfma_f32_16x16x32_bf16 v[120:123], a[240:243], v[188:191], v[120:123]
v_accvgpr_mov_b32 a44, a124
v_accvgpr_mov_b32 a45, a125
v_mfma_f32_16x16x32_bf16 v[120:123], a[244:247], v[192:195], v[120:123]
v_accvgpr_mov_b32 a46, a126
v_accvgpr_mov_b32 a47, a127
v_mfma_f32_16x16x32_bf16 a[184:187], a[240:243], v[196:199], a[184:187]
s_waitcnt lgkmcnt(0)
v_accvgpr_mov_b32 a48, a128
v_accvgpr_mov_b32 a49, a129
v_mfma_f32_16x16x32_bf16 v[28:31], a[248:251], v[164:167], v[28:31]
v_accvgpr_mov_b32 a50, a130
v_accvgpr_mov_b32 a51, a131
v_mfma_f32_16x16x32_bf16 v[28:31], a[252:255], v[168:171], v[28:31]
v_accvgpr_mov_b32 a52, a132
v_accvgpr_mov_b32 a53, a133
v_mfma_f32_16x16x32_bf16 v[60:63], a[248:251], v[172:175], v[60:63]
v_accvgpr_mov_b32 a54, a134
v_accvgpr_mov_b32 a55, a135
v_mfma_f32_16x16x32_bf16 v[60:63], a[252:255], v[176:179], v[60:63]
v_accvgpr_mov_b32 a56, a136
v_accvgpr_mov_b32 a57, a137
v_mfma_f32_16x16x32_bf16 v[92:95], a[248:251], v[180:183], v[92:95]
v_accvgpr_mov_b32 a58, a138
v_accvgpr_mov_b32 a59, a139
v_mfma_f32_16x16x32_bf16 v[92:95], a[252:255], v[184:187], v[92:95]
v_accvgpr_mov_b32 a60, a140
v_accvgpr_mov_b32 a61, a141
v_mfma_f32_16x16x32_bf16 v[124:127], a[248:251], v[188:191], v[124:127]
v_accvgpr_mov_b32 a62, a142
v_accvgpr_mov_b32 a63, a143
v_mfma_f32_16x16x32_bf16 v[124:127], a[252:255], v[192:195], v[124:127]
v_accvgpr_mov_b32 a64, a144
v_accvgpr_mov_b32 a65, a145
v_mfma_f32_16x16x32_bf16 a[188:191], a[248:251], v[196:199], a[188:191]
v_accvgpr_mov_b32 a66, a146
v_accvgpr_mov_b32 a67, a147
ds_write_b128 v250, a[168:171] offset:0
ds_write_b128 v250, a[172:175] offset:1024
ds_write_b32 v252, v229
ds_write_b32 v201, v200
v_mov_b32 v229, 0
v_accvgpr_mov_b32 a68, a148
v_accvgpr_mov_b32 a69, a149
v_accvgpr_mov_b32 a70, a150
v_accvgpr_mov_b32 a71, a151
v_accvgpr_mov_b32 a72, a152
v_accvgpr_mov_b32 a73, a153
ds_write_b128 v250, a[184:187] offset:2048
ds_write_b128 v250, a[188:191] offset:3072
v_accvgpr_mov_b32 a74, a154
v_accvgpr_mov_b32 a75, a155
v_accvgpr_mov_b32 a76, a156
v_accvgpr_mov_b32 a77, a157
v_accvgpr_mov_b32 a78, a158
v_accvgpr_mov_b32 a79, a159
v_pk_mul_f32 v[0:1], v[0:1], v[230:231] op_sel:[0,0] op_sel_hi:[1,0]
v_pk_mul_f32 v[2:3], v[2:3], v[230:231] op_sel:[0,0] op_sel_hi:[1,0]
v_pk_mul_f32 v[4:5], v[4:5], v[230:231] op_sel:[0,0] op_sel_hi:[1,0]
v_pk_mul_f32 v[6:7], v[6:7], v[230:231] op_sel:[0,0] op_sel_hi:[1,0]
s_add_u32 s50, s64, 0
v_cvt_pk_bf16_f32 v0, v0, v1
v_cvt_pk_bf16_f32 v1, v2, v3
v_cvt_pk_bf16_f32 v2, v4, v5
v_cvt_pk_bf16_f32 v3, v6, v7
buffer_store_dwordx4 v[0:3], v249, s[44:47], s50 offen offset:0 sc1
v_pk_mul_f32 v[32:33], v[32:33], v[230:231] op_sel:[0,1] op_sel_hi:[1,1]
v_pk_mul_f32 v[34:35], v[34:35], v[230:231] op_sel:[0,1] op_sel_hi:[1,1]
v_pk_mul_f32 v[36:37], v[36:37], v[230:231] op_sel:[0,1] op_sel_hi:[1,1]
v_pk_mul_f32 v[38:39], v[38:39], v[230:231] op_sel:[0,1] op_sel_hi:[1,1]
s_add_u32 s50, s64, 2048
v_cvt_pk_bf16_f32 v32, v32, v33
v_cvt_pk_bf16_f32 v33, v34, v35
v_cvt_pk_bf16_f32 v34, v36, v37
v_mov_b32 v208, 152576
s_waitcnt lgkmcnt(0)
s_barrier
ds_read_b128 v[180:183], v253 offset:0
ds_read_b128 v[184:187], v253 offset:16
ds_read_b128 v[188:191], v253 offset:512
ds_read_b128 v[192:195], v253 offset:528
ds_read_b128 v[196:199], v208
ds_read_b128 v[164:167], v251 offset:0
ds_read_b128 v[168:171], v251 offset:1024
ds_read_b128 v[172:175], v251 offset:2048
ds_read_b128 v[176:179], v251 offset:3072
v_cvt_pk_bf16_f32 v35, v38, v39
buffer_store_dwordx4 v[32:35], v249, s[44:47], s50 offen offset:0 sc1
v_pk_mul_f32 v[64:65], v[64:65], v[232:233] op_sel:[0,0] op_sel_hi:[1,0]
v_pk_mul_f32 v[66:67], v[66:67], v[232:233] op_sel:[0,0] op_sel_hi:[1,0]
v_pk_mul_f32 v[68:69], v[68:69], v[232:233] op_sel:[0,0] op_sel_hi:[1,0]
v_pk_mul_f32 v[70:71], v[70:71], v[232:233] op_sel:[0,0] op_sel_hi:[1,0]
s_add_u32 s50, s64, 4096
v_cvt_pk_bf16_f32 v64, v64, v65
v_cvt_pk_bf16_f32 v65, v66, v67
v_cvt_pk_bf16_f32 v66, v68, v69
v_cvt_pk_bf16_f32 v67, v70, v71
buffer_store_dwordx4 v[64:67], v249, s[44:47], s50 offen offset:0 sc1
v_pk_mul_f32 v[96:97], v[96:97], v[232:233] op_sel:[0,1] op_sel_hi:[1,1]
v_pk_mul_f32 v[98:99], v[98:99], v[232:233] op_sel:[0,1] op_sel_hi:[1,1]
v_pk_mul_f32 v[100:101], v[100:101], v[232:233] op_sel:[0,1] op_sel_hi:[1,1]
v_pk_mul_f32 v[102:103], v[102:103], v[232:233] op_sel:[0,1] op_sel_hi:[1,1]
s_add_u32 s50, s64, 6144
v_cvt_pk_bf16_f32 v96, v96, v97
v_cvt_pk_bf16_f32 v97, v98, v99
v_cvt_pk_bf16_f32 v98, v100, v101
v_cvt_pk_bf16_f32 v99, v102, v103
buffer_store_dwordx4 v[96:99], v249, s[44:47], s50 offen offset:0 sc1
v_pk_mul_f32 v[8:9], v[8:9], v[230:231] op_sel:[0,0] op_sel_hi:[1,0]
v_pk_mul_f32 v[10:11], v[10:11], v[230:231] op_sel:[0,0] op_sel_hi:[1,0]
v_pk_mul_f32 v[12:13], v[12:13], v[230:231] op_sel:[0,0] op_sel_hi:[1,0]
v_pk_mul_f32 v[14:15], v[14:15], v[230:231] op_sel:[0,0] op_sel_hi:[1,0]
s_add_u32 s50, s65, 0
s_nop 0
v_cvt_pk_bf16_f32 v8, v8, v9
v_cvt_pk_bf16_f32 v9, v10, v11
v_cvt_pk_bf16_f32 v10, v12, v13
v_cvt_pk_bf16_f32 v11, v14, v15
buffer_store_dwordx4 v[8:11], v249, s[44:47], s50 offen offset:0 sc1
v_pk_mul_f32 v[40:41], v[40:41], v[230:231] op_sel:[0,1] op_sel_hi:[1,1]
v_pk_mul_f32 v[42:43], v[42:43], v[230:231] op_sel:[0,1] op_sel_hi:[1,1]
v_pk_mul_f32 v[44:45], v[44:45], v[230:231] op_sel:[0,1] op_sel_hi:[1,1]
v_pk_mul_f32 v[46:47], v[46:47], v[230:231] op_sel:[0,1] op_sel_hi:[1,1]
s_add_u32 s50, s65, 2048
v_cvt_pk_bf16_f32 v40, v40, v41
v_cvt_pk_bf16_f32 v41, v42, v43
v_cvt_pk_bf16_f32 v42, v44, v45
v_cvt_pk_bf16_f32 v43, v46, v47
buffer_store_dwordx4 v[40:43], v249, s[44:47], s50 offen offset:0 sc1
v_pk_mul_f32 v[72:73], v[72:73], v[232:233] op_sel:[0,0] op_sel_hi:[1,0]
v_pk_mul_f32 v[74:75], v[74:75], v[232:233] op_sel:[0,0] op_sel_hi:[1,0]
v_pk_mul_f32 v[76:77], v[76:77], v[232:233] op_sel:[0,0] op_sel_hi:[1,0]
v_pk_mul_f32 v[78:79], v[78:79], v[232:233] op_sel:[0,0] op_sel_hi:[1,0]
v_cvt_pk_bf16_f32 v72, v72, v73
v_cvt_pk_bf16_f32 v73, v74, v75
v_cvt_pk_bf16_f32 v74, v76, v77
v_cvt_pk_bf16_f32 v75, v78, v79
v_accvgpr_write_b32 a104, v72
v_accvgpr_write_b32 a105, v73
v_accvgpr_write_b32 a106, v74
v_accvgpr_write_b32 a107, v75
v_pk_mul_f32 v[104:105], v[104:105], v[232:233] op_sel:[0,1] op_sel_hi:[1,1]
v_pk_mul_f32 v[106:107], v[106:107], v[232:233] op_sel:[0,1] op_sel_hi:[1,1]
v_pk_mul_f32 v[108:109], v[108:109], v[232:233] op_sel:[0,1] op_sel_hi:[1,1]
v_pk_mul_f32 v[110:111], v[110:111], v[232:233] op_sel:[0,1] op_sel_hi:[1,1]
v_cvt_pk_bf16_f32 v104, v104, v105
v_cvt_pk_bf16_f32 v105, v106, v107
v_cvt_pk_bf16_f32 v106, v108, v109
v_cvt_pk_bf16_f32 v107, v110, v111
v_accvgpr_write_b32 a108, v104
v_accvgpr_write_b32 a109, v105
v_accvgpr_write_b32 a110, v106
v_accvgpr_write_b32 a111, v107
v_pk_mul_f32 v[16:17], v[16:17], v[230:231] op_sel:[0,0] op_sel_hi:[1,0]
v_pk_mul_f32 v[18:19], v[18:19], v[230:231] op_sel:[0,0] op_sel_hi:[1,0]
v_pk_mul_f32 v[20:21], v[20:21], v[230:231] op_sel:[0,0] op_sel_hi:[1,0]
v_pk_mul_f32 v[22:23], v[22:23], v[230:231] op_sel:[0,0] op_sel_hi:[1,0]
v_cvt_pk_bf16_f32 v16, v16, v17
v_cvt_pk_bf16_f32 v17, v18, v19
v_cvt_pk_bf16_f32 v18, v20, v21
v_cvt_pk_bf16_f32 v19, v22, v23
v_accvgpr_write_b32 a112, v16
v_accvgpr_write_b32 a113, v17
v_accvgpr_write_b32 a114, v18
v_accvgpr_write_b32 a115, v19
v_pk_mul_f32 v[48:49], v[48:49], v[230:231] op_sel:[0,1] op_sel_hi:[1,1]
v_pk_mul_f32 v[50:51], v[50:51], v[230:231] op_sel:[0,1] op_sel_hi:[1,1]
v_pk_mul_f32 v[52:53], v[52:53], v[230:231] op_sel:[0,1] op_sel_hi:[1,1]
v_pk_mul_f32 v[54:55], v[54:55], v[230:231] op_sel:[0,1] op_sel_hi:[1,1]
v_cvt_pk_bf16_f32 v48, v48, v49
v_cvt_pk_bf16_f32 v49, v50, v51
v_cvt_pk_bf16_f32 v50, v52, v53
v_cvt_pk_bf16_f32 v51, v54, v55
v_accvgpr_write_b32 a116, v48
v_accvgpr_write_b32 a117, v49
v_accvgpr_write_b32 a118, v50
v_accvgpr_write_b32 a119, v51
v_pk_mul_f32 v[80:81], v[80:81], v[232:233] op_sel:[0,0] op_sel_hi:[1,0]
v_pk_mul_f32 v[82:83], v[82:83], v[232:233] op_sel:[0,0] op_sel_hi:[1,0]
v_pk_mul_f32 v[84:85], v[84:85], v[232:233] op_sel:[0,0] op_sel_hi:[1,0]
v_pk_mul_f32 v[86:87], v[86:87], v[232:233] op_sel:[0,0] op_sel_hi:[1,0]
v_cvt_pk_bf16_f32 v80, v80, v81
v_cvt_pk_bf16_f32 v81, v82, v83
v_cvt_pk_bf16_f32 v82, v84, v85
v_cvt_pk_bf16_f32 v83, v86, v87
v_accvgpr_write_b32 a120, v80
v_accvgpr_write_b32 a121, v81
v_accvgpr_write_b32 a122, v82
v_accvgpr_write_b32 a123, v83
v_pk_mul_f32 v[112:113], v[112:113], v[232:233] op_sel:[0,1] op_sel_hi:[1,1]
v_pk_mul_f32 v[114:115], v[114:115], v[232:233] op_sel:[0,1] op_sel_hi:[1,1]
v_pk_mul_f32 v[116:117], v[116:117], v[232:233] op_sel:[0,1] op_sel_hi:[1,1]
v_pk_mul_f32 v[118:119], v[118:119], v[232:233] op_sel:[0,1] op_sel_hi:[1,1]
v_cvt_pk_bf16_f32 v112, v112, v113
v_cvt_pk_bf16_f32 v113, v114, v115
v_cvt_pk_bf16_f32 v114, v116, v117
v_cvt_pk_bf16_f32 v115, v118, v119
v_accvgpr_write_b32 a124, v112
v_accvgpr_write_b32 a125, v113
v_accvgpr_write_b32 a126, v114
v_accvgpr_write_b32 a127, v115
v_pk_mul_f32 v[24:25], v[24:25], v[230:231] op_sel:[0,0] op_sel_hi:[1,0]
v_pk_mul_f32 v[26:27], v[26:27], v[230:231] op_sel:[0,0] op_sel_hi:[1,0]
v_pk_mul_f32 v[28:29], v[28:29], v[230:231] op_sel:[0,0] op_sel_hi:[1,0]
v_pk_mul_f32 v[30:31], v[30:31], v[230:231] op_sel:[0,0] op_sel_hi:[1,0]
v_cvt_pk_bf16_f32 v24, v24, v25
v_cvt_pk_bf16_f32 v25, v26, v27
v_cvt_pk_bf16_f32 v26, v28, v29
v_cvt_pk_bf16_f32 v27, v30, v31
v_accvgpr_write_b32 a128, v24
v_accvgpr_write_b32 a129, v25
v_accvgpr_write_b32 a130, v26
v_accvgpr_write_b32 a131, v27
v_pk_mul_f32 v[56:57], v[56:57], v[230:231] op_sel:[0,1] op_sel_hi:[1,1]
v_pk_mul_f32 v[58:59], v[58:59], v[230:231] op_sel:[0,1] op_sel_hi:[1,1]
v_pk_mul_f32 v[60:61], v[60:61], v[230:231] op_sel:[0,1] op_sel_hi:[1,1]
v_pk_mul_f32 v[62:63], v[62:63], v[230:231] op_sel:[0,1] op_sel_hi:[1,1]
v_cvt_pk_bf16_f32 v56, v56, v57
v_cvt_pk_bf16_f32 v57, v58, v59
v_cvt_pk_bf16_f32 v58, v60, v61
v_cvt_pk_bf16_f32 v59, v62, v63
v_accvgpr_write_b32 a132, v56
v_accvgpr_write_b32 a133, v57
v_accvgpr_write_b32 a134, v58
v_accvgpr_write_b32 a135, v59
v_pk_mul_f32 v[88:89], v[88:89], v[232:233] op_sel:[0,0] op_sel_hi:[1,0]
v_pk_mul_f32 v[90:91], v[90:91], v[232:233] op_sel:[0,0] op_sel_hi:[1,0]
v_pk_mul_f32 v[92:93], v[92:93], v[232:233] op_sel:[0,0] op_sel_hi:[1,0]
v_pk_mul_f32 v[94:95], v[94:95], v[232:233] op_sel:[0,0] op_sel_hi:[1,0]
v_cvt_pk_bf16_f32 v88, v88, v89
v_cvt_pk_bf16_f32 v89, v90, v91
v_cvt_pk_bf16_f32 v90, v92, v93
v_cvt_pk_bf16_f32 v91, v94, v95
v_accvgpr_write_b32 a136, v88
v_accvgpr_write_b32 a137, v89
v_accvgpr_write_b32 a138, v90
v_accvgpr_write_b32 a139, v91
v_pk_mul_f32 v[120:121], v[120:121], v[232:233] op_sel:[0,1] op_sel_hi:[1,1]
v_pk_mul_f32 v[122:123], v[122:123], v[232:233] op_sel:[0,1] op_sel_hi:[1,1]
v_pk_mul_f32 v[124:125], v[124:125], v[232:233] op_sel:[0,1] op_sel_hi:[1,1]
v_pk_mul_f32 v[126:127], v[126:127], v[232:233] op_sel:[0,1] op_sel_hi:[1,1]
v_cvt_pk_bf16_f32 v120, v120, v121
v_cvt_pk_bf16_f32 v121, v122, v123
v_cvt_pk_bf16_f32 v122, v124, v125
v_cvt_pk_bf16_f32 v123, v126, v127
v_accvgpr_write_b32 a140, v120
v_accvgpr_write_b32 a141, v121
v_accvgpr_write_b32 a142, v122
v_accvgpr_write_b32 a143, v123
s_waitcnt lgkmcnt(8)
v_pk_add_f32 v[180:181], v[180:181], v[182:183]
s_waitcnt lgkmcnt(7)
v_pk_add_f32 v[184:185], v[184:185], v[186:187]
v_pk_add_f32 v[180:181], v[180:181], v[184:185]
v_add_f32 v180, v180, v181
s_waitcnt lgkmcnt(6)
v_pk_add_f32 v[188:189], v[188:189], v[190:191]
s_waitcnt lgkmcnt(5)
v_pk_add_f32 v[192:193], v[192:193], v[194:195]
v_pk_add_f32 v[188:189], v[188:189], v[192:193]
v_add_f32 v188, v188, v189
s_cmp_lt_u32 s48, 2
s_cselect_b64 vcc, -1, 0
v_cndmask_b32 v200, v188, v180, vcc
v_rcp_f32 v234, v200
s_waitcnt lgkmcnt(4)
v_or3_b32 v196, v196, v197, v198
v_or_b32 v196, v196, v199
v_min_u32 v181, v180, v188
v_max_u32 v182, v180, v188
v_cmp_ne_u32 s[72:73], 0, v196
v_cmp_gt_u32 s[96:97], s74, v181
v_cmp_lt_u32 vcc, s75, v182
s_nop 0
v_accvgpr_read_b32 v200, a160
v_accvgpr_read_b32 v201, a161
v_accvgpr_read_b32 v202, a162
v_accvgpr_read_b32 v203, a163
v_accvgpr_read_b32 v204, a164
v_accvgpr_read_b32 v205, a165
v_accvgpr_read_b32 v206, a166
v_accvgpr_read_b32 v207, a167
s_or_b64 s[72:73], s[72:73], vcc
s_or_b64 s[72:73], s[72:73], s[96:97]
s_waitcnt lgkmcnt(3)
v_pk_add_f32 v[164:165], v[164:165], v[200:201]
v_pk_add_f32 v[166:167], v[166:167], v[202:203]
s_waitcnt lgkmcnt(2)
v_pk_add_f32 v[168:169], v[168:169], v[204:205]
v_pk_add_f32 v[170:171], v[170:171], v[206:207]
v_pk_mul_f32 v[164:165], v[164:165], v[234:235] op_sel:[0,0] op_sel_hi:[1,0]
v_pk_mul_f32 v[166:167], v[166:167], v[234:235] op_sel:[0,0] op_sel_hi:[1,0]
v_pk_mul_f32 v[168:169], v[168:169], v[234:235] op_sel:[0,0] op_sel_hi:[1,0]
v_pk_mul_f32 v[170:171], v[170:171], v[234:235] op_sel:[0,0] op_sel_hi:[1,0]
v_cvt_pk_bf16_f32 v164, v164, v165
v_cvt_pk_bf16_f32 v165, v166, v167
v_cvt_pk_bf16_f32 v166, v168, v169
v_cvt_pk_bf16_f32 v167, v170, v171
v_accvgpr_write_b32 a144, v164
v_accvgpr_write_b32 a145, v165
v_accvgpr_write_b32 a146, v166
v_accvgpr_write_b32 a147, v167
v_accvgpr_read_b32 v200, a176
v_accvgpr_read_b32 v201, a177
v_accvgpr_read_b32 v202, a178
v_accvgpr_read_b32 v203, a179
v_accvgpr_read_b32 v204, a180
v_accvgpr_read_b32 v205, a181
v_accvgpr_read_b32 v206, a182
v_accvgpr_read_b32 v207, a183
s_waitcnt lgkmcnt(1)
v_pk_add_f32 v[172:173], v[172:173], v[200:201]
v_pk_add_f32 v[174:175], v[174:175], v[202:203]
s_waitcnt lgkmcnt(0)
v_pk_add_f32 v[176:177], v[176:177], v[204:205]
v_pk_add_f32 v[178:179], v[178:179], v[206:207]
v_pk_mul_f32 v[172:173], v[172:173], v[234:235] op_sel:[0,0] op_sel_hi:[1,0]
v_pk_mul_f32 v[174:175], v[174:175], v[234:235] op_sel:[0,0] op_sel_hi:[1,0]
v_pk_mul_f32 v[176:177], v[176:177], v[234:235] op_sel:[0,0] op_sel_hi:[1,0]
v_pk_mul_f32 v[178:179], v[178:179], v[234:235] op_sel:[0,0] op_sel_hi:[1,0]
v_cvt_pk_bf16_f32 v172, v172, v173
v_cvt_pk_bf16_f32 v173, v174, v175
v_cvt_pk_bf16_f32 v174, v176, v177
v_cvt_pk_bf16_f32 v175, v178, v179
v_accvgpr_write_b32 a148, v172
v_accvgpr_write_b32 a149, v173
v_accvgpr_write_b32 a150, v174
v_accvgpr_write_b32 a151, v175
s_mov_b32 s8, s80
s_and_b32 s9, s81, 0xffff
s_mov_b32 s10, 64
s_mov_b32 s11, 0x20000
v_mov_b32 v200, 1
s_mov_b64 exec, 1
buffer_atomic_add v200, off, s[8:11], s7 sc1
s_mov_b64 exec, -1
s_mov_b32 s63, 1
s_branch L_s_head
L_s_last:
v_mfma_f32_16x16x32_bf16 v[200:203], a[208:211], a[0:3], 0
v_add_f32 v220, v238, v220
v_exp_f32 v220, v220
v_mfma_f32_16x16x32_bf16 v[200:203], a[212:215], a[4:7], v[200:203]
ds_read_b64_tr_b16 a[248:249], v244 offset:16928
ds_read_b64_tr_b16 a[250:251], v244 offset:21152
v_mfma_f32_16x16x32_bf16 v[200:203], a[216:219], a[8:11], v[200:203]
s_add_u32 m0, s59, 64
v_add_f32 v221, v238, v221
v_exp_f32 v221, v221
v_mfma_f32_16x16x32_bf16 v[200:203], a[220:223], a[12:15], v[200:203]
s_waitcnt lgkmcnt(2)
ds_read_b64_tr_b16 a[252:253], v246 offset:16928
ds_read_b64_tr_b16 a[254:255], v246 offset:21152
buffer_load_dwordx4 v248, s[40:43], s57 offen offset:2048 nt lds
v_mfma_f32_16x16x32_bf16 v[0:3], a[240:243], v[164:167], v[0:3]
v_add_f32 v222, v238, v222
v_exp_f32 v222, v222
v_mfma_f32_16x16x32_bf16 v[0:3], a[244:247], v[168:171], v[0:3]
ds_read_b128 a[224:227], v240 offset:4224
v_cvt_pk_bf16_f32 v194, v220, v221
v_mfma_f32_16x16x32_bf16 v[32:35], a[240:243], v[172:175], v[32:35]
v_add_f32 v223, v238, v223
v_exp_f32 v223, v223
v_mfma_f32_16x16x32_bf16 v[32:35], a[244:247], v[176:179], v[32:35]
ds_read_b128 a[228:231], v241 offset:4224
v_cvt_pk_bf16_f32 v195, v222, v223
v_mfma_f32_16x16x32_bf16 v[204:207], a[208:211], a[16:19], 0
v_add_f32 v200, v235, v200
v_exp_f32 v200, v200
v_mfma_f32_16x16x32_bf16 v[204:207], a[212:215], a[20:23], v[204:207]
ds_read_b128 a[232:235], v240 offset:4736
v_mfma_f32_16x16x32_bf16 v[204:207], a[216:219], a[24:27], v[204:207]
v_add_f32 v201, v235, v201
v_exp_f32 v201, v201
v_mfma_f32_16x16x32_bf16 v[204:207], a[220:223], a[28:31], v[204:207]
ds_read_b128 a[236:239], v241 offset:4736
v_cvt_pk_bf16_f32 v128, v200, v201
v_mfma_f32_16x16x32_bf16 v[64:67], a[240:243], v[180:183], v[64:67]
v_add_f32 v202, v235, v202
v_exp_f32 v202, v202
v_mfma_f32_16x16x32_bf16 v[64:67], a[244:247], v[184:187], v[64:67]
v_mfma_f32_16x16x32_bf16 a[160:163], a[240:243], v[196:199], a[160:163]
v_add_f32 v203, v235, v203
v_exp_f32 v203, v203
v_mfma_f32_16x16x32_bf16 v[96:99], a[240:243], v[188:191], v[96:99]
v_cvt_pk_bf16_f32 v129, v202, v203
v_mfma_f32_16x16x32_bf16 v[96:99], a[244:247], v[192:195], v[96:99]
ds_read_b64_tr_b16 a[240:241], v245 offset:16896
v_mfma_f32_16x16x32_bf16 v[208:211], a[208:211], a[32:35], 0
v_add_f32 v204, v236, v204
v_exp_f32 v204, v204
v_mfma_f32_16x16x32_bf16 v[208:211], a[212:215], a[36:39], v[208:211]
ds_read_b64_tr_b16 a[242:243], v245 offset:21120
ds_read_b64_tr_b16 a[244:245], v247 offset:16896
v_mfma_f32_16x16x32_bf16 v[208:211], a[216:219], a[40:43], v[208:211]
v_add_f32 v205, v236, v205
v_exp_f32 v205, v205
v_mfma_f32_16x16x32_bf16 v[208:211], a[220:223], a[44:47], v[208:211]
s_waitcnt lgkmcnt(7)
ds_read_b64_tr_b16 a[246:247], v247 offset:21120
v_cvt_pk_bf16_f32 v136, v204, v205
v_mfma_f32_16x16x32_bf16 v[4:7], a[248:251], v[164:167], v[4:7]
s_add_u32 m0, s59, 96
v_add_f32 v206, v236, v206
v_exp_f32 v206, v206
v_mfma_f32_16x16x32_bf16 v[4:7], a[252:255], v[168:171], v[4:7]
buffer_load_dwordx4 v248, s[40:43], s57 offen offset:3072 nt lds
v_mfma_f32_16x16x32_bf16 v[36:39], a[248:251], v[172:175], v[36:39]
s_add_u32 s57, s57, 16384
v_add_f32 v207, v236, v207
v_exp_f32 v207, v207
v_mfma_f32_16x16x32_bf16 v[36:39], a[252:255], v[176:179], v[36:39]
s_add_u32 s59, s59, 16896
v_cvt_pk_bf16_f32 v137, v206, v207
v_mfma_f32_16x16x32_bf16 v[212:215], a[208:211], a[48:51], 0
s_cmp_eq_u32 s59, s70
v_add_f32 v208, v237, v208
v_exp_f32 v208, v208
v_mfma_f32_16x16x32_bf16 v[212:215], a[212:215], a[52:55], v[212:215]
s_cselect_b32 s59, s68, s59
v_mfma_f32_16x16x32_bf16 v[212:215], a[216:219], a[56:59], v[212:215]
v_add_f32 v209, v237, v209
v_exp_f32 v209, v209
v_mfma_f32_16x16x32_bf16 v[212:215], a[220:223], a[60:63], v[212:215]
v_cvt_pk_bf16_f32 v144, v208, v209
v_mfma_f32_16x16x32_bf16 v[68:71], a[248:251], v[180:183], v[68:71]
v_add_f32 v210, v237, v210
v_exp_f32 v210, v210
v_mfma_f32_16x16x32_bf16 v[68:71], a[252:255], v[184:187], v[68:71]
v_mfma_f32_16x16x32_bf16 v[100:103], a[248:251], v[188:191], v[100:103]
v_add_f32 v211, v237, v211
v_exp_f32 v211, v211
v_mfma_f32_16x16x32_bf16 v[100:103], a[252:255], v[192:195], v[100:103]
v_cvt_pk_bf16_f32 v145, v210, v211
v_mfma_f32_16x16x32_bf16 v[216:219], a[208:211], a[64:67], 0
v_add_f32 v212, v238, v212
v_exp_f32 v212, v212
v_mfma_f32_16x16x32_bf16 v[216:219], a[212:215], a[68:71], v[216:219]
v_mfma_f32_16x16x32_bf16 v[216:219], a[216:219], a[72:75], v[216:219]
v_add_f32 v213, v238, v213
v_exp_f32 v213, v213
v_mfma_f32_16x16x32_bf16 v[216:219], a[220:223], a[76:79], v[216:219]
ds_read_b128 a[208:211], v242 offset:0
v_cvt_pk_bf16_f32 v152, v212, v213
v_mfma_f32_16x16x32_bf16 a[164:167], a[248:251], v[196:199], a[164:167]
v_add_f32 v214, v238, v214
v_exp_f32 v214, v214
v_smfmac_f32_16x16x64_bf16 a[192:195], v[224:227], v[164:171], v228
s_waitcnt lgkmcnt(1)
ds_read_b64_tr_b16 a[248:249], v245 offset:16928
ds_read_b64_tr_b16 a[250:251], v245 offset:21152
v_mfma_f32_16x16x32_bf16 v[8:11], a[240:243], v[164:167], v[8:11]
s_mov_b32 m0, s58
v_add_f32 v215, v238, v215
v_exp_f32 v215, v215
v_mfma_f32_16x16x32_bf16 v[8:11], a[244:247], v[168:171], v[8:11]
ds_read_b64_tr_b16 a[252:253], v247 offset:16928
ds_read_b64_tr_b16 a[254:255], v247 offset:21152
buffer_load_dwordx4 v248, s[36:39], s56 offen offset:0 nt lds
v_mfma_f32_16x16x32_bf16 v[220:223], a[224:227], a[0:3], 0
v_add_f32 v216, v239, v216
v_exp_f32 v216, v216
v_mfma_f32_16x16x32_bf16 v[220:223], a[228:231], a[4:7], v[220:223]
ds_read_b128 a[212:215], v243 offset:0
v_cvt_pk_bf16_f32 v153, v214, v215
v_mfma_f32_16x16x32_bf16 v[220:223], a[232:235], a[8:11], v[220:223]
v_add_f32 v217, v239, v217
v_exp_f32 v217, v217
v_mfma_f32_16x16x32_bf16 v[220:223], a[236:239], a[12:15], v[220:223]
ds_read_b128 a[216:219], v242 offset:512
v_cvt_pk_bf16_f32 v160, v216, v217
v_mfma_f32_16x16x32_bf16 v[40:43], a[240:243], v[172:175], v[40:43]
v_add_f32 v218, v239, v218
v_exp_f32 v218, v218
v_mfma_f32_16x16x32_bf16 v[40:43], a[244:247], v[176:179], v[40:43]
ds_read_b128 a[220:223], v243 offset:512
v_add_f32 v229, v229, v216
v_mfma_f32_16x16x32_bf16 v[72:75], a[240:243], v[180:183], v[72:75]
v_add_f32 v219, v239, v219
v_exp_f32 v219, v219
v_mfma_f32_16x16x32_bf16 v[72:75], a[244:247], v[184:187], v[72:75]
v_cvt_pk_bf16_f32 v161, v218, v219
v_add_f32 v229, v229, v217
v_mfma_f32_16x16x32_bf16 v[200:203], a[224:227], a[16:19], 0
v_add_f32 v220, v235, v220
v_exp_f32 v220, v220
v_mfma_f32_16x16x32_bf16 v[200:203], a[228:231], a[20:23], v[200:203]
v_add_f32 v229, v229, v218
v_add_f32 v229, v229, v219
v_mfma_f32_16x16x32_bf16 v[200:203], a[232:235], a[24:27], v[200:203]
v_add_f32 v221, v235, v221
v_exp_f32 v221, v221
v_mfma_f32_16x16x32_bf16 v[200:203], a[236:239], a[28:31], v[200:203]
v_cvt_pk_bf16_f32 v130, v220, v221
v_mfma_f32_16x16x32_bf16 v[104:107], a[240:243], v[188:191], v[104:107]
v_add_f32 v222, v235, v222
v_exp_f32 v222, v222
v_mfma_f32_16x16x32_bf16 v[104:107], a[244:247], v[192:195], v[104:107]
v_mfma_f32_16x16x32_bf16 a[168:171], a[240:243], v[196:199], a[168:171]
s_waitcnt lgkmcnt(3)
v_add_f32 v223, v235, v223
v_exp_f32 v223, v223
v_mfma_f32_16x16x32_bf16 v[12:15], a[248:251], v[164:167], v[12:15]
ds_read_b64_tr_b16 a[240:241], v244 offset:17408
ds_read_b64_tr_b16 a[242:243], v244 offset:21632
v_mfma_f32_16x16x32_bf16 v[12:15], a[252:255], v[168:171], v[12:15]
s_add_u32 m0, s58, 32
ds_read_b64_tr_b16 a[244:245], v246 offset:17408
v_cvt_pk_bf16_f32 v131, v222, v223
v_mfma_f32_16x16x32_bf16 v[204:207], a[224:227], a[32:35], 0
v_add_f32 v200, v236, v200
v_exp_f32 v200, v200
v_mfma_f32_16x16x32_bf16 v[204:207], a[228:231], a[36:39], v[204:207]
ds_read_b64_tr_b16 a[246:247], v246 offset:21632
buffer_load_dwordx4 v248, s[36:39], s56 offen offset:1024 nt lds
v_mfma_f32_16x16x32_bf16 v[204:207], a[232:235], a[40:43], v[204:207]
v_add_f32 v201, v236, v201
v_exp_f32 v201, v201
v_mfma_f32_16x16x32_bf16 v[204:207], a[236:239], a[44:47], v[204:207]
v_cvt_pk_bf16_f32 v138, v200, v201
v_mfma_f32_16x16x32_bf16 v[44:47], a[248:251], v[172:175], v[44:47]
v_add_f32 v202, v236, v202
v_exp_f32 v202, v202
v_mfma_f32_16x16x32_bf16 v[44:47], a[252:255], v[176:179], v[44:47]
v_mfma_f32_16x16x32_bf16 v[76:79], a[248:251], v[180:183], v[76:79]
v_add_f32 v203, v236, v203
v_exp_f32 v203, v203
v_mfma_f32_16x16x32_bf16 v[76:79], a[252:255], v[184:187], v[76:79]
v_cvt_pk_bf16_f32 v139, v202, v203
v_mfma_f32_16x16x32_bf16 v[208:211], a[224:227], a[48:51], 0
v_add_f32 v204, v237, v204
v_exp_f32 v204, v204
v_mfma_f32_16x16x32_bf16 v[208:211], a[228:231], a[52:55], v[208:211]
v_mfma_f32_16x16x32_bf16 v[208:211], a[232:235], a[56:59], v[208:211]
v_add_f32 v205, v237, v205
v_exp_f32 v205, v205
v_mfma_f32_16x16x32_bf16 v[208:211], a[236:239], a[60:63], v[208:211]
v_cvt_pk_bf16_f32 v146, v204, v205
v_mfma_f32_16x16x32_bf16 v[108:111], a[248:251], v[188:191], v[108:111]
v_add_f32 v206, v237, v206
v_exp_f32 v206, v206
v_mfma_f32_16x16x32_bf16 v[108:111], a[252:255], v[192:195], v[108:111]
v_mfma_f32_16x16x32_bf16 a[172:175], a[248:251], v[196:199], a[172:175]
v_add_f32 v207, v237, v207
v_exp_f32 v207, v207
v_smfmac_f32_16x16x64_bf16 a[196:199], v[224:227], v[172:179], v228
ds_read_b64_tr_b16 a[248:249], v244 offset:17440
ds_read_b64_tr_b16 a[250:251], v244 offset:21664
v_mfma_f32_16x16x32_bf16 v[212:215], a[224:227], a[64:67], 0
v_add_f32 v208, v238, v208
v_exp_f32 v208, v208
v_mfma_f32_16x16x32_bf16 v[212:215], a[228:231], a[68:71], v[212:215]
ds_read_b64_tr_b16 a[252:253], v246 offset:17440
ds_read_b64_tr_b16 a[254:255], v246 offset:21664
v_mfma_f32_16x16x32_bf16 v[212:215], a[232:235], a[72:75], v[212:215]
s_add_u32 m0, s58, 64
v_add_f32 v209, v238, v209
v_exp_f32 v209, v209
v_mfma_f32_16x16x32_bf16 v[212:215], a[236:239], a[76:79], v[212:215]
s_waitcnt lgkmcnt(4)
ds_read_b128 a[224:227], v242 offset:4224
buffer_load_dwordx4 v248, s[36:39], s56 offen offset:2048 nt lds
v_cvt_pk_bf16_f32 v147, v206, v207
v_mfma_f32_16x16x32_bf16 v[16:19], a[240:243], v[164:167], v[16:19]
v_add_f32 v210, v238, v210
v_exp_f32 v210, v210
v_mfma_f32_16x16x32_bf16 v[16:19], a[244:247], v[168:171], v[16:19]
ds_read_b128 a[228:231], v243 offset:4224
v_cvt_pk_bf16_f32 v154, v208, v209
v_mfma_f32_16x16x32_bf16 v[48:51], a[240:243], v[172:175], v[48:51]
v_add_f32 v211, v238, v211
v_exp_f32 v211, v211
v_mfma_f32_16x16x32_bf16 v[48:51], a[244:247], v[176:179], v[48:51]
ds_read_b128 a[232:235], v242 offset:4736
v_cvt_pk_bf16_f32 v155, v210, v211
v_mfma_f32_16x16x32_bf16 v[216:219], a[208:211], a[0:3], 0
v_add_f32 v212, v239, v212
v_exp_f32 v212, v212
v_mfma_f32_16x16x32_bf16 v[216:219], a[212:215], a[4:7], v[216:219]
ds_read_b128 a[236:239], v243 offset:4736
v_add_f32 v229, v229, v212
v_mfma_f32_16x16x32_bf16 v[216:219], a[216:219], a[8:11], v[216:219]
v_add_f32 v213, v239, v213
v_exp_f32 v213, v213
v_mfma_f32_16x16x32_bf16 v[216:219], a[220:223], a[12:15], v[216:219]
v_cvt_pk_bf16_f32 v162, v212, v213
v_add_f32 v229, v229, v213
v_mfma_f32_16x16x32_bf16 v[80:83], a[240:243], v[180:183], v[80:83]
v_add_f32 v214, v239, v214
v_exp_f32 v214, v214
v_mfma_f32_16x16x32_bf16 v[80:83], a[244:247], v[184:187], v[80:83]
v_add_f32 v229, v229, v214
v_add_u32 v244, s61, v244
v_mfma_f32_16x16x32_bf16 v[112:115], a[240:243], v[188:191], v[112:115]
v_add_f32 v215, v239, v215
v_exp_f32 v215, v215
v_mfma_f32_16x16x32_bf16 v[112:115], a[244:247], v[192:195], v[112:115]
v_cvt_pk_bf16_f32 v163, v214, v215
v_add_f32 v229, v229, v215
v_mfma_f32_16x16x32_bf16 v[220:223], a[208:211], a[16:19], 0
v_add_f32 v216, v235, v216
v_exp_f32 v216, v216
v_mfma_f32_16x16x32_bf16 v[220:223], a[212:215], a[20:23], v[220:223]
v_add_u32 v246, s61, v246
v_mfma_f32_16x16x32_bf16 v[220:223], a[216:219], a[24:27], v[220:223]
v_add_f32 v217, v235, v217
v_exp_f32 v217, v217
v_mfma_f32_16x16x32_bf16 v[220:223], a[220:223], a[28:31], v[220:223]
v_cvt_pk_bf16_f32 v132, v216, v217
v_mfma_f32_16x16x32_bf16 a[176:179], a[240:243], v[196:199], a[176:179]
s_waitcnt lgkmcnt(4)
v_add_f32 v218, v235, v218
v_exp_f32 v218, v218
v_mfma_f32_16x16x32_bf16 v[20:23], a[248:251], v[164:167], v[20:23]
s_add_u32 m0, s58, 96
ds_read_b64_tr_b16 a[240:241], v245 offset:17408
ds_read_b64_tr_b16 a[242:243], v245 offset:21632
v_mfma_f32_16x16x32_bf16 v[20:23], a[252:255], v[168:171], v[20:23]
v_add_f32 v219, v235, v219
v_exp_f32_e64 v219, v219
v_mfma_f32_16x16x32_bf16 v[52:55], a[248:251], v[172:175], v[52:55]
ds_read_b64_tr_b16 a[244:245], v247 offset:17408
ds_read_b64_tr_b16 a[246:247], v247 offset:21632
v_mfma_f32_16x16x32_bf16 v[52:55], a[252:255], v[176:179], v[52:55]
buffer_load_dwordx4 v248, s[36:39], s56 offen offset:3072 nt lds
v_cvt_pk_bf16_f32 v133, v218, v219
v_mfma_f32_16x16x32_bf16 v[200:203], a[208:211], a[32:35], 0
v_add_f32 v220, v236, v220
v_exp_f32 v220, v220
v_mfma_f32_16x16x32_bf16 v[200:203], a[212:215], a[36:39], v[200:203]
v_mfma_f32_16x16x32_bf16 v[200:203], a[216:219], a[40:43], v[200:203]
v_add_f32 v221, v236, v221
v_exp_f32 v221, v221
v_mfma_f32_16x16x32_bf16 v[200:203], a[220:223], a[44:47], v[200:203]
v_cvt_pk_bf16_f32 v140, v220, v221
v_mfma_f32_16x16x32_bf16 v[84:87], a[248:251], v[180:183], v[84:87]
v_add_f32 v222, v236, v222
v_exp_f32 v222, v222
v_mfma_f32_16x16x32_bf16 v[84:87], a[252:255], v[184:187], v[84:87]
v_mfma_f32_16x16x32_bf16 v[116:119], a[248:251], v[188:191], v[116:119]
v_add_f32 v223, v236, v223
v_exp_f32 v223, v223
v_mfma_f32_16x16x32_bf16 v[116:119], a[252:255], v[192:195], v[116:119]
v_cvt_pk_bf16_f32 v141, v222, v223
v_mfma_f32_16x16x32_bf16 v[204:207], a[208:211], a[48:51], 0
v_add_f32 v200, v237, v200
v_exp_f32 v200, v200
v_mfma_f32_16x16x32_bf16 v[204:207], a[212:215], a[52:55], v[204:207]
v_mfma_f32_16x16x32_bf16 v[204:207], a[216:219], a[56:59], v[204:207]
v_add_f32 v201, v237, v201
v_exp_f32 v201, v201
v_mfma_f32_16x16x32_bf16 v[204:207], a[220:223], a[60:63], v[204:207]
v_cvt_pk_bf16_f32 v148, v200, v201
v_mfma_f32_16x16x32_bf16 a[180:183], a[248:251], v[196:199], a[180:183]
v_add_f32 v202, v237, v202
v_exp_f32 v202, v202
v_smfmac_f32_16x16x64_bf16 a[200:203], v[224:227], v[180:187], v228
s_waitcnt lgkmcnt(0)
ds_read_b64_tr_b16 a[248:249], v245 offset:17440
ds_read_b64_tr_b16 a[250:251], v245 offset:21664
v_mfma_f32_16x16x32_bf16 v[24:27], a[240:243], v[164:167], v[24:27]
v_add_f32 v203, v237, v203
v_exp_f32 v203, v203
v_mfma_f32_16x16x32_bf16 v[24:27], a[244:247], v[168:171], v[24:27]
ds_read_b64_tr_b16 a[252:253], v247 offset:17440
ds_read_b64_tr_b16 a[254:255], v247 offset:21664
v_mfma_f32_16x16x32_bf16 v[208:211], a[224:227], a[0:3], 0
v_add_f32 v204, v238, v204
v_exp_f32 v204, v204
v_mfma_f32_16x16x32_bf16 v[208:211], a[228:231], a[4:7], v[208:211]
v_cvt_pk_bf16_f32 v149, v202, v203
v_add_u32 v245, s61, v245
v_mfma_f32_16x16x32_bf16 v[208:211], a[232:235], a[8:11], v[208:211]
v_add_f32 v205, v238, v205
v_exp_f32 v205, v205
v_mfma_f32_16x16x32_bf16 v[208:211], a[236:239], a[12:15], v[208:211]
s_waitcnt vmcnt(12)
s_barrier
v_mfma_f32_16x16x32_bf16 v[56:59], a[240:243], v[172:175], v[56:59]
s_mov_b32 m0, s59
v_add_f32 v206, v238, v206
v_exp_f32 v206, v206
v_mfma_f32_16x16x32_bf16 v[56:59], a[244:247], v[176:179], v[56:59]
ds_read_b128 a[208:211], v240 offset:16896
buffer_load_dwordx4 v248, s[40:43], s57 offen offset:0 nt lds
v_cvt_pk_bf16_f32 v156, v204, v205
v_mfma_f32_16x16x32_bf16 v[88:91], a[240:243], v[180:183], v[88:91]
v_add_f32 v207, v238, v207
v_exp_f32 v207, v207
v_mfma_f32_16x16x32_bf16 v[88:91], a[244:247], v[184:187], v[88:91]
ds_read_b128 a[212:215], v241 offset:16896
v_cvt_pk_bf16_f32 v157, v206, v207
v_mfma_f32_16x16x32_bf16 v[212:215], a[224:227], a[16:19], 0
v_add_f32 v208, v235, v208
v_exp_f32 v208, v208
v_mfma_f32_16x16x32_bf16 v[212:215], a[228:231], a[20:23], v[212:215]
ds_read_b128 a[216:219], v240 offset:17408
v_add_u32 v247, s61, v247
v_mfma_f32_16x16x32_bf16 v[212:215], a[232:235], a[24:27], v[212:215]
s_mul_i32 s61, s61, -1
v_add_f32 v209, v235, v209
v_exp_f32 v209, v209
v_mfma_f32_16x16x32_bf16 v[212:215], a[236:239], a[28:31], v[212:215]
ds_read_b128 a[220:223], v241 offset:17408
v_cvt_pk_bf16_f32 v134, v208, v209
v_mfma_f32_16x16x32_bf16 v[120:123], a[240:243], v[188:191], v[120:123]
v_add_f32 v210, v235, v210
v_exp_f32 v210, v210
v_mfma_f32_16x16x32_bf16 v[120:123], a[244:247], v[192:195], v[120:123]
v_mfma_f32_16x16x32_bf16 a[184:187], a[240:243], v[196:199], a[184:187]
v_add_f32 v211, v235, v211
v_exp_f32 v211, v211
v_smfmac_f32_16x16x64_bf16 a[204:207], v[224:227], v[188:195], v228
ds_read_b64_tr_b16 a[240:241], v244 offset:0
ds_read_b64_tr_b16 a[242:243], v244 offset:4224
v_mfma_f32_16x16x32_bf16 v[216:219], a[224:227], a[32:35], 0
v_add_f32 v212, v236, v212
v_exp_f32 v212, v212
v_mfma_f32_16x16x32_bf16 v[216:219], a[228:231], a[36:39], v[216:219]
ds_read_b64_tr_b16 a[244:245], v246 offset:0
ds_read_b64_tr_b16 a[246:247], v246 offset:4224
v_mfma_f32_16x16x32_bf16 v[216:219], a[232:235], a[40:43], v[216:219]
v_add_f32 v213, v236, v213
v_exp_f32 v213, v213
v_mfma_f32_16x16x32_bf16 v[216:219], a[236:239], a[44:47], v[216:219]
s_waitcnt lgkmcnt(8)
v_cvt_pk_bf16_f32 v135, v210, v211
v_cvt_pk_bf16_f32 v142, v212, v213
v_mfma_f32_16x16x32_bf16 v[28:31], a[248:251], v[164:167], v[28:31]
v_add_f32 v214, v236, v214
v_exp_f32 v214, v214
v_mfma_f32_16x16x32_bf16 v[28:31], a[252:255], v[168:171], v[28:31]
v_mfma_f32_16x16x32_bf16 v[60:63], a[248:251], v[172:175], v[60:63]
s_add_u32 m0, s59, 32
v_add_f32 v215, v236, v215
v_exp_f32 v215, v215
v_mfma_f32_16x16x32_bf16 v[60:63], a[252:255], v[176:179], v[60:63]
buffer_load_dwordx4 v248, s[40:43], s57 offen offset:1024 nt lds
v_cvt_pk_bf16_f32 v143, v214, v215
v_mfma_f32_16x16x32_bf16 v[220:223], a[224:227], a[48:51], 0
v_add_f32 v216, v237, v216
v_exp_f32 v216, v216
v_mfma_f32_16x16x32_bf16 v[220:223], a[228:231], a[52:55], v[220:223]
v_mfma_f32_16x16x32_bf16 v[220:223], a[232:235], a[56:59], v[220:223]
v_add_f32 v217, v237, v217
v_exp_f32 v217, v217
v_mfma_f32_16x16x32_bf16 v[220:223], a[236:239], a[60:63], v[220:223]
v_cvt_pk_bf16_f32 v150, v216, v217
v_mfma_f32_16x16x32_bf16 v[92:95], a[248:251], v[180:183], v[92:95]
v_add_f32 v218, v237, v218
v_exp_f32 v218, v218
v_mfma_f32_16x16x32_bf16 v[92:95], a[252:255], v[184:187], v[92:95]
v_mfma_f32_16x16x32_bf16 v[124:127], a[248:251], v[188:191], v[124:127]
v_add_f32 v219, v237, v219
v_exp_f32 v219, v219
v_mfma_f32_16x16x32_bf16 v[124:127], a[252:255], v[192:195], v[124:127]
s_waitcnt lgkmcnt(4)
v_cvt_pk_bf16_f32 v151, v218, v219
v_mfma_f32_16x16x32_bf16 a[188:191], a[248:251], v[196:199], a[188:191]
v_mfma_f32_16x16x32_bf16 v[200:203], a[208:211], a[0:3], 0
v_add_f32 v220, v238, v220
v_exp_f32 v220, v220
v_mfma_f32_16x16x32_bf16 v[200:203], a[212:215], a[4:7], v[200:203]
ds_read_b64_tr_b16 a[248:249], v244 offset:32
ds_read_b64_tr_b16 a[250:251], v244 offset:4256
v_mfma_f32_16x16x32_bf16 v[200:203], a[216:219], a[8:11], v[200:203]
s_add_u32 m0, s59, 64
v_add_f32 v221, v238, v221
v_exp_f32 v221, v221
v_mfma_f32_16x16x32_bf16 v[200:203], a[220:223], a[12:15], v[200:203]
s_waitcnt lgkmcnt(2)
ds_read_b64_tr_b16 a[252:253], v246 offset:32
ds_read_b64_tr_b16 a[254:255], v246 offset:4256
buffer_load_dwordx4 v248, s[40:43], s57 offen offset:2048 nt lds
v_mfma_f32_16x16x32_bf16 v[0:3], a[240:243], v[128:131], v[0:3]
v_add_f32 v222, v238, v222
v_exp_f32 v222, v222
v_mfma_f32_16x16x32_bf16 v[0:3], a[244:247], v[132:135], v[0:3]
ds_read_b128 a[224:227], v240 offset:21120
v_cvt_pk_bf16_f32 v158, v220, v221
v_mfma_f32_16x16x32_bf16 v[32:35], a[240:243], v[136:139], v[32:35]
s_add_u32 m0, s59, 96
v_add_f32 v223, v238, v223
v_exp_f32 v223, v223
v_mfma_f32_16x16x32_bf16 v[32:35], a[244:247], v[140:143], v[32:35]
ds_read_b128 a[228:231], v241 offset:21120
v_cvt_pk_bf16_f32 v159, v222, v223
v_mfma_f32_16x16x32_bf16 v[204:207], a[208:211], a[16:19], 0
v_add_f32 v200, v235, v200
v_exp_f32 v200, v200
v_mfma_f32_16x16x32_bf16 v[204:207], a[212:215], a[20:23], v[204:207]
ds_read_b128 a[232:235], v240 offset:21632
buffer_load_dwordx4 v248, s[40:43], s57 offen offset:3072 nt lds
v_mfma_f32_16x16x32_bf16 v[204:207], a[216:219], a[24:27], v[204:207]
s_add_u32 s57, s57, 16384
v_add_f32 v201, v235, v201
v_exp_f32 v201, v201
v_mfma_f32_16x16x32_bf16 v[204:207], a[220:223], a[28:31], v[204:207]
s_add_u32 s59, s59, 16896
ds_read_b128 a[236:239], v241 offset:21632
v_cvt_pk_bf16_f32 v164, v200, v201
v_mfma_f32_16x16x32_bf16 v[64:67], a[240:243], v[144:147], v[64:67]
s_cmp_eq_u32 s59, s70
v_add_f32 v202, v235, v202
v_exp_f32 v202, v202
v_mfma_f32_16x16x32_bf16 v[64:67], a[244:247], v[148:151], v[64:67]
s_cselect_b32 s59, s68, s59
v_add_u32 v240, s60, v240
v_add_u32 v241, s60, v241
v_mfma_f32_16x16x32_bf16 a[160:163], a[240:243], v[160:163], a[160:163]
v_add_f32 v203, v235, v203
v_exp_f32 v203, v203
v_mfma_f32_16x16x32_bf16 v[96:99], a[240:243], v[152:155], v[96:99]
s_add_u32 s50, s65, 4096
v_cvt_pk_bf16_f32 v165, v202, v203
v_mfma_f32_16x16x32_bf16 v[96:99], a[244:247], v[156:159], v[96:99]
ds_read_b64_tr_b16 a[240:241], v245 offset:0
buffer_store_dwordx4 a[104:107], v249, s[44:47], s50 offen offset:0 sc1
v_mfma_f32_16x16x32_bf16 v[208:211], a[208:211], a[32:35], 0
v_add_f32 v204, v236, v204
v_exp_f32 v204, v204
v_mfma_f32_16x16x32_bf16 v[208:211], a[212:215], a[36:39], v[208:211]
ds_read_b64_tr_b16 a[242:243], v245 offset:4224
ds_read_b64_tr_b16 a[244:245], v247 offset:0
v_mfma_f32_16x16x32_bf16 v[208:211], a[216:219], a[40:43], v[208:211]
v_add_f32 v205, v236, v205
v_exp_f32 v205, v205
v_mfma_f32_16x16x32_bf16 v[208:211], a[220:223], a[44:47], v[208:211]
s_waitcnt lgkmcnt(7)
ds_read_b64_tr_b16 a[246:247], v247 offset:4224
v_cvt_pk_bf16_f32 v172, v204, v205
v_mfma_f32_16x16x32_bf16 v[4:7], a[248:251], v[128:131], v[4:7]
v_add_f32 v206, v236, v206
v_exp_f32 v206, v206
v_mfma_f32_16x16x32_bf16 v[4:7], a[252:255], v[132:135], v[4:7]
v_mfma_f32_16x16x32_bf16 v[36:39], a[248:251], v[136:139], v[36:39]
v_add_f32 v207, v236, v207
v_exp_f32 v207, v207
v_mfma_f32_16x16x32_bf16 v[36:39], a[252:255], v[140:143], v[36:39]
v_cvt_pk_bf16_f32 v173, v206, v207
v_mfma_f32_16x16x32_bf16 v[212:215], a[208:211], a[48:51], 0
v_add_f32 v208, v237, v208
v_exp_f32 v208, v208
v_mfma_f32_16x16x32_bf16 v[212:215], a[212:215], a[52:55], v[212:215]
v_mfma_f32_16x16x32_bf16 v[212:215], a[216:219], a[56:59], v[212:215]
v_add_f32 v209, v237, v209
v_exp_f32 v209, v209
v_mfma_f32_16x16x32_bf16 v[212:215], a[220:223], a[60:63], v[212:215]
v_cvt_pk_bf16_f32 v180, v208, v209
v_mfma_f32_16x16x32_bf16 v[68:71], a[248:251], v[144:147], v[68:71]
v_add_f32 v210, v237, v210
v_exp_f32 v210, v210
v_mfma_f32_16x16x32_bf16 v[68:71], a[252:255], v[148:151], v[68:71]
v_mfma_f32_16x16x32_bf16 v[100:103], a[248:251], v[152:155], v[100:103]
v_add_f32 v211, v237, v211
v_exp_f32 v211, v211
v_mfma_f32_16x16x32_bf16 v[100:103], a[252:255], v[156:159], v[100:103]
v_cvt_pk_bf16_f32 v181, v210, v211
v_mfma_f32_16x16x32_bf16 v[216:219], a[208:211], a[64:67], 0
v_add_f32 v212, v238, v212
v_exp_f32 v212, v212
v_mfma_f32_16x16x32_bf16 v[216:219], a[212:215], a[68:71], v[216:219]
v_mfma_f32_16x16x32_bf16 v[216:219], a[216:219], a[72:75], v[216:219]
v_add_f32 v213, v238, v213
v_exp_f32 v213, v213
v_mfma_f32_16x16x32_bf16 v[216:219], a[220:223], a[76:79], v[216:219]
s_add_u32 s50, s65, 6144
ds_read_b128 a[208:211], v242 offset:16896
v_cvt_pk_bf16_f32 v188, v212, v213
v_mfma_f32_16x16x32_bf16 a[164:167], a[248:251], v[160:163], a[164:167]
v_add_f32 v214, v238, v214
v_exp_f32 v214, v214
v_smfmac_f32_16x16x64_bf16 a[192:195], v[224:227], v[128:135], v228
s_waitcnt lgkmcnt(1)
ds_read_b64_tr_b16 a[248:249], v245 offset:32
ds_read_b64_tr_b16 a[250:251], v245 offset:4256
v_mfma_f32_16x16x32_bf16 v[8:11], a[240:243], v[128:131], v[8:11]
v_add_f32 v215, v238, v215
v_exp_f32 v215, v215
v_mfma_f32_16x16x32_bf16 v[8:11], a[244:247], v[132:135], v[8:11]
ds_read_b64_tr_b16 a[252:253], v247 offset:32
ds_read_b64_tr_b16 a[254:255], v247 offset:4256
v_mfma_f32_16x16x32_bf16 v[220:223], a[224:227], a[0:3], 0
v_add_f32 v216, v239, v216
v_exp_f32 v216, v216
v_mfma_f32_16x16x32_bf16 v[220:223], a[228:231], a[4:7], v[220:223]
ds_read_b128 a[212:215], v243 offset:16896
v_cvt_pk_bf16_f32 v189, v214, v215
v_mfma_f32_16x16x32_bf16 v[220:223], a[232:235], a[8:11], v[220:223]
v_add_f32 v217, v239, v217
v_exp_f32 v217, v217
v_mfma_f32_16x16x32_bf16 v[220:223], a[236:239], a[12:15], v[220:223]
ds_read_b128 a[216:219], v242 offset:17408
v_cvt_pk_bf16_f32 v196, v216, v217
v_mfma_f32_16x16x32_bf16 v[40:43], a[240:243], v[136:139], v[40:43]
v_add_f32 v218, v239, v218
v_exp_f32 v218, v218
v_mfma_f32_16x16x32_bf16 v[40:43], a[244:247], v[140:143], v[40:43]
ds_read_b128 a[220:223], v243 offset:17408
v_add_f32 v229, v229, v216
v_mfma_f32_16x16x32_bf16 v[72:75], a[240:243], v[144:147], v[72:75]
v_add_f32 v219, v239, v219
v_exp_f32 v219, v219
v_mfma_f32_16x16x32_bf16 v[72:75], a[244:247], v[148:151], v[72:75]
v_cvt_pk_bf16_f32 v197, v218, v219
v_add_f32 v229, v229, v217
v_mfma_f32_16x16x32_bf16 v[200:203], a[224:227], a[16:19], 0
v_add_f32 v220, v235, v220
v_exp_f32 v220, v220
v_mfma_f32_16x16x32_bf16 v[200:203], a[228:231], a[20:23], v[200:203]
v_add_f32 v229, v229, v218
v_add_f32 v229, v229, v219
v_mfma_f32_16x16x32_bf16 v[200:203], a[232:235], a[24:27], v[200:203]
v_add_f32 v221, v235, v221
v_exp_f32 v221, v221
v_mfma_f32_16x16x32_bf16 v[200:203], a[236:239], a[28:31], v[200:203]
buffer_store_dwordx4 a[108:111], v249, s[44:47], s50 offen offset:0 sc1
v_cvt_pk_bf16_f32 v166, v220, v221
v_mfma_f32_16x16x32_bf16 v[104:107], a[240:243], v[152:155], v[104:107]
v_add_f32 v222, v235, v222
v_exp_f32 v222, v222
v_mfma_f32_16x16x32_bf16 v[104:107], a[244:247], v[156:159], v[104:107]
v_mfma_f32_16x16x32_bf16 a[168:171], a[240:243], v[160:163], a[168:171]
s_waitcnt lgkmcnt(3)
v_add_f32 v223, v235, v223
v_exp_f32_e64 v223, v223
v_mfma_f32_16x16x32_bf16 v[12:15], a[248:251], v[128:131], v[12:15]
s_add_u32 s50, s64, 294912
ds_read_b64_tr_b16 a[240:241], v244 offset:512
ds_read_b64_tr_b16 a[242:243], v244 offset:4736
v_mfma_f32_16x16x32_bf16 v[12:15], a[252:255], v[132:135], v[12:15]
ds_read_b64_tr_b16 a[244:245], v246 offset:512
v_cvt_pk_bf16_f32 v167, v222, v223
v_mfma_f32_16x16x32_bf16 v[204:207], a[224:227], a[32:35], 0
v_add_f32 v200, v236, v200
v_exp_f32 v200, v200
v_mfma_f32_16x16x32_bf16 v[204:207], a[228:231], a[36:39], v[204:207]
ds_read_b64_tr_b16 a[246:247], v246 offset:4736
buffer_store_dwordx4 a[112:115], v249, s[44:47], s50 offen offset:0 sc1
v_mfma_f32_16x16x32_bf16 v[204:207], a[232:235], a[40:43], v[204:207]
v_add_f32 v201, v236, v201
v_exp_f32 v201, v201
v_mfma_f32_16x16x32_bf16 v[204:207], a[236:239], a[44:47], v[204:207]
v_cvt_pk_bf16_f32 v174, v200, v201
v_mfma_f32_16x16x32_bf16 v[44:47], a[248:251], v[136:139], v[44:47]
v_add_f32 v202, v236, v202
v_exp_f32 v202, v202
v_mfma_f32_16x16x32_bf16 v[44:47], a[252:255], v[140:143], v[44:47]
v_mfma_f32_16x16x32_bf16 v[76:79], a[248:251], v[144:147], v[76:79]
v_add_f32 v203, v236, v203
v_exp_f32 v203, v203
v_mfma_f32_16x16x32_bf16 v[76:79], a[252:255], v[148:151], v[76:79]
v_cvt_pk_bf16_f32 v175, v202, v203
v_mfma_f32_16x16x32_bf16 v[208:211], a[224:227], a[48:51], 0
v_add_f32 v204, v237, v204
v_exp_f32 v204, v204
v_mfma_f32_16x16x32_bf16 v[208:211], a[228:231], a[52:55], v[208:211]
v_mfma_f32_16x16x32_bf16 v[208:211], a[232:235], a[56:59], v[208:211]
v_add_f32 v205, v237, v205
v_exp_f32 v205, v205
v_mfma_f32_16x16x32_bf16 v[208:211], a[236:239], a[60:63], v[208:211]
v_cvt_pk_bf16_f32 v182, v204, v205
v_mfma_f32_16x16x32_bf16 v[108:111], a[248:251], v[152:155], v[108:111]
v_add_f32 v206, v237, v206
v_exp_f32 v206, v206
v_mfma_f32_16x16x32_bf16 v[108:111], a[252:255], v[156:159], v[108:111]
v_mfma_f32_16x16x32_bf16 a[172:175], a[248:251], v[160:163], a[172:175]
v_add_f32 v207, v237, v207
v_exp_f32 v207, v207
v_smfmac_f32_16x16x64_bf16 a[196:199], v[224:227], v[136:143], v228
ds_read_b64_tr_b16 a[248:249], v244 offset:544
ds_read_b64_tr_b16 a[250:251], v244 offset:4768
v_mfma_f32_16x16x32_bf16 v[212:215], a[224:227], a[64:67], 0
v_add_f32 v208, v238, v208
v_exp_f32 v208, v208
v_mfma_f32_16x16x32_bf16 v[212:215], a[228:231], a[68:71], v[212:215]
ds_read_b64_tr_b16 a[252:253], v246 offset:544
ds_read_b64_tr_b16 a[254:255], v246 offset:4768
v_mfma_f32_16x16x32_bf16 v[212:215], a[232:235], a[72:75], v[212:215]
v_add_f32 v209, v238, v209
v_exp_f32 v209, v209
v_mfma_f32_16x16x32_bf16 v[212:215], a[236:239], a[76:79], v[212:215]
s_waitcnt lgkmcnt(4)
ds_read_b128 a[224:227], v242 offset:21120
v_cvt_pk_bf16_f32 v183, v206, v207
v_mfma_f32_16x16x32_bf16 v[16:19], a[240:243], v[128:131], v[16:19]
v_add_f32 v210, v238, v210
v_exp_f32 v210, v210
v_mfma_f32_16x16x32_bf16 v[16:19], a[244:247], v[132:135], v[16:19]
s_add_u32 s50, s64, 296960
ds_read_b128 a[228:231], v243 offset:21120
v_cvt_pk_bf16_f32 v190, v208, v209
v_mfma_f32_16x16x32_bf16 v[48:51], a[240:243], v[136:139], v[48:51]
v_add_f32 v211, v238, v211
v_exp_f32 v211, v211
v_mfma_f32_16x16x32_bf16 v[48:51], a[244:247], v[140:143], v[48:51]
ds_read_b128 a[232:235], v242 offset:21632
v_cvt_pk_bf16_f32 v191, v210, v211
v_mfma_f32_16x16x32_bf16 v[216:219], a[208:211], a[0:3], 0
v_add_f32 v212, v239, v212
v_exp_f32 v212, v212
v_mfma_f32_16x16x32_bf16 v[216:219], a[212:215], a[4:7], v[216:219]
ds_read_b128 a[236:239], v243 offset:21632
v_add_f32 v229, v229, v212
v_mfma_f32_16x16x32_bf16 v[216:219], a[216:219], a[8:11], v[216:219]
v_add_f32 v213, v239, v213
v_exp_f32 v213, v213
v_mfma_f32_16x16x32_bf16 v[216:219], a[220:223], a[12:15], v[216:219]
v_cvt_pk_bf16_f32 v198, v212, v213
v_add_f32 v229, v229, v213
v_mfma_f32_16x16x32_bf16 v[80:83], a[240:243], v[144:147], v[80:83]
v_add_f32 v214, v239, v214
v_exp_f32 v214, v214
v_mfma_f32_16x16x32_bf16 v[80:83], a[244:247], v[148:151], v[80:83]
v_add_f32 v229, v229, v214
v_add_u32 v242, s60, v242
v_mfma_f32_16x16x32_bf16 v[112:115], a[240:243], v[152:155], v[112:115]
v_add_f32 v215, v239, v215
v_exp_f32 v215, v215
v_mfma_f32_16x16x32_bf16 v[112:115], a[244:247], v[156:159], v[112:115]
v_cvt_pk_bf16_f32 v199, v214, v215
v_add_f32 v229, v229, v215
v_mfma_f32_16x16x32_bf16 v[220:223], a[208:211], a[16:19], 0
v_add_f32 v216, v235, v216
v_exp_f32 v216, v216
v_mfma_f32_16x16x32_bf16 v[220:223], a[212:215], a[20:23], v[220:223]
buffer_store_dwordx4 a[116:119], v249, s[44:47], s50 offen offset:0 sc1
v_add_u32 v243, s60, v243
v_mfma_f32_16x16x32_bf16 v[220:223], a[216:219], a[24:27], v[220:223]
s_mul_i32 s60, s60, -1
v_add_f32 v217, v235, v217
v_exp_f32 v217, v217
v_mfma_f32_16x16x32_bf16 v[220:223], a[220:223], a[28:31], v[220:223]
v_cvt_pk_bf16_f32 v168, v216, v217
v_mfma_f32_16x16x32_bf16 a[176:179], a[240:243], v[160:163], a[176:179]
s_waitcnt lgkmcnt(4)
v_add_f32 v218, v235, v218
v_exp_f32 v218, v218
v_mfma_f32_16x16x32_bf16 v[20:23], a[248:251], v[128:131], v[20:23]
ds_read_b64_tr_b16 a[240:241], v245 offset:512
ds_read_b64_tr_b16 a[242:243], v245 offset:4736
v_mfma_f32_16x16x32_bf16 v[20:23], a[252:255], v[132:135], v[20:23]
v_add_f32 v219, v235, v219
v_exp_f32_e64 v219, v219
v_mfma_f32_16x16x32_bf16 v[52:55], a[248:251], v[136:139], v[52:55]
ds_read_b64_tr_b16 a[244:245], v247 offset:512
ds_read_b64_tr_b16 a[246:247], v247 offset:4736
v_mfma_f32_16x16x32_bf16 v[52:55], a[252:255], v[140:143], v[52:55]
s_add_u32 s50, s64, 299008
v_cvt_pk_bf16_f32 v169, v218, v219
v_mfma_f32_16x16x32_bf16 v[200:203], a[208:211], a[32:35], 0
v_add_f32 v220, v236, v220
v_exp_f32 v220, v220
v_mfma_f32_16x16x32_bf16 v[200:203], a[212:215], a[36:39], v[200:203]
buffer_store_dwordx4 a[120:123], v249, s[44:47], s50 offen offset:0 sc1
v_mfma_f32_16x16x32_bf16 v[200:203], a[216:219], a[40:43], v[200:203]
v_add_f32 v221, v236, v221
v_exp_f32 v221, v221
v_mfma_f32_16x16x32_bf16 v[200:203], a[220:223], a[44:47], v[200:203]
v_cvt_pk_bf16_f32 v176, v220, v221
v_mfma_f32_16x16x32_bf16 v[84:87], a[248:251], v[144:147], v[84:87]
v_add_f32 v222, v236, v222
v_exp_f32 v222, v222
v_mfma_f32_16x16x32_bf16 v[84:87], a[252:255], v[148:151], v[84:87]
v_mfma_f32_16x16x32_bf16 v[116:119], a[248:251], v[152:155], v[116:119]
v_add_f32 v223, v236, v223
v_exp_f32 v223, v223
v_mfma_f32_16x16x32_bf16 v[116:119], a[252:255], v[156:159], v[116:119]
v_cvt_pk_bf16_f32 v177, v222, v223
v_mfma_f32_16x16x32_bf16 v[204:207], a[208:211], a[48:51], 0
v_add_f32 v200, v237, v200
v_exp_f32 v200, v200
v_mfma_f32_16x16x32_bf16 v[204:207], a[212:215], a[52:55], v[204:207]
v_mfma_f32_16x16x32_bf16 v[204:207], a[216:219], a[56:59], v[204:207]
v_add_f32 v201, v237, v201
v_exp_f32 v201, v201
v_mfma_f32_16x16x32_bf16 v[204:207], a[220:223], a[60:63], v[204:207]
v_cvt_pk_bf16_f32 v184, v200, v201
v_mfma_f32_16x16x32_bf16 a[180:183], a[248:251], v[160:163], a[180:183]
v_add_f32 v202, v237, v202
v_exp_f32 v202, v202
v_smfmac_f32_16x16x64_bf16 a[200:203], v[224:227], v[144:151], v228
s_waitcnt lgkmcnt(0)
ds_read_b64_tr_b16 a[248:249], v245 offset:544
ds_read_b64_tr_b16 a[250:251], v245 offset:4768
v_mfma_f32_16x16x32_bf16 v[24:27], a[240:243], v[128:131], v[24:27]
v_add_f32 v203, v237, v203
v_exp_f32 v203, v203
v_mfma_f32_16x16x32_bf16 v[24:27], a[244:247], v[132:135], v[24:27]
ds_read_b64_tr_b16 a[252:253], v247 offset:544
ds_read_b64_tr_b16 a[254:255], v247 offset:4768
v_mfma_f32_16x16x32_bf16 v[208:211], a[224:227], a[0:3], 0
v_add_f32 v204, v238, v204
v_exp_f32 v204, v204
v_mfma_f32_16x16x32_bf16 v[208:211], a[228:231], a[4:7], v[208:211]
v_cvt_pk_bf16_f32 v185, v202, v203
v_mfma_f32_16x16x32_bf16 v[208:211], a[232:235], a[8:11], v[208:211]
v_add_f32 v205, v238, v205
v_exp_f32 v205, v205
v_mfma_f32_16x16x32_bf16 v[208:211], a[236:239], a[12:15], v[208:211]
s_waitcnt vmcnt(13)
s_barrier
v_mfma_f32_16x16x32_bf16 v[56:59], a[240:243], v[136:139], v[56:59]
s_mov_b32 m0, s59
v_add_f32 v206, v238, v206
v_exp_f32 v206, v206
v_mfma_f32_16x16x32_bf16 v[56:59], a[244:247], v[140:143], v[56:59]
ds_read_b128 a[208:211], v240 offset:0
buffer_load_dwordx4 v248, s[40:43], s57 offen offset:0 nt lds
v_cvt_pk_bf16_f32 v192, v204, v205
v_mfma_f32_16x16x32_bf16 v[88:91], a[240:243], v[144:147], v[88:91]
v_add_f32 v207, v238, v207
v_exp_f32 v207, v207
v_mfma_f32_16x16x32_bf16 v[88:91], a[244:247], v[148:151], v[88:91]
s_add_u32 s50, s64, 301056
ds_read_b128 a[212:215], v241 offset:0
v_cvt_pk_bf16_f32 v193, v206, v207
v_mfma_f32_16x16x32_bf16 v[212:215], a[224:227], a[16:19], 0
v_add_f32 v208, v235, v208
v_exp_f32 v208, v208
v_mfma_f32_16x16x32_bf16 v[212:215], a[228:231], a[20:23], v[212:215]
ds_read_b128 a[216:219], v240 offset:512
buffer_store_dwordx4 a[124:127], v249, s[44:47], s50 offen offset:0 sc1
v_mfma_f32_16x16x32_bf16 v[212:215], a[232:235], a[24:27], v[212:215]
v_add_f32 v209, v235, v209
v_exp_f32 v209, v209
v_mfma_f32_16x16x32_bf16 v[212:215], a[236:239], a[28:31], v[212:215]
ds_read_b128 a[220:223], v241 offset:512
v_cvt_pk_bf16_f32 v170, v208, v209
v_mfma_f32_16x16x32_bf16 v[120:123], a[240:243], v[152:155], v[120:123]
v_add_f32 v210, v235, v210
v_exp_f32 v210, v210
v_mfma_f32_16x16x32_bf16 v[120:123], a[244:247], v[156:159], v[120:123]
v_mfma_f32_16x16x32_bf16 a[184:187], a[240:243], v[160:163], a[184:187]
v_add_f32 v211, v235, v211
v_exp_f32 v211, v211
v_smfmac_f32_16x16x64_bf16 a[204:207], v[224:227], v[152:159], v228
ds_read_b64_tr_b16 a[240:241], v244 offset:16896
ds_read_b64_tr_b16 a[242:243], v244 offset:21120
v_mfma_f32_16x16x32_bf16 v[216:219], a[224:227], a[32:35], 0
v_add_f32 v212, v236, v212
v_exp_f32 v212, v212
v_mfma_f32_16x16x32_bf16 v[216:219], a[228:231], a[36:39], v[216:219]
ds_read_b64_tr_b16 a[244:245], v246 offset:16896
ds_read_b64_tr_b16 a[246:247], v246 offset:21120
v_mfma_f32_16x16x32_bf16 v[216:219], a[232:235], a[40:43], v[216:219]
v_add_f32 v213, v236, v213
v_exp_f32 v213, v213
v_mfma_f32_16x16x32_bf16 v[216:219], a[236:239], a[44:47], v[216:219]
s_waitcnt lgkmcnt(8)
v_cvt_pk_bf16_f32 v171, v210, v211
v_cvt_pk_bf16_f32 v178, v212, v213
v_mfma_f32_16x16x32_bf16 v[28:31], a[248:251], v[128:131], v[28:31]
v_add_f32 v214, v236, v214
v_exp_f32 v214, v214
v_mfma_f32_16x16x32_bf16 v[28:31], a[252:255], v[132:135], v[28:31]
v_mfma_f32_16x16x32_bf16 v[60:63], a[248:251], v[136:139], v[60:63]
s_add_u32 m0, s59, 32
v_add_f32 v215, v236, v215
v_exp_f32 v215, v215
v_mfma_f32_16x16x32_bf16 v[60:63], a[252:255], v[140:143], v[60:63]
buffer_load_dwordx4 v248, s[40:43], s57 offen offset:1024 nt lds
v_cvt_pk_bf16_f32 v179, v214, v215
v_mfma_f32_16x16x32_bf16 v[220:223], a[224:227], a[48:51], 0
v_add_f32 v216, v237, v216
v_exp_f32 v216, v216
v_mfma_f32_16x16x32_bf16 v[220:223], a[228:231], a[52:55], v[220:223]
v_mfma_f32_16x16x32_bf16 v[220:223], a[232:235], a[56:59], v[220:223]
v_add_f32 v217, v237, v217
v_exp_f32 v217, v217
v_mfma_f32_16x16x32_bf16 v[220:223], a[236:239], a[60:63], v[220:223]
v_cvt_pk_bf16_f32 v186, v216, v217
v_mfma_f32_16x16x32_bf16 v[92:95], a[248:251], v[144:147], v[92:95]
v_add_f32 v218, v237, v218
v_exp_f32 v218, v218
v_mfma_f32_16x16x32_bf16 v[92:95], a[252:255], v[148:151], v[92:95]
v_mfma_f32_16x16x32_bf16 v[124:127], a[248:251], v[152:155], v[124:127]
v_add_f32 v219, v237, v219
v_exp_f32 v219, v219
v_mfma_f32_16x16x32_bf16 v[124:127], a[252:255], v[156:159], v[124:127]
s_waitcnt lgkmcnt(4)
v_cvt_pk_bf16_f32 v187, v218, v219
v_mfma_f32_16x16x32_bf16 a[188:191], a[248:251], v[160:163], a[188:191]
v_mfma_f32_16x16x32_bf16 v[200:203], a[208:211], a[0:3], 0
v_add_f32 v220, v238, v220
v_exp_f32 v220, v220
v_mfma_f32_16x16x32_bf16 v[200:203], a[212:215], a[4:7], v[200:203]
ds_read_b64_tr_b16 a[248:249], v244 offset:16928
ds_read_b64_tr_b16 a[250:251], v244 offset:21152
v_mfma_f32_16x16x32_bf16 v[200:203], a[216:219], a[8:11], v[200:203]
s_add_u32 m0, s59, 64
v_add_f32 v221, v238, v221
v_exp_f32 v221, v221
v_mfma_f32_16x16x32_bf16 v[200:203], a[220:223], a[12:15], v[200:203]
s_waitcnt lgkmcnt(2)
ds_read_b64_tr_b16 a[252:253], v246 offset:16928
ds_read_b64_tr_b16 a[254:255], v246 offset:21152
buffer_load_dwordx4 v248, s[40:43], s57 offen offset:2048 nt lds
v_mfma_f32_16x16x32_bf16 v[0:3], a[240:243], v[164:167], v[0:3]
v_add_f32 v222, v238, v222
v_exp_f32 v222, v222
v_mfma_f32_16x16x32_bf16 v[0:3], a[244:247], v[168:171], v[0:3]
ds_read_b128 a[224:227], v240 offset:4224
v_cvt_pk_bf16_f32 v194, v220, v221
v_mfma_f32_16x16x32_bf16 v[32:35], a[240:243], v[172:175], v[32:35]
s_add_u32 m0, s59, 96
v_add_f32 v223, v238, v223
v_exp_f32 v223, v223
v_mfma_f32_16x16x32_bf16 v[32:35], a[244:247], v[176:179], v[32:35]
ds_read_b128 a[228:231], v241 offset:4224
v_cvt_pk_bf16_f32 v195, v222, v223
v_mfma_f32_16x16x32_bf16 v[204:207], a[208:211], a[16:19], 0
v_add_f32 v200, v235, v200
v_exp_f32 v200, v200
v_mfma_f32_16x16x32_bf16 v[204:207], a[212:215], a[20:23], v[204:207]
ds_read_b128 a[232:235], v240 offset:4736
buffer_load_dwordx4 v248, s[40:43], s57 offen offset:3072 nt lds
v_mfma_f32_16x16x32_bf16 v[204:207], a[216:219], a[24:27], v[204:207]
v_add_f32 v201, v235, v201
v_exp_f32 v201, v201
v_mfma_f32_16x16x32_bf16 v[204:207], a[220:223], a[28:31], v[204:207]
s_mov_b32 s36, s80
ds_read_b128 a[236:239], v241 offset:4736
v_cvt_pk_bf16_f32 v128, v200, v201
v_mfma_f32_16x16x32_bf16 v[64:67], a[240:243], v[180:183], v[64:67]
v_add_f32 v202, v235, v202
v_exp_f32 v202, v202
v_mfma_f32_16x16x32_bf16 v[64:67], a[244:247], v[184:187], v[64:67]
v_bfe_u32 v254, v249, 4, 4
v_mfma_f32_16x16x32_bf16 a[160:163], a[240:243], v[196:199], a[160:163]
v_add_f32 v203, v235, v203
v_exp_f32 v203, v203
v_mfma_f32_16x16x32_bf16 v[96:99], a[240:243], v[188:191], v[96:99]
s_and_b32 s37, s81, 0xffff
s_mov_b32 s38, 64
v_cvt_pk_bf16_f32 v129, v202, v203
v_mfma_f32_16x16x32_bf16 v[96:99], a[244:247], v[192:195], v[96:99]
s_mov_b32 s39, 0x20000
ds_read_b64_tr_b16 a[240:241], v245 offset:16896
v_lshlrev_b32 v254, 2, v254
v_mfma_f32_16x16x32_bf16 v[208:211], a[208:211], a[32:35], 0
v_add_f32 v204, v236, v204
v_exp_f32 v204, v204
v_mfma_f32_16x16x32_bf16 v[208:211], a[212:215], a[36:39], v[208:211]
s_add_u32 s50, s65, 294912
ds_read_b64_tr_b16 a[242:243], v245 offset:21120
ds_read_b64_tr_b16 a[244:245], v247 offset:16896
v_mfma_f32_16x16x32_bf16 v[208:211], a[216:219], a[40:43], v[208:211]
v_add_f32 v205, v236, v205
v_exp_f32 v205, v205
v_mfma_f32_16x16x32_bf16 v[208:211], a[220:223], a[44:47], v[208:211]
s_waitcnt lgkmcnt(7)
ds_read_b64_tr_b16 a[246:247], v247 offset:21120
v_cvt_pk_bf16_f32 v136, v204, v205
v_mfma_f32_16x16x32_bf16 v[4:7], a[248:251], v[164:167], v[4:7]
v_add_f32 v206, v236, v206
v_exp_f32 v206, v206
v_mfma_f32_16x16x32_bf16 v[4:7], a[252:255], v[168:171], v[4:7]
buffer_load_dword v255, v254, s[36:39], 0 offen sc1
v_mfma_f32_16x16x32_bf16 v[36:39], a[248:251], v[172:175], v[36:39]
v_add_f32 v207, v236, v207
v_exp_f32 v207, v207
v_mfma_f32_16x16x32_bf16 v[36:39], a[252:255], v[176:179], v[36:39]
buffer_store_dwordx4 a[128:131], v249, s[44:47], s50 offen offset:0 sc1
v_cvt_pk_bf16_f32 v137, v206, v207
v_mfma_f32_16x16x32_bf16 v[212:215], a[208:211], a[48:51], 0
v_add_f32 v208, v237, v208
v_exp_f32 v208, v208
v_mfma_f32_16x16x32_bf16 v[212:215], a[212:215], a[52:55], v[212:215]
s_sub_u32 s28, s12, 2048
s_subb_u32 s29, s13, 0
s_and_b32 s29, s29, 0xffff
v_mfma_f32_16x16x32_bf16 v[212:215], a[216:219], a[56:59], v[212:215]
v_add_f32 v209, v237, v209
v_exp_f32 v209, v209
v_mfma_f32_16x16x32_bf16 v[212:215], a[220:223], a[60:63], v[212:215]
s_mov_b32 s30, 4720640
s_mov_b32 s31, 0x20000
v_cvt_pk_bf16_f32 v144, v208, v209
v_mfma_f32_16x16x32_bf16 v[68:71], a[248:251], v[180:183], v[68:71]
v_add_f32 v210, v237, v210
v_exp_f32 v210, v210
v_mfma_f32_16x16x32_bf16 v[68:71], a[252:255], v[184:187], v[68:71]
s_mul_i32 s51, s26, 18874368
s_add_u32 s32, s24, s51
s_addc_u32 s33, s25, 0
v_mfma_f32_16x16x32_bf16 v[100:103], a[248:251], v[188:191], v[100:103]
v_add_f32 v211, v237, v211
v_exp_f32 v211, v211
v_mfma_f32_16x16x32_bf16 v[100:103], a[252:255], v[192:195], v[100:103]
s_sub_u32 s32, s32, 4096
s_subb_u32 s33, s33, 0
v_cvt_pk_bf16_f32 v145, v210, v211
v_mfma_f32_16x16x32_bf16 v[216:219], a[208:211], a[64:67], 0
v_add_f32 v212, v238, v212
v_exp_f32 v212, v212
v_mfma_f32_16x16x32_bf16 v[216:219], a[212:215], a[68:71], v[216:219]
s_and_b32 s33, s33, 0xffff
s_mov_b32 s34, 18878464
s_mov_b32 s35, 0x20000
v_mfma_f32_16x16x32_bf16 v[216:219], a[216:219], a[72:75], v[216:219]
v_add_f32 v213, v238, v213
v_exp_f32 v213, v213
v_mfma_f32_16x16x32_bf16 v[216:219], a[220:223], a[76:79], v[216:219]
s_add_u32 s40, s24, 41943040
ds_read_b128 a[208:211], v242 offset:0
v_cvt_pk_bf16_f32 v152, v212, v213
v_mfma_f32_16x16x32_bf16 a[164:167], a[248:251], v[196:199], a[164:167]
v_add_f32 v214, v238, v214
v_exp_f32 v214, v214
v_smfmac_f32_16x16x64_bf16 a[192:195], v[224:227], v[164:171], v228
s_waitcnt lgkmcnt(1)
ds_read_b64_tr_b16 a[248:249], v245 offset:16928
ds_read_b64_tr_b16 a[250:251], v245 offset:21152
v_mfma_f32_16x16x32_bf16 v[8:11], a[240:243], v[164:167], v[8:11]
v_add_f32 v215, v238, v215
v_exp_f32 v215, v215
v_mfma_f32_16x16x32_bf16 v[8:11], a[244:247], v[168:171], v[8:11]
ds_read_b64_tr_b16 a[252:253], v247 offset:16928
ds_read_b64_tr_b16 a[254:255], v247 offset:21152
v_mfma_f32_16x16x32_bf16 v[220:223], a[224:227], a[0:3], 0
v_add_f32 v216, v239, v216
v_exp_f32 v216, v216
v_mfma_f32_16x16x32_bf16 v[220:223], a[228:231], a[4:7], v[220:223]
s_addc_u32 s41, s25, 0
ds_read_b128 a[212:215], v243 offset:0
v_cvt_pk_bf16_f32 v153, v214, v215
v_mfma_f32_16x16x32_bf16 v[220:223], a[232:235], a[8:11], v[220:223]
v_add_f32 v217, v239, v217
v_exp_f32 v217, v217
v_mfma_f32_16x16x32_bf16 v[220:223], a[236:239], a[12:15], v[220:223]
s_and_b32 s41, s41, 0xffff
ds_read_b128 a[216:219], v242 offset:512
v_cvt_pk_bf16_f32 v160, v216, v217
v_mfma_f32_16x16x32_bf16 v[40:43], a[240:243], v[172:175], v[40:43]
v_add_f32 v218, v239, v218
v_exp_f32 v218, v218
v_mfma_f32_16x16x32_bf16 v[40:43], a[244:247], v[176:179], v[40:43]
s_mov_b32 s42, 8554496
ds_read_b128 a[220:223], v243 offset:512
v_add_f32 v229, v229, v216
v_mfma_f32_16x16x32_bf16 v[72:75], a[240:243], v[180:183], v[72:75]
v_add_f32 v219, v239, v219
v_exp_f32 v219, v219
v_mfma_f32_16x16x32_bf16 v[72:75], a[244:247], v[184:187], v[72:75]
s_add_u32 s50, s65, 296960
v_cvt_pk_bf16_f32 v161, v218, v219
v_add_f32 v229, v229, v217
v_mfma_f32_16x16x32_bf16 v[200:203], a[224:227], a[16:19], 0
v_add_f32 v220, v235, v220
v_exp_f32 v220, v220
v_mfma_f32_16x16x32_bf16 v[200:203], a[228:231], a[20:23], v[200:203]
v_add_f32 v229, v229, v218
v_add_f32 v229, v229, v219
v_mfma_f32_16x16x32_bf16 v[200:203], a[232:235], a[24:27], v[200:203]
v_add_f32 v221, v235, v221
v_exp_f32 v221, v221
v_mfma_f32_16x16x32_bf16 v[200:203], a[236:239], a[28:31], v[200:203]
buffer_store_dwordx4 a[132:135], v249, s[44:47], s50 offen offset:0 sc1
v_cvt_pk_bf16_f32 v130, v220, v221
v_mfma_f32_16x16x32_bf16 v[104:107], a[240:243], v[188:191], v[104:107]
v_add_f32 v222, v235, v222
v_exp_f32 v222, v222
v_mfma_f32_16x16x32_bf16 v[104:107], a[244:247], v[192:195], v[104:107]
s_mov_b32 s43, 0x20000
s_lshl_b32 s51, s26, 3
s_add_u32 s51, s51, s27
v_mfma_f32_16x16x32_bf16 a[168:171], a[240:243], v[196:199], a[168:171]
s_waitcnt lgkmcnt(3)
v_add_f32 v223, v235, v223
v_exp_f32 v223, v223
v_mfma_f32_16x16x32_bf16 v[12:15], a[248:251], v[164:167], v[12:15]
s_lshl_b32 s51, s51, 5
ds_read_b64_tr_b16 a[240:241], v244 offset:17408
ds_read_b64_tr_b16 a[242:243], v244 offset:21632
v_mfma_f32_16x16x32_bf16 v[12:15], a[252:255], v[168:171], v[12:15]
s_add_u32 s51, s51, s3
ds_read_b64_tr_b16 a[244:245], v246 offset:17408
v_cvt_pk_bf16_f32 v131, v222, v223
v_mfma_f32_16x16x32_bf16 v[204:207], a[224:227], a[32:35], 0
v_add_f32 v200, v236, v200
v_exp_f32 v200, v200
v_mfma_f32_16x16x32_bf16 v[204:207], a[228:231], a[36:39], v[204:207]
s_lshl_b32 s51, s51, 2
s_add_u32 s51, s51, 8519680
ds_read_b64_tr_b16 a[246:247], v246 offset:21632
v_mfma_f32_16x16x32_bf16 v[204:207], a[232:235], a[40:43], v[204:207]
v_add_f32 v201, v236, v201
v_exp_f32 v201, v201
v_mfma_f32_16x16x32_bf16 v[204:207], a[236:239], a[44:47], v[204:207]
s_xor_b32 s100, s51, 32
s_cmp_eq_u32 s48, 0
v_cvt_pk_bf16_f32 v138, v200, v201
v_mfma_f32_16x16x32_bf16 v[44:47], a[248:251], v[172:175], v[44:47]
v_add_f32 v202, v236, v202
v_exp_f32 v202, v202
v_mfma_f32_16x16x32_bf16 v[44:47], a[252:255], v[176:179], v[44:47]
s_cselect_b32 s67, s51, 1073741824
s_and_b32 s51, s2, 2
s_lshl_b32 s51, s51, 4
v_mfma_f32_16x16x32_bf16 v[76:79], a[248:251], v[180:183], v[76:79]
v_add_f32 v203, v236, v203
v_exp_f32 v203, v203
v_mfma_f32_16x16x32_bf16 v[76:79], a[252:255], v[184:187], v[76:79]
s_lshr_b32 s55, s2, 3
s_add_u32 s55, s55, s51
v_cvt_pk_bf16_f32 v139, v202, v203
v_mfma_f32_16x16x32_bf16 v[208:211], a[224:227], a[48:51], 0
v_add_f32 v204, v237, v204
v_exp_f32 v204, v204
v_mfma_f32_16x16x32_bf16 v[208:211], a[228:231], a[52:55], v[208:211]
s_and_b32 s4, s2, 1
s_mul_i32 s60, s55, 43691
s_lshr_b32 s60, s60, 17
v_mfma_f32_16x16x32_bf16 v[208:211], a[232:235], a[56:59], v[208:211]
v_add_f32 v205, v237, v205
v_exp_f32 v205, v205
v_mfma_f32_16x16x32_bf16 v[208:211], a[236:239], a[60:63], v[208:211]
s_add_u32 s50, s65, 299008
v_cvt_pk_bf16_f32 v146, v204, v205
v_lshrrev_b32 v230, 8, v249
v_mfma_f32_16x16x32_bf16 v[108:111], a[248:251], v[188:191], v[108:111]
v_add_f32 v206, v237, v206
v_exp_f32 v206, v206
v_mfma_f32_16x16x32_bf16 v[108:111], a[252:255], v[192:195], v[108:111]
buffer_store_dwordx4 a[136:139], v249, s[44:47], s50 offen offset:0 sc1
v_mfma_f32_16x16x32_bf16 a[172:175], a[248:251], v[196:199], a[172:175]
v_add_f32 v207, v237, v207
v_exp_f32 v207, v207
v_smfmac_f32_16x16x64_bf16 a[196:199], v[224:227], v[172:179], v228
s_mul_i32 s71, s60, 3
ds_read_b64_tr_b16 a[248:249], v244 offset:17440
ds_read_b64_tr_b16 a[250:251], v244 offset:21664
v_mfma_f32_16x16x32_bf16 v[212:215], a[224:227], a[64:67], 0
v_add_f32 v208, v238, v208
v_exp_f32 v208, v208
v_mfma_f32_16x16x32_bf16 v[212:215], a[228:231], a[68:71], v[212:215]
s_sub_u32 s71, s55, s71
ds_read_b64_tr_b16 a[252:253], v246 offset:17440
ds_read_b64_tr_b16 a[254:255], v246 offset:21664
v_mfma_f32_16x16x32_bf16 v[212:215], a[232:235], a[72:75], v[212:215]
v_add_f32 v209, v238, v209
v_exp_f32 v209, v209
v_mfma_f32_16x16x32_bf16 v[212:215], a[236:239], a[76:79], v[212:215]
s_waitcnt lgkmcnt(4)
ds_read_b128 a[224:227], v242 offset:4224
v_cvt_pk_bf16_f32 v147, v206, v207
v_mfma_f32_16x16x32_bf16 v[16:19], a[240:243], v[164:167], v[16:19]
v_add_f32 v210, v238, v210
v_exp_f32 v210, v210
v_mfma_f32_16x16x32_bf16 v[16:19], a[244:247], v[168:171], v[16:19]
s_lshr_b32 s19, s48, 1
ds_read_b128 a[228:231], v243 offset:4224
v_cvt_pk_bf16_f32 v154, v208, v209
v_mfma_f32_16x16x32_bf16 v[48:51], a[240:243], v[172:175], v[48:51]
v_add_f32 v211, v238, v211
v_exp_f32 v211, v211
v_mfma_f32_16x16x32_bf16 v[48:51], a[244:247], v[176:179], v[48:51]
ds_read_b128 a[232:235], v242 offset:4736
v_cvt_pk_bf16_f32 v155, v210, v211
v_mfma_f32_16x16x32_bf16 v[216:219], a[208:211], a[0:3], 0
v_add_f32 v212, v239, v212
v_exp_f32 v212, v212
v_mfma_f32_16x16x32_bf16 v[216:219], a[212:215], a[4:7], v[216:219]
s_and_b32 s70, s48, 1
ds_read_b128 a[236:239], v243 offset:4736
v_add_f32 v229, v229, v212
v_mfma_f32_16x16x32_bf16 v[216:219], a[216:219], a[8:11], v[216:219]
v_add_f32 v213, v239, v213
v_exp_f32 v213, v213
v_mfma_f32_16x16x32_bf16 v[216:219], a[220:223], a[12:15], v[216:219]
s_cmp_eq_u32 s4, 0
v_cvt_pk_bf16_f32 v162, v212, v213
v_add_f32 v229, v229, v213
v_mfma_f32_16x16x32_bf16 v[80:83], a[240:243], v[180:183], v[80:83]
v_add_f32 v214, v239, v214
v_exp_f32 v214, v214
v_mfma_f32_16x16x32_bf16 v[80:83], a[244:247], v[184:187], v[80:83]
s_cselect_b32 s6, 1, -1
v_add_f32 v229, v229, v214
v_add_u32 v244, s61, v244
v_mfma_f32_16x16x32_bf16 v[112:115], a[240:243], v[188:191], v[112:115]
v_add_f32 v215, v239, v215
v_exp_f32 v215, v215
v_mfma_f32_16x16x32_bf16 v[112:115], a[244:247], v[192:195], v[112:115]
s_cselect_b32 s15, 0, 6
v_cvt_pk_bf16_f32 v163, v214, v215
v_add_f32 v229, v229, v215
v_mfma_f32_16x16x32_bf16 v[220:223], a[208:211], a[16:19], 0
v_add_f32 v216, v235, v216
v_exp_f32 v216, v216
v_mfma_f32_16x16x32_bf16 v[220:223], a[212:215], a[20:23], v[220:223]
s_mul_i32 s52, s60, 7
s_add_u32 s15, s15, s52
v_add_u32 v246, s61, v246
v_mfma_f32_16x16x32_bf16 v[220:223], a[216:219], a[24:27], v[220:223]
v_add_f32 v217, v235, v217
v_exp_f32 v217, v217
v_mfma_f32_16x16x32_bf16 v[220:223], a[220:223], a[28:31], v[220:223]
s_mul_i32 s53, s52, 3641
s_lshr_b32 s53, s53, 16
v_cvt_pk_bf16_f32 v132, v216, v217
v_mfma_f32_16x16x32_bf16 a[176:179], a[240:243], v[196:199], a[176:179]
s_waitcnt lgkmcnt(4)
v_add_f32 v218, v235, v218
v_exp_f32 v218, v218
v_mfma_f32_16x16x32_bf16 v[20:23], a[248:251], v[164:167], v[20:23]
s_min_u32 s53, s53, 7
ds_read_b64_tr_b16 a[240:241], v245 offset:17408
ds_read_b64_tr_b16 a[242:243], v245 offset:21632
v_mfma_f32_16x16x32_bf16 v[20:23], a[252:255], v[168:171], v[20:23]
v_add_f32 v219, v235, v219
v_exp_f32 v219, v219
v_mfma_f32_16x16x32_bf16 v[52:55], a[248:251], v[172:175], v[52:55]
s_add_u32 s54, s52, 6
ds_read_b64_tr_b16 a[244:245], v247 offset:17408
ds_read_b64_tr_b16 a[246:247], v247 offset:21632
v_mfma_f32_16x16x32_bf16 v[52:55], a[252:255], v[176:179], v[52:55]
s_mul_i32 s54, s54, 3641
s_lshr_b32 s54, s54, 16
v_cvt_pk_bf16_f32 v133, v218, v219
v_mfma_f32_16x16x32_bf16 v[200:203], a[208:211], a[32:35], 0
v_add_f32 v220, v236, v220
v_exp_f32 v220, v220
v_mfma_f32_16x16x32_bf16 v[200:203], a[212:215], a[36:39], v[200:203]
s_min_u32 s54, s54, 7
s_sub_u32 s54, s54, s53
s_add_u32 s50, s65, 301056
v_mfma_f32_16x16x32_bf16 v[200:203], a[216:219], a[40:43], v[200:203]
v_add_f32 v221, v236, v221
v_exp_f32 v221, v221
v_mfma_f32_16x16x32_bf16 v[200:203], a[220:223], a[44:47], v[200:203]
buffer_store_dwordx4 a[140:143], v249, s[44:47], s50 offen offset:0 sc1
v_cvt_pk_bf16_f32 v140, v220, v221
v_mfma_f32_16x16x32_bf16 v[84:87], a[248:251], v[180:183], v[84:87]
v_add_f32 v222, v236, v222
v_exp_f32 v222, v222
v_mfma_f32_16x16x32_bf16 v[84:87], a[252:255], v[184:187], v[84:87]
s_lshl_b32 s54, s54, 7
s_lshl_b32 s51, s26, 3
s_add_u32 s53, s53, s51
v_mfma_f32_16x16x32_bf16 v[116:119], a[248:251], v[188:191], v[116:119]
v_add_f32 v223, v236, v223
v_exp_f32 v223, v223
v_mfma_f32_16x16x32_bf16 v[116:119], a[252:255], v[192:195], v[116:119]
s_lshl_b32 s53, s53, 7
s_lshl_b32 s51, s4, 5
v_cvt_pk_bf16_f32 v141, v222, v223
v_mfma_f32_16x16x32_bf16 v[204:207], a[208:211], a[48:51], 0
v_add_f32 v200, v237, v200
v_exp_f32 v200, v200
v_mfma_f32_16x16x32_bf16 v[204:207], a[212:215], a[52:55], v[204:207]
s_add_u32 s53, s53, s51
s_add_u32 s69, s53, 8519680
s_lshl_b32 s16, s70, 10
v_mfma_f32_16x16x32_bf16 v[204:207], a[216:219], a[56:59], v[204:207]
v_add_f32 v201, v237, v201
v_exp_f32 v201, v201
v_mfma_f32_16x16x32_bf16 v[204:207], a[220:223], a[60:63], v[204:207]
s_lshl_b32 s51, s15, 11
s_add_u32 s16, s16, s51
v_cvt_pk_bf16_f32 v148, v200, v201
v_mfma_f32_16x16x32_bf16 a[180:183], a[248:251], v[196:199], a[180:183]
v_add_f32 v202, v237, v202
v_exp_f32 v202, v202
v_smfmac_f32_16x16x64_bf16 a[200:203], v[224:227], v[180:187], v228
s_waitcnt lgkmcnt(0)
ds_read_b64_tr_b16 a[248:249], v245 offset:17440
ds_read_b64_tr_b16 a[250:251], v245 offset:21664
v_mfma_f32_16x16x32_bf16 v[24:27], a[240:243], v[164:167], v[24:27]
v_add_f32 v203, v237, v203
v_exp_f32 v203, v203
v_mfma_f32_16x16x32_bf16 v[24:27], a[244:247], v[168:171], v[24:27]
ds_read_b64_tr_b16 a[252:253], v247 offset:17440
ds_read_b64_tr_b16 a[254:255], v247 offset:21664
v_mfma_f32_16x16x32_bf16 v[208:211], a[224:227], a[0:3], 0
v_add_f32 v204, v238, v204
v_exp_f32 v204, v204
v_mfma_f32_16x16x32_bf16 v[208:211], a[228:231], a[4:7], v[208:211]
s_add_u32 s16, s16, 4096
v_cvt_pk_bf16_f32 v149, v202, v203
v_add_u32 v245, s61, v245
v_mfma_f32_16x16x32_bf16 v[208:211], a[232:235], a[8:11], v[208:211]
v_add_f32 v205, v238, v205
v_exp_f32 v205, v205
v_mfma_f32_16x16x32_bf16 v[208:211], a[236:239], a[12:15], v[208:211]
s_waitcnt vmcnt(15)
s_barrier
v_mfma_f32_16x16x32_bf16 v[56:59], a[240:243], v[172:175], v[56:59]
v_add_f32 v206, v238, v206
v_exp_f32 v206, v206
v_mfma_f32_16x16x32_bf16 v[56:59], a[244:247], v[176:179], v[56:59]
s_lshl_b32 s52, s6, 11
ds_read_b128 a[208:211], v240 offset:16896
v_cvt_pk_bf16_f32 v156, v204, v205
v_mfma_f32_16x16x32_bf16 v[88:91], a[240:243], v[180:183], v[88:91]
v_add_f32 v207, v238, v207
v_exp_f32 v207, v207
v_mfma_f32_16x16x32_bf16 v[88:91], a[244:247], v[184:187], v[88:91]
s_mul_i32 s51, s52, 6
ds_read_b128 a[212:215], v241 offset:16896
v_cvt_pk_bf16_f32 v157, v206, v207
v_mfma_f32_16x16x32_bf16 v[212:215], a[224:227], a[16:19], 0
v_add_f32 v208, v235, v208
v_exp_f32 v208, v208
v_mfma_f32_16x16x32_bf16 v[212:215], a[228:231], a[20:23], v[212:215]
s_add_u32 s59, s16, s51
ds_read_b128 a[216:219], v240 offset:17408
v_add_u32 v247, s61, v247
v_mfma_f32_16x16x32_bf16 v[212:215], a[232:235], a[24:27], v[212:215]
s_mul_i32 s61, s61, -1
v_add_f32 v209, v235, v209
v_exp_f32 v209, v209
v_mfma_f32_16x16x32_bf16 v[212:215], a[236:239], a[28:31], v[212:215]
s_lshl_b32 s51, s19, 9
ds_read_b128 a[220:223], v241 offset:17408
v_cvt_pk_bf16_f32 v134, v208, v209
v_mfma_f32_16x16x32_bf16 v[120:123], a[240:243], v[188:191], v[120:123]
v_add_f32 v210, v235, v210
v_exp_f32 v210, v210
v_mfma_f32_16x16x32_bf16 v[120:123], a[244:247], v[192:195], v[120:123]
s_add_u32 s59, s59, s51
s_mul_i32 s51, s19, 3
s_add_u32 s50, s66, 0
v_mfma_f32_16x16x32_bf16 a[184:187], a[240:243], v[196:199], a[184:187]
v_add_f32 v211, v235, v211
v_exp_f32 v211, v211
v_smfmac_f32_16x16x64_bf16 a[204:207], v[224:227], v[188:195], v228
ds_read_b64_tr_b16 a[240:241], v244 offset:0
ds_read_b64_tr_b16 a[242:243], v244 offset:4224
v_mfma_f32_16x16x32_bf16 v[216:219], a[224:227], a[32:35], 0
v_add_f32 v212, v236, v212
v_exp_f32 v212, v212
v_mfma_f32_16x16x32_bf16 v[216:219], a[228:231], a[36:39], v[216:219]
ds_read_b64_tr_b16 a[244:245], v246 offset:0
ds_read_b64_tr_b16 a[246:247], v246 offset:4224
v_mfma_f32_16x16x32_bf16 v[216:219], a[232:235], a[40:43], v[216:219]
v_add_f32 v213, v236, v213
v_exp_f32 v213, v213
v_mfma_f32_16x16x32_bf16 v[216:219], a[236:239], a[44:47], v[216:219]
s_waitcnt lgkmcnt(8)
v_cvt_pk_bf16_f32 v135, v210, v211
v_cvt_pk_bf16_f32 v142, v212, v213
v_mfma_f32_16x16x32_bf16 v[28:31], a[248:251], v[164:167], v[28:31]
v_add_f32 v214, v236, v214
v_exp_f32 v214, v214
v_mfma_f32_16x16x32_bf16 v[28:31], a[252:255], v[168:171], v[28:31]
buffer_store_dwordx4 a[144:147], v249, s[44:47], s50 offen offset:0 sc1
v_mfma_f32_16x16x32_bf16 v[60:63], a[248:251], v[172:175], v[60:63]
v_add_f32 v215, v236, v215
v_exp_f32 v215, v215
v_mfma_f32_16x16x32_bf16 v[60:63], a[252:255], v[176:179], v[60:63]
s_mul_i32 s51, s51, s52
s_add_u32 s56, s16, s51
v_cvt_pk_bf16_f32 v143, v214, v215
v_mfma_f32_16x16x32_bf16 v[220:223], a[224:227], a[48:51], 0
v_add_f32 v216, v237, v216
v_exp_f32 v216, v216
v_mfma_f32_16x16x32_bf16 v[220:223], a[228:231], a[52:55], v[220:223]
s_sub_u32 s52, s52, 1024
s_add_u32 s57, s56, s52
s_add_u32 s58, s57, s52
v_mfma_f32_16x16x32_bf16 v[220:223], a[232:235], a[56:59], v[220:223]
v_add_f32 v217, v237, v217
v_exp_f32 v217, v217
v_mfma_f32_16x16x32_bf16 v[220:223], a[236:239], a[60:63], v[220:223]
s_mul_i32 s9, s70, 7168
s_mul_i32 s51, s19, 3072
v_cvt_pk_bf16_f32 v150, v216, v217
v_mfma_f32_16x16x32_bf16 v[92:95], a[248:251], v[180:183], v[92:95]
v_add_f32 v218, v237, v218
v_exp_f32 v218, v218
v_mfma_f32_16x16x32_bf16 v[92:95], a[252:255], v[184:187], v[92:95]
s_add_u32 s9, s9, s51
s_mul_i32 s14, s19, 4294964736
s_add_u32 s14, s14, 6144
v_mfma_f32_16x16x32_bf16 v[124:127], a[248:251], v[188:191], v[124:127]
v_add_f32 v219, v237, v219
v_exp_f32 v219, v219
v_mfma_f32_16x16x32_bf16 v[124:127], a[252:255], v[192:195], v[124:127]
s_waitcnt lgkmcnt(4)
s_mul_i32 s7, s70, 5152
v_cvt_pk_bf16_f32 v151, v218, v219
v_mfma_f32_16x16x32_bf16 a[188:191], a[248:251], v[196:199], a[188:191]
s_add_u32 s7, s7, s51
s_add_u32 s7, s7, 14336
s_add_u32 s10, s9, 155904
s_lshl_b32 s18, s19, 3
s_add_u32 s18, s18, s70
s_mul_i32 s18, s18, 4608
s_add_u32 s50, s66, 294912
buffer_store_dwordx4 a[148:151], v249, s[44:47], s50 offen offset:0 sc1
s_mul_i32 s51, s71, 384
s_add_u32 s18, s18, s51
s_mul_i32 s5, s19, 1536
s_lshl_b32 s8, s70, 5
s_add_u32 s5, s5, s8
s_add_u32 s5, s5, 14336
s_mul_i32 s101, s26, 1152
s_add_u32 s101, s101, s51
s_mul_i32 s51, s19, 192
s_add_u32 s8, s8, s51
s_xor_b32 s70, s69, 32
s_andn2_b32 s51, s2, 1
s_lshl_b32 s51, s51, 7
s_mul_i32 s71, s4, 68
s_add_u32 s51, s51, 8521740
s_add_u32 s71, s71, s51
s_lshl_b32 s16, s4, 5
v_mfma_f32_16x16x32_bf16 v[200:203], a[208:211], a[0:3], 0
v_add_f32 v220, v238, v220
v_exp_f32 v220, v220
v_mfma_f32_16x16x32_bf16 v[200:203], a[212:215], a[4:7], v[200:203]
s_add_u32 s64, s64, 589824
ds_read_b64_tr_b16 a[248:249], v244 offset:32
ds_read_b64_tr_b16 a[250:251], v244 offset:4256
v_mfma_f32_16x16x32_bf16 v[200:203], a[216:219], a[8:11], v[200:203]
v_add_f32 v221, v238, v221
v_exp_f32 v221, v221
v_mfma_f32_16x16x32_bf16 v[200:203], a[220:223], a[12:15], v[200:203]
s_waitcnt lgkmcnt(2)
ds_read_b64_tr_b16 a[252:253], v246 offset:32
ds_read_b64_tr_b16 a[254:255], v246 offset:4256
v_mfma_f32_16x16x32_bf16 v[0:3], a[240:243], v[128:131], v[0:3]
v_add_f32 v222, v238, v222
v_exp_f32 v222, v222
v_mfma_f32_16x16x32_bf16 v[0:3], a[244:247], v[132:135], v[0:3]
s_add_u32 s65, s65, 589824
ds_read_b128 a[224:227], v240 offset:21120
v_cvt_pk_bf16_f32 v158, v220, v221
v_mfma_f32_16x16x32_bf16 v[32:35], a[240:243], v[136:139], v[32:35]
v_add_f32 v223, v238, v223
v_exp_f32 v223, v223
v_mfma_f32_16x16x32_bf16 v[32:35], a[244:247], v[140:143], v[32:35]
s_add_u32 s66, s66, 589824
ds_read_b128 a[228:231], v241 offset:21120
v_cvt_pk_bf16_f32 v159, v222, v223
v_mfma_f32_16x16x32_bf16 v[204:207], a[208:211], a[16:19], 0
v_add_f32 v200, v235, v200
v_exp_f32 v200, v200
v_mfma_f32_16x16x32_bf16 v[204:207], a[212:215], a[20:23], v[204:207]
s_lshl_b32 s53, s2, 2
s_add_u32 s53, s53, s48
ds_read_b128 a[232:235], v240 offset:21632
v_mfma_f32_16x16x32_bf16 v[204:207], a[216:219], a[24:27], v[204:207]
v_add_f32 v201, v235, v201
v_exp_f32 v201, v201
v_mfma_f32_16x16x32_bf16 v[204:207], a[220:223], a[28:31], v[204:207]
s_mov_b32 s17, 4
ds_read_b128 a[236:239], v241 offset:21632
v_cvt_pk_bf16_f32 v164, v200, v201
v_mfma_f32_16x16x32_bf16 v[64:67], a[240:243], v[144:147], v[64:67]
v_add_f32 v202, v235, v202
v_exp_f32 v202, v202
v_mfma_f32_16x16x32_bf16 v[64:67], a[244:247], v[148:151], v[64:67]
s_mov_b32 s11, 77952
s_mov_b32 s62, 8
s_mov_b32 s63, 24
v_mfma_f32_16x16x32_bf16 a[160:163], a[240:243], v[160:163], a[160:163]
v_add_f32 v203, v235, v203
v_exp_f32 v203, v203
v_mfma_f32_16x16x32_bf16 v[96:99], a[240:243], v[152:155], v[96:99]
v_cvt_pk_bf16_f32 v165, v202, v203
v_bfe_u32 v231, v249, 6, 2
v_mfma_f32_16x16x32_bf16 v[96:99], a[244:247], v[156:159], v[96:99]
ds_read_b64_tr_b16 a[240:241], v245 offset:0
v_bfe_u32 v232, v249, 4, 2
v_mfma_f32_16x16x32_bf16 v[208:211], a[208:211], a[32:35], 0
v_add_f32 v204, v236, v204
v_exp_f32 v204, v204
v_mfma_f32_16x16x32_bf16 v[208:211], a[212:215], a[36:39], v[208:211]
ds_read_b64_tr_b16 a[242:243], v245 offset:4224
ds_read_b64_tr_b16 a[244:245], v247 offset:0
v_mfma_f32_16x16x32_bf16 v[208:211], a[216:219], a[40:43], v[208:211]
v_add_f32 v205, v236, v205
v_exp_f32 v205, v205
v_mfma_f32_16x16x32_bf16 v[208:211], a[220:223], a[44:47], v[208:211]
s_waitcnt lgkmcnt(7)
ds_read_b64_tr_b16 a[246:247], v247 offset:4224
v_cvt_pk_bf16_f32 v172, v204, v205
v_mfma_f32_16x16x32_bf16 v[4:7], a[248:251], v[128:131], v[4:7]
v_add_f32 v206, v236, v206
v_exp_f32 v206, v206
v_mfma_f32_16x16x32_bf16 v[4:7], a[252:255], v[132:135], v[4:7]
v_and_b32 v233, 1, v230
v_lshrrev_b32 v234, 1, v230
v_mfma_f32_16x16x32_bf16 v[36:39], a[248:251], v[136:139], v[36:39]
v_add_f32 v207, v236, v207
v_exp_f32 v207, v207
v_mfma_f32_16x16x32_bf16 v[36:39], a[252:255], v[140:143], v[36:39]
v_cvt_pk_bf16_f32 v173, v206, v207
v_lshl_add_u32 v248, v233, 3, v231
v_mfma_f32_16x16x32_bf16 v[212:215], a[208:211], a[48:51], 0
s_waitcnt vmcnt(0)
s_barrier
v_add_f32 v208, v237, v208
v_exp_f32 v208, v208
v_mfma_f32_16x16x32_bf16 v[212:215], a[212:215], a[52:55], v[212:215]
buffer_store_dword v228, off, s[40:43], s67 sc1
v_cmp_gt_u32 vcc, 16, v255
v_mfma_f32_16x16x32_bf16 v[212:215], a[216:219], a[56:59], v[212:215]
v_add_f32 v209, v237, v209
v_exp_f32 v209, v209
v_mfma_f32_16x16x32_bf16 v[212:215], a[220:223], a[60:63], v[212:215]
v_cvt_pk_bf16_f32 v180, v208, v209
v_mul_u32_u24 v248, 1152, v248
v_mfma_f32_16x16x32_bf16 v[68:71], a[248:251], v[144:147], v[68:71]
s_cbranch_vccnz L_s_spin0
L_s_back0:
v_add_f32 v210, v237, v210
v_exp_f32 v210, v210
v_mfma_f32_16x16x32_bf16 v[68:71], a[252:255], v[148:151], v[68:71]
v_lshl_add_u32 v248, v234, 6, v248
v_lshl_add_u32 v248, v232, 4, v248
v_mfma_f32_16x16x32_bf16 v[100:103], a[248:251], v[152:155], v[100:103]
v_add_f32 v211, v237, v211
v_exp_f32 v211, v211
v_mfma_f32_16x16x32_bf16 v[100:103], a[252:255], v[156:159], v[100:103]
v_cvt_pk_bf16_f32 v181, v210, v211
v_mul_u32_u24 v254, 12320, v233
v_mfma_f32_16x16x32_bf16 v[216:219], a[208:211], a[64:67], 0
v_add_f32 v212, v238, v212
v_exp_f32 v212, v212
v_mfma_f32_16x16x32_bf16 v[216:219], a[212:215], a[68:71], v[216:219]
v_lshl_add_u32 v231, v231, 6, v254
v_lshl_add_u32 v231, v234, 8, v231
v_mfma_f32_16x16x32_bf16 v[216:219], a[216:219], a[72:75], v[216:219]
v_add_f32 v213, v238, v213
v_exp_f32 v213, v213
v_mfma_f32_16x16x32_bf16 v[216:219], a[220:223], a[76:79], v[216:219]
ds_read_b128 a[208:211], v242 offset:16896
v_cvt_pk_bf16_f32 v188, v212, v213
v_mfma_f32_16x16x32_bf16 a[164:167], a[248:251], v[160:163], a[164:167]
v_add_f32 v214, v238, v214
v_exp_f32 v214, v214
v_smfmac_f32_16x16x64_bf16 a[192:195], v[224:227], v[128:135], v228
s_waitcnt lgkmcnt(1)
ds_read_b64_tr_b16 a[248:249], v245 offset:32
ds_read_b64_tr_b16 a[250:251], v245 offset:4256
v_mfma_f32_16x16x32_bf16 v[8:11], a[240:243], v[128:131], v[8:11]
v_add_f32 v215, v238, v215
v_exp_f32 v215, v215
v_mfma_f32_16x16x32_bf16 v[8:11], a[244:247], v[132:135], v[8:11]
ds_read_b64_tr_b16 a[252:253], v247 offset:32
ds_read_b64_tr_b16 a[254:255], v247 offset:4256
v_mfma_f32_16x16x32_bf16 v[220:223], a[224:227], a[0:3], 0
v_add_f32 v216, v239, v216
v_exp_f32 v216, v216
v_mfma_f32_16x16x32_bf16 v[220:223], a[228:231], a[4:7], v[220:223]
ds_read_b128 a[212:215], v243 offset:16896
v_cvt_pk_bf16_f32 v189, v214, v215
v_mfma_f32_16x16x32_bf16 v[220:223], a[232:235], a[8:11], v[220:223]
v_add_f32 v217, v239, v217
v_exp_f32 v217, v217
v_mfma_f32_16x16x32_bf16 v[220:223], a[236:239], a[12:15], v[220:223]
ds_read_b128 a[216:219], v242 offset:17408
v_cvt_pk_bf16_f32 v196, v216, v217
v_mfma_f32_16x16x32_bf16 v[40:43], a[240:243], v[136:139], v[40:43]
v_add_f32 v218, v239, v218
v_exp_f32 v218, v218
v_mfma_f32_16x16x32_bf16 v[40:43], a[244:247], v[140:143], v[40:43]
ds_read_b128 a[220:223], v243 offset:17408
v_add_f32 v229, v229, v216
v_mfma_f32_16x16x32_bf16 v[72:75], a[240:243], v[144:147], v[72:75]
v_add_f32 v219, v239, v219
v_exp_f32 v219, v219
v_mfma_f32_16x16x32_bf16 v[72:75], a[244:247], v[148:151], v[72:75]
v_cvt_pk_bf16_f32 v197, v218, v219
v_add_f32 v229, v229, v217
v_mfma_f32_16x16x32_bf16 v[200:203], a[224:227], a[16:19], 0
v_add_f32 v220, v235, v220
v_exp_f32 v220, v220
v_mfma_f32_16x16x32_bf16 v[200:203], a[228:231], a[20:23], v[200:203]
v_add_f32 v229, v229, v218
v_add_f32 v229, v229, v219
v_mfma_f32_16x16x32_bf16 v[200:203], a[232:235], a[24:27], v[200:203]
v_add_f32 v221, v235, v221
v_exp_f32 v221, v221
v_mfma_f32_16x16x32_bf16 v[200:203], a[236:239], a[28:31], v[200:203]
v_cvt_pk_bf16_f32 v166, v220, v221
v_lshl_add_u32 v231, v232, 3, v231
v_mfma_f32_16x16x32_bf16 v[104:107], a[240:243], v[152:155], v[104:107]
v_add_f32 v222, v235, v222
v_exp_f32 v222, v222
v_mfma_f32_16x16x32_bf16 v[104:107], a[244:247], v[156:159], v[104:107]
v_bfe_u32 v232, v249, 4, 4
v_mul_u32_u24 v254, 400, v232
v_mfma_f32_16x16x32_bf16 a[168:171], a[240:243], v[160:163], a[168:171]
s_waitcnt lgkmcnt(3)
v_add_f32 v223, v235, v223
v_exp_f32_e64 v223, v223
v_mfma_f32_16x16x32_bf16 v[12:15], a[248:251], v[128:131], v[12:15]
ds_read_b64_tr_b16 a[240:241], v244 offset:512
ds_read_b64_tr_b16 a[242:243], v244 offset:4736
v_mfma_f32_16x16x32_bf16 v[12:15], a[252:255], v[132:135], v[12:15]
ds_read_b64_tr_b16 a[244:245], v246 offset:512
v_cvt_pk_bf16_f32 v167, v222, v223
v_mfma_f32_16x16x32_bf16 v[204:207], a[224:227], a[32:35], 0
v_add_f32 v200, v236, v200
v_exp_f32 v200, v200
v_mfma_f32_16x16x32_bf16 v[204:207], a[228:231], a[36:39], v[204:207]
ds_read_b64_tr_b16 a[246:247], v246 offset:4736
v_lshl_add_u32 v230, v230, 3, v254
v_mfma_f32_16x16x32_bf16 v[204:207], a[232:235], a[40:43], v[204:207]
v_add_f32 v201, v236, v201
v_exp_f32 v201, v201
v_mfma_f32_16x16x32_bf16 v[204:207], a[236:239], a[44:47], v[204:207]
v_cvt_pk_bf16_f32 v174, v200, v201
v_mul_u32_u24 v254, 15, v234
v_mfma_f32_16x16x32_bf16 v[44:47], a[248:251], v[136:139], v[44:47]
v_add_f32 v202, v236, v202
v_exp_f32 v202, v202
v_mfma_f32_16x16x32_bf16 v[44:47], a[252:255], v[140:143], v[44:47]
v_xor_b32 v232, v232, v254
v_and_b32 v254, 14, v232
v_mfma_f32_16x16x32_bf16 v[76:79], a[248:251], v[144:147], v[76:79]
v_add_f32 v203, v236, v203
v_exp_f32 v203, v203
v_mfma_f32_16x16x32_bf16 v[76:79], a[252:255], v[148:151], v[76:79]
v_cvt_pk_bf16_f32 v175, v202, v203
v_add_u32 v232, v232, v254
v_mfma_f32_16x16x32_bf16 v[208:211], a[224:227], a[48:51], 0
v_add_f32 v204, v237, v204
v_exp_f32 v204, v204
v_mfma_f32_16x16x32_bf16 v[208:211], a[228:231], a[52:55], v[208:211]
v_or_b32 v254, v233, v234
v_lshl_add_u32 v232, v254, 1, v232
v_mfma_f32_16x16x32_bf16 v[208:211], a[232:235], a[56:59], v[208:211]
v_add_f32 v205, v237, v205
v_exp_f32 v205, v205
v_mfma_f32_16x16x32_bf16 v[208:211], a[236:239], a[60:63], v[208:211]
v_cvt_pk_bf16_f32 v182, v204, v205
v_and_b32 v254, v233, v234
v_mfma_f32_16x16x32_bf16 v[108:111], a[248:251], v[152:155], v[108:111]
v_add_f32 v206, v237, v206
v_exp_f32 v206, v206
v_mfma_f32_16x16x32_bf16 v[108:111], a[252:255], v[156:159], v[108:111]
v_lshl_add_u32 v232, v254, 6, v232
v_lshl_add_u32 v232, v234, 5, v232
v_mfma_f32_16x16x32_bf16 a[172:175], a[248:251], v[160:163], a[172:175]
v_add_f32 v207, v237, v207
v_exp_f32 v207, v207
v_smfmac_f32_16x16x64_bf16 a[196:199], v[224:227], v[136:143], v228
ds_read_b64_tr_b16 a[248:249], v244 offset:544
ds_read_b64_tr_b16 a[250:251], v244 offset:4768
v_mfma_f32_16x16x32_bf16 v[212:215], a[224:227], a[64:67], 0
v_add_f32 v208, v238, v208
v_exp_f32 v208, v208
v_mfma_f32_16x16x32_bf16 v[212:215], a[228:231], a[68:71], v[212:215]
ds_read_b64_tr_b16 a[252:253], v246 offset:544
ds_read_b64_tr_b16 a[254:255], v246 offset:4768
v_mfma_f32_16x16x32_bf16 v[212:215], a[232:235], a[72:75], v[212:215]
v_add_f32 v209, v238, v209
v_exp_f32 v209, v209
v_mfma_f32_16x16x32_bf16 v[212:215], a[236:239], a[76:79], v[212:215]
s_waitcnt lgkmcnt(4)
ds_read_b128 a[224:227], v242 offset:21120
v_cvt_pk_bf16_f32 v183, v206, v207
v_mfma_f32_16x16x32_bf16 v[16:19], a[240:243], v[128:131], v[16:19]
v_add_f32 v210, v238, v210
v_exp_f32 v210, v210
v_mfma_f32_16x16x32_bf16 v[16:19], a[244:247], v[132:135], v[16:19]
ds_read_b128 a[228:231], v243 offset:21120
v_cvt_pk_bf16_f32 v190, v208, v209
v_mfma_f32_16x16x32_bf16 v[48:51], a[240:243], v[136:139], v[48:51]
v_add_f32 v211, v238, v211
v_exp_f32 v211, v211
v_mfma_f32_16x16x32_bf16 v[48:51], a[244:247], v[140:143], v[48:51]
ds_read_b128 a[232:235], v242 offset:21632
v_cvt_pk_bf16_f32 v191, v210, v211
v_mfma_f32_16x16x32_bf16 v[216:219], a[208:211], a[0:3], 0
v_add_f32 v212, v239, v212
v_exp_f32 v212, v212
v_mfma_f32_16x16x32_bf16 v[216:219], a[212:215], a[4:7], v[216:219]
ds_read_b128 a[236:239], v243 offset:21632
v_add_f32 v229, v229, v212
v_mfma_f32_16x16x32_bf16 v[216:219], a[216:219], a[8:11], v[216:219]
v_add_f32 v213, v239, v213
v_exp_f32 v213, v213
v_mfma_f32_16x16x32_bf16 v[216:219], a[220:223], a[12:15], v[216:219]
v_cvt_pk_bf16_f32 v198, v212, v213
v_add_f32 v229, v229, v213
v_mfma_f32_16x16x32_bf16 v[80:83], a[240:243], v[144:147], v[80:83]
v_add_f32 v214, v239, v214
v_exp_f32 v214, v214
v_mfma_f32_16x16x32_bf16 v[80:83], a[244:247], v[148:151], v[80:83]
v_add_f32 v229, v229, v214
v_bfe_u32 v234, v249, 4, 3
v_mfma_f32_16x16x32_bf16 v[112:115], a[240:243], v[152:155], v[112:115]
v_add_f32 v215, v239, v215
v_exp_f32 v215, v215
v_mfma_f32_16x16x32_bf16 v[112:115], a[244:247], v[156:159], v[112:115]
v_cvt_pk_bf16_f32 v199, v214, v215
v_add_f32 v229, v229, v215
v_mfma_f32_16x16x32_bf16 v[220:223], a[208:211], a[16:19], 0
v_add_f32 v216, v235, v216
v_exp_f32 v216, v216
v_mfma_f32_16x16x32_bf16 v[220:223], a[212:215], a[20:23], v[220:223]
v_mul_u32_u24 v254, s54, v233
v_lshl_add_u32 v254, v234, 2, v254
v_mfma_f32_16x16x32_bf16 v[220:223], a[216:219], a[24:27], v[220:223]
v_add_f32 v217, v235, v217
v_exp_f32 v217, v217
v_mfma_f32_16x16x32_bf16 v[220:223], a[220:223], a[28:31], v[220:223]
s_xor_b32 s54, s53, 4
v_cvt_pk_bf16_f32 v168, v216, v217
v_add_u32 v241, s5, v231
v_mfma_f32_16x16x32_bf16 a[176:179], a[240:243], v[160:163], a[176:179]
s_waitcnt lgkmcnt(4)
v_add_f32 v218, v235, v218
v_exp_f32 v218, v218
v_mfma_f32_16x16x32_bf16 v[20:23], a[248:251], v[128:131], v[20:23]
ds_read_b64_tr_b16 a[240:241], v245 offset:512
ds_read_b64_tr_b16 a[242:243], v245 offset:4736
v_mfma_f32_16x16x32_bf16 v[20:23], a[252:255], v[132:135], v[20:23]
v_add_f32 v219, v235, v219
v_exp_f32 v219, v219
v_mfma_f32_16x16x32_bf16 v[52:55], a[248:251], v[136:139], v[52:55]
ds_read_b64_tr_b16 a[244:245], v247 offset:512
ds_read_b64_tr_b16 a[246:247], v247 offset:4736
v_mfma_f32_16x16x32_bf16 v[52:55], a[252:255], v[140:143], v[52:55]
v_cvt_pk_bf16_f32 v169, v218, v219
v_mov_b32 v240, v249
v_mfma_f32_16x16x32_bf16 v[200:203], a[208:211], a[32:35], 0
v_add_f32 v220, v236, v220
v_exp_f32 v220, v220
v_mfma_f32_16x16x32_bf16 v[200:203], a[212:215], a[36:39], v[200:203]
v_add_u32 v242, s8, v230
v_xor_b32 v243, s16, v232
v_mfma_f32_16x16x32_bf16 v[200:203], a[216:219], a[40:43], v[200:203]
v_add_f32 v221, v236, v221
v_exp_f32 v221, v221
v_mfma_f32_16x16x32_bf16 v[200:203], a[220:223], a[44:47], v[200:203]
v_cvt_pk_bf16_f32 v176, v220, v221
v_readlane_b32 s16, v243, 0
v_mfma_f32_16x16x32_bf16 v[84:87], a[248:251], v[144:147], v[84:87]
v_add_f32 v222, v236, v222
v_exp_f32 v222, v222
v_mfma_f32_16x16x32_bf16 v[84:87], a[252:255], v[148:151], v[84:87]
s_add_u32 s8, s9, 0
s_mul_i32 s5, s16, 294912
s_mul_i32 s16, s16, 73728
v_mfma_f32_16x16x32_bf16 v[116:119], a[248:251], v[152:155], v[116:119]
v_add_f32 v223, v236, v223
v_exp_f32 v223, v223
v_mfma_f32_16x16x32_bf16 v[116:119], a[252:255], v[156:159], v[116:119]
s_add_u32 s52, s16, s18
v_cvt_pk_bf16_f32 v177, v222, v223
v_mfma_f32_16x16x32_bf16 v[204:207], a[208:211], a[48:51], 0
v_add_f32 v200, v237, v200
v_exp_f32 v200, v200
v_mfma_f32_16x16x32_bf16 v[204:207], a[212:215], a[52:55], v[204:207]
buffer_load_dword v255, v254, s[40:43], s69 offen sc1
v_mfma_f32_16x16x32_bf16 v[204:207], a[216:219], a[56:59], v[204:207]
v_add_f32 v201, v237, v201
v_exp_f32 v201, v201
v_mfma_f32_16x16x32_bf16 v[204:207], a[220:223], a[60:63], v[204:207]
v_cvt_pk_bf16_f32 v184, v200, v201
v_mfma_f32_16x16x32_bf16 a[180:183], a[248:251], v[160:163], a[180:183]
v_add_f32 v202, v237, v202
v_exp_f32 v202, v202
v_smfmac_f32_16x16x64_bf16 a[200:203], v[224:227], v[144:151], v228
s_waitcnt lgkmcnt(0)
ds_read_b64_tr_b16 a[248:249], v245 offset:544
ds_read_b64_tr_b16 a[250:251], v245 offset:4768
v_mfma_f32_16x16x32_bf16 v[24:27], a[240:243], v[128:131], v[24:27]
v_add_f32 v203, v237, v203
v_exp_f32 v203, v203
v_mfma_f32_16x16x32_bf16 v[24:27], a[244:247], v[132:135], v[24:27]
ds_read_b64_tr_b16 a[252:253], v247 offset:544
ds_read_b64_tr_b16 a[254:255], v247 offset:4768
v_mfma_f32_16x16x32_bf16 v[208:211], a[224:227], a[0:3], 0
v_add_f32 v204, v238, v204
v_exp_f32 v204, v204
v_mfma_f32_16x16x32_bf16 v[208:211], a[228:231], a[4:7], v[208:211]
v_cvt_pk_bf16_f32 v185, v202, v203
v_mfma_f32_16x16x32_bf16 v[208:211], a[232:235], a[8:11], v[208:211]
v_add_f32 v205, v238, v205
v_exp_f32 v205, v205
v_mfma_f32_16x16x32_bf16 v[208:211], a[236:239], a[12:15], v[208:211]
s_barrier
v_mfma_f32_16x16x32_bf16 v[56:59], a[240:243], v[136:139], v[56:59]
v_add_f32 v206, v238, v206
v_exp_f32 v206, v206
v_mfma_f32_16x16x32_bf16 v[56:59], a[244:247], v[140:143], v[56:59]
s_add_u32 m0, s8, s7
s_add_u32 s51, s52, 2048
v_cvt_pk_bf16_f32 v192, v204, v205
v_mfma_f32_16x16x32_bf16 v[88:91], a[240:243], v[144:147], v[88:91]
v_add_f32 v207, v238, v207
v_exp_f32 v207, v207
v_mfma_f32_16x16x32_bf16 v[88:91], a[244:247], v[148:151], v[88:91]
buffer_load_dwordx4 v248, s[28:31], s51 offen offset:0 lds
v_cvt_pk_bf16_f32 v193, v206, v207
v_mfma_f32_16x16x32_bf16 v[212:215], a[224:227], a[16:19], 0
v_add_f32 v208, v235, v208
v_exp_f32 v208, v208
v_mfma_f32_16x16x32_bf16 v[212:215], a[228:231], a[20:23], v[212:215]
s_add_u32 s51, s52, 1152
v_mfma_f32_16x16x32_bf16 v[212:215], a[232:235], a[24:27], v[212:215]
v_add_f32 v209, v235, v209
v_exp_f32 v209, v209
v_mfma_f32_16x16x32_bf16 v[212:215], a[236:239], a[28:31], v[212:215]
buffer_load_dwordx4 v248, s[28:31], s51 offen offset:1024 lds
v_cvt_pk_bf16_f32 v170, v208, v209
v_mfma_f32_16x16x32_bf16 v[120:123], a[240:243], v[152:155], v[120:123]
v_add_f32 v210, v235, v210
v_exp_f32 v210, v210
v_mfma_f32_16x16x32_bf16 v[120:123], a[244:247], v[156:159], v[120:123]
s_add_u32 s51, s52, 256
v_mfma_f32_16x16x32_bf16 a[184:187], a[240:243], v[160:163], a[184:187]
v_add_f32 v211, v235, v211
v_exp_f32 v211, v211
v_smfmac_f32_16x16x64_bf16 a[204:207], v[224:227], v[152:159], v228
ds_read_b64_tr_b16 a[240:241], v244 offset:16896
ds_read_b64_tr_b16 a[242:243], v244 offset:21120
v_mfma_f32_16x16x32_bf16 v[216:219], a[224:227], a[32:35], 0
v_add_f32 v212, v236, v212
v_exp_f32 v212, v212
v_mfma_f32_16x16x32_bf16 v[216:219], a[228:231], a[36:39], v[216:219]
ds_read_b64_tr_b16 a[244:245], v246 offset:16896
ds_read_b64_tr_b16 a[246:247], v246 offset:21120
v_mfma_f32_16x16x32_bf16 v[216:219], a[232:235], a[40:43], v[216:219]
v_add_f32 v213, v236, v213
v_exp_f32 v213, v213
v_mfma_f32_16x16x32_bf16 v[216:219], a[236:239], a[44:47], v[216:219]
s_waitcnt lgkmcnt(4)
v_cvt_pk_bf16_f32 v171, v210, v211
v_cvt_pk_bf16_f32 v178, v212, v213
v_mfma_f32_16x16x32_bf16 v[28:31], a[248:251], v[128:131], v[28:31]
v_add_f32 v214, v236, v214
v_exp_f32 v214, v214
v_mfma_f32_16x16x32_bf16 v[28:31], a[252:255], v[132:135], v[28:31]
buffer_load_dwordx4 v248, s[28:31], s51 offen offset:2048 lds
v_mfma_f32_16x16x32_bf16 v[60:63], a[248:251], v[136:139], v[60:63]
v_add_f32 v215, v236, v215
v_exp_f32 v215, v215
v_mfma_f32_16x16x32_bf16 v[60:63], a[252:255], v[140:143], v[60:63]
s_add_u32 m0, m0, 3072
s_add_u32 s51, s52, 20480
v_cvt_pk_bf16_f32 v179, v214, v215
v_mfma_f32_16x16x32_bf16 v[220:223], a[224:227], a[48:51], 0
v_add_f32 v216, v237, v216
v_exp_f32 v216, v216
v_mfma_f32_16x16x32_bf16 v[220:223], a[228:231], a[52:55], v[220:223]
buffer_load_dwordx4 v248, s[28:31], s51 offen offset:0 lds
v_mfma_f32_16x16x32_bf16 v[220:223], a[232:235], a[56:59], v[220:223]
v_add_f32 v217, v237, v217
v_exp_f32 v217, v217
v_mfma_f32_16x16x32_bf16 v[220:223], a[236:239], a[60:63], v[220:223]
s_add_u32 s51, s52, 19584
v_cvt_pk_bf16_f32 v186, v216, v217
v_mfma_f32_16x16x32_bf16 v[92:95], a[248:251], v[144:147], v[92:95]
v_add_f32 v218, v237, v218
v_exp_f32 v218, v218
v_mfma_f32_16x16x32_bf16 v[92:95], a[252:255], v[148:151], v[92:95]
buffer_load_dwordx4 v248, s[28:31], s51 offen offset:1024 lds
v_mfma_f32_16x16x32_bf16 v[124:127], a[248:251], v[152:155], v[124:127]
v_add_f32 v219, v237, v219
v_exp_f32 v219, v219
v_mfma_f32_16x16x32_bf16 v[124:127], a[252:255], v[156:159], v[124:127]
s_add_u32 s51, s52, 18688
v_cvt_pk_bf16_f32 v187, v218, v219
v_mfma_f32_16x16x32_bf16 a[188:191], a[248:251], v[160:163], a[188:191]
s_waitcnt vmcnt(5)
buffer_load_dwordx4 v248, s[28:31], s51 offen offset:2048 lds
v_cmp_eq_u32 vcc, 0, v255
s_nop 4
s_cbranch_vccnz L_s_spin1
L_s_back1:
s_waitcnt lgkmcnt(2)
v_mfma_f32_16x16x32_bf16 v[0:3], a[240:243], v[164:167], v[0:3]
s_waitcnt lgkmcnt(0)
s_mov_b32 m0, s8
v_add_f32 v220, v238, v220
v_exp_f32 v220, v220
v_mfma_f32_16x16x32_bf16 v[0:3], a[244:247], v[168:171], v[0:3]
s_add_u32 s51, s5, s56
v_add_f32 v221, v238, v221
v_exp_f32 v221, v221
v_mfma_f32_16x16x32_bf16 v[32:35], a[240:243], v[172:175], v[32:35]
v_add_f32 v222, v238, v222
v_exp_f32 v222, v222
v_mfma_f32_16x16x32_bf16 v[32:35], a[244:247], v[176:179], v[32:35]
v_add_f32 v223, v238, v223
v_exp_f32 v223, v223
v_mfma_f32_16x16x32_bf16 v[64:67], a[240:243], v[180:183], v[64:67]
ds_read_b64_tr_b16 a[248:249], v244 offset:16928
v_cvt_pk_bf16_f32 v194, v220, v221
v_mfma_f32_16x16x32_bf16 v[64:67], a[244:247], v[184:187], v[64:67]
ds_read_b64_tr_b16 a[250:251], v244 offset:21152
v_cvt_pk_bf16_f32 v195, v222, v223
v_mfma_f32_16x16x32_bf16 a[160:163], a[240:243], v[196:199], a[160:163]
ds_read_b64_tr_b16 a[252:253], v246 offset:16928
buffer_load_dwordx4 v249, s[32:35], s51 offen offset:0 sc1 lds
v_mfma_f32_16x16x32_bf16 v[96:99], a[240:243], v[188:191], v[96:99]
s_add_u32 s51, s5, s57
ds_read_b64_tr_b16 a[254:255], v246 offset:21152
v_mfma_f32_16x16x32_bf16 v[96:99], a[244:247], v[192:195], v[96:99]
ds_read_b64_tr_b16 a[240:241], v245 offset:16896
buffer_load_dwordx4 v249, s[32:35], s51 offen offset:1024 sc1 lds
v_smfmac_f32_16x16x64_bf16 a[192:195], v[224:227], v[164:171], v228
s_add_u32 s51, s5, s58
ds_read_b64_tr_b16 a[242:243], v245 offset:21120
v_smfmac_f32_16x16x64_bf16 a[196:199], v[224:227], v[172:179], v228
ds_read_b64_tr_b16 a[244:245], v247 offset:16896
buffer_load_dwordx4 v249, s[32:35], s51 offen offset:2048 sc1 lds
v_smfmac_f32_16x16x64_bf16 a[200:203], v[224:227], v[180:187], v228
s_add_u32 m0, s8, s14
ds_read_b64_tr_b16 a[246:247], v247 offset:21120
v_smfmac_f32_16x16x64_bf16 a[204:207], v[224:227], v[188:195], v228
s_waitcnt lgkmcnt(4)
v_mfma_f32_16x16x32_bf16 v[4:7], a[248:251], v[164:167], v[4:7]
s_barrier
v_mfma_f32_16x16x32_bf16 v[4:7], a[252:255], v[168:171], v[4:7]
s_add_u32 s51, s5, s59
v_mfma_f32_16x16x32_bf16 v[36:39], a[248:251], v[172:175], v[36:39]
s_mov_b32 exec_hi, 0
buffer_load_dwordx4 v249, s[32:35], s51 offen sc1 lds
s_mov_b32 exec_hi, -1
v_mfma_f32_16x16x32_bf16 v[36:39], a[252:255], v[176:179], v[36:39]
v_readlane_b32 s16, v243, 1
v_mfma_f32_16x16x32_bf16 v[68:71], a[248:251], v[180:183], v[68:71]
s_add_u32 s8, s9, 38976
v_mfma_f32_16x16x32_bf16 v[68:71], a[252:255], v[184:187], v[68:71]
s_mul_i32 s5, s16, 294912
v_mfma_f32_16x16x32_bf16 v[100:103], a[248:251], v[188:191], v[100:103]
s_mul_i32 s16, s16, 73728
v_mfma_f32_16x16x32_bf16 v[100:103], a[252:255], v[192:195], v[100:103]
s_add_u32 s52, s16, s18
v_accvgpr_read_b32 v200, a192
v_accvgpr_read_b32 v201, a193
v_mfma_f32_16x16x32_bf16 a[164:167], a[248:251], v[196:199], a[164:167]
s_waitcnt lgkmcnt(0)
ds_read_b64_tr_b16 a[248:249], v245 offset:16928
v_accvgpr_read_b32 v202, a196
v_mfma_f32_16x16x32_bf16 v[8:11], a[240:243], v[164:167], v[8:11]
s_mov_b32 m0, s8
ds_read_b64_tr_b16 a[250:251], v245 offset:21152
v_accvgpr_read_b32 v203, a197
v_mfma_f32_16x16x32_bf16 v[8:11], a[244:247], v[168:171], v[8:11]
s_add_u32 s51, s5, s56
ds_read_b64_tr_b16 a[252:253], v247 offset:16928
v_accvgpr_read_b32 v204, a200
v_mfma_f32_16x16x32_bf16 v[40:43], a[240:243], v[172:175], v[40:43]
ds_read_b64_tr_b16 a[254:255], v247 offset:21152
buffer_load_dwordx4 v249, s[32:35], s51 offen offset:0 sc1 lds
v_mfma_f32_16x16x32_bf16 v[40:43], a[244:247], v[176:179], v[40:43]
s_add_u32 s51, s5, s57
v_accvgpr_read_b32 v205, a201
v_accvgpr_read_b32 v206, a204
v_mfma_f32_16x16x32_bf16 v[72:75], a[240:243], v[180:183], v[72:75]
buffer_load_dwordx4 v249, s[32:35], s51 offen offset:1024 sc1 lds
v_accvgpr_read_b32 v207, a205
v_mfma_f32_16x16x32_bf16 v[72:75], a[244:247], v[184:187], v[72:75]
s_add_u32 s51, s5, s58
v_add_f32 v200, v200, v201
v_add_f32 v202, v202, v203
v_mfma_f32_16x16x32_bf16 v[104:107], a[240:243], v[188:191], v[104:107]
buffer_load_dwordx4 v249, s[32:35], s51 offen offset:2048 sc1 lds
v_add_f32 v204, v204, v205
v_mfma_f32_16x16x32_bf16 v[104:107], a[244:247], v[192:195], v[104:107]
s_add_u32 m0, s8, s14
v_add_f32 v206, v206, v207
v_mfma_f32_16x16x32_bf16 a[168:171], a[240:243], v[196:199], a[168:171]
s_waitcnt lgkmcnt(0)
ds_read_b64_tr_b16 a[240:241], v244 offset:17408
v_mfma_f32_16x16x32_bf16 v[12:15], a[248:251], v[164:167], v[12:15]
s_add_u32 s51, s5, s59
ds_read_b64_tr_b16 a[242:243], v244 offset:21632
v_mfma_f32_16x16x32_bf16 v[12:15], a[252:255], v[168:171], v[12:15]
ds_read_b64_tr_b16 a[244:245], v246 offset:17408
v_mfma_f32_16x16x32_bf16 v[44:47], a[248:251], v[172:175], v[44:47]
ds_read_b64_tr_b16 a[246:247], v246 offset:21632
v_mfma_f32_16x16x32_bf16 v[44:47], a[252:255], v[176:179], v[44:47]
s_mov_b32 exec_hi, 0
buffer_load_dwordx4 v249, s[32:35], s51 offen sc1 lds
s_mov_b32 exec_hi, -1
v_mfma_f32_16x16x32_bf16 v[76:79], a[248:251], v[180:183], v[76:79]
s_add_u32 m0, s8, s7
v_rcp_f32 v230, v200
v_mfma_f32_16x16x32_bf16 v[76:79], a[252:255], v[184:187], v[76:79]
s_add_u32 s51, s52, 2048
v_rcp_f32 v231, v202
v_mfma_f32_16x16x32_bf16 v[108:111], a[248:251], v[188:191], v[108:111]
buffer_load_dwordx4 v248, s[28:31], s51 offen offset:0 lds
v_mfma_f32_16x16x32_bf16 v[108:111], a[252:255], v[192:195], v[108:111]
s_add_u32 s51, s52, 1152
v_rcp_f32 v232, v204
v_mfma_f32_16x16x32_bf16 a[172:175], a[248:251], v[196:199], a[172:175]
s_waitcnt lgkmcnt(0)
ds_read_b64_tr_b16 a[248:249], v244 offset:17440
buffer_load_dwordx4 v248, s[28:31], s51 offen offset:1024 lds
v_mfma_f32_16x16x32_bf16 v[16:19], a[240:243], v[164:167], v[16:19]
s_add_u32 s51, s52, 256
ds_read_b64_tr_b16 a[250:251], v244 offset:21664
v_mfma_f32_16x16x32_bf16 v[16:19], a[244:247], v[168:171], v[16:19]
ds_read_b64_tr_b16 a[252:253], v246 offset:17440
buffer_load_dwordx4 v248, s[28:31], s51 offen offset:2048 lds
v_mfma_f32_16x16x32_bf16 v[48:51], a[240:243], v[172:175], v[48:51]
s_add_u32 m0, m0, 3072
ds_read_b64_tr_b16 a[254:255], v246 offset:21664
v_mfma_f32_16x16x32_bf16 v[48:51], a[244:247], v[176:179], v[48:51]
s_add_u32 s51, s52, 20480
v_rcp_f32_e64 v233, v206
v_mfma_f32_16x16x32_bf16 v[80:83], a[240:243], v[180:183], v[80:83]
buffer_load_dwordx4 v248, s[28:31], s51 offen offset:0 lds
v_min3_u32 v201, v200, v202, v204
v_mfma_f32_16x16x32_bf16 v[80:83], a[244:247], v[184:187], v[80:83]
s_add_u32 s51, s52, 19584
v_max3_u32 v203, v200, v202, v204
v_min_u32 v201, v201, v206
v_mfma_f32_16x16x32_bf16 v[112:115], a[240:243], v[188:191], v[112:115]
buffer_load_dwordx4 v248, s[28:31], s51 offen offset:1024 lds
v_max_u32 v203, v203, v206
v_mfma_f32_16x16x32_bf16 v[112:115], a[244:247], v[192:195], v[112:115]
s_add_u32 s51, s52, 18688
v_cmp_gt_u32 s[72:73], s74, v201
v_cmp_lt_u32 vcc, s75, v203
v_mfma_f32_16x16x32_bf16 a[176:179], a[240:243], v[196:199], a[176:179]
s_waitcnt lgkmcnt(0)
ds_read_b64_tr_b16 a[240:241], v245 offset:17408
buffer_load_dwordx4 v248, s[28:31], s51 offen offset:2048 lds
v_mfma_f32_16x16x32_bf16 v[20:23], a[248:251], v[164:167], v[20:23]
s_lshl_b32 s50, s48, 2
ds_read_b64_tr_b16 a[242:243], v245 offset:21632
v_readlane_b32 s16, v243, 2
v_mfma_f32_16x16x32_bf16 v[20:23], a[252:255], v[168:171], v[20:23]
s_add_u32 s8, s9, 77952
s_add_u32 s50, s50, 152576
ds_read_b64_tr_b16 a[244:245], v247 offset:17408
v_mfma_f32_16x16x32_bf16 v[52:55], a[248:251], v[172:175], v[52:55]
s_mul_i32 s5, s16, 294912
s_or_b64 s[72:73], s[72:73], vcc
ds_read_b64_tr_b16 a[246:247], v247 offset:21632
v_mfma_f32_16x16x32_bf16 v[52:55], a[252:255], v[176:179], v[52:55]
s_mul_i32 s16, s16, 73728
s_or_b32 s72, s72, s73
v_mov_b32 v201, s50
v_mfma_f32_16x16x32_bf16 v[84:87], a[248:251], v[180:183], v[84:87]
s_add_u32 s52, s16, s18
v_mov_b32 v200, s72
v_mul_f32 v0, v230, v0
v_mfma_f32_16x16x32_bf16 v[84:87], a[252:255], v[184:187], v[84:87]
s_mov_b32 m0, s8
v_mul_f32 v1, v230, v1
v_mul_f32 v2, v230, v2
v_mfma_f32_16x16x32_bf16 v[116:119], a[248:251], v[188:191], v[116:119]
s_add_u32 s51, s5, s56
v_mul_f32 v3, v230, v3
v_mul_f32 v4, v230, v4
v_mfma_f32_16x16x32_bf16 v[116:119], a[252:255], v[192:195], v[116:119]
buffer_load_dwordx4 v249, s[32:35], s51 offen offset:0 sc1 lds
v_mul_f32 v5, v230, v5
v_mfma_f32_16x16x32_bf16 a[180:183], a[248:251], v[196:199], a[180:183]
s_waitcnt lgkmcnt(0)
ds_read_b64_tr_b16 a[248:249], v245 offset:17440
v_mul_f32 v6, v230, v6
v_mfma_f32_16x16x32_bf16 v[24:27], a[240:243], v[164:167], v[24:27]
s_add_u32 s51, s5, s57
ds_read_b64_tr_b16 a[250:251], v245 offset:21664
v_mul_f32 v7, v230, v7
v_mfma_f32_16x16x32_bf16 v[24:27], a[244:247], v[168:171], v[24:27]
s_add_u32 s50, s64, 0
ds_read_b64_tr_b16 a[252:253], v247 offset:17440
buffer_load_dwordx4 v249, s[32:35], s51 offen offset:1024 sc1 lds
v_mfma_f32_16x16x32_bf16 v[56:59], a[240:243], v[172:175], v[56:59]
s_add_u32 s51, s5, s58
ds_read_b64_tr_b16 a[254:255], v247 offset:21664
v_cvt_pk_bf16_f32 v0, v0, v1
v_mfma_f32_16x16x32_bf16 v[56:59], a[244:247], v[176:179], v[56:59]
buffer_load_dwordx4 v249, s[32:35], s51 offen offset:2048 sc1 lds
v_cvt_pk_bf16_f32 v1, v2, v3
v_mfma_f32_16x16x32_bf16 v[88:91], a[240:243], v[180:183], v[88:91]
s_add_u32 m0, s8, s14
v_cvt_pk_bf16_f32 v2, v4, v5
v_cvt_pk_bf16_f32 v3, v6, v7
v_mfma_f32_16x16x32_bf16 v[88:91], a[244:247], v[184:187], v[88:91]
s_add_u32 s51, s5, s59
v_mfma_f32_16x16x32_bf16 v[120:123], a[240:243], v[188:191], v[120:123]
s_mov_b32 exec_hi, 0
buffer_load_dwordx4 v249, s[32:35], s51 offen sc1 lds
s_mov_b32 exec_hi, -1
v_mfma_f32_16x16x32_bf16 v[120:123], a[244:247], v[192:195], v[120:123]
s_add_u32 m0, s8, s7
v_mfma_f32_16x16x32_bf16 a[184:187], a[240:243], v[196:199], a[184:187]
s_waitcnt lgkmcnt(0)
buffer_store_dwordx4 v[0:3], v249, s[44:47], s50 offen offset:0 sc1
v_mfma_f32_16x16x32_bf16 v[28:31], a[248:251], v[164:167], v[28:31]
s_add_u32 s51, s52, 2048
v_mul_f32 v32, v231, v32
v_mul_f32 v33, v231, v33
v_mfma_f32_16x16x32_bf16 v[28:31], a[252:255], v[168:171], v[28:31]
buffer_load_dwordx4 v248, s[28:31], s51 offen offset:0 lds
v_mul_f32 v34, v231, v34
v_mfma_f32_16x16x32_bf16 v[60:63], a[248:251], v[172:175], v[60:63]
s_add_u32 s51, s52, 1152
v_mul_f32 v35, v231, v35
v_mul_f32 v36, v231, v36
v_mfma_f32_16x16x32_bf16 v[60:63], a[252:255], v[176:179], v[60:63]
buffer_load_dwordx4 v248, s[28:31], s51 offen offset:1024 lds
v_mul_f32 v37, v231, v37
v_mfma_f32_16x16x32_bf16 v[92:95], a[248:251], v[180:183], v[92:95]
v_mul_f32 v38, v231, v38
v_mul_f32 v39, v231, v39
v_mfma_f32_16x16x32_bf16 v[92:95], a[252:255], v[184:187], v[92:95]
s_add_u32 s50, s64, 2048
v_cvt_pk_bf16_f32 v32, v32, v33
v_cvt_pk_bf16_f32 v33, v34, v35
v_mfma_f32_16x16x32_bf16 v[124:127], a[248:251], v[188:191], v[124:127]
v_cvt_pk_bf16_f32 v34, v36, v37
v_cvt_pk_bf16_f32 v35, v38, v39
v_mfma_f32_16x16x32_bf16 v[124:127], a[252:255], v[192:195], v[124:127]
buffer_store_dwordx4 v[32:35], v249, s[44:47], s50 offen offset:0 sc1
v_mfma_f32_16x16x32_bf16 a[188:191], a[248:251], v[196:199], a[188:191]
v_mul_f32 v64, v232, v64
v_mul_f32 v65, v232, v65
s_add_u32 s51, s52, 256
v_pk_mul_f32 v[66:67], v[66:67], v[232:233] op_sel:[0,0] op_sel_hi:[1,0]
v_pk_mul_f32 v[68:69], v[68:69], v[232:233] op_sel:[0,0] op_sel_hi:[1,0]
v_pk_mul_f32 v[70:71], v[70:71], v[232:233] op_sel:[0,0] op_sel_hi:[1,0]
s_add_u32 s50, s64, 4096
v_cvt_pk_bf16_f32 v64, v64, v65
v_cvt_pk_bf16_f32 v65, v66, v67
buffer_load_dwordx4 v248, s[28:31], s51 offen offset:2048 lds
s_add_u32 m0, m0, 3072
s_add_u32 s51, s52, 20480
v_cvt_pk_bf16_f32 v66, v68, v69
v_cvt_pk_bf16_f32 v67, v70, v71
buffer_store_dwordx4 v[64:67], v249, s[44:47], s50 offen offset:0 sc1
v_pk_mul_f32 v[96:97], v[96:97], v[232:233] op_sel:[0,1] op_sel_hi:[1,1]
v_pk_mul_f32 v[98:99], v[98:99], v[232:233] op_sel:[0,1] op_sel_hi:[1,1]
v_pk_mul_f32 v[100:101], v[100:101], v[232:233] op_sel:[0,1] op_sel_hi:[1,1]
buffer_load_dwordx4 v248, s[28:31], s51 offen offset:0 lds
s_add_u32 s51, s52, 19584
v_pk_mul_f32 v[102:103], v[102:103], v[232:233] op_sel:[0,1] op_sel_hi:[1,1]
s_add_u32 s50, s64, 6144
v_cvt_pk_bf16_f32 v96, v96, v97
v_cvt_pk_bf16_f32 v97, v98, v99
v_cvt_pk_bf16_f32 v98, v100, v101
v_cvt_pk_bf16_f32 v99, v102, v103
buffer_load_dwordx4 v248, s[28:31], s51 offen offset:1024 lds
s_add_u32 s51, s52, 18688
buffer_store_dwordx4 v[96:99], v249, s[44:47], s50 offen offset:0 sc1
v_pk_mul_f32 v[8:9], v[8:9], v[230:231] op_sel:[0,0] op_sel_hi:[1,0]
v_pk_mul_f32 v[10:11], v[10:11], v[230:231] op_sel:[0,0] op_sel_hi:[1,0]
v_pk_mul_f32 v[12:13], v[12:13], v[230:231] op_sel:[0,0] op_sel_hi:[1,0]
v_pk_mul_f32 v[14:15], v[14:15], v[230:231] op_sel:[0,0] op_sel_hi:[1,0]
s_add_u32 s50, s65, 0
s_nop 0
buffer_load_dwordx4 v248, s[28:31], s51 offen offset:2048 lds
v_cvt_pk_bf16_f32 v8, v8, v9
v_cvt_pk_bf16_f32 v9, v10, v11
v_cvt_pk_bf16_f32 v10, v12, v13
v_cvt_pk_bf16_f32 v11, v14, v15
buffer_store_dwordx4 v[8:11], v249, s[44:47], s50 offen offset:0 sc1
v_pk_mul_f32 v[40:41], v[40:41], v[230:231] op_sel:[0,1] op_sel_hi:[1,1]
v_pk_mul_f32 v[42:43], v[42:43], v[230:231] op_sel:[0,1] op_sel_hi:[1,1]
v_pk_mul_f32 v[44:45], v[44:45], v[230:231] op_sel:[0,1] op_sel_hi:[1,1]
v_pk_mul_f32 v[46:47], v[46:47], v[230:231] op_sel:[0,1] op_sel_hi:[1,1]
s_add_u32 s50, s65, 2048
v_cvt_pk_bf16_f32 v40, v40, v41
v_cvt_pk_bf16_f32 v41, v42, v43
v_cvt_pk_bf16_f32 v42, v44, v45
v_cvt_pk_bf16_f32 v43, v46, v47
buffer_store_dwordx4 v[40:43], v249, s[44:47], s50 offen offset:0 sc1
v_pk_mul_f32 v[72:73], v[72:73], v[232:233] op_sel:[0,0] op_sel_hi:[1,0]
v_pk_mul_f32 v[74:75], v[74:75], v[232:233] op_sel:[0,0] op_sel_hi:[1,0]
v_pk_mul_f32 v[76:77], v[76:77], v[232:233] op_sel:[0,0] op_sel_hi:[1,0]
v_pk_mul_f32 v[78:79], v[78:79], v[232:233] op_sel:[0,0] op_sel_hi:[1,0]
s_add_u32 s50, s65, 4096
v_cvt_pk_bf16_f32 v72, v72, v73
v_cvt_pk_bf16_f32 v73, v74, v75
v_cvt_pk_bf16_f32 v74, v76, v77
v_cvt_pk_bf16_f32 v75, v78, v79
buffer_store_dwordx4 v[72:75], v249, s[44:47], s50 offen offset:0 sc1
v_pk_mul_f32 v[104:105], v[104:105], v[232:233] op_sel:[0,1] op_sel_hi:[1,1]
v_pk_mul_f32 v[106:107], v[106:107], v[232:233] op_sel:[0,1] op_sel_hi:[1,1]
v_pk_mul_f32 v[108:109], v[108:109], v[232:233] op_sel:[0,1] op_sel_hi:[1,1]
v_pk_mul_f32 v[110:111], v[110:111], v[232:233] op_sel:[0,1] op_sel_hi:[1,1]
s_add_u32 s50, s65, 6144
v_cvt_pk_bf16_f32 v104, v104, v105
v_cvt_pk_bf16_f32 v105, v106, v107
v_cvt_pk_bf16_f32 v106, v108, v109
v_cvt_pk_bf16_f32 v107, v110, v111
buffer_store_dwordx4 v[104:107], v249, s[44:47], s50 offen offset:0 sc1
v_pk_mul_f32 v[16:17], v[16:17], v[230:231] op_sel:[0,0] op_sel_hi:[1,0]
v_pk_mul_f32 v[18:19], v[18:19], v[230:231] op_sel:[0,0] op_sel_hi:[1,0]
v_pk_mul_f32 v[20:21], v[20:21], v[230:231] op_sel:[0,0] op_sel_hi:[1,0]
v_pk_mul_f32 v[22:23], v[22:23], v[230:231] op_sel:[0,0] op_sel_hi:[1,0]
s_add_u32 s50, s64, 294912
v_cvt_pk_bf16_f32 v16, v16, v17
v_cvt_pk_bf16_f32 v17, v18, v19
v_cvt_pk_bf16_f32 v18, v20, v21
v_cvt_pk_bf16_f32 v19, v22, v23
buffer_store_dwordx4 v[16:19], v249, s[44:47], s50 offen offset:0 sc1
v_pk_mul_f32 v[48:49], v[48:49], v[230:231] op_sel:[0,1] op_sel_hi:[1,1]
v_pk_mul_f32 v[50:51], v[50:51], v[230:231] op_sel:[0,1] op_sel_hi:[1,1]
v_pk_mul_f32 v[52:53], v[52:53], v[230:231] op_sel:[0,1] op_sel_hi:[1,1]
v_pk_mul_f32 v[54:55], v[54:55], v[230:231] op_sel:[0,1] op_sel_hi:[1,1]
s_add_u32 s50, s64, 296960
v_cvt_pk_bf16_f32 v48, v48, v49
v_cvt_pk_bf16_f32 v49, v50, v51
v_cvt_pk_bf16_f32 v50, v52, v53
v_cvt_pk_bf16_f32 v51, v54, v55
buffer_store_dwordx4 v[48:51], v249, s[44:47], s50 offen offset:0 sc1
v_pk_mul_f32 v[80:81], v[80:81], v[232:233] op_sel:[0,0] op_sel_hi:[1,0]
v_pk_mul_f32 v[82:83], v[82:83], v[232:233] op_sel:[0,0] op_sel_hi:[1,0]
v_readlane_b32 s16, v243, 3
s_add_u32 s8, s9, 116928
s_mul_i32 s5, s16, 294912
s_mul_i32 s16, s16, 73728
s_add_u32 s52, s16, s18
s_nop 0
ds_write_b128 v250, a[168:171] offset:0
ds_write_b128 v250, a[172:175] offset:1024
ds_write_b128 v250, a[184:187] offset:2048
ds_write_b128 v250, a[188:191] offset:3072
ds_write_b32 v252, v229
ds_write_b32 v201, v200
v_pk_mul_f32 v[84:85], v[84:85], v[232:233] op_sel:[0,0] op_sel_hi:[1,0]
v_pk_mul_f32 v[86:87], v[86:87], v[232:233] op_sel:[0,0] op_sel_hi:[1,0]
s_add_u32 s50, s64, 299008
v_cvt_pk_bf16_f32 v80, v80, v81
v_cvt_pk_bf16_f32 v81, v82, v83
v_cvt_pk_bf16_f32 v82, v84, v85
v_cvt_pk_bf16_f32 v83, v86, v87
buffer_store_dwordx4 v[80:83], v249, s[44:47], s50 offen offset:0 sc1
v_pk_mul_f32 v[112:113], v[112:113], v[232:233] op_sel:[0,1] op_sel_hi:[1,1]
v_pk_mul_f32 v[114:115], v[114:115], v[232:233] op_sel:[0,1] op_sel_hi:[1,1]
v_pk_mul_f32 v[116:117], v[116:117], v[232:233] op_sel:[0,1] op_sel_hi:[1,1]
v_pk_mul_f32 v[118:119], v[118:119], v[232:233] op_sel:[0,1] op_sel_hi:[1,1]
s_add_u32 s50, s64, 301056
v_cvt_pk_bf16_f32 v112, v112, v113
v_cvt_pk_bf16_f32 v113, v114, v115
v_cvt_pk_bf16_f32 v114, v116, v117
v_cvt_pk_bf16_f32 v115, v118, v119
buffer_store_dwordx4 v[112:115], v249, s[44:47], s50 offen offset:0 sc1
v_pk_mul_f32 v[24:25], v[24:25], v[230:231] op_sel:[0,0] op_sel_hi:[1,0]
v_pk_mul_f32 v[26:27], v[26:27], v[230:231] op_sel:[0,0] op_sel_hi:[1,0]
v_pk_mul_f32 v[28:29], v[28:29], v[230:231] op_sel:[0,0] op_sel_hi:[1,0]
v_pk_mul_f32 v[30:31], v[30:31], v[230:231] op_sel:[0,0] op_sel_hi:[1,0]
v_cvt_pk_bf16_f32 v24, v24, v25
v_cvt_pk_bf16_f32 v25, v26, v27
v_cvt_pk_bf16_f32 v26, v28, v29
v_cvt_pk_bf16_f32 v27, v30, v31
v_pk_mul_f32 v[56:57], v[56:57], v[230:231] op_sel:[0,1] op_sel_hi:[1,1]
v_pk_mul_f32 v[58:59], v[58:59], v[230:231] op_sel:[0,1] op_sel_hi:[1,1]
v_pk_mul_f32 v[60:61], v[60:61], v[230:231] op_sel:[0,1] op_sel_hi:[1,1]
v_pk_mul_f32 v[62:63], v[62:63], v[230:231] op_sel:[0,1] op_sel_hi:[1,1]
v_cvt_pk_bf16_f32 v56, v56, v57
v_cvt_pk_bf16_f32 v57, v58, v59
v_cvt_pk_bf16_f32 v58, v60, v61
v_cvt_pk_bf16_f32 v59, v62, v63
v_mov_b32 v208, 152576
s_waitcnt vmcnt(32) lgkmcnt(0)
s_barrier
ds_read_b128 v[180:183], v253 offset:0
ds_read_b128 v[184:187], v253 offset:16
ds_read_b128 v[188:191], v253 offset:512
ds_read_b128 v[192:195], v253 offset:528
ds_read_b128 v[196:199], v208
ds_read_b128 v[164:167], v251 offset:0
ds_read_b128 v[168:171], v251 offset:1024
ds_read_b128 v[172:175], v251 offset:2048
ds_read_b128 v[176:179], v251 offset:3072
ds_read_b64_tr_b16 a[56:57], v241 offset:0
ds_read_b64_tr_b16 a[58:59], v241 offset:3072
ds_read_b64_tr_b16 a[64:65], v241 offset:512
ds_read_b64_tr_b16 a[66:67], v241 offset:3584
ds_read_b64_tr_b16 a[72:73], v241 offset:1024
ds_read_b64_tr_b16 a[74:75], v241 offset:4096
v_pk_mul_f32 v[88:89], v[88:89], v[232:233] op_sel:[0,0] op_sel_hi:[1,0]
v_pk_mul_f32 v[90:91], v[90:91], v[232:233] op_sel:[0,0] op_sel_hi:[1,0]
v_pk_mul_f32 v[92:93], v[92:93], v[232:233] op_sel:[0,0] op_sel_hi:[1,0]
v_pk_mul_f32 v[94:95], v[94:95], v[232:233] op_sel:[0,0] op_sel_hi:[1,0]
v_cvt_pk_bf16_f32 v88, v88, v89
v_cvt_pk_bf16_f32 v89, v90, v91
v_cvt_pk_bf16_f32 v90, v92, v93
v_cvt_pk_bf16_f32 v91, v94, v95
v_pk_mul_f32 v[120:121], v[120:121], v[232:233] op_sel:[0,1] op_sel_hi:[1,1]
v_pk_mul_f32 v[122:123], v[122:123], v[232:233] op_sel:[0,1] op_sel_hi:[1,1]
v_pk_mul_f32 v[124:125], v[124:125], v[232:233] op_sel:[0,1] op_sel_hi:[1,1]
v_pk_mul_f32 v[126:127], v[126:127], v[232:233] op_sel:[0,1] op_sel_hi:[1,1]
v_cvt_pk_bf16_f32 v120, v120, v121
v_cvt_pk_bf16_f32 v121, v122, v123
v_cvt_pk_bf16_f32 v122, v124, v125
v_cvt_pk_bf16_f32 v123, v126, v127
s_waitcnt lgkmcnt(14)
v_pk_add_f32 v[180:181], v[180:181], v[182:183]
s_waitcnt lgkmcnt(13)
v_pk_add_f32 v[184:185], v[184:185], v[186:187]
v_pk_add_f32 v[180:181], v[180:181], v[184:185]
v_add_f32 v180, v180, v181
s_waitcnt lgkmcnt(12)
v_pk_add_f32 v[188:189], v[188:189], v[190:191]
s_waitcnt lgkmcnt(11)
v_pk_add_f32 v[192:193], v[192:193], v[194:195]
v_pk_add_f32 v[188:189], v[188:189], v[192:193]
v_add_f32 v188, v188, v189
s_cmp_lt_u32 s48, 2
s_cselect_b64 vcc, -1, 0
v_cndmask_b32 v200, v188, v180, vcc
v_rcp_f32 v234, v200
s_waitcnt lgkmcnt(10)
v_or3_b32 v196, v196, v197, v198
v_or_b32 v196, v196, v199
v_min_u32 v181, v180, v188
v_max_u32 v182, v180, v188
v_cmp_ne_u32 s[72:73], 0, v196
v_cmp_gt_u32 s[96:97], s74, v181
v_cmp_lt_u32 vcc, s75, v182
s_nop 0
v_accvgpr_read_b32 v200, a160
v_accvgpr_read_b32 v201, a161
v_accvgpr_read_b32 v202, a162
v_accvgpr_read_b32 v203, a163
v_accvgpr_read_b32 v204, a164
v_accvgpr_read_b32 v205, a165
v_accvgpr_read_b32 v206, a166
v_accvgpr_read_b32 v207, a167
s_or_b64 s[72:73], s[72:73], vcc
s_or_b64 s[72:73], s[72:73], s[96:97]
s_waitcnt lgkmcnt(9)
v_pk_add_f32 v[164:165], v[164:165], v[200:201]
v_pk_add_f32 v[166:167], v[166:167], v[202:203]
s_waitcnt lgkmcnt(8)
v_pk_add_f32 v[168:169], v[168:169], v[204:205]
v_pk_add_f32 v[170:171], v[170:171], v[206:207]
ds_read_b64_tr_b16 a[60:61], v241 offset:6144
ds_read_b64_tr_b16 a[62:63], v241 offset:9216
ds_read_b64_tr_b16 a[68:69], v241 offset:6656
ds_read_b64_tr_b16 a[70:71], v241 offset:9728
ds_read_b64_tr_b16 a[76:77], v241 offset:7168
ds_read_b64_tr_b16 a[78:79], v241 offset:10240
ds_read_b128 a[0:3], v240 offset:0
ds_read_b128 a[4:7], v240 offset:7168
ds_read_b128 a[8:11], v240 offset:1024
ds_read_b128 a[12:15], v240 offset:8192
v_pk_mul_f32 v[164:165], v[164:165], v[234:235] op_sel:[0,0] op_sel_hi:[1,0]
v_pk_mul_f32 v[166:167], v[166:167], v[234:235] op_sel:[0,0] op_sel_hi:[1,0]
v_pk_mul_f32 v[168:169], v[168:169], v[234:235] op_sel:[0,0] op_sel_hi:[1,0]
v_pk_mul_f32 v[170:171], v[170:171], v[234:235] op_sel:[0,0] op_sel_hi:[1,0]
v_cvt_pk_bf16_f32 v164, v164, v165
v_cvt_pk_bf16_f32 v165, v166, v167
v_cvt_pk_bf16_f32 v166, v168, v169
v_cvt_pk_bf16_f32 v167, v170, v171
v_accvgpr_read_b32 v200, a176
v_accvgpr_read_b32 v201, a177
v_accvgpr_read_b32 v202, a178
v_accvgpr_read_b32 v203, a179
v_accvgpr_read_b32 v204, a180
v_accvgpr_read_b32 v205, a181
v_accvgpr_read_b32 v206, a182
v_accvgpr_read_b32 v207, a183
s_waitcnt lgkmcnt(15)
v_pk_add_f32 v[172:173], v[172:173], v[200:201]
v_pk_add_f32 v[174:175], v[174:175], v[202:203]
s_waitcnt lgkmcnt(15)
v_pk_add_f32 v[176:177], v[176:177], v[204:205]
v_pk_add_f32 v[178:179], v[178:179], v[206:207]
ds_read_b128 a[16:19], v240 offset:2048
ds_read_b128 a[20:23], v240 offset:9216
ds_read_b128 a[24:27], v240 offset:3072
ds_read_b128 a[28:31], v240 offset:10240
ds_read_b128 a[32:35], v240 offset:4096
ds_read_b128 a[36:39], v240 offset:11264
ds_read_b128 a[40:43], v240 offset:5120
ds_read_b128 a[44:47], v240 offset:12288
ds_read_b128 a[48:51], v240 offset:6144
ds_read_b128 a[52:55], v240 offset:13312
v_pk_mul_f32 v[172:173], v[172:173], v[234:235] op_sel:[0,0] op_sel_hi:[1,0]
v_pk_mul_f32 v[174:175], v[174:175], v[234:235] op_sel:[0,0] op_sel_hi:[1,0]
v_pk_mul_f32 v[176:177], v[176:177], v[234:235] op_sel:[0,0] op_sel_hi:[1,0]
v_pk_mul_f32 v[178:179], v[178:179], v[234:235] op_sel:[0,0] op_sel_hi:[1,0]
v_cvt_pk_bf16_f32 v172, v172, v173
v_cvt_pk_bf16_f32 v173, v174, v175
v_cvt_pk_bf16_f32 v174, v176, v177
v_cvt_pk_bf16_f32 v175, v178, v179
s_branch L_join
L_s_spin0:
s_cselect_b32 s98, 1, 0
s_mov_b32 s99, 4194304
L_s_spin0_l:
s_sub_u32 s99, s99, 1
s_cmp_eq_u32 s99, 0
s_cbranch_scc1 L_s_spin0_e
v_bfe_u32 v255, v249, 4, 4
v_lshlrev_b32 v255, 2, v255
buffer_load_dword v255, v255, s[36:39], 0 offen sc1
s_waitcnt vmcnt(0)
v_cmp_gt_u32 vcc, 16, v255
s_nop 4
s_cbranch_vccnz L_s_spin0_l
L_s_spin0_e:
s_cmp_eq_u32 s98, 1
s_branch L_s_back0
L_s_spin1:
s_cselect_b32 s98, 1, 0
s_mov_b32 s99, 4194304
L_s_spin1_l:
s_sub_u32 s99, s99, 1
s_cmp_eq_u32 s99, 0
s_cbranch_scc1 L_s_spin1_e
buffer_load_dword v255, v254, s[40:43], s69 offen sc1
s_waitcnt vmcnt(0)
v_cmp_eq_u32 vcc, 0, v255
s_nop 4
s_cbranch_vccnz L_s_spin1_l
L_s_spin1_e:
s_cmp_eq_u32 s98, 1
s_branch L_s_back1
.section .rodata,"a"
.p2align 6
.amdhsa_kernel concat_heads__mha_block_cached__gqa_block_cached__near_ridge_kernel
  .amdhsa_next_free_vgpr 512
  .amdhsa_next_free_sgpr 102
  .amdhsa_accum_offset 256
  .amdhsa_group_segment_fixed_size 0
  .amdhsa_kernarg_size 104
  .amdhsa_user_sgpr_count 2
  .amdhsa_user_sgpr_kernarg_segment_ptr 1
  .amdhsa_system_sgpr_workgroup_id_x 1
.end_amdhsa_kernel
```
